```python
import torch

def _softmax(x, axis=-1):
    return torch.softmax(x, dim=axis)
def _gelu(x):
    return torch.nn.functional.gelu(x, approximate="tanh")
def _silu(x):
    return torch.nn.functional.silu(x)
def _sigmoid(x):
    return torch.sigmoid(x)
def _layernorm(x, axis=-1, eps=1e-5):
    m = x.mean(dim=axis, keepdim=True)
    v = x.var(dim=axis, keepdim=True, unbiased=False)
    return (x - m) / torch.sqrt(v + eps)
def _scatter_add(tgt, idx, src, axis=0):
    return tgt.clone().index_add_(axis, idx, src)
def _segment_sum(src, seg, n):
    out = torch.zeros((n,) + src.shape[1:], dtype=src.dtype)
    return out.index_add_(0, seg, src)
def _pad(x, pw):
    flat = tuple(v for pair in reversed(pw) for v in pair)
    return torch.nn.functional.pad(x, flat)

kernel_name = 'standalone__mha_block_cached__near_ridge'

def setup_inputs():

    _w = (lambda a: (lambda t: t.to(torch.bfloat16) if t.is_floating_point() else t)(torch.as_tensor(a)))
    B, Sq, D = 32, 160, 576
    H, Sk, Dh = 32, 512, 128
    return {
        "x": _w((lambda *s: torch.randn(*s, dtype=torch.bfloat16) * 0.8)(B, Sq, D)),
        "k_cache": _w((lambda *s: torch.randn(*s, dtype=torch.bfloat16) * 0.8)(B, H, Sk, Dh)),
        "v_cache": _w((lambda *s: torch.randn(*s, dtype=torch.bfloat16) * 0.05)(B, H, Sk, Dh)),
        "wq": _w((lambda *s: torch.randn(*s, dtype=torch.bfloat16) * 0.8)(D, H * Dh) * (D ** -0.5)),
        "wo": _w((lambda *s: torch.randn(*s, dtype=torch.bfloat16) * 0.05)(H * Dh, D) * ((H * Dh) ** -0.5)),
    }

def reference(x, k_cache, v_cache, wq, wo):
    B, Sq, D = x.shape
    H, Dh = 32, 128
    q = (lambda x, *d: x.permute(*d))((x @ wq).reshape(B, Sq, H, Dh), 0, 2, 1, 3)
    scores = torch.einsum("bhqd,bhkd->bhqk", q, k_cache) * (Dh ** -0.5)
    p = _softmax(scores, axis=-1)
    o = torch.einsum("bhqk,bhkd->bhqd", p, v_cache)
    return (lambda x, *d: x.permute(*d))(o, 0, 2, 1, 3).reshape(B, Sq, H * Dh) @ wo
```

```asm
; @launch kernel=attn_kernel grid=(256,1,1) block=(256,1,1) lds=163840
; @launch kernel=oproj_kernel grid=(256,1,1) block=(256,1,1) lds=163840
.amdgcn_target "amdgcn-amd-amdhsa--gfx950"
.text
.globl attn_kernel
.type attn_kernel,@function
.globl oproj_kernel
.type oproj_kernel,@function
.p2align 8
attn_kernel:
  s_cmp_ge_u32 s2, 256
  s_cbranch_scc1 L_a_done
  s_load_dwordx8 s[64:71], s[0:1], 0
  s_load_dwordx2 s[72:73], s[0:1], 32
  s_load_dwordx2 s[74:75], s[0:1], 56
  v_lshrrev_b32 v31, 6, v0
  v_and_b32 v30, 63, v0
  s_nop 0
  v_readfirstlane_b32 s55, v31
  v_lshrrev_b32 v31, 4, v30
  v_and_b32 v32, 15, v30
  v_lshrrev_b32 v33, 2, v32
  v_and_b32 v34, 3, v30
  s_and_b32 s80, s55, 1
  s_lshr_b32 s81, s55, 1
  s_lshl_b32 s32, s80, 12
  s_mul_i32 s59, s81, 81920
  s_add_u32 s79, s32, s59
  s_lshr_b32 s82, s2, 4
  s_add_u32 s82, s82, s2
  s_lshl_b32 s83, s81, 3
  s_add_u32 s82, s82, s83
  s_and_b32 s82, s82, 15
  s_lshl_b32 s82, s82, 13
  v_add_u32 v236, 0, v31
  v_xor_b32 v236, v236, v32
  v_lshlrev_b32 v236, 4, v236
  v_lshl_add_u32 v236, v31, 8, v236
  v_add_u32 v1, s32, v236
  v_add_u32 v236, 4, v31
  v_xor_b32 v236, v236, v32
  v_lshlrev_b32 v236, 4, v236
  v_lshl_add_u32 v236, v31, 8, v236
  v_add_u32 v2, s32, v236
  v_add_u32 v236, 8, v31
  v_xor_b32 v236, v236, v32
  v_lshlrev_b32 v236, 4, v236
  v_lshl_add_u32 v236, v31, 8, v236
  v_add_u32 v3, s32, v236
  v_add_u32 v236, 12, v31
  v_xor_b32 v236, v236, v32
  v_lshlrev_b32 v236, 4, v236
  v_lshl_add_u32 v236, v31, 8, v236
  v_add_u32 v4, s32, v236
  v_add_u32 v236, 0, v31
  v_lshlrev_b32 v236, 1, v236
  v_xor_b32 v236, v236, v32
  v_lshlrev_b32 v236, 4, v236
  v_lshl_add_u32 v236, v31, 8, v236
  v_add_u32 v5, s32, v236
  v_add_u32 v236, 4, v31
  v_lshlrev_b32 v236, 1, v236
  v_xor_b32 v236, v236, v32
  v_lshlrev_b32 v236, 4, v236
  v_lshl_add_u32 v236, v31, 8, v236
  v_add_u32 v6, s32, v236
  s_lshl_b32 s50, s80, 17
  v_lshlrev_b32 v236, 2, v31
  v_xor_b32 v236, v236, v32
  v_lshlrev_b32 v236, 4, v236
  v_lshl_add_u32 v236, v31, 13, v236
  v_add_u32 v236, 0, v236
  v_add_u32 v7, s50, v236
  v_lshlrev_b32 v236, 2, v31
  v_xor_b32 v236, v236, v32
  v_lshlrev_b32 v236, 4, v236
  v_lshl_add_u32 v236, v31, 13, v236
  v_add_u32 v236, 31744, v236
  v_add_u32 v8, s50, v236
  v_lshlrev_b32 v236, 2, v31
  v_xor_b32 v236, v236, v32
  v_lshlrev_b32 v236, 4, v236
  v_lshl_add_u32 v236, v31, 13, v236
  v_add_u32 v236, 63488, v236
  v_add_u32 v9, s50, v236
  v_lshlrev_b32 v236, 2, v31
  v_xor_b32 v236, v236, v32
  v_lshlrev_b32 v236, 4, v236
  v_lshl_add_u32 v236, v31, 13, v236
  v_add_u32 v236, 95232, v236
  v_add_u32 v10, s50, v236
  s_mul_i32 s50, s80, 92160
  s_mul_i32 s51, s81, 9216
  s_add_u32 s50, s50, s51
  v_lshrrev_b32 v237, 3, v30
  v_mul_u32_u24 v236, 1152, v237
  v_and_b32 v11, 7, v30
  v_xor_b32 v11, v11, v237
  v_lshl_add_u32 v236, v11, 4, v236
  v_add_u32 v11, s50, v236
  s_mul_i32 s47, s80, 10240
  s_add_u32 s47, s47, 24576
  v_and_b32 v236, 7, v32
  v_xor_b32 v236, v236, v31
  v_lshlrev_b32 v236, 4, v236
  v_lshl_add_u32 v236, v32, 7, v236
  v_add_u32 v252, s47, v236
  v_xor_b32 v253, 64, v252
  v_add_u32 v254, 81920, v252
  v_add_u32 v255, 81920, v253
  s_lshl_b32 s51, s81, 10
  s_add_u32 s47, s47, s51
  s_lshr_b32 s50, s2, 3
  s_lshl_b32 s50, s50, 2
  s_add_u32 s50, s50, s55
  s_mul_i32 s49, s50, 11520
  s_bfe_u32 s51, s2, 0x20001
  s_mul_i32 s51, s51, 1474560
  s_add_u32 s49, s49, s51
  s_lshr_b32 s57, s50, 1
  s_lshl_b32 s57, s57, 13
  s_and_b32 s51, s2, 1
  s_lshl_b32 s51, s51, 12
  s_add_u32 s57, s57, s51
  s_lshl_b32 s51, s80, 11
  s_add_u32 s57, s57, s51
  v_add_u32 v236, 0, v31
  v_xor_b32 v236, v236, v32
  v_lshlrev_b32 v236, 4, v236
  v_lshl_add_u32 v236, v32, 8, v236
  v_add_u32 v236, 49152, v236
  v_add_u32 v12, s59, v236
  v_add_u32 v236, 4, v31
  v_xor_b32 v236, v236, v32
  v_lshlrev_b32 v236, 4, v236
  v_lshl_add_u32 v236, v32, 8, v236
  v_add_u32 v236, 49152, v236
  v_add_u32 v13, s59, v236
  v_add_u32 v236, 8, v31
  v_xor_b32 v236, v236, v32
  v_lshlrev_b32 v236, 4, v236
  v_lshl_add_u32 v236, v32, 8, v236
  v_add_u32 v236, 49152, v236
  v_add_u32 v14, s59, v236
  v_add_u32 v236, 12, v31
  v_xor_b32 v236, v236, v32
  v_lshlrev_b32 v236, 4, v236
  v_lshl_add_u32 v236, v32, 8, v236
  v_add_u32 v236, 49152, v236
  v_add_u32 v15, s59, v236
  v_and_b32 v237, 1, v31
  v_lshl_add_u32 v237, v237, 2, v33
  v_lshlrev_b32 v237, 1, v237
  v_lshrrev_b32 v236, 1, v34
  v_add_u32 v236, 0, v236
  v_xor_b32 v236, v236, v237
  v_lshlrev_b32 v236, 4, v236
  v_lshl_add_u32 v16, v31, 2, v33
  v_lshl_add_u32 v236, v16, 8, v236
  v_and_b32 v16, 1, v34
  v_lshl_add_u32 v16, v16, 3, v236
  v_add_u32 v16, s59, v16
  v_lshrrev_b32 v236, 1, v34
  v_add_u32 v236, 2, v236
  v_xor_b32 v236, v236, v237
  v_lshlrev_b32 v236, 4, v236
  v_lshl_add_u32 v17, v31, 2, v33
  v_lshl_add_u32 v236, v17, 8, v236
  v_and_b32 v17, 1, v34
  v_lshl_add_u32 v17, v17, 3, v236
  v_add_u32 v17, s59, v17
  v_lshrrev_b32 v236, 1, v34
  v_add_u32 v236, 4, v236
  v_xor_b32 v236, v236, v237
  v_lshlrev_b32 v236, 4, v236
  v_lshl_add_u32 v18, v31, 2, v33
  v_lshl_add_u32 v236, v18, 8, v236
  v_and_b32 v18, 1, v34
  v_lshl_add_u32 v18, v18, 3, v236
  v_add_u32 v18, s59, v18
  v_lshrrev_b32 v236, 1, v34
  v_add_u32 v236, 6, v236
  v_xor_b32 v236, v236, v237
  v_lshlrev_b32 v236, 4, v236
  v_lshl_add_u32 v19, v31, 2, v33
  v_lshl_add_u32 v236, v19, 8, v236
  v_and_b32 v19, 1, v34
  v_lshl_add_u32 v19, v19, 3, v236
  v_add_u32 v19, s59, v19
  v_lshrrev_b32 v236, 1, v34
  v_add_u32 v236, 8, v236
  v_xor_b32 v236, v236, v237
  v_lshlrev_b32 v236, 4, v236
  v_lshl_add_u32 v20, v31, 2, v33
  v_lshl_add_u32 v236, v20, 8, v236
  v_and_b32 v20, 1, v34
  v_lshl_add_u32 v20, v20, 3, v236
  v_add_u32 v20, s59, v20
  v_lshrrev_b32 v236, 1, v34
  v_add_u32 v236, 10, v236
  v_xor_b32 v236, v236, v237
  v_lshlrev_b32 v236, 4, v236
  v_lshl_add_u32 v21, v31, 2, v33
  v_lshl_add_u32 v236, v21, 8, v236
  v_and_b32 v21, 1, v34
  v_lshl_add_u32 v21, v21, 3, v236
  v_add_u32 v21, s59, v21
  v_lshrrev_b32 v236, 1, v34
  v_add_u32 v236, 12, v236
  v_xor_b32 v236, v236, v237
  v_lshlrev_b32 v236, 4, v236
  v_lshl_add_u32 v22, v31, 2, v33
  v_lshl_add_u32 v236, v22, 8, v236
  v_and_b32 v22, 1, v34
  v_lshl_add_u32 v22, v22, 3, v236
  v_add_u32 v22, s59, v22
  v_lshrrev_b32 v236, 1, v34
  v_add_u32 v236, 14, v236
  v_xor_b32 v236, v236, v237
  v_lshlrev_b32 v236, 4, v236
  v_lshl_add_u32 v23, v31, 2, v33
  v_lshl_add_u32 v236, v23, 8, v236
  v_and_b32 v23, 1, v34
  v_lshl_add_u32 v23, v23, 3, v236
  v_add_u32 v23, s59, v23
  v_xor_b32 v236, 0, v33
  v_lshl_add_u32 v236, v236, 2, v34
  v_lshlrev_b32 v236, 4, v236
  v_lshl_add_u32 v237, v31, 3, v33
  v_lshl_add_u32 v24, v237, 8, v236
  v_add_u32 v24, s59, v24
  v_xor_b32 v236, 1, v33
  v_lshl_add_u32 v236, v236, 2, v34
  v_lshlrev_b32 v236, 4, v236
  v_lshl_add_u32 v237, v31, 3, v33
  v_lshl_add_u32 v25, v237, 8, v236
  v_add_u32 v25, s59, v25
  v_xor_b32 v236, 2, v33
  v_lshl_add_u32 v236, v236, 2, v34
  v_lshlrev_b32 v236, 4, v236
  v_lshl_add_u32 v237, v31, 3, v33
  v_lshl_add_u32 v26, v237, 8, v236
  v_add_u32 v26, s59, v26
  v_xor_b32 v236, 3, v33
  v_lshl_add_u32 v236, v236, 2, v34
  v_lshlrev_b32 v236, 4, v236
  v_lshl_add_u32 v237, v31, 3, v33
  v_lshl_add_u32 v27, v237, 8, v236
  v_add_u32 v27, s59, v27
  v_lshlrev_b32 v28, 4, v30
  v_mul_u32_u24 v236, 4608, v31
  v_lshl_add_u32 v29, v32, 1, v236
  v_mov_b32 v236, 0x3f803f80
  v_accvgpr_write_b32 a244, v236
  v_accvgpr_write_b32 a245, v236
  v_accvgpr_write_b32 a246, v236
  v_accvgpr_write_b32 a247, v236
  v_mov_b32 v35, 1266679808
  s_mov_b32 s48, 1040356334
  s_bfe_u32 s58, s2, 0x20001
  s_lshl_b32 s58, s58, 3
  s_bfe_u32 s59, s2, 0x30003
  s_add_u32 s58, s58, s59
  s_and_b32 s50, s2, 1
  s_lshl_b32 s50, s50, 2
  s_lshr_b32 s51, s2, 6
  s_add_u32 s50, s50, s51
  s_lshl_b32 s54, s58, 5
  s_lshl_b32 s50, s50, 2
  s_add_u32 s54, s54, s50
  s_add_u32 s54, s54, s81
  s_mul_i32 s37, s58, 184320
  s_add_u32 s38, s37, 18432
  s_add_u32 s39, s37, 36864
  s_add_u32 s40, s37, 55296
  s_add_u32 s41, s37, 73728
  s_mov_b32 s33, s54
  s_mov_b32 s46, 0
  s_mov_b32 s56, 0
  s_mov_b32 s53, 0
  s_waitcnt lgkmcnt(0)
  s_mov_b32 s8, s64
  s_and_b32 s9, s65, 0xffff
  s_mov_b32 s10, 5898240
  s_mov_b32 s11, 0x00020000
  s_mov_b32 s12, s66
  s_and_b32 s13, s67, 0xffff
  s_mov_b32 s14, 134217728
  s_mov_b32 s15, 0x00020000
  s_mov_b32 s16, s68
  s_and_b32 s17, s69, 0xffff
  s_mov_b32 s18, 134217728
  s_mov_b32 s19, 0x00020000
  s_mov_b32 s20, s70
  s_and_b32 s21, s71, 0xffff
  s_mov_b32 s22, 4718592
  s_mov_b32 s23, 0x00020000
  s_mov_b32 s28, s72
  s_and_b32 s29, s73, 0xffff
  s_mov_b32 s30, 4718592
  s_mov_b32 s31, 0x00020000
  s_mov_b32 s24, s74
  s_and_b32 s25, s75, 0xffff
  s_mov_b32 s26, 46661632
  s_mov_b32 s27, 0x00020000
  s_lshl_b32 s78, s2, 2
  s_add_u32 s78, s78, s55
  s_lshl_b32 s78, s78, 7
  s_add_u32 s78, s78, 0x4000000
L_cold:
  s_lshl_b32 s34, s33, 17
  s_xor_b32 s35, s34, 262144
  s_and_b32 s50, s33, 31
  s_lshl_b32 s36, s50, 8
  s_xor_b32 s52, s36, 512
  s_cmp_eq_u32 s46, 0
  s_cselect_b32 s35, s35, 2130706432
  s_cselect_b32 s52, s52, 2130706432
  s_lshr_b32 s51, s33, 5
  s_mul_i32 s51, s51, 10
  s_mul_i32 s58, s80, 5
  s_add_u32 s51, s51, s58
  s_lshl_b32 s51, s51, 17
  s_lshl_b32 s50, s50, 12
  s_add_u32 s42, s51, s50
  s_lshl_b32 s50, s33, 1
  s_add_u32 s50, s50, s80
  s_lshr_b32 s51, s50, 4
  s_and_b32 s50, s50, 15
  s_mul_i32 s58, s51, 36864
  s_mul_i32 s59, s50, 96
  s_add_u32 s43, s58, s59
  s_add_u32 s44, s43, 18432
  s_mul_i32 s58, s50, 393216
  s_lshl_b32 s59, s51, 10
  s_add_u32 s58, s58, s59
  s_add_u32 s45, s58, 41943040
  s_cmp_lt_u32 s50, 12
  s_cselect_b32 s43, s43, 2130706432
  s_cselect_b32 s44, s44, 2130706432
  s_cselect_b32 s45, s45, 2130706432
  s_cmp_lg_u32 s56, 0
  s_cselect_b64 s[60:61], -1, 0
  v_lshrrev_b32 v236, 4, v28
  v_add_u32 v237, 0, v236
  v_mul_u32_u24 v241, 205, v237
  v_lshrrev_b32 v241, 11, v241
  v_mul_u32_u24 v242, 10, v241
  v_sub_u32 v237, v237, v242
  v_mul_u32_u24 v237, 1152, v237
  v_lshl_add_u32 v238, v241, 6, v237
  v_add_u32 v237, 64, v236
  v_mul_u32_u24 v241, 205, v237
  v_lshrrev_b32 v241, 11, v241
  v_mul_u32_u24 v242, 10, v241
  v_sub_u32 v237, v237, v242
  v_mul_u32_u24 v237, 1152, v237
  v_lshl_add_u32 v239, v241, 6, v237
  v_add_u32 v237, 128, v236
  v_mul_u32_u24 v241, 205, v237
  v_lshrrev_b32 v241, 11, v241
  v_mul_u32_u24 v242, 10, v241
  v_sub_u32 v237, v237, v242
  v_mul_u32_u24 v237, 1152, v237
  v_lshl_add_u32 v240, v241, 6, v237
  v_and_b32 v237, 31, v236
  v_lshrrev_b32 v241, 5, v236
  v_lshlrev_b32 v241, 19, v241
  v_lshl_add_u32 v241, v237, 6, v241
  v_add_u32 v87, s79, v28
  s_add_u32 m0, s47, 0
  s_add_u32 s51, s37, 0
  buffer_load_dwordx4 v11, s[8:11], s51 offen lds
  s_add_u32 m0, s47, 2048
  s_add_u32 s51, s38, 0
  buffer_load_dwordx4 v11, s[8:11], s51 offen lds
  s_add_u32 m0, s47, 4096
  s_add_u32 s51, s39, 0
  buffer_load_dwordx4 v11, s[8:11], s51 offen lds
  s_add_u32 m0, s47, 6144
  s_add_u32 s51, s40, 0
  buffer_load_dwordx4 v11, s[8:11], s51 offen lds
  s_add_u32 m0, s47, 8192
  s_add_u32 s51, s41, 0
  buffer_load_dwordx4 v11, s[8:11], s51 offen lds
  s_add_u32 m0, s79, 0
  s_add_u32 s51, s36, 0
  buffer_load_dwordx4 v7, s[20:23], s51 offen offset:0 lds
  buffer_load_dwordx4 v8, s[20:23], s51 offen offset:1024 lds
  buffer_load_dwordx4 v9, s[20:23], s51 offen offset:2048 lds
  buffer_load_dwordx4 v10, s[20:23], s51 offen offset:3072 lds
  buffer_load_dword v76, v238, s[8:11], s49 offen
  s_add_u32 s51, s57, 0
  buffer_load_dword v77, v241, s[20:23], s51 offen
  buffer_load_dword v76, v239, s[8:11], s49 offen
  s_add_u32 s51, s57, 1048576
  buffer_load_dword v77, v241, s[20:23], s51 offen
  buffer_load_dword v76, v240, s[8:11], s49 offen
  s_add_u32 s51, s57, 2097152
  buffer_load_dword v77, v241, s[20:23], s51 offen
  s_add_u32 s51, s57, 3145728
  buffer_load_dword v77, v241, s[20:23], s51 offen
  s_add_u32 s51, s57, 4194304
  buffer_load_dword v77, v241, s[20:23], s51 offen
  s_add_u32 m0, s79, 8192
  s_add_u32 s51, s36, 262144
  buffer_load_dwordx4 v7, s[20:23], s51 offen offset:0 lds
  buffer_load_dwordx4 v8, s[20:23], s51 offen offset:1024 lds
  buffer_load_dwordx4 v9, s[20:23], s51 offen offset:2048 lds
  buffer_load_dwordx4 v10, s[20:23], s51 offen offset:3072 lds
  s_add_u32 m0, s47, 81920
  s_add_u32 s51, s37, 128
  buffer_load_dwordx4 v11, s[8:11], s51 offen lds
  s_add_u32 m0, s47, 83968
  s_add_u32 s51, s38, 128
  buffer_load_dwordx4 v11, s[8:11], s51 offen lds
  s_add_u32 m0, s47, 86016
  s_add_u32 s51, s39, 128
  buffer_load_dwordx4 v11, s[8:11], s51 offen lds
  s_add_u32 m0, s47, 88064
  s_add_u32 s51, s40, 128
  buffer_load_dwordx4 v11, s[8:11], s51 offen lds
  s_add_u32 m0, s47, 90112
  s_add_u32 s51, s41, 128
  buffer_load_dwordx4 v11, s[8:11], s51 offen lds
  s_add_u32 m0, s79, 16384
  s_add_u32 s51, s36, 524288
  buffer_load_dwordx4 v7, s[20:23], s51 offen offset:0 lds
  buffer_load_dwordx4 v8, s[20:23], s51 offen offset:1024 lds
  buffer_load_dwordx4 v9, s[20:23], s51 offen offset:2048 lds
  buffer_load_dwordx4 v10, s[20:23], s51 offen offset:3072 lds
  s_waitcnt vmcnt(21)
  s_barrier
  ds_read_b64_tr_b16 a[160:161], v24 offset:0
  ds_read_b64_tr_b16 a[162:163], v24 offset:1024
  ds_read_b64_tr_b16 a[164:165], v24 offset:8
  ds_read_b64_tr_b16 a[166:167], v24 offset:1032
  ds_read_b64_tr_b16 a[168:169], v25 offset:0
  ds_read_b64_tr_b16 a[170:171], v25 offset:1024
  ds_read_b64_tr_b16 a[172:173], v25 offset:8
  ds_read_b64_tr_b16 a[174:175], v25 offset:1032
  ds_read_b64_tr_b16 a[176:177], v26 offset:0
  ds_read_b64_tr_b16 a[178:179], v26 offset:1024
  ds_read_b64_tr_b16 a[180:181], v26 offset:8
  ds_read_b64_tr_b16 a[182:183], v26 offset:1032
  ds_read_b64_tr_b16 a[184:185], v27 offset:0
  ds_read_b64_tr_b16 a[186:187], v27 offset:1024
  ds_read_b64_tr_b16 a[188:189], v27 offset:8
  ds_read_b64_tr_b16 a[190:191], v27 offset:1032
  ds_read_b128 v[36:39], v252 offset:0
  ds_read_b128 v[44:47], v252 offset:2048
  ds_read_b128 v[52:55], v252 offset:4096
  ds_read_b128 v[60:63], v252 offset:6144
  ds_read_b128 v[68:71], v252 offset:8192
  ds_read_b128 v[40:43], v253 offset:0
  ds_read_b128 v[48:51], v253 offset:2048
  ds_read_b128 v[56:59], v253 offset:4096
  ds_read_b128 v[64:67], v253 offset:6144
  ds_read_b128 v[72:75], v253 offset:8192
  s_waitcnt vmcnt(9) lgkmcnt(0)
  s_barrier
  v_mfma_f32_16x16x32_bf16 v[92:95], a[160:163], v[36:39], 0
  ds_read_b64_tr_b16 a[192:193], v24 offset:8192
  v_mfma_f32_16x16x32_bf16 v[100:103], a[160:163], v[44:47], 0
  s_add_u32 m0, s47, 0
  s_add_u32 s51, s37, 256
  buffer_load_dwordx4 v11, s[8:11], s51 offen lds
  v_mfma_f32_16x16x32_bf16 v[108:111], a[160:163], v[52:55], 0
  ds_read_b64_tr_b16 a[194:195], v24 offset:9216
  v_mfma_f32_16x16x32_bf16 v[116:119], a[160:163], v[60:63], 0
  v_mfma_f32_16x16x32_bf16 v[124:127], a[160:163], v[68:71], 0
  ds_read_b64_tr_b16 a[196:197], v24 offset:8200
  v_mfma_f32_16x16x32_bf16 v[96:99], a[164:167], v[36:39], 0
  v_mfma_f32_16x16x32_bf16 v[104:107], a[164:167], v[44:47], 0
  ds_read_b64_tr_b16 a[198:199], v24 offset:9224
  s_add_u32 m0, s47, 2048
  s_add_u32 s51, s38, 256
  buffer_load_dwordx4 v11, s[8:11], s51 offen lds
  v_mfma_f32_16x16x32_bf16 v[112:115], a[164:167], v[52:55], 0
  v_mfma_f32_16x16x32_bf16 v[120:123], a[164:167], v[60:63], 0
  ds_read_b64_tr_b16 a[200:201], v25 offset:8192
  v_mfma_f32_16x16x32_bf16 v[128:131], a[164:167], v[68:71], 0
  v_mfma_f32_16x16x32_bf16 v[132:135], a[168:171], v[36:39], 0
  ds_read_b64_tr_b16 a[202:203], v25 offset:9216
  v_mfma_f32_16x16x32_bf16 v[140:143], a[168:171], v[44:47], 0
  s_add_u32 m0, s47, 4096
  s_add_u32 s51, s39, 256
  buffer_load_dwordx4 v11, s[8:11], s51 offen lds
  v_mfma_f32_16x16x32_bf16 v[148:151], a[168:171], v[52:55], 0
  ds_read_b64_tr_b16 a[204:205], v25 offset:8200
  v_mfma_f32_16x16x32_bf16 v[156:159], a[168:171], v[60:63], 0
  v_mfma_f32_16x16x32_bf16 v[164:167], a[168:171], v[68:71], 0
  ds_read_b64_tr_b16 a[206:207], v25 offset:9224
  v_mfma_f32_16x16x32_bf16 v[136:139], a[172:175], v[36:39], 0
  v_mfma_f32_16x16x32_bf16 v[144:147], a[172:175], v[44:47], 0
  ds_read_b64_tr_b16 a[208:209], v26 offset:8192
  s_add_u32 m0, s79, 0
  s_add_u32 s51, s36, 786432
  buffer_load_dwordx4 v7, s[20:23], s51 offen offset:0 lds
  v_mfma_f32_16x16x32_bf16 v[152:155], a[172:175], v[52:55], 0
  v_mfma_f32_16x16x32_bf16 v[160:163], a[172:175], v[60:63], 0
  ds_read_b64_tr_b16 a[210:211], v26 offset:9216
  v_mfma_f32_16x16x32_bf16 v[168:171], a[172:175], v[68:71], 0
  v_mfma_f32_16x16x32_bf16 v[172:175], a[176:179], v[36:39], 0
  ds_read_b64_tr_b16 a[212:213], v26 offset:8200
  v_mfma_f32_16x16x32_bf16 v[180:183], a[176:179], v[44:47], 0
  buffer_load_dwordx4 v8, s[20:23], s51 offen offset:1024 lds
  v_mfma_f32_16x16x32_bf16 v[188:191], a[176:179], v[52:55], 0
  ds_read_b64_tr_b16 a[214:215], v26 offset:9224
  v_mfma_f32_16x16x32_bf16 v[196:199], a[176:179], v[60:63], 0
  v_mfma_f32_16x16x32_bf16 v[204:207], a[176:179], v[68:71], 0
  ds_read_b64_tr_b16 a[216:217], v27 offset:8192
  v_mfma_f32_16x16x32_bf16 v[176:179], a[180:183], v[36:39], 0
  v_mfma_f32_16x16x32_bf16 v[184:187], a[180:183], v[44:47], 0
  ds_read_b64_tr_b16 a[218:219], v27 offset:9216
  buffer_load_dwordx4 v9, s[20:23], s51 offen offset:2048 lds
  v_mfma_f32_16x16x32_bf16 v[192:195], a[180:183], v[52:55], 0
  v_mfma_f32_16x16x32_bf16 v[200:203], a[180:183], v[60:63], 0
  ds_read_b64_tr_b16 a[220:221], v27 offset:8200
  v_mfma_f32_16x16x32_bf16 v[208:211], a[180:183], v[68:71], 0
  v_mfma_f32_16x16x32_bf16 v[212:215], a[184:187], v[36:39], 0
  ds_read_b64_tr_b16 a[222:223], v27 offset:9224
  v_mfma_f32_16x16x32_bf16 v[220:223], a[184:187], v[44:47], 0
  buffer_load_dwordx4 v10, s[20:23], s51 offen offset:3072 lds
  v_mfma_f32_16x16x32_bf16 v[228:231], a[184:187], v[52:55], 0
  v_mfma_f32_16x16x32_bf16 v[236:239], a[184:187], v[60:63], 0
  v_mfma_f32_16x16x32_bf16 v[244:247], a[184:187], v[68:71], 0
  v_mfma_f32_16x16x32_bf16 v[216:219], a[188:191], v[36:39], 0
  v_mfma_f32_16x16x32_bf16 v[224:227], a[188:191], v[44:47], 0
  v_mfma_f32_16x16x32_bf16 v[232:235], a[188:191], v[52:55], 0
  v_mfma_f32_16x16x32_bf16 v[240:243], a[188:191], v[60:63], 0
  v_mfma_f32_16x16x32_bf16 v[248:251], a[188:191], v[68:71], 0
  s_waitcnt vmcnt(7) lgkmcnt(0)
  s_barrier
  v_mfma_f32_16x16x32_bf16 v[92:95], a[192:195], v[40:43], v[92:95]
  ds_read_b64_tr_b16 a[160:161], v24 offset:16384
  v_mfma_f32_16x16x32_bf16 v[100:103], a[192:195], v[48:51], v[100:103]
  s_add_u32 m0, s47, 6144
  s_add_u32 s51, s40, 256
  buffer_load_dwordx4 v11, s[8:11], s51 offen lds
  v_mfma_f32_16x16x32_bf16 v[108:111], a[192:195], v[56:59], v[108:111]
  ds_read_b64_tr_b16 a[162:163], v24 offset:17408
  v_mfma_f32_16x16x32_bf16 v[116:119], a[192:195], v[64:67], v[116:119]
  ds_read_b128 a[0:3], v254 offset:0
  v_mfma_f32_16x16x32_bf16 v[124:127], a[192:195], v[72:75], v[124:127]
  ds_read_b64_tr_b16 a[164:165], v24 offset:16392
  v_mfma_f32_16x16x32_bf16 v[96:99], a[196:199], v[40:43], v[96:99]
  v_mfma_f32_16x16x32_bf16 v[104:107], a[196:199], v[48:51], v[104:107]
  ds_read_b128 a[8:11], v254 offset:2048
  ds_read_b64_tr_b16 a[166:167], v24 offset:17416
  s_add_u32 m0, s47, 8192
  s_add_u32 s51, s41, 256
  buffer_load_dwordx4 v11, s[8:11], s51 offen lds
  v_mfma_f32_16x16x32_bf16 v[112:115], a[196:199], v[56:59], v[112:115]
  v_mfma_f32_16x16x32_bf16 v[120:123], a[196:199], v[64:67], v[120:123]
  ds_read_b64_tr_b16 a[168:169], v25 offset:16384
  v_mfma_f32_16x16x32_bf16 v[128:131], a[196:199], v[72:75], v[128:131]
  ds_read_b128 a[16:19], v254 offset:4096
  v_mfma_f32_16x16x32_bf16 v[132:135], a[200:203], v[40:43], v[132:135]
  ds_read_b64_tr_b16 a[170:171], v25 offset:17408
  v_mfma_f32_16x16x32_bf16 v[140:143], a[200:203], v[48:51], v[140:143]
  s_add_u32 m0, s79, 8192
  s_add_u32 s51, s36, 1048576
  buffer_load_dwordx4 v7, s[20:23], s51 offen offset:0 lds
  v_mfma_f32_16x16x32_bf16 v[148:151], a[200:203], v[56:59], v[148:151]
  ds_read_b128 a[24:27], v254 offset:6144
  ds_read_b64_tr_b16 a[172:173], v25 offset:16392
  v_mfma_f32_16x16x32_bf16 v[156:159], a[200:203], v[64:67], v[156:159]
  v_mfma_f32_16x16x32_bf16 v[164:167], a[200:203], v[72:75], v[164:167]
  ds_read_b64_tr_b16 a[174:175], v25 offset:17416
  v_mfma_f32_16x16x32_bf16 v[136:139], a[204:207], v[40:43], v[136:139]
  ds_read_b128 a[32:35], v254 offset:8192
  v_mfma_f32_16x16x32_bf16 v[144:147], a[204:207], v[48:51], v[144:147]
  ds_read_b64_tr_b16 a[176:177], v26 offset:16384
  buffer_load_dwordx4 v8, s[20:23], s51 offen offset:1024 lds
  v_mfma_f32_16x16x32_bf16 v[152:155], a[204:207], v[56:59], v[152:155]
  v_mfma_f32_16x16x32_bf16 v[160:163], a[204:207], v[64:67], v[160:163]
  ds_read_b128 a[4:7], v255 offset:0
  ds_read_b64_tr_b16 a[178:179], v26 offset:17408
  v_mfma_f32_16x16x32_bf16 v[168:171], a[204:207], v[72:75], v[168:171]
  v_mfma_f32_16x16x32_bf16 v[172:175], a[208:211], v[40:43], v[172:175]
  ds_read_b64_tr_b16 a[180:181], v26 offset:16392
  v_mfma_f32_16x16x32_bf16 v[180:183], a[208:211], v[48:51], v[180:183]
  ds_read_b128 a[12:15], v255 offset:2048
  buffer_load_dwordx4 v9, s[20:23], s51 offen offset:2048 lds
  v_mfma_f32_16x16x32_bf16 v[188:191], a[208:211], v[56:59], v[188:191]
  ds_read_b64_tr_b16 a[182:183], v26 offset:17416
  v_mfma_f32_16x16x32_bf16 v[196:199], a[208:211], v[64:67], v[196:199]
  v_mfma_f32_16x16x32_bf16 v[204:207], a[208:211], v[72:75], v[204:207]
  ds_read_b128 a[20:23], v255 offset:4096
  ds_read_b64_tr_b16 a[184:185], v27 offset:16384
  v_mfma_f32_16x16x32_bf16 v[176:179], a[212:215], v[40:43], v[176:179]
  v_mfma_f32_16x16x32_bf16 v[184:187], a[212:215], v[48:51], v[184:187]
  ds_read_b64_tr_b16 a[186:187], v27 offset:17408
  buffer_load_dwordx4 v10, s[20:23], s51 offen offset:3072 lds
  v_mfma_f32_16x16x32_bf16 v[192:195], a[212:215], v[56:59], v[192:195]
  ds_read_b128 a[28:31], v255 offset:6144
  v_mfma_f32_16x16x32_bf16 v[200:203], a[212:215], v[64:67], v[200:203]
  ds_read_b64_tr_b16 a[188:189], v27 offset:16392
  v_mfma_f32_16x16x32_bf16 v[208:211], a[212:215], v[72:75], v[208:211]
  v_mfma_f32_16x16x32_bf16 v[212:215], a[216:219], v[40:43], v[212:215]
  ds_read_b128 a[36:39], v255 offset:8192
  ds_read_b64_tr_b16 a[190:191], v27 offset:17416
  v_mfma_f32_16x16x32_bf16 v[220:223], a[216:219], v[48:51], v[220:223]
  v_mfma_f32_16x16x32_bf16 v[228:231], a[216:219], v[56:59], v[228:231]
  v_mfma_f32_16x16x32_bf16 v[236:239], a[216:219], v[64:67], v[236:239]
  v_mfma_f32_16x16x32_bf16 v[244:247], a[216:219], v[72:75], v[244:247]
  v_mfma_f32_16x16x32_bf16 v[216:219], a[220:223], v[40:43], v[216:219]
  v_mfma_f32_16x16x32_bf16 v[224:227], a[220:223], v[48:51], v[224:227]
  v_mfma_f32_16x16x32_bf16 v[232:235], a[220:223], v[56:59], v[232:235]
  v_mfma_f32_16x16x32_bf16 v[240:243], a[220:223], v[64:67], v[240:243]
  v_mfma_f32_16x16x32_bf16 v[248:251], a[220:223], v[72:75], v[248:251]
  s_waitcnt vmcnt(6) lgkmcnt(0)
  s_barrier
  v_mfma_f32_16x16x32_bf16 v[92:95], a[160:163], a[0:3], v[92:95]
  ds_read_b64_tr_b16 a[192:193], v24 offset:0
  v_mfma_f32_16x16x32_bf16 v[100:103], a[160:163], a[8:11], v[100:103]
  s_add_u32 m0, s47, 81920
  s_add_u32 s51, s37, 384
  buffer_load_dwordx4 v11, s[8:11], s51 offen lds
  v_mfma_f32_16x16x32_bf16 v[108:111], a[160:163], a[16:19], v[108:111]
  ds_read_b64_tr_b16 a[194:195], v24 offset:1024
  v_mfma_f32_16x16x32_bf16 v[116:119], a[160:163], a[24:27], v[116:119]
  v_mfma_f32_16x16x32_bf16 v[124:127], a[160:163], a[32:35], v[124:127]
  ds_read_b64_tr_b16 a[196:197], v24 offset:8
  v_mfma_f32_16x16x32_bf16 v[96:99], a[164:167], a[0:3], v[96:99]
  v_mfma_f32_16x16x32_bf16 v[104:107], a[164:167], a[8:11], v[104:107]
  ds_read_b64_tr_b16 a[198:199], v24 offset:1032
  s_add_u32 m0, s47, 83968
  s_add_u32 s51, s38, 384
  buffer_load_dwordx4 v11, s[8:11], s51 offen lds
  v_mfma_f32_16x16x32_bf16 v[112:115], a[164:167], a[16:19], v[112:115]
  v_mfma_f32_16x16x32_bf16 v[120:123], a[164:167], a[24:27], v[120:123]
  ds_read_b64_tr_b16 a[200:201], v25 offset:0
  v_mfma_f32_16x16x32_bf16 v[128:131], a[164:167], a[32:35], v[128:131]
  v_mfma_f32_16x16x32_bf16 v[132:135], a[168:171], a[0:3], v[132:135]
  ds_read_b64_tr_b16 a[202:203], v25 offset:1024
  v_mfma_f32_16x16x32_bf16 v[140:143], a[168:171], a[8:11], v[140:143]
  s_add_u32 m0, s47, 86016
  s_add_u32 s51, s39, 384
  buffer_load_dwordx4 v11, s[8:11], s51 offen lds
  v_mfma_f32_16x16x32_bf16 v[148:151], a[168:171], a[16:19], v[148:151]
  ds_read_b64_tr_b16 a[204:205], v25 offset:8
  v_mfma_f32_16x16x32_bf16 v[156:159], a[168:171], a[24:27], v[156:159]
  v_mfma_f32_16x16x32_bf16 v[164:167], a[168:171], a[32:35], v[164:167]
  ds_read_b64_tr_b16 a[206:207], v25 offset:1032
  v_mfma_f32_16x16x32_bf16 v[136:139], a[172:175], a[0:3], v[136:139]
  v_mfma_f32_16x16x32_bf16 v[144:147], a[172:175], a[8:11], v[144:147]
  ds_read_b64_tr_b16 a[208:209], v26 offset:0
  s_add_u32 m0, s79, 16384
  s_add_u32 s51, s36, 1310720
  buffer_load_dwordx4 v7, s[20:23], s51 offen offset:0 lds
  v_mfma_f32_16x16x32_bf16 v[152:155], a[172:175], a[16:19], v[152:155]
  v_mfma_f32_16x16x32_bf16 v[160:163], a[172:175], a[24:27], v[160:163]
  ds_read_b64_tr_b16 a[210:211], v26 offset:1024
  v_mfma_f32_16x16x32_bf16 v[168:171], a[172:175], a[32:35], v[168:171]
  v_mfma_f32_16x16x32_bf16 v[172:175], a[176:179], a[0:3], v[172:175]
  ds_read_b64_tr_b16 a[212:213], v26 offset:8
  v_mfma_f32_16x16x32_bf16 v[180:183], a[176:179], a[8:11], v[180:183]
  buffer_load_dwordx4 v8, s[20:23], s51 offen offset:1024 lds
  v_mfma_f32_16x16x32_bf16 v[188:191], a[176:179], a[16:19], v[188:191]
  ds_read_b64_tr_b16 a[214:215], v26 offset:1032
  v_mfma_f32_16x16x32_bf16 v[196:199], a[176:179], a[24:27], v[196:199]
  v_mfma_f32_16x16x32_bf16 v[204:207], a[176:179], a[32:35], v[204:207]
  ds_read_b64_tr_b16 a[216:217], v27 offset:0
  v_mfma_f32_16x16x32_bf16 v[176:179], a[180:183], a[0:3], v[176:179]
  v_mfma_f32_16x16x32_bf16 v[184:187], a[180:183], a[8:11], v[184:187]
  ds_read_b64_tr_b16 a[218:219], v27 offset:1024
  buffer_load_dwordx4 v9, s[20:23], s51 offen offset:2048 lds
  v_mfma_f32_16x16x32_bf16 v[192:195], a[180:183], a[16:19], v[192:195]
  v_mfma_f32_16x16x32_bf16 v[200:203], a[180:183], a[24:27], v[200:203]
  ds_read_b64_tr_b16 a[220:221], v27 offset:8
  v_mfma_f32_16x16x32_bf16 v[208:211], a[180:183], a[32:35], v[208:211]
  v_mfma_f32_16x16x32_bf16 v[212:215], a[184:187], a[0:3], v[212:215]
  ds_read_b64_tr_b16 a[222:223], v27 offset:1032
  v_mfma_f32_16x16x32_bf16 v[220:223], a[184:187], a[8:11], v[220:223]
  buffer_load_dwordx4 v10, s[20:23], s51 offen offset:3072 lds
  v_mfma_f32_16x16x32_bf16 v[228:231], a[184:187], a[16:19], v[228:231]
  v_mfma_f32_16x16x32_bf16 v[236:239], a[184:187], a[24:27], v[236:239]
  v_mfma_f32_16x16x32_bf16 v[244:247], a[184:187], a[32:35], v[244:247]
  v_mfma_f32_16x16x32_bf16 v[216:219], a[188:191], a[0:3], v[216:219]
  v_mfma_f32_16x16x32_bf16 v[224:227], a[188:191], a[8:11], v[224:227]
  v_mfma_f32_16x16x32_bf16 v[232:235], a[188:191], a[16:19], v[232:235]
  v_mfma_f32_16x16x32_bf16 v[240:243], a[188:191], a[24:27], v[240:243]
  v_mfma_f32_16x16x32_bf16 v[248:251], a[188:191], a[32:35], v[248:251]
  s_waitcnt vmcnt(7) lgkmcnt(0)
  s_barrier
  v_mfma_f32_16x16x32_bf16 v[92:95], a[192:195], a[4:7], v[92:95]
  ds_read_b64_tr_b16 a[160:161], v24 offset:8192
  v_mfma_f32_16x16x32_bf16 v[100:103], a[192:195], a[12:15], v[100:103]
  s_add_u32 m0, s47, 88064
  s_add_u32 s51, s40, 384
  buffer_load_dwordx4 v11, s[8:11], s51 offen lds
  v_mfma_f32_16x16x32_bf16 v[108:111], a[192:195], a[20:23], v[108:111]
  ds_read_b64_tr_b16 a[162:163], v24 offset:9216
  v_mfma_f32_16x16x32_bf16 v[116:119], a[192:195], a[28:31], v[116:119]
  ds_read_b128 v[36:39], v252 offset:0
  v_mfma_f32_16x16x32_bf16 v[124:127], a[192:195], a[36:39], v[124:127]
  ds_read_b64_tr_b16 a[164:165], v24 offset:8200
  s_add_u32 m0, s47, 90112
  s_add_u32 s51, s41, 384
  buffer_load_dwordx4 v11, s[8:11], s51 offen lds
  v_mfma_f32_16x16x32_bf16 v[96:99], a[196:199], a[4:7], v[96:99]
  v_mfma_f32_16x16x32_bf16 v[104:107], a[196:199], a[12:15], v[104:107]
  ds_read_b128 v[44:47], v252 offset:2048
  ds_read_b64_tr_b16 a[166:167], v24 offset:9224
  v_mfma_f32_16x16x32_bf16 v[112:115], a[196:199], a[20:23], v[112:115]
  s_add_u32 m0, s79, 0
  s_add_u32 s51, s36, 1572864
  buffer_load_dwordx4 v7, s[20:23], s51 offen offset:0 lds
  v_mfma_f32_16x16x32_bf16 v[120:123], a[196:199], a[28:31], v[120:123]
  ds_read_b64_tr_b16 a[168:169], v25 offset:8192
  v_mfma_f32_16x16x32_bf16 v[128:131], a[196:199], a[36:39], v[128:131]
  ds_read_b128 v[52:55], v252 offset:4096
  v_mfma_f32_16x16x32_bf16 v[132:135], a[200:203], a[4:7], v[132:135]
  ds_read_b64_tr_b16 a[170:171], v25 offset:9216
  buffer_load_dwordx4 v8, s[20:23], s51 offen offset:1024 lds
  v_mfma_f32_16x16x32_bf16 v[140:143], a[200:203], a[12:15], v[140:143]
  v_mfma_f32_16x16x32_bf16 v[148:151], a[200:203], a[20:23], v[148:151]
  ds_read_b128 v[60:63], v252 offset:6144
  ds_read_b64_tr_b16 a[172:173], v25 offset:8200
  v_mfma_f32_16x16x32_bf16 v[156:159], a[200:203], a[28:31], v[156:159]
  buffer_load_dwordx4 v9, s[20:23], s51 offen offset:2048 lds
  v_mfma_f32_16x16x32_bf16 v[164:167], a[200:203], a[36:39], v[164:167]
  ds_read_b64_tr_b16 a[174:175], v25 offset:9224
  v_mfma_f32_16x16x32_bf16 v[136:139], a[204:207], a[4:7], v[136:139]
  ds_read_b128 v[68:71], v252 offset:8192
  v_mfma_f32_16x16x32_bf16 v[144:147], a[204:207], a[12:15], v[144:147]
  ds_read_b64_tr_b16 a[176:177], v26 offset:8192
  buffer_load_dwordx4 v10, s[20:23], s51 offen offset:3072 lds
  v_mfma_f32_16x16x32_bf16 v[152:155], a[204:207], a[20:23], v[152:155]
  v_mfma_f32_16x16x32_bf16 v[160:163], a[204:207], a[28:31], v[160:163]
  ds_read_b128 v[40:43], v253 offset:0
  ds_read_b64_tr_b16 a[178:179], v26 offset:9216
  v_mfma_f32_16x16x32_bf16 v[168:171], a[204:207], a[36:39], v[168:171]
  s_add_u32 m0, s79, 49152
  s_add_u32 s50, s82, 0
  s_and_b32 s50, s50, 0x1ffff
  s_add_u32 s50, s50, s34
  buffer_load_dwordx4 v1, s[12:15], s50 offen offset:0 nt lds
  v_mfma_f32_16x16x32_bf16 v[172:175], a[208:211], a[4:7], v[172:175]
  ds_read_b64_tr_b16 a[180:181], v26 offset:8200
  v_mfma_f32_16x16x32_bf16 v[180:183], a[208:211], a[12:15], v[180:183]
  ds_read_b128 v[48:51], v253 offset:2048
  v_mfma_f32_16x16x32_bf16 v[188:191], a[208:211], a[20:23], v[188:191]
  ds_read_b64_tr_b16 a[182:183], v26 offset:9224
  buffer_load_dwordx4 v2, s[12:15], s50 offen offset:1024 nt lds
  v_mfma_f32_16x16x32_bf16 v[196:199], a[208:211], a[28:31], v[196:199]
  v_mfma_f32_16x16x32_bf16 v[204:207], a[208:211], a[36:39], v[204:207]
  ds_read_b128 v[56:59], v253 offset:4096
  ds_read_b64_tr_b16 a[184:185], v27 offset:8192
  v_mfma_f32_16x16x32_bf16 v[176:179], a[212:215], a[4:7], v[176:179]
  buffer_load_dwordx4 v3, s[12:15], s50 offen offset:2048 nt lds
  v_mfma_f32_16x16x32_bf16 v[184:187], a[212:215], a[12:15], v[184:187]
  ds_read_b64_tr_b16 a[186:187], v27 offset:9216
  v_mfma_f32_16x16x32_bf16 v[192:195], a[212:215], a[20:23], v[192:195]
  ds_read_b128 v[64:67], v253 offset:6144
  v_mfma_f32_16x16x32_bf16 v[200:203], a[212:215], a[28:31], v[200:203]
  ds_read_b64_tr_b16 a[188:189], v27 offset:8200
  buffer_load_dwordx4 v4, s[12:15], s50 offen offset:3072 nt lds
  v_mfma_f32_16x16x32_bf16 v[208:211], a[212:215], a[36:39], v[208:211]
  v_mfma_f32_16x16x32_bf16 v[212:215], a[216:219], a[4:7], v[212:215]
  ds_read_b128 v[72:75], v253 offset:8192
  ds_read_b64_tr_b16 a[190:191], v27 offset:9224
  v_mfma_f32_16x16x32_bf16 v[220:223], a[216:219], a[12:15], v[220:223]
  v_mfma_f32_16x16x32_bf16 v[228:231], a[216:219], a[20:23], v[228:231]
  v_mfma_f32_16x16x32_bf16 v[236:239], a[216:219], a[28:31], v[236:239]
  v_mfma_f32_16x16x32_bf16 v[244:247], a[216:219], a[36:39], v[244:247]
  v_mfma_f32_16x16x32_bf16 v[216:219], a[220:223], a[4:7], v[216:219]
  v_mfma_f32_16x16x32_bf16 v[224:227], a[220:223], a[12:15], v[224:227]
  v_mfma_f32_16x16x32_bf16 v[232:235], a[220:223], a[20:23], v[232:235]
  v_mfma_f32_16x16x32_bf16 v[240:243], a[220:223], a[28:31], v[240:243]
  v_mfma_f32_16x16x32_bf16 v[248:251], a[220:223], a[36:39], v[248:251]
  s_waitcnt vmcnt(10) lgkmcnt(0)
  s_barrier
  v_mfma_f32_16x16x32_bf16 v[92:95], a[160:163], v[36:39], v[92:95]
  ds_read_b64_tr_b16 a[192:193], v24 offset:16384
  v_mfma_f32_16x16x32_bf16 v[100:103], a[160:163], v[44:47], v[100:103]
  s_add_u32 m0, s47, 0
  s_add_u32 s51, s37, 512
  buffer_load_dwordx4 v11, s[8:11], s51 offen lds
  v_mfma_f32_16x16x32_bf16 v[108:111], a[160:163], v[52:55], v[108:111]
  ds_read_b64_tr_b16 a[194:195], v24 offset:17408
  v_mfma_f32_16x16x32_bf16 v[116:119], a[160:163], v[60:63], v[116:119]
  v_mfma_f32_16x16x32_bf16 v[124:127], a[160:163], v[68:71], v[124:127]
  ds_read_b64_tr_b16 a[196:197], v24 offset:16392
  v_mfma_f32_16x16x32_bf16 v[96:99], a[164:167], v[36:39], v[96:99]
  v_mfma_f32_16x16x32_bf16 v[104:107], a[164:167], v[44:47], v[104:107]
  ds_read_b64_tr_b16 a[198:199], v24 offset:17416
  s_add_u32 m0, s47, 2048
  s_add_u32 s51, s38, 512
  buffer_load_dwordx4 v11, s[8:11], s51 offen lds
  v_mfma_f32_16x16x32_bf16 v[112:115], a[164:167], v[52:55], v[112:115]
  v_mfma_f32_16x16x32_bf16 v[120:123], a[164:167], v[60:63], v[120:123]
  ds_read_b64_tr_b16 a[200:201], v25 offset:16384
  v_mfma_f32_16x16x32_bf16 v[128:131], a[164:167], v[68:71], v[128:131]
  v_mfma_f32_16x16x32_bf16 v[132:135], a[168:171], v[36:39], v[132:135]
  ds_read_b64_tr_b16 a[202:203], v25 offset:17408
  v_mfma_f32_16x16x32_bf16 v[140:143], a[168:171], v[44:47], v[140:143]
  s_add_u32 m0, s47, 4096
  s_add_u32 s51, s39, 512
  buffer_load_dwordx4 v11, s[8:11], s51 offen lds
  v_mfma_f32_16x16x32_bf16 v[148:151], a[168:171], v[52:55], v[148:151]
  ds_read_b64_tr_b16 a[204:205], v25 offset:16392
  v_mfma_f32_16x16x32_bf16 v[156:159], a[168:171], v[60:63], v[156:159]
  v_mfma_f32_16x16x32_bf16 v[164:167], a[168:171], v[68:71], v[164:167]
  ds_read_b64_tr_b16 a[206:207], v25 offset:17416
  v_mfma_f32_16x16x32_bf16 v[136:139], a[172:175], v[36:39], v[136:139]
  v_mfma_f32_16x16x32_bf16 v[144:147], a[172:175], v[44:47], v[144:147]
  ds_read_b64_tr_b16 a[208:209], v26 offset:16384
  s_add_u32 m0, s79, 8192
  s_add_u32 s51, s36, 1835008
  buffer_load_dwordx4 v7, s[20:23], s51 offen offset:0 lds
  v_mfma_f32_16x16x32_bf16 v[152:155], a[172:175], v[52:55], v[152:155]
  v_mfma_f32_16x16x32_bf16 v[160:163], a[172:175], v[60:63], v[160:163]
  ds_read_b64_tr_b16 a[210:211], v26 offset:17408
  v_mfma_f32_16x16x32_bf16 v[168:171], a[172:175], v[68:71], v[168:171]
  v_mfma_f32_16x16x32_bf16 v[172:175], a[176:179], v[36:39], v[172:175]
  ds_read_b64_tr_b16 a[212:213], v26 offset:16392
  v_mfma_f32_16x16x32_bf16 v[180:183], a[176:179], v[44:47], v[180:183]
  buffer_load_dwordx4 v8, s[20:23], s51 offen offset:1024 lds
  v_mfma_f32_16x16x32_bf16 v[188:191], a[176:179], v[52:55], v[188:191]
  ds_read_b64_tr_b16 a[214:215], v26 offset:17416
  v_mfma_f32_16x16x32_bf16 v[196:199], a[176:179], v[60:63], v[196:199]
  v_mfma_f32_16x16x32_bf16 v[204:207], a[176:179], v[68:71], v[204:207]
  ds_read_b64_tr_b16 a[216:217], v27 offset:16384
  v_mfma_f32_16x16x32_bf16 v[176:179], a[180:183], v[36:39], v[176:179]
  v_mfma_f32_16x16x32_bf16 v[184:187], a[180:183], v[44:47], v[184:187]
  ds_read_b64_tr_b16 a[218:219], v27 offset:17408
  buffer_load_dwordx4 v9, s[20:23], s51 offen offset:2048 lds
  v_mfma_f32_16x16x32_bf16 v[192:195], a[180:183], v[52:55], v[192:195]
  v_mfma_f32_16x16x32_bf16 v[200:203], a[180:183], v[60:63], v[200:203]
  ds_read_b64_tr_b16 a[220:221], v27 offset:16392
  v_mfma_f32_16x16x32_bf16 v[208:211], a[180:183], v[68:71], v[208:211]
  v_mfma_f32_16x16x32_bf16 v[212:215], a[184:187], v[36:39], v[212:215]
  ds_read_b64_tr_b16 a[222:223], v27 offset:17416
  v_mfma_f32_16x16x32_bf16 v[220:223], a[184:187], v[44:47], v[220:223]
  buffer_load_dwordx4 v10, s[20:23], s51 offen offset:3072 lds
  v_mfma_f32_16x16x32_bf16 v[228:231], a[184:187], v[52:55], v[228:231]
  v_mfma_f32_16x16x32_bf16 v[236:239], a[184:187], v[60:63], v[236:239]
  v_mfma_f32_16x16x32_bf16 v[244:247], a[184:187], v[68:71], v[244:247]
  v_mfma_f32_16x16x32_bf16 v[216:219], a[188:191], v[36:39], v[216:219]
  v_mfma_f32_16x16x32_bf16 v[224:227], a[188:191], v[44:47], v[224:227]
  v_mfma_f32_16x16x32_bf16 v[232:235], a[188:191], v[52:55], v[232:235]
  v_mfma_f32_16x16x32_bf16 v[240:243], a[188:191], v[60:63], v[240:243]
  v_mfma_f32_16x16x32_bf16 v[248:251], a[188:191], v[68:71], v[248:251]
  s_waitcnt vmcnt(11) lgkmcnt(0)
  s_barrier
  v_mfma_f32_16x16x32_bf16 v[92:95], a[192:195], v[40:43], v[92:95]
  ds_read_b64_tr_b16 a[160:161], v24 offset:0
  v_mfma_f32_16x16x32_bf16 v[100:103], a[192:195], v[48:51], v[100:103]
  s_add_u32 m0, s47, 6144
  s_add_u32 s51, s40, 512
  buffer_load_dwordx4 v11, s[8:11], s51 offen lds
  v_mfma_f32_16x16x32_bf16 v[108:111], a[192:195], v[56:59], v[108:111]
  ds_read_b64_tr_b16 a[162:163], v24 offset:1024
  v_mfma_f32_16x16x32_bf16 v[116:119], a[192:195], v[64:67], v[116:119]
  ds_read_b128 a[0:3], v254 offset:0
  v_mfma_f32_16x16x32_bf16 v[124:127], a[192:195], v[72:75], v[124:127]
  ds_read_b64_tr_b16 a[164:165], v24 offset:8
  s_add_u32 m0, s47, 8192
  s_add_u32 s51, s41, 512
  buffer_load_dwordx4 v11, s[8:11], s51 offen lds
  v_mfma_f32_16x16x32_bf16 v[96:99], a[196:199], v[40:43], v[96:99]
  v_mfma_f32_16x16x32_bf16 v[104:107], a[196:199], v[48:51], v[104:107]
  ds_read_b128 a[8:11], v254 offset:2048
  ds_read_b64_tr_b16 a[166:167], v24 offset:1032
  v_mfma_f32_16x16x32_bf16 v[112:115], a[196:199], v[56:59], v[112:115]
  s_add_u32 m0, s79, 16384
  s_add_u32 s51, s36, 2097152
  buffer_load_dwordx4 v7, s[20:23], s51 offen offset:0 lds
  v_mfma_f32_16x16x32_bf16 v[120:123], a[196:199], v[64:67], v[120:123]
  ds_read_b64_tr_b16 a[168:169], v25 offset:0
  v_mfma_f32_16x16x32_bf16 v[128:131], a[196:199], v[72:75], v[128:131]
  ds_read_b128 a[16:19], v254 offset:4096
  v_mfma_f32_16x16x32_bf16 v[132:135], a[200:203], v[40:43], v[132:135]
  ds_read_b64_tr_b16 a[170:171], v25 offset:1024
  buffer_load_dwordx4 v8, s[20:23], s51 offen offset:1024 lds
  v_mfma_f32_16x16x32_bf16 v[140:143], a[200:203], v[48:51], v[140:143]
  v_mfma_f32_16x16x32_bf16 v[148:151], a[200:203], v[56:59], v[148:151]
  ds_read_b128 a[24:27], v254 offset:6144
  ds_read_b64_tr_b16 a[172:173], v25 offset:8
  v_mfma_f32_16x16x32_bf16 v[156:159], a[200:203], v[64:67], v[156:159]
  buffer_load_dwordx4 v9, s[20:23], s51 offen offset:2048 lds
  v_mfma_f32_16x16x32_bf16 v[164:167], a[200:203], v[72:75], v[164:167]
  ds_read_b64_tr_b16 a[174:175], v25 offset:1032
  v_mfma_f32_16x16x32_bf16 v[136:139], a[204:207], v[40:43], v[136:139]
  ds_read_b128 a[32:35], v254 offset:8192
  v_mfma_f32_16x16x32_bf16 v[144:147], a[204:207], v[48:51], v[144:147]
  ds_read_b64_tr_b16 a[176:177], v26 offset:0
  buffer_load_dwordx4 v10, s[20:23], s51 offen offset:3072 lds
  v_mfma_f32_16x16x32_bf16 v[152:155], a[204:207], v[56:59], v[152:155]
  v_mfma_f32_16x16x32_bf16 v[160:163], a[204:207], v[64:67], v[160:163]
  ds_read_b128 a[4:7], v255 offset:0
  ds_read_b64_tr_b16 a[178:179], v26 offset:1024
  v_mfma_f32_16x16x32_bf16 v[168:171], a[204:207], v[72:75], v[168:171]
  s_add_u32 m0, s79, 57344
  s_add_u32 s50, s82, 8192
  s_and_b32 s50, s50, 0x1ffff
  s_add_u32 s50, s50, s34
  buffer_load_dwordx4 v1, s[12:15], s50 offen offset:0 nt lds
  v_mfma_f32_16x16x32_bf16 v[172:175], a[208:211], v[40:43], v[172:175]
  ds_read_b64_tr_b16 a[180:181], v26 offset:8
  v_mfma_f32_16x16x32_bf16 v[180:183], a[208:211], v[48:51], v[180:183]
  ds_read_b128 a[12:15], v255 offset:2048
  v_mfma_f32_16x16x32_bf16 v[188:191], a[208:211], v[56:59], v[188:191]
  ds_read_b64_tr_b16 a[182:183], v26 offset:1032
  buffer_load_dwordx4 v2, s[12:15], s50 offen offset:1024 nt lds
  v_mfma_f32_16x16x32_bf16 v[196:199], a[208:211], v[64:67], v[196:199]
  v_mfma_f32_16x16x32_bf16 v[204:207], a[208:211], v[72:75], v[204:207]
  ds_read_b128 a[20:23], v255 offset:4096
  ds_read_b64_tr_b16 a[184:185], v27 offset:0
  v_mfma_f32_16x16x32_bf16 v[176:179], a[212:215], v[40:43], v[176:179]
  buffer_load_dwordx4 v3, s[12:15], s50 offen offset:2048 nt lds
  v_mfma_f32_16x16x32_bf16 v[184:187], a[212:215], v[48:51], v[184:187]
  ds_read_b64_tr_b16 a[186:187], v27 offset:1024
  v_mfma_f32_16x16x32_bf16 v[192:195], a[212:215], v[56:59], v[192:195]
  ds_read_b128 a[28:31], v255 offset:6144
  v_mfma_f32_16x16x32_bf16 v[200:203], a[212:215], v[64:67], v[200:203]
  ds_read_b64_tr_b16 a[188:189], v27 offset:8
  buffer_load_dwordx4 v4, s[12:15], s50 offen offset:3072 nt lds
  v_mfma_f32_16x16x32_bf16 v[208:211], a[212:215], v[72:75], v[208:211]
  v_mfma_f32_16x16x32_bf16 v[212:215], a[216:219], v[40:43], v[212:215]
  ds_read_b128 a[36:39], v255 offset:8192
  ds_read_b64_tr_b16 a[190:191], v27 offset:1032
  v_mfma_f32_16x16x32_bf16 v[220:223], a[216:219], v[48:51], v[220:223]
  v_mfma_f32_16x16x32_bf16 v[228:231], a[216:219], v[56:59], v[228:231]
  v_mfma_f32_16x16x32_bf16 v[236:239], a[216:219], v[64:67], v[236:239]
  v_mfma_f32_16x16x32_bf16 v[244:247], a[216:219], v[72:75], v[244:247]
  v_mfma_f32_16x16x32_bf16 v[216:219], a[220:223], v[40:43], v[216:219]
  v_mfma_f32_16x16x32_bf16 v[224:227], a[220:223], v[48:51], v[224:227]
  v_mfma_f32_16x16x32_bf16 v[232:235], a[220:223], v[56:59], v[232:235]
  v_mfma_f32_16x16x32_bf16 v[240:243], a[220:223], v[64:67], v[240:243]
  v_mfma_f32_16x16x32_bf16 v[248:251], a[220:223], v[72:75], v[248:251]
  s_waitcnt vmcnt(10) lgkmcnt(0)
  s_barrier
  v_mfma_f32_16x16x32_bf16 v[92:95], a[160:163], a[0:3], v[92:95]
  ds_read_b64_tr_b16 a[192:193], v24 offset:8192
  v_mfma_f32_16x16x32_bf16 v[100:103], a[160:163], a[8:11], v[100:103]
  s_add_u32 m0, s47, 81920
  s_add_u32 s51, s37, 640
  buffer_load_dwordx4 v11, s[8:11], s51 offen lds
  v_mfma_f32_16x16x32_bf16 v[108:111], a[160:163], a[16:19], v[108:111]
  ds_read_b64_tr_b16 a[194:195], v24 offset:9216
  v_mfma_f32_16x16x32_bf16 v[116:119], a[160:163], a[24:27], v[116:119]
  v_mfma_f32_16x16x32_bf16 v[124:127], a[160:163], a[32:35], v[124:127]
  ds_read_b64_tr_b16 a[196:197], v24 offset:8200
  v_mfma_f32_16x16x32_bf16 v[96:99], a[164:167], a[0:3], v[96:99]
  v_mfma_f32_16x16x32_bf16 v[104:107], a[164:167], a[8:11], v[104:107]
  ds_read_b64_tr_b16 a[198:199], v24 offset:9224
  s_add_u32 m0, s47, 83968
  s_add_u32 s51, s38, 640
  buffer_load_dwordx4 v11, s[8:11], s51 offen lds
  v_mfma_f32_16x16x32_bf16 v[112:115], a[164:167], a[16:19], v[112:115]
  v_mfma_f32_16x16x32_bf16 v[120:123], a[164:167], a[24:27], v[120:123]
  ds_read_b64_tr_b16 a[200:201], v25 offset:8192
  v_mfma_f32_16x16x32_bf16 v[128:131], a[164:167], a[32:35], v[128:131]
  v_mfma_f32_16x16x32_bf16 v[132:135], a[168:171], a[0:3], v[132:135]
  ds_read_b64_tr_b16 a[202:203], v25 offset:9216
  v_mfma_f32_16x16x32_bf16 v[140:143], a[168:171], a[8:11], v[140:143]
  s_add_u32 m0, s47, 86016
  s_add_u32 s51, s39, 640
  buffer_load_dwordx4 v11, s[8:11], s51 offen lds
  v_mfma_f32_16x16x32_bf16 v[148:151], a[168:171], a[16:19], v[148:151]
  ds_read_b64_tr_b16 a[204:205], v25 offset:8200
  v_mfma_f32_16x16x32_bf16 v[156:159], a[168:171], a[24:27], v[156:159]
  v_mfma_f32_16x16x32_bf16 v[164:167], a[168:171], a[32:35], v[164:167]
  ds_read_b64_tr_b16 a[206:207], v25 offset:9224
  v_mfma_f32_16x16x32_bf16 v[136:139], a[172:175], a[0:3], v[136:139]
  v_mfma_f32_16x16x32_bf16 v[144:147], a[172:175], a[8:11], v[144:147]
  ds_read_b64_tr_b16 a[208:209], v26 offset:8192
  s_add_u32 m0, s79, 0
  s_add_u32 s51, s36, 2359296
  buffer_load_dwordx4 v7, s[20:23], s51 offen offset:0 lds
  v_mfma_f32_16x16x32_bf16 v[152:155], a[172:175], a[16:19], v[152:155]
  v_mfma_f32_16x16x32_bf16 v[160:163], a[172:175], a[24:27], v[160:163]
  ds_read_b64_tr_b16 a[210:211], v26 offset:9216
  v_mfma_f32_16x16x32_bf16 v[168:171], a[172:175], a[32:35], v[168:171]
  v_mfma_f32_16x16x32_bf16 v[172:175], a[176:179], a[0:3], v[172:175]
  ds_read_b64_tr_b16 a[212:213], v26 offset:8200
  v_mfma_f32_16x16x32_bf16 v[180:183], a[176:179], a[8:11], v[180:183]
  buffer_load_dwordx4 v8, s[20:23], s51 offen offset:1024 lds
  v_mfma_f32_16x16x32_bf16 v[188:191], a[176:179], a[16:19], v[188:191]
  ds_read_b64_tr_b16 a[214:215], v26 offset:9224
  v_mfma_f32_16x16x32_bf16 v[196:199], a[176:179], a[24:27], v[196:199]
  v_mfma_f32_16x16x32_bf16 v[204:207], a[176:179], a[32:35], v[204:207]
  ds_read_b64_tr_b16 a[216:217], v27 offset:8192
  v_mfma_f32_16x16x32_bf16 v[176:179], a[180:183], a[0:3], v[176:179]
  v_mfma_f32_16x16x32_bf16 v[184:187], a[180:183], a[8:11], v[184:187]
  ds_read_b64_tr_b16 a[218:219], v27 offset:9216
  buffer_load_dwordx4 v9, s[20:23], s51 offen offset:2048 lds
  v_mfma_f32_16x16x32_bf16 v[192:195], a[180:183], a[16:19], v[192:195]
  v_mfma_f32_16x16x32_bf16 v[200:203], a[180:183], a[24:27], v[200:203]
  ds_read_b64_tr_b16 a[220:221], v27 offset:8200
  v_mfma_f32_16x16x32_bf16 v[208:211], a[180:183], a[32:35], v[208:211]
  v_mfma_f32_16x16x32_bf16 v[212:215], a[184:187], a[0:3], v[212:215]
  ds_read_b64_tr_b16 a[222:223], v27 offset:9224
  v_mfma_f32_16x16x32_bf16 v[220:223], a[184:187], a[8:11], v[220:223]
  buffer_load_dwordx4 v10, s[20:23], s51 offen offset:3072 lds
  v_mfma_f32_16x16x32_bf16 v[228:231], a[184:187], a[16:19], v[228:231]
  v_mfma_f32_16x16x32_bf16 v[236:239], a[184:187], a[24:27], v[236:239]
  v_mfma_f32_16x16x32_bf16 v[244:247], a[184:187], a[32:35], v[244:247]
  v_mfma_f32_16x16x32_bf16 v[216:219], a[188:191], a[0:3], v[216:219]
  v_mfma_f32_16x16x32_bf16 v[224:227], a[188:191], a[8:11], v[224:227]
  v_mfma_f32_16x16x32_bf16 v[232:235], a[188:191], a[16:19], v[232:235]
  v_mfma_f32_16x16x32_bf16 v[240:243], a[188:191], a[24:27], v[240:243]
  v_mfma_f32_16x16x32_bf16 v[248:251], a[188:191], a[32:35], v[248:251]
  s_waitcnt vmcnt(11) lgkmcnt(0)
  s_barrier
  v_mfma_f32_16x16x32_bf16 v[92:95], a[192:195], a[4:7], v[92:95]
  ds_read_b64_tr_b16 a[160:161], v24 offset:16384
  v_mfma_f32_16x16x32_bf16 v[100:103], a[192:195], a[12:15], v[100:103]
  s_add_u32 m0, s47, 88064
  s_add_u32 s51, s40, 640
  buffer_load_dwordx4 v11, s[8:11], s51 offen lds
  v_mfma_f32_16x16x32_bf16 v[108:111], a[192:195], a[20:23], v[108:111]
  ds_read_b64_tr_b16 a[162:163], v24 offset:17408
  v_mfma_f32_16x16x32_bf16 v[116:119], a[192:195], a[28:31], v[116:119]
  ds_read_b128 v[36:39], v252 offset:0
  v_mfma_f32_16x16x32_bf16 v[124:127], a[192:195], a[36:39], v[124:127]
  ds_read_b64_tr_b16 a[164:165], v24 offset:16392
  s_add_u32 m0, s47, 90112
  s_add_u32 s51, s41, 640
  buffer_load_dwordx4 v11, s[8:11], s51 offen lds
  v_mfma_f32_16x16x32_bf16 v[96:99], a[196:199], a[4:7], v[96:99]
  v_mfma_f32_16x16x32_bf16 v[104:107], a[196:199], a[12:15], v[104:107]
  ds_read_b128 v[44:47], v252 offset:2048
  ds_read_b64_tr_b16 a[166:167], v24 offset:17416
  v_mfma_f32_16x16x32_bf16 v[112:115], a[196:199], a[20:23], v[112:115]
  s_add_u32 m0, s79, 8192
  s_add_u32 s51, s36, 2621440
  buffer_load_dwordx4 v7, s[20:23], s51 offen offset:0 lds
  v_mfma_f32_16x16x32_bf16 v[120:123], a[196:199], a[28:31], v[120:123]
  ds_read_b64_tr_b16 a[168:169], v25 offset:16384
  v_mfma_f32_16x16x32_bf16 v[128:131], a[196:199], a[36:39], v[128:131]
  ds_read_b128 v[52:55], v252 offset:4096
  v_mfma_f32_16x16x32_bf16 v[132:135], a[200:203], a[4:7], v[132:135]
  ds_read_b64_tr_b16 a[170:171], v25 offset:17408
  buffer_load_dwordx4 v8, s[20:23], s51 offen offset:1024 lds
  v_mfma_f32_16x16x32_bf16 v[140:143], a[200:203], a[12:15], v[140:143]
  v_mfma_f32_16x16x32_bf16 v[148:151], a[200:203], a[20:23], v[148:151]
  ds_read_b128 v[60:63], v252 offset:6144
  ds_read_b64_tr_b16 a[172:173], v25 offset:16392
  v_mfma_f32_16x16x32_bf16 v[156:159], a[200:203], a[28:31], v[156:159]
  buffer_load_dwordx4 v9, s[20:23], s51 offen offset:2048 lds
  v_mfma_f32_16x16x32_bf16 v[164:167], a[200:203], a[36:39], v[164:167]
  ds_read_b64_tr_b16 a[174:175], v25 offset:17416
  v_mfma_f32_16x16x32_bf16 v[136:139], a[204:207], a[4:7], v[136:139]
  ds_read_b128 v[68:71], v252 offset:8192
  v_mfma_f32_16x16x32_bf16 v[144:147], a[204:207], a[12:15], v[144:147]
  ds_read_b64_tr_b16 a[176:177], v26 offset:16384
  buffer_load_dwordx4 v10, s[20:23], s51 offen offset:3072 lds
  v_mfma_f32_16x16x32_bf16 v[152:155], a[204:207], a[20:23], v[152:155]
  v_mfma_f32_16x16x32_bf16 v[160:163], a[204:207], a[28:31], v[160:163]
  ds_read_b128 v[40:43], v253 offset:0
  ds_read_b64_tr_b16 a[178:179], v26 offset:17408
  v_mfma_f32_16x16x32_bf16 v[168:171], a[204:207], a[36:39], v[168:171]
  s_add_u32 m0, s79, 65536
  s_add_u32 s50, s82, 16384
  s_and_b32 s50, s50, 0x1ffff
  s_add_u32 s50, s50, s34
  buffer_load_dwordx4 v1, s[12:15], s50 offen offset:0 nt lds
  v_mfma_f32_16x16x32_bf16 v[172:175], a[208:211], a[4:7], v[172:175]
  ds_read_b64_tr_b16 a[180:181], v26 offset:16392
  v_mfma_f32_16x16x32_bf16 v[180:183], a[208:211], a[12:15], v[180:183]
  ds_read_b128 v[48:51], v253 offset:2048
  v_mfma_f32_16x16x32_bf16 v[188:191], a[208:211], a[20:23], v[188:191]
  ds_read_b64_tr_b16 a[182:183], v26 offset:17416
  buffer_load_dwordx4 v2, s[12:15], s50 offen offset:1024 nt lds
  v_mfma_f32_16x16x32_bf16 v[196:199], a[208:211], a[28:31], v[196:199]
  v_mfma_f32_16x16x32_bf16 v[204:207], a[208:211], a[36:39], v[204:207]
  ds_read_b128 v[56:59], v253 offset:4096
  ds_read_b64_tr_b16 a[184:185], v27 offset:16384
  v_mfma_f32_16x16x32_bf16 v[176:179], a[212:215], a[4:7], v[176:179]
  buffer_load_dwordx4 v3, s[12:15], s50 offen offset:2048 nt lds
  v_mfma_f32_16x16x32_bf16 v[184:187], a[212:215], a[12:15], v[184:187]
  ds_read_b64_tr_b16 a[186:187], v27 offset:17408
  v_mfma_f32_16x16x32_bf16 v[192:195], a[212:215], a[20:23], v[192:195]
  ds_read_b128 v[64:67], v253 offset:6144
  v_mfma_f32_16x16x32_bf16 v[200:203], a[212:215], a[28:31], v[200:203]
  ds_read_b64_tr_b16 a[188:189], v27 offset:16392
  buffer_load_dwordx4 v4, s[12:15], s50 offen offset:3072 nt lds
  v_mfma_f32_16x16x32_bf16 v[208:211], a[212:215], a[36:39], v[208:211]
  v_mfma_f32_16x16x32_bf16 v[212:215], a[216:219], a[4:7], v[212:215]
  ds_read_b128 v[72:75], v253 offset:8192
  ds_read_b64_tr_b16 a[190:191], v27 offset:17416
  v_mfma_f32_16x16x32_bf16 v[220:223], a[216:219], a[12:15], v[220:223]
  v_mfma_f32_16x16x32_bf16 v[228:231], a[216:219], a[20:23], v[228:231]
  v_mfma_f32_16x16x32_bf16 v[236:239], a[216:219], a[28:31], v[236:239]
  v_mfma_f32_16x16x32_bf16 v[244:247], a[216:219], a[36:39], v[244:247]
  v_mfma_f32_16x16x32_bf16 v[216:219], a[220:223], a[4:7], v[216:219]
  v_mfma_f32_16x16x32_bf16 v[224:227], a[220:223], a[12:15], v[224:227]
  v_mfma_f32_16x16x32_bf16 v[232:235], a[220:223], a[20:23], v[232:235]
  v_mfma_f32_16x16x32_bf16 v[240:243], a[220:223], a[28:31], v[240:243]
  v_mfma_f32_16x16x32_bf16 v[248:251], a[220:223], a[36:39], v[248:251]
  s_waitcnt vmcnt(10) lgkmcnt(0)
  s_barrier
  v_mfma_f32_16x16x32_bf16 v[92:95], a[160:163], v[36:39], v[92:95]
  ds_read_b64_tr_b16 a[192:193], v24 offset:0
  v_mfma_f32_16x16x32_bf16 v[100:103], a[160:163], v[44:47], v[100:103]
  s_add_u32 m0, s47, 0
  s_add_u32 s51, s37, 768
  buffer_load_dwordx4 v11, s[8:11], s51 offen lds
  v_mfma_f32_16x16x32_bf16 v[108:111], a[160:163], v[52:55], v[108:111]
  ds_read_b64_tr_b16 a[194:195], v24 offset:1024
  v_mfma_f32_16x16x32_bf16 v[116:119], a[160:163], v[60:63], v[116:119]
  v_mfma_f32_16x16x32_bf16 v[124:127], a[160:163], v[68:71], v[124:127]
  ds_read_b64_tr_b16 a[196:197], v24 offset:8
  v_mfma_f32_16x16x32_bf16 v[96:99], a[164:167], v[36:39], v[96:99]
  v_mfma_f32_16x16x32_bf16 v[104:107], a[164:167], v[44:47], v[104:107]
  ds_read_b64_tr_b16 a[198:199], v24 offset:1032
  s_add_u32 m0, s47, 2048
  s_add_u32 s51, s38, 768
  buffer_load_dwordx4 v11, s[8:11], s51 offen lds
  v_mfma_f32_16x16x32_bf16 v[112:115], a[164:167], v[52:55], v[112:115]
  v_mfma_f32_16x16x32_bf16 v[120:123], a[164:167], v[60:63], v[120:123]
  ds_read_b64_tr_b16 a[200:201], v25 offset:0
  v_mfma_f32_16x16x32_bf16 v[128:131], a[164:167], v[68:71], v[128:131]
  v_mfma_f32_16x16x32_bf16 v[132:135], a[168:171], v[36:39], v[132:135]
  ds_read_b64_tr_b16 a[202:203], v25 offset:1024
  v_mfma_f32_16x16x32_bf16 v[140:143], a[168:171], v[44:47], v[140:143]
  s_add_u32 m0, s47, 4096
  s_add_u32 s51, s39, 768
  buffer_load_dwordx4 v11, s[8:11], s51 offen lds
  v_mfma_f32_16x16x32_bf16 v[148:151], a[168:171], v[52:55], v[148:151]
  ds_read_b64_tr_b16 a[204:205], v25 offset:8
  v_mfma_f32_16x16x32_bf16 v[156:159], a[168:171], v[60:63], v[156:159]
  v_mfma_f32_16x16x32_bf16 v[164:167], a[168:171], v[68:71], v[164:167]
  ds_read_b64_tr_b16 a[206:207], v25 offset:1032
  v_mfma_f32_16x16x32_bf16 v[136:139], a[172:175], v[36:39], v[136:139]
  v_mfma_f32_16x16x32_bf16 v[144:147], a[172:175], v[44:47], v[144:147]
  ds_read_b64_tr_b16 a[208:209], v26 offset:0
  s_add_u32 m0, s79, 16384
  s_add_u32 s51, s36, 2883584
  buffer_load_dwordx4 v7, s[20:23], s51 offen offset:0 lds
  v_mfma_f32_16x16x32_bf16 v[152:155], a[172:175], v[52:55], v[152:155]
  v_mfma_f32_16x16x32_bf16 v[160:163], a[172:175], v[60:63], v[160:163]
  ds_read_b64_tr_b16 a[210:211], v26 offset:1024
  v_mfma_f32_16x16x32_bf16 v[168:171], a[172:175], v[68:71], v[168:171]
  v_mfma_f32_16x16x32_bf16 v[172:175], a[176:179], v[36:39], v[172:175]
  ds_read_b64_tr_b16 a[212:213], v26 offset:8
  v_mfma_f32_16x16x32_bf16 v[180:183], a[176:179], v[44:47], v[180:183]
  buffer_load_dwordx4 v8, s[20:23], s51 offen offset:1024 lds
  v_mfma_f32_16x16x32_bf16 v[188:191], a[176:179], v[52:55], v[188:191]
  ds_read_b64_tr_b16 a[214:215], v26 offset:1032
  v_mfma_f32_16x16x32_bf16 v[196:199], a[176:179], v[60:63], v[196:199]
  v_mfma_f32_16x16x32_bf16 v[204:207], a[176:179], v[68:71], v[204:207]
  ds_read_b64_tr_b16 a[216:217], v27 offset:0
  v_mfma_f32_16x16x32_bf16 v[176:179], a[180:183], v[36:39], v[176:179]
  v_mfma_f32_16x16x32_bf16 v[184:187], a[180:183], v[44:47], v[184:187]
  ds_read_b64_tr_b16 a[218:219], v27 offset:1024
  buffer_load_dwordx4 v9, s[20:23], s51 offen offset:2048 lds
  v_mfma_f32_16x16x32_bf16 v[192:195], a[180:183], v[52:55], v[192:195]
  v_mfma_f32_16x16x32_bf16 v[200:203], a[180:183], v[60:63], v[200:203]
  ds_read_b64_tr_b16 a[220:221], v27 offset:8
  v_mfma_f32_16x16x32_bf16 v[208:211], a[180:183], v[68:71], v[208:211]
  v_mfma_f32_16x16x32_bf16 v[212:215], a[184:187], v[36:39], v[212:215]
  ds_read_b64_tr_b16 a[222:223], v27 offset:1032
  v_mfma_f32_16x16x32_bf16 v[220:223], a[184:187], v[44:47], v[220:223]
  buffer_load_dwordx4 v10, s[20:23], s51 offen offset:3072 lds
  v_mfma_f32_16x16x32_bf16 v[228:231], a[184:187], v[52:55], v[228:231]
  v_mfma_f32_16x16x32_bf16 v[236:239], a[184:187], v[60:63], v[236:239]
  v_mfma_f32_16x16x32_bf16 v[244:247], a[184:187], v[68:71], v[244:247]
  v_mfma_f32_16x16x32_bf16 v[216:219], a[188:191], v[36:39], v[216:219]
  v_mfma_f32_16x16x32_bf16 v[224:227], a[188:191], v[44:47], v[224:227]
  v_mfma_f32_16x16x32_bf16 v[232:235], a[188:191], v[52:55], v[232:235]
  v_mfma_f32_16x16x32_bf16 v[240:243], a[188:191], v[60:63], v[240:243]
  v_mfma_f32_16x16x32_bf16 v[248:251], a[188:191], v[68:71], v[248:251]
  s_waitcnt vmcnt(11) lgkmcnt(0)
  s_barrier
  v_mfma_f32_16x16x32_bf16 v[92:95], a[192:195], v[40:43], v[92:95]
  ds_read_b64_tr_b16 a[160:161], v24 offset:8192
  v_mfma_f32_16x16x32_bf16 v[100:103], a[192:195], v[48:51], v[100:103]
  s_add_u32 m0, s47, 6144
  s_add_u32 s51, s40, 768
  buffer_load_dwordx4 v11, s[8:11], s51 offen lds
  v_mfma_f32_16x16x32_bf16 v[108:111], a[192:195], v[56:59], v[108:111]
  ds_read_b64_tr_b16 a[162:163], v24 offset:9216
  v_mfma_f32_16x16x32_bf16 v[116:119], a[192:195], v[64:67], v[116:119]
  ds_read_b128 a[0:3], v254 offset:0
  v_mfma_f32_16x16x32_bf16 v[124:127], a[192:195], v[72:75], v[124:127]
  ds_read_b64_tr_b16 a[164:165], v24 offset:8200
  s_add_u32 m0, s47, 8192
  s_add_u32 s51, s41, 768
  buffer_load_dwordx4 v11, s[8:11], s51 offen lds
  v_mfma_f32_16x16x32_bf16 v[96:99], a[196:199], v[40:43], v[96:99]
  v_mfma_f32_16x16x32_bf16 v[104:107], a[196:199], v[48:51], v[104:107]
  ds_read_b128 a[8:11], v254 offset:2048
  ds_read_b64_tr_b16 a[166:167], v24 offset:9224
  v_mfma_f32_16x16x32_bf16 v[112:115], a[196:199], v[56:59], v[112:115]
  s_add_u32 m0, s79, 0
  s_add_u32 s51, s36, 3145728
  buffer_load_dwordx4 v7, s[20:23], s51 offen offset:0 lds
  v_mfma_f32_16x16x32_bf16 v[120:123], a[196:199], v[64:67], v[120:123]
  ds_read_b64_tr_b16 a[168:169], v25 offset:8192
  v_mfma_f32_16x16x32_bf16 v[128:131], a[196:199], v[72:75], v[128:131]
  ds_read_b128 a[16:19], v254 offset:4096
  v_mfma_f32_16x16x32_bf16 v[132:135], a[200:203], v[40:43], v[132:135]
  ds_read_b64_tr_b16 a[170:171], v25 offset:9216
  buffer_load_dwordx4 v8, s[20:23], s51 offen offset:1024 lds
  v_mfma_f32_16x16x32_bf16 v[140:143], a[200:203], v[48:51], v[140:143]
  v_mfma_f32_16x16x32_bf16 v[148:151], a[200:203], v[56:59], v[148:151]
  ds_read_b128 a[24:27], v254 offset:6144
  ds_read_b64_tr_b16 a[172:173], v25 offset:8200
  v_mfma_f32_16x16x32_bf16 v[156:159], a[200:203], v[64:67], v[156:159]
  buffer_load_dwordx4 v9, s[20:23], s51 offen offset:2048 lds
  v_mfma_f32_16x16x32_bf16 v[164:167], a[200:203], v[72:75], v[164:167]
  ds_read_b64_tr_b16 a[174:175], v25 offset:9224
  v_mfma_f32_16x16x32_bf16 v[136:139], a[204:207], v[40:43], v[136:139]
  ds_read_b128 a[32:35], v254 offset:8192
  v_mfma_f32_16x16x32_bf16 v[144:147], a[204:207], v[48:51], v[144:147]
  ds_read_b64_tr_b16 a[176:177], v26 offset:8192
  buffer_load_dwordx4 v10, s[20:23], s51 offen offset:3072 lds
  v_mfma_f32_16x16x32_bf16 v[152:155], a[204:207], v[56:59], v[152:155]
  v_mfma_f32_16x16x32_bf16 v[160:163], a[204:207], v[64:67], v[160:163]
  ds_read_b128 a[4:7], v255 offset:0
  ds_read_b64_tr_b16 a[178:179], v26 offset:9216
  v_mfma_f32_16x16x32_bf16 v[168:171], a[204:207], v[72:75], v[168:171]
  s_add_u32 m0, s79, 73728
  s_add_u32 s50, s82, 24576
  s_and_b32 s50, s50, 0x1ffff
  s_add_u32 s50, s50, s34
  buffer_load_dwordx4 v1, s[12:15], s50 offen offset:0 nt lds
  v_mfma_f32_16x16x32_bf16 v[172:175], a[208:211], v[40:43], v[172:175]
  ds_read_b64_tr_b16 a[180:181], v26 offset:8200
  v_mfma_f32_16x16x32_bf16 v[180:183], a[208:211], v[48:51], v[180:183]
  ds_read_b128 a[12:15], v255 offset:2048
  v_mfma_f32_16x16x32_bf16 v[188:191], a[208:211], v[56:59], v[188:191]
  ds_read_b64_tr_b16 a[182:183], v26 offset:9224
  buffer_load_dwordx4 v2, s[12:15], s50 offen offset:1024 nt lds
  v_mfma_f32_16x16x32_bf16 v[196:199], a[208:211], v[64:67], v[196:199]
  v_mfma_f32_16x16x32_bf16 v[204:207], a[208:211], v[72:75], v[204:207]
  ds_read_b128 a[20:23], v255 offset:4096
  ds_read_b64_tr_b16 a[184:185], v27 offset:8192
  v_mfma_f32_16x16x32_bf16 v[176:179], a[212:215], v[40:43], v[176:179]
  buffer_load_dwordx4 v3, s[12:15], s50 offen offset:2048 nt lds
  v_mfma_f32_16x16x32_bf16 v[184:187], a[212:215], v[48:51], v[184:187]
  ds_read_b64_tr_b16 a[186:187], v27 offset:9216
  v_mfma_f32_16x16x32_bf16 v[192:195], a[212:215], v[56:59], v[192:195]
  ds_read_b128 a[28:31], v255 offset:6144
  v_mfma_f32_16x16x32_bf16 v[200:203], a[212:215], v[64:67], v[200:203]
  ds_read_b64_tr_b16 a[188:189], v27 offset:8200
  buffer_load_dwordx4 v4, s[12:15], s50 offen offset:3072 nt lds
  v_mfma_f32_16x16x32_bf16 v[208:211], a[212:215], v[72:75], v[208:211]
  v_mfma_f32_16x16x32_bf16 v[212:215], a[216:219], v[40:43], v[212:215]
  ds_read_b128 a[36:39], v255 offset:8192
  ds_read_b64_tr_b16 a[190:191], v27 offset:9224
  v_mfma_f32_16x16x32_bf16 v[220:223], a[216:219], v[48:51], v[220:223]
  v_mfma_f32_16x16x32_bf16 v[228:231], a[216:219], v[56:59], v[228:231]
  v_mfma_f32_16x16x32_bf16 v[236:239], a[216:219], v[64:67], v[236:239]
  v_mfma_f32_16x16x32_bf16 v[244:247], a[216:219], v[72:75], v[244:247]
  v_mfma_f32_16x16x32_bf16 v[216:219], a[220:223], v[40:43], v[216:219]
  v_mfma_f32_16x16x32_bf16 v[224:227], a[220:223], v[48:51], v[224:227]
  v_mfma_f32_16x16x32_bf16 v[232:235], a[220:223], v[56:59], v[232:235]
  v_mfma_f32_16x16x32_bf16 v[240:243], a[220:223], v[64:67], v[240:243]
  v_mfma_f32_16x16x32_bf16 v[248:251], a[220:223], v[72:75], v[248:251]
  s_waitcnt vmcnt(10) lgkmcnt(0)
  s_barrier
  v_mfma_f32_16x16x32_bf16 v[92:95], a[160:163], a[0:3], v[92:95]
  ds_read_b64_tr_b16 a[192:193], v24 offset:16384
  v_mfma_f32_16x16x32_bf16 v[100:103], a[160:163], a[8:11], v[100:103]
  s_add_u32 m0, s47, 81920
  s_add_u32 s51, s37, 896
  buffer_load_dwordx4 v11, s[8:11], s51 offen lds
  v_mfma_f32_16x16x32_bf16 v[108:111], a[160:163], a[16:19], v[108:111]
  ds_read_b64_tr_b16 a[194:195], v24 offset:17408
  v_mfma_f32_16x16x32_bf16 v[116:119], a[160:163], a[24:27], v[116:119]
  v_mfma_f32_16x16x32_bf16 v[124:127], a[160:163], a[32:35], v[124:127]
  ds_read_b64_tr_b16 a[196:197], v24 offset:16392
  v_mfma_f32_16x16x32_bf16 v[96:99], a[164:167], a[0:3], v[96:99]
  v_mfma_f32_16x16x32_bf16 v[104:107], a[164:167], a[8:11], v[104:107]
  ds_read_b64_tr_b16 a[198:199], v24 offset:17416
  s_add_u32 m0, s47, 83968
  s_add_u32 s51, s38, 896
  buffer_load_dwordx4 v11, s[8:11], s51 offen lds
  v_mfma_f32_16x16x32_bf16 v[112:115], a[164:167], a[16:19], v[112:115]
  v_mfma_f32_16x16x32_bf16 v[120:123], a[164:167], a[24:27], v[120:123]
  ds_read_b64_tr_b16 a[200:201], v25 offset:16384
  v_mfma_f32_16x16x32_bf16 v[128:131], a[164:167], a[32:35], v[128:131]
  v_mfma_f32_16x16x32_bf16 v[132:135], a[168:171], a[0:3], v[132:135]
  ds_read_b64_tr_b16 a[202:203], v25 offset:17408
  v_mfma_f32_16x16x32_bf16 v[140:143], a[168:171], a[8:11], v[140:143]
  s_add_u32 m0, s47, 86016
  s_add_u32 s51, s39, 896
  buffer_load_dwordx4 v11, s[8:11], s51 offen lds
  v_mfma_f32_16x16x32_bf16 v[148:151], a[168:171], a[16:19], v[148:151]
  ds_read_b64_tr_b16 a[204:205], v25 offset:16392
  v_mfma_f32_16x16x32_bf16 v[156:159], a[168:171], a[24:27], v[156:159]
  v_mfma_f32_16x16x32_bf16 v[164:167], a[168:171], a[32:35], v[164:167]
  ds_read_b64_tr_b16 a[206:207], v25 offset:17416
  v_mfma_f32_16x16x32_bf16 v[136:139], a[172:175], a[0:3], v[136:139]
  v_mfma_f32_16x16x32_bf16 v[144:147], a[172:175], a[8:11], v[144:147]
  ds_read_b64_tr_b16 a[208:209], v26 offset:16384
  s_add_u32 m0, s79, 8192
  s_add_u32 s51, s36, 3407872
  buffer_load_dwordx4 v7, s[20:23], s51 offen offset:0 lds
  v_mfma_f32_16x16x32_bf16 v[152:155], a[172:175], a[16:19], v[152:155]
  v_mfma_f32_16x16x32_bf16 v[160:163], a[172:175], a[24:27], v[160:163]
  ds_read_b64_tr_b16 a[210:211], v26 offset:17408
  v_mfma_f32_16x16x32_bf16 v[168:171], a[172:175], a[32:35], v[168:171]
  v_mfma_f32_16x16x32_bf16 v[172:175], a[176:179], a[0:3], v[172:175]
  ds_read_b64_tr_b16 a[212:213], v26 offset:16392
  v_mfma_f32_16x16x32_bf16 v[180:183], a[176:179], a[8:11], v[180:183]
  buffer_load_dwordx4 v8, s[20:23], s51 offen offset:1024 lds
  v_mfma_f32_16x16x32_bf16 v[188:191], a[176:179], a[16:19], v[188:191]
  ds_read_b64_tr_b16 a[214:215], v26 offset:17416
  v_mfma_f32_16x16x32_bf16 v[196:199], a[176:179], a[24:27], v[196:199]
  v_mfma_f32_16x16x32_bf16 v[204:207], a[176:179], a[32:35], v[204:207]
  ds_read_b64_tr_b16 a[216:217], v27 offset:16384
  v_mfma_f32_16x16x32_bf16 v[176:179], a[180:183], a[0:3], v[176:179]
  v_mfma_f32_16x16x32_bf16 v[184:187], a[180:183], a[8:11], v[184:187]
  ds_read_b64_tr_b16 a[218:219], v27 offset:17408
  buffer_load_dwordx4 v9, s[20:23], s51 offen offset:2048 lds
  v_mfma_f32_16x16x32_bf16 v[192:195], a[180:183], a[16:19], v[192:195]
  v_mfma_f32_16x16x32_bf16 v[200:203], a[180:183], a[24:27], v[200:203]
  ds_read_b64_tr_b16 a[220:221], v27 offset:16392
  v_mfma_f32_16x16x32_bf16 v[208:211], a[180:183], a[32:35], v[208:211]
  v_mfma_f32_16x16x32_bf16 v[212:215], a[184:187], a[0:3], v[212:215]
  ds_read_b64_tr_b16 a[222:223], v27 offset:17416
  v_mfma_f32_16x16x32_bf16 v[220:223], a[184:187], a[8:11], v[220:223]
  buffer_load_dwordx4 v10, s[20:23], s51 offen offset:3072 lds
  v_mfma_f32_16x16x32_bf16 v[228:231], a[184:187], a[16:19], v[228:231]
  v_mfma_f32_16x16x32_bf16 v[236:239], a[184:187], a[24:27], v[236:239]
  v_mfma_f32_16x16x32_bf16 v[244:247], a[184:187], a[32:35], v[244:247]
  v_mfma_f32_16x16x32_bf16 v[216:219], a[188:191], a[0:3], v[216:219]
  v_mfma_f32_16x16x32_bf16 v[224:227], a[188:191], a[8:11], v[224:227]
  v_mfma_f32_16x16x32_bf16 v[232:235], a[188:191], a[16:19], v[232:235]
  v_mfma_f32_16x16x32_bf16 v[240:243], a[188:191], a[24:27], v[240:243]
  v_mfma_f32_16x16x32_bf16 v[248:251], a[188:191], a[32:35], v[248:251]
  s_waitcnt vmcnt(11) lgkmcnt(0)
  s_barrier
  v_mfma_f32_16x16x32_bf16 v[92:95], a[192:195], a[4:7], v[92:95]
  ds_read_b64_tr_b16 a[160:161], v24 offset:0
  v_mfma_f32_16x16x32_bf16 v[100:103], a[192:195], a[12:15], v[100:103]
  s_add_u32 m0, s47, 88064
  s_add_u32 s51, s40, 896
  buffer_load_dwordx4 v11, s[8:11], s51 offen lds
  v_mfma_f32_16x16x32_bf16 v[108:111], a[192:195], a[20:23], v[108:111]
  ds_read_b64_tr_b16 a[162:163], v24 offset:1024
  v_mfma_f32_16x16x32_bf16 v[116:119], a[192:195], a[28:31], v[116:119]
  ds_read_b128 v[36:39], v252 offset:0
  v_mfma_f32_16x16x32_bf16 v[124:127], a[192:195], a[36:39], v[124:127]
  ds_read_b64_tr_b16 a[164:165], v24 offset:8
  s_add_u32 m0, s47, 90112
  s_add_u32 s51, s41, 896
  buffer_load_dwordx4 v11, s[8:11], s51 offen lds
  v_mfma_f32_16x16x32_bf16 v[96:99], a[196:199], a[4:7], v[96:99]
  v_mfma_f32_16x16x32_bf16 v[104:107], a[196:199], a[12:15], v[104:107]
  ds_read_b128 v[44:47], v252 offset:2048
  ds_read_b64_tr_b16 a[166:167], v24 offset:1032
  v_mfma_f32_16x16x32_bf16 v[112:115], a[196:199], a[20:23], v[112:115]
  s_add_u32 m0, s79, 16384
  s_add_u32 s51, s36, 3670016
  buffer_load_dwordx4 v7, s[20:23], s51 offen offset:0 lds
  v_mfma_f32_16x16x32_bf16 v[120:123], a[196:199], a[28:31], v[120:123]
  ds_read_b64_tr_b16 a[168:169], v25 offset:0
  v_mfma_f32_16x16x32_bf16 v[128:131], a[196:199], a[36:39], v[128:131]
  ds_read_b128 v[52:55], v252 offset:4096
  v_mfma_f32_16x16x32_bf16 v[132:135], a[200:203], a[4:7], v[132:135]
  ds_read_b64_tr_b16 a[170:171], v25 offset:1024
  buffer_load_dwordx4 v8, s[20:23], s51 offen offset:1024 lds
  v_mfma_f32_16x16x32_bf16 v[140:143], a[200:203], a[12:15], v[140:143]
  v_mfma_f32_16x16x32_bf16 v[148:151], a[200:203], a[20:23], v[148:151]
  ds_read_b128 v[60:63], v252 offset:6144
  ds_read_b64_tr_b16 a[172:173], v25 offset:8
  v_mfma_f32_16x16x32_bf16 v[156:159], a[200:203], a[28:31], v[156:159]
  buffer_load_dwordx4 v9, s[20:23], s51 offen offset:2048 lds
  v_mfma_f32_16x16x32_bf16 v[164:167], a[200:203], a[36:39], v[164:167]
  ds_read_b64_tr_b16 a[174:175], v25 offset:1032
  v_mfma_f32_16x16x32_bf16 v[136:139], a[204:207], a[4:7], v[136:139]
  ds_read_b128 v[68:71], v252 offset:8192
  v_mfma_f32_16x16x32_bf16 v[144:147], a[204:207], a[12:15], v[144:147]
  ds_read_b64_tr_b16 a[176:177], v26 offset:0
  buffer_load_dwordx4 v10, s[20:23], s51 offen offset:3072 lds
  v_mfma_f32_16x16x32_bf16 v[152:155], a[204:207], a[20:23], v[152:155]
  v_mfma_f32_16x16x32_bf16 v[160:163], a[204:207], a[28:31], v[160:163]
  ds_read_b128 v[40:43], v253 offset:0
  ds_read_b64_tr_b16 a[178:179], v26 offset:1024
  v_mfma_f32_16x16x32_bf16 v[168:171], a[204:207], a[36:39], v[168:171]
  s_nop 0
  s_add_u32 s50, s82, 0
  s_and_b32 s50, s50, 0x1ffff
  s_add_u32 s50, s50, s34
  buffer_load_dwordx4 a[40:43], v5, s[16:19], s50 offen offset:0 nt
  v_mfma_f32_16x16x32_bf16 v[172:175], a[208:211], a[4:7], v[172:175]
  ds_read_b64_tr_b16 a[180:181], v26 offset:8
  v_mfma_f32_16x16x32_bf16 v[180:183], a[208:211], a[12:15], v[180:183]
  ds_read_b128 v[48:51], v253 offset:2048
  v_mfma_f32_16x16x32_bf16 v[188:191], a[208:211], a[20:23], v[188:191]
  ds_read_b64_tr_b16 a[182:183], v26 offset:1032
  buffer_load_dwordx4 a[44:47], v6, s[16:19], s50 offen offset:1024 nt
  v_mfma_f32_16x16x32_bf16 v[196:199], a[208:211], a[28:31], v[196:199]
  v_mfma_f32_16x16x32_bf16 v[204:207], a[208:211], a[36:39], v[204:207]
  ds_read_b128 v[56:59], v253 offset:4096
  ds_read_b64_tr_b16 a[184:185], v27 offset:0
  v_mfma_f32_16x16x32_bf16 v[176:179], a[212:215], a[4:7], v[176:179]
  buffer_load_dwordx4 a[48:51], v5, s[16:19], s50 offen offset:2048 nt
  v_mfma_f32_16x16x32_bf16 v[184:187], a[212:215], a[12:15], v[184:187]
  ds_read_b64_tr_b16 a[186:187], v27 offset:1024
  v_mfma_f32_16x16x32_bf16 v[192:195], a[212:215], a[20:23], v[192:195]
  ds_read_b128 v[64:67], v253 offset:6144
  v_mfma_f32_16x16x32_bf16 v[200:203], a[212:215], a[28:31], v[200:203]
  ds_read_b64_tr_b16 a[188:189], v27 offset:8
  buffer_load_dwordx4 a[52:55], v6, s[16:19], s50 offen offset:3072 nt
  v_mfma_f32_16x16x32_bf16 v[208:211], a[212:215], a[36:39], v[208:211]
  v_mfma_f32_16x16x32_bf16 v[212:215], a[216:219], a[4:7], v[212:215]
  ds_read_b128 v[72:75], v253 offset:8192
  ds_read_b64_tr_b16 a[190:191], v27 offset:1032
  v_mfma_f32_16x16x32_bf16 v[220:223], a[216:219], a[12:15], v[220:223]
  v_mfma_f32_16x16x32_bf16 v[228:231], a[216:219], a[20:23], v[228:231]
  v_mfma_f32_16x16x32_bf16 v[236:239], a[216:219], a[28:31], v[236:239]
  v_mfma_f32_16x16x32_bf16 v[244:247], a[216:219], a[36:39], v[244:247]
  v_mfma_f32_16x16x32_bf16 v[216:219], a[220:223], a[4:7], v[216:219]
  v_mfma_f32_16x16x32_bf16 v[224:227], a[220:223], a[12:15], v[224:227]
  v_mfma_f32_16x16x32_bf16 v[232:235], a[220:223], a[20:23], v[232:235]
  v_mfma_f32_16x16x32_bf16 v[240:243], a[220:223], a[28:31], v[240:243]
  v_mfma_f32_16x16x32_bf16 v[248:251], a[220:223], a[36:39], v[248:251]
  s_waitcnt vmcnt(10) lgkmcnt(0)
  s_barrier
  v_mfma_f32_16x16x32_bf16 v[92:95], a[160:163], v[36:39], v[92:95]
  ds_read_b64_tr_b16 a[192:193], v24 offset:8192
  v_mfma_f32_16x16x32_bf16 v[100:103], a[160:163], v[44:47], v[100:103]
  s_add_u32 m0, s47, 0
  s_add_u32 s51, s37, 1024
  buffer_load_dwordx4 v11, s[8:11], s51 offen lds
  v_mfma_f32_16x16x32_bf16 v[108:111], a[160:163], v[52:55], v[108:111]
  ds_read_b64_tr_b16 a[194:195], v24 offset:9216
  v_mfma_f32_16x16x32_bf16 v[116:119], a[160:163], v[60:63], v[116:119]
  v_mfma_f32_16x16x32_bf16 v[124:127], a[160:163], v[68:71], v[124:127]
  ds_read_b64_tr_b16 a[196:197], v24 offset:8200
  v_mfma_f32_16x16x32_bf16 v[96:99], a[164:167], v[36:39], v[96:99]
  v_mfma_f32_16x16x32_bf16 v[104:107], a[164:167], v[44:47], v[104:107]
  ds_read_b64_tr_b16 a[198:199], v24 offset:9224
  s_add_u32 m0, s47, 2048
  s_add_u32 s51, s38, 1024
  buffer_load_dwordx4 v11, s[8:11], s51 offen lds
  v_mfma_f32_16x16x32_bf16 v[112:115], a[164:167], v[52:55], v[112:115]
  v_mfma_f32_16x16x32_bf16 v[120:123], a[164:167], v[60:63], v[120:123]
  ds_read_b64_tr_b16 a[200:201], v25 offset:8192
  v_mfma_f32_16x16x32_bf16 v[128:131], a[164:167], v[68:71], v[128:131]
  v_mfma_f32_16x16x32_bf16 v[132:135], a[168:171], v[36:39], v[132:135]
  ds_read_b64_tr_b16 a[202:203], v25 offset:9216
  v_mfma_f32_16x16x32_bf16 v[140:143], a[168:171], v[44:47], v[140:143]
  s_add_u32 m0, s47, 4096
  s_add_u32 s51, s39, 1024
  buffer_load_dwordx4 v11, s[8:11], s51 offen lds
  v_mfma_f32_16x16x32_bf16 v[148:151], a[168:171], v[52:55], v[148:151]
  ds_read_b64_tr_b16 a[204:205], v25 offset:8200
  v_mfma_f32_16x16x32_bf16 v[156:159], a[168:171], v[60:63], v[156:159]
  v_mfma_f32_16x16x32_bf16 v[164:167], a[168:171], v[68:71], v[164:167]
  ds_read_b64_tr_b16 a[206:207], v25 offset:9224
  v_mfma_f32_16x16x32_bf16 v[136:139], a[172:175], v[36:39], v[136:139]
  v_mfma_f32_16x16x32_bf16 v[144:147], a[172:175], v[44:47], v[144:147]
  ds_read_b64_tr_b16 a[208:209], v26 offset:8192
  s_add_u32 m0, s79, 0
  s_add_u32 s51, s36, 3932160
  buffer_load_dwordx4 v7, s[20:23], s51 offen offset:0 lds
  v_mfma_f32_16x16x32_bf16 v[152:155], a[172:175], v[52:55], v[152:155]
  v_mfma_f32_16x16x32_bf16 v[160:163], a[172:175], v[60:63], v[160:163]
  ds_read_b64_tr_b16 a[210:211], v26 offset:9216
  v_mfma_f32_16x16x32_bf16 v[168:171], a[172:175], v[68:71], v[168:171]
  v_mfma_f32_16x16x32_bf16 v[172:175], a[176:179], v[36:39], v[172:175]
  ds_read_b64_tr_b16 a[212:213], v26 offset:8200
  v_mfma_f32_16x16x32_bf16 v[180:183], a[176:179], v[44:47], v[180:183]
  buffer_load_dwordx4 v8, s[20:23], s51 offen offset:1024 lds
  v_mfma_f32_16x16x32_bf16 v[188:191], a[176:179], v[52:55], v[188:191]
  ds_read_b64_tr_b16 a[214:215], v26 offset:9224
  v_mfma_f32_16x16x32_bf16 v[196:199], a[176:179], v[60:63], v[196:199]
  v_mfma_f32_16x16x32_bf16 v[204:207], a[176:179], v[68:71], v[204:207]
  ds_read_b64_tr_b16 a[216:217], v27 offset:8192
  v_mfma_f32_16x16x32_bf16 v[176:179], a[180:183], v[36:39], v[176:179]
  v_mfma_f32_16x16x32_bf16 v[184:187], a[180:183], v[44:47], v[184:187]
  ds_read_b64_tr_b16 a[218:219], v27 offset:9216
  buffer_load_dwordx4 v9, s[20:23], s51 offen offset:2048 lds
  v_mfma_f32_16x16x32_bf16 v[192:195], a[180:183], v[52:55], v[192:195]
  v_mfma_f32_16x16x32_bf16 v[200:203], a[180:183], v[60:63], v[200:203]
  ds_read_b64_tr_b16 a[220:221], v27 offset:8200
  v_mfma_f32_16x16x32_bf16 v[208:211], a[180:183], v[68:71], v[208:211]
  v_mfma_f32_16x16x32_bf16 v[212:215], a[184:187], v[36:39], v[212:215]
  ds_read_b64_tr_b16 a[222:223], v27 offset:9224
  v_mfma_f32_16x16x32_bf16 v[220:223], a[184:187], v[44:47], v[220:223]
  buffer_load_dwordx4 v10, s[20:23], s51 offen offset:3072 lds
  v_mfma_f32_16x16x32_bf16 v[228:231], a[184:187], v[52:55], v[228:231]
  v_mfma_f32_16x16x32_bf16 v[236:239], a[184:187], v[60:63], v[236:239]
  v_mfma_f32_16x16x32_bf16 v[244:247], a[184:187], v[68:71], v[244:247]
  v_mfma_f32_16x16x32_bf16 v[216:219], a[188:191], v[36:39], v[216:219]
  v_mfma_f32_16x16x32_bf16 v[224:227], a[188:191], v[44:47], v[224:227]
  v_mfma_f32_16x16x32_bf16 v[232:235], a[188:191], v[52:55], v[232:235]
  v_mfma_f32_16x16x32_bf16 v[240:243], a[188:191], v[60:63], v[240:243]
  v_mfma_f32_16x16x32_bf16 v[248:251], a[188:191], v[68:71], v[248:251]
  s_waitcnt vmcnt(11) lgkmcnt(0)
  s_barrier
  v_mfma_f32_16x16x32_bf16 v[92:95], a[192:195], v[40:43], v[92:95]
  ds_read_b64_tr_b16 a[160:161], v24 offset:16384
  v_mfma_f32_16x16x32_bf16 v[100:103], a[192:195], v[48:51], v[100:103]
  s_add_u32 m0, s47, 6144
  s_add_u32 s51, s40, 1024
  buffer_load_dwordx4 v11, s[8:11], s51 offen lds
  v_mfma_f32_16x16x32_bf16 v[108:111], a[192:195], v[56:59], v[108:111]
  ds_read_b64_tr_b16 a[162:163], v24 offset:17408
  v_mfma_f32_16x16x32_bf16 v[116:119], a[192:195], v[64:67], v[116:119]
  ds_read_b128 a[0:3], v254 offset:0
  v_mfma_f32_16x16x32_bf16 v[124:127], a[192:195], v[72:75], v[124:127]
  ds_read_b64_tr_b16 a[164:165], v24 offset:16392
  s_add_u32 m0, s47, 8192
  s_add_u32 s51, s41, 1024
  buffer_load_dwordx4 v11, s[8:11], s51 offen lds
  v_mfma_f32_16x16x32_bf16 v[96:99], a[196:199], v[40:43], v[96:99]
  v_mfma_f32_16x16x32_bf16 v[104:107], a[196:199], v[48:51], v[104:107]
  ds_read_b128 a[8:11], v254 offset:2048
  ds_read_b64_tr_b16 a[166:167], v24 offset:17416
  v_mfma_f32_16x16x32_bf16 v[112:115], a[196:199], v[56:59], v[112:115]
  s_add_u32 m0, s79, 8192
  s_add_u32 s51, s36, 4194304
  buffer_load_dwordx4 v7, s[20:23], s51 offen offset:0 lds
  v_mfma_f32_16x16x32_bf16 v[120:123], a[196:199], v[64:67], v[120:123]
  ds_read_b64_tr_b16 a[168:169], v25 offset:16384
  v_mfma_f32_16x16x32_bf16 v[128:131], a[196:199], v[72:75], v[128:131]
  ds_read_b128 a[16:19], v254 offset:4096
  v_mfma_f32_16x16x32_bf16 v[132:135], a[200:203], v[40:43], v[132:135]
  ds_read_b64_tr_b16 a[170:171], v25 offset:17408
  buffer_load_dwordx4 v8, s[20:23], s51 offen offset:1024 lds
  v_mfma_f32_16x16x32_bf16 v[140:143], a[200:203], v[48:51], v[140:143]
  v_mfma_f32_16x16x32_bf16 v[148:151], a[200:203], v[56:59], v[148:151]
  ds_read_b128 a[24:27], v254 offset:6144
  ds_read_b64_tr_b16 a[172:173], v25 offset:16392
  v_mfma_f32_16x16x32_bf16 v[156:159], a[200:203], v[64:67], v[156:159]
  buffer_load_dwordx4 v9, s[20:23], s51 offen offset:2048 lds
  v_mfma_f32_16x16x32_bf16 v[164:167], a[200:203], v[72:75], v[164:167]
  ds_read_b64_tr_b16 a[174:175], v25 offset:17416
  v_mfma_f32_16x16x32_bf16 v[136:139], a[204:207], v[40:43], v[136:139]
  ds_read_b128 a[32:35], v254 offset:8192
  v_mfma_f32_16x16x32_bf16 v[144:147], a[204:207], v[48:51], v[144:147]
  ds_read_b64_tr_b16 a[176:177], v26 offset:16384
  buffer_load_dwordx4 v10, s[20:23], s51 offen offset:3072 lds
  v_mfma_f32_16x16x32_bf16 v[152:155], a[204:207], v[56:59], v[152:155]
  v_mfma_f32_16x16x32_bf16 v[160:163], a[204:207], v[64:67], v[160:163]
  ds_read_b128 a[4:7], v255 offset:0
  ds_read_b64_tr_b16 a[178:179], v26 offset:17408
  v_mfma_f32_16x16x32_bf16 v[168:171], a[204:207], v[72:75], v[168:171]
  s_nop 0
  s_add_u32 s50, s82, 8192
  s_and_b32 s50, s50, 0x1ffff
  s_add_u32 s50, s50, s34
  buffer_load_dwordx4 a[56:59], v5, s[16:19], s50 offen offset:0 nt
  v_mfma_f32_16x16x32_bf16 v[172:175], a[208:211], v[40:43], v[172:175]
  ds_read_b64_tr_b16 a[180:181], v26 offset:16392
  v_mfma_f32_16x16x32_bf16 v[180:183], a[208:211], v[48:51], v[180:183]
  ds_read_b128 a[12:15], v255 offset:2048
  v_mfma_f32_16x16x32_bf16 v[188:191], a[208:211], v[56:59], v[188:191]
  ds_read_b64_tr_b16 a[182:183], v26 offset:17416
  buffer_load_dwordx4 a[60:63], v6, s[16:19], s50 offen offset:1024 nt
  v_mfma_f32_16x16x32_bf16 v[196:199], a[208:211], v[64:67], v[196:199]
  v_mfma_f32_16x16x32_bf16 v[204:207], a[208:211], v[72:75], v[204:207]
  ds_read_b128 a[20:23], v255 offset:4096
  ds_read_b64_tr_b16 a[184:185], v27 offset:16384
  v_mfma_f32_16x16x32_bf16 v[176:179], a[212:215], v[40:43], v[176:179]
  buffer_load_dwordx4 a[64:67], v5, s[16:19], s50 offen offset:2048 nt
  v_mfma_f32_16x16x32_bf16 v[184:187], a[212:215], v[48:51], v[184:187]
  ds_read_b64_tr_b16 a[186:187], v27 offset:17408
  v_mfma_f32_16x16x32_bf16 v[192:195], a[212:215], v[56:59], v[192:195]
  ds_read_b128 a[28:31], v255 offset:6144
  v_mfma_f32_16x16x32_bf16 v[200:203], a[212:215], v[64:67], v[200:203]
  ds_read_b64_tr_b16 a[188:189], v27 offset:16392
  buffer_load_dwordx4 a[68:71], v6, s[16:19], s50 offen offset:3072 nt
  v_mfma_f32_16x16x32_bf16 v[208:211], a[212:215], v[72:75], v[208:211]
  v_mfma_f32_16x16x32_bf16 v[212:215], a[216:219], v[40:43], v[212:215]
  ds_read_b128 a[36:39], v255 offset:8192
  ds_read_b64_tr_b16 a[190:191], v27 offset:17416
  v_mfma_f32_16x16x32_bf16 v[220:223], a[216:219], v[48:51], v[220:223]
  v_mfma_f32_16x16x32_bf16 v[228:231], a[216:219], v[56:59], v[228:231]
  v_mfma_f32_16x16x32_bf16 v[236:239], a[216:219], v[64:67], v[236:239]
  v_mfma_f32_16x16x32_bf16 v[244:247], a[216:219], v[72:75], v[244:247]
  v_mfma_f32_16x16x32_bf16 v[216:219], a[220:223], v[40:43], v[216:219]
  v_mfma_f32_16x16x32_bf16 v[224:227], a[220:223], v[48:51], v[224:227]
  v_mfma_f32_16x16x32_bf16 v[232:235], a[220:223], v[56:59], v[232:235]
  v_mfma_f32_16x16x32_bf16 v[240:243], a[220:223], v[64:67], v[240:243]
  v_mfma_f32_16x16x32_bf16 v[248:251], a[220:223], v[72:75], v[248:251]
  s_waitcnt vmcnt(10) lgkmcnt(0)
  s_barrier
  v_mfma_f32_16x16x32_bf16 v[92:95], a[160:163], a[0:3], v[92:95]
  ds_read_b64_tr_b16 a[192:193], v24 offset:0
  v_mfma_f32_16x16x32_bf16 v[100:103], a[160:163], a[8:11], v[100:103]
  s_add_u32 m0, s79, 16384
  s_add_u32 s51, s36, 4456448
  buffer_load_dwordx4 v7, s[20:23], s51 offen offset:0 lds
  v_mfma_f32_16x16x32_bf16 v[108:111], a[160:163], a[16:19], v[108:111]
  ds_read_b64_tr_b16 a[194:195], v24 offset:1024
  v_mfma_f32_16x16x32_bf16 v[116:119], a[160:163], a[24:27], v[116:119]
  v_mfma_f32_16x16x32_bf16 v[124:127], a[160:163], a[32:35], v[124:127]
  ds_read_b64_tr_b16 a[196:197], v24 offset:8
  buffer_load_dwordx4 v8, s[20:23], s51 offen offset:1024 lds
  v_mfma_f32_16x16x32_bf16 v[96:99], a[164:167], a[0:3], v[96:99]
  v_mfma_f32_16x16x32_bf16 v[104:107], a[164:167], a[8:11], v[104:107]
  ds_read_b64_tr_b16 a[198:199], v24 offset:1032
  v_mfma_f32_16x16x32_bf16 v[112:115], a[164:167], a[16:19], v[112:115]
  buffer_load_dwordx4 v9, s[20:23], s51 offen offset:2048 lds
  v_mfma_f32_16x16x32_bf16 v[120:123], a[164:167], a[24:27], v[120:123]
  ds_read_b64_tr_b16 a[200:201], v25 offset:0
  v_mfma_f32_16x16x32_bf16 v[128:131], a[164:167], a[32:35], v[128:131]
  v_mfma_f32_16x16x32_bf16 v[132:135], a[168:171], a[0:3], v[132:135]
  ds_read_b64_tr_b16 a[202:203], v25 offset:1024
  buffer_load_dwordx4 v10, s[20:23], s51 offen offset:3072 lds
  v_mfma_f32_16x16x32_bf16 v[140:143], a[168:171], a[8:11], v[140:143]
  v_mfma_f32_16x16x32_bf16 v[148:151], a[168:171], a[16:19], v[148:151]
  ds_read_b64_tr_b16 a[204:205], v25 offset:8
  v_mfma_f32_16x16x32_bf16 v[156:159], a[168:171], a[24:27], v[156:159]
  s_nop 0
  s_add_u32 s50, s82, 16384
  s_and_b32 s50, s50, 0x1ffff
  s_add_u32 s50, s50, s34
  buffer_load_dwordx4 a[72:75], v5, s[16:19], s50 offen offset:0 nt
  v_mfma_f32_16x16x32_bf16 v[164:167], a[168:171], a[32:35], v[164:167]
  ds_read_b64_tr_b16 a[206:207], v25 offset:1032
  v_mfma_f32_16x16x32_bf16 v[136:139], a[172:175], a[0:3], v[136:139]
  v_mfma_f32_16x16x32_bf16 v[144:147], a[172:175], a[8:11], v[144:147]
  ds_read_b64_tr_b16 a[208:209], v26 offset:0
  buffer_load_dwordx4 a[76:79], v6, s[16:19], s50 offen offset:1024 nt
  v_mfma_f32_16x16x32_bf16 v[152:155], a[172:175], a[16:19], v[152:155]
  v_mfma_f32_16x16x32_bf16 v[160:163], a[172:175], a[24:27], v[160:163]
  ds_read_b64_tr_b16 a[210:211], v26 offset:1024
  v_mfma_f32_16x16x32_bf16 v[168:171], a[172:175], a[32:35], v[168:171]
  buffer_load_dwordx4 a[80:83], v5, s[16:19], s50 offen offset:2048 nt
  v_mfma_f32_16x16x32_bf16 v[172:175], a[176:179], a[0:3], v[172:175]
  ds_read_b64_tr_b16 a[212:213], v26 offset:8
  v_mfma_f32_16x16x32_bf16 v[180:183], a[176:179], a[8:11], v[180:183]
  v_mfma_f32_16x16x32_bf16 v[188:191], a[176:179], a[16:19], v[188:191]
  ds_read_b64_tr_b16 a[214:215], v26 offset:1032
  buffer_load_dwordx4 a[84:87], v6, s[16:19], s50 offen offset:3072 nt
  v_mfma_f32_16x16x32_bf16 v[196:199], a[176:179], a[24:27], v[196:199]
  v_mfma_f32_16x16x32_bf16 v[204:207], a[176:179], a[32:35], v[204:207]
  ds_read_b64_tr_b16 a[216:217], v27 offset:0
  v_mfma_f32_16x16x32_bf16 v[176:179], a[180:183], a[0:3], v[176:179]
  v_mfma_f32_16x16x32_bf16 v[184:187], a[180:183], a[8:11], v[184:187]
  ds_read_b64_tr_b16 a[218:219], v27 offset:1024
  v_mfma_f32_16x16x32_bf16 v[192:195], a[180:183], a[16:19], v[192:195]
  v_mfma_f32_16x16x32_bf16 v[200:203], a[180:183], a[24:27], v[200:203]
  ds_read_b64_tr_b16 a[220:221], v27 offset:8
  v_mfma_f32_16x16x32_bf16 v[208:211], a[180:183], a[32:35], v[208:211]
  v_mfma_f32_16x16x32_bf16 v[212:215], a[184:187], a[0:3], v[212:215]
  ds_read_b64_tr_b16 a[222:223], v27 offset:1032
  v_mfma_f32_16x16x32_bf16 v[220:223], a[184:187], a[8:11], v[220:223]
  v_mfma_f32_16x16x32_bf16 v[228:231], a[184:187], a[16:19], v[228:231]
  v_mfma_f32_16x16x32_bf16 v[236:239], a[184:187], a[24:27], v[236:239]
  v_mfma_f32_16x16x32_bf16 v[244:247], a[184:187], a[32:35], v[244:247]
  v_mfma_f32_16x16x32_bf16 v[216:219], a[188:191], a[0:3], v[216:219]
  v_mfma_f32_16x16x32_bf16 v[224:227], a[188:191], a[8:11], v[224:227]
  v_mfma_f32_16x16x32_bf16 v[232:235], a[188:191], a[16:19], v[232:235]
  v_mfma_f32_16x16x32_bf16 v[240:243], a[188:191], a[24:27], v[240:243]
  v_mfma_f32_16x16x32_bf16 v[248:251], a[188:191], a[32:35], v[248:251]
  s_waitcnt vmcnt(12) lgkmcnt(0)
  s_barrier
  v_mfma_f32_16x16x32_bf16 v[92:95], a[192:195], a[4:7], v[92:95]
  ds_read_b64_tr_b16 a[160:161], v24 offset:8192
  v_mfma_f32_16x16x32_bf16 v[100:103], a[192:195], a[12:15], v[100:103]
  s_nop 0
  s_add_u32 s50, s82, 24576
  s_and_b32 s50, s50, 0x1ffff
  s_add_u32 s50, s50, s34
  buffer_load_dwordx4 a[88:91], v5, s[16:19], s50 offen offset:0 nt
  v_mfma_f32_16x16x32_bf16 v[108:111], a[192:195], a[20:23], v[108:111]
  ds_read_b64_tr_b16 a[162:163], v24 offset:9216
  v_mfma_f32_16x16x32_bf16 v[116:119], a[192:195], a[28:31], v[116:119]
  ds_read_b128 v[36:39], v252 offset:0
  v_mfma_f32_16x16x32_bf16 v[124:127], a[192:195], a[36:39], v[124:127]
  ds_read_b64_tr_b16 a[164:165], v24 offset:8200
  v_mfma_f32_16x16x32_bf16 v[96:99], a[196:199], a[4:7], v[96:99]
  v_mfma_f32_16x16x32_bf16 v[104:107], a[196:199], a[12:15], v[104:107]
  ds_read_b128 v[44:47], v252 offset:2048
  ds_read_b64_tr_b16 a[166:167], v24 offset:9224
  buffer_load_dwordx4 a[92:95], v6, s[16:19], s50 offen offset:1024 nt
  v_mfma_f32_16x16x32_bf16 v[112:115], a[196:199], a[20:23], v[112:115]
  v_mfma_f32_16x16x32_bf16 v[120:123], a[196:199], a[28:31], v[120:123]
  ds_read_b64_tr_b16 a[168:169], v25 offset:8192
  v_mfma_f32_16x16x32_bf16 v[128:131], a[196:199], a[36:39], v[128:131]
  ds_read_b128 v[52:55], v252 offset:4096
  v_mfma_f32_16x16x32_bf16 v[132:135], a[200:203], a[4:7], v[132:135]
  ds_read_b64_tr_b16 a[170:171], v25 offset:9216
  v_mfma_f32_16x16x32_bf16 v[140:143], a[200:203], a[12:15], v[140:143]
  buffer_load_dwordx4 a[96:99], v5, s[16:19], s50 offen offset:2048 nt
  v_mfma_f32_16x16x32_bf16 v[148:151], a[200:203], a[20:23], v[148:151]
  ds_read_b128 v[60:63], v252 offset:6144
  ds_read_b64_tr_b16 a[172:173], v25 offset:8200
  v_mfma_f32_16x16x32_bf16 v[156:159], a[200:203], a[28:31], v[156:159]
  v_mfma_f32_16x16x32_bf16 v[164:167], a[200:203], a[36:39], v[164:167]
  ds_read_b64_tr_b16 a[174:175], v25 offset:9224
  v_mfma_f32_16x16x32_bf16 v[136:139], a[204:207], a[4:7], v[136:139]
  ds_read_b128 v[68:71], v252 offset:8192
  v_mfma_f32_16x16x32_bf16 v[144:147], a[204:207], a[12:15], v[144:147]
  ds_read_b64_tr_b16 a[176:177], v26 offset:8192
  buffer_load_dwordx4 a[100:103], v6, s[16:19], s50 offen offset:3072 nt
  v_mfma_f32_16x16x32_bf16 v[152:155], a[204:207], a[20:23], v[152:155]
  v_mfma_f32_16x16x32_bf16 v[160:163], a[204:207], a[28:31], v[160:163]
  ds_read_b128 v[40:43], v253 offset:0
  ds_read_b64_tr_b16 a[178:179], v26 offset:9216
  v_mfma_f32_16x16x32_bf16 v[168:171], a[204:207], a[36:39], v[168:171]
  v_mfma_f32_16x16x32_bf16 v[172:175], a[208:211], a[4:7], v[172:175]
  ds_read_b64_tr_b16 a[180:181], v26 offset:8200
  v_mfma_f32_16x16x32_bf16 v[180:183], a[208:211], a[12:15], v[180:183]
  ds_read_b128 v[48:51], v253 offset:2048
  v_mfma_f32_16x16x32_bf16 v[188:191], a[208:211], a[20:23], v[188:191]
  ds_read_b64_tr_b16 a[182:183], v26 offset:9224
  v_mfma_f32_16x16x32_bf16 v[196:199], a[208:211], a[28:31], v[196:199]
  v_mfma_f32_16x16x32_bf16 v[204:207], a[208:211], a[36:39], v[204:207]
  ds_read_b128 v[56:59], v253 offset:4096
  ds_read_b64_tr_b16 a[184:185], v27 offset:8192
  v_mfma_f32_16x16x32_bf16 v[176:179], a[212:215], a[4:7], v[176:179]
  v_mfma_f32_16x16x32_bf16 v[184:187], a[212:215], a[12:15], v[184:187]
  ds_read_b64_tr_b16 a[186:187], v27 offset:9216
  v_mfma_f32_16x16x32_bf16 v[192:195], a[212:215], a[20:23], v[192:195]
  ds_read_b128 v[64:67], v253 offset:6144
  v_mfma_f32_16x16x32_bf16 v[200:203], a[212:215], a[28:31], v[200:203]
  ds_read_b64_tr_b16 a[188:189], v27 offset:8200
  v_mfma_f32_16x16x32_bf16 v[208:211], a[212:215], a[36:39], v[208:211]
  v_mfma_f32_16x16x32_bf16 v[212:215], a[216:219], a[4:7], v[212:215]
  ds_read_b128 v[72:75], v253 offset:8192
  ds_read_b64_tr_b16 a[190:191], v27 offset:9224
  v_mfma_f32_16x16x32_bf16 v[220:223], a[216:219], a[12:15], v[220:223]
  v_mfma_f32_16x16x32_bf16 v[228:231], a[216:219], a[20:23], v[228:231]
  v_mfma_f32_16x16x32_bf16 v[236:239], a[216:219], a[28:31], v[236:239]
  v_mfma_f32_16x16x32_bf16 v[244:247], a[216:219], a[36:39], v[244:247]
  v_mfma_f32_16x16x32_bf16 v[216:219], a[220:223], a[4:7], v[216:219]
  v_mfma_f32_16x16x32_bf16 v[224:227], a[220:223], a[12:15], v[224:227]
  v_mfma_f32_16x16x32_bf16 v[232:235], a[220:223], a[20:23], v[232:235]
  v_mfma_f32_16x16x32_bf16 v[240:243], a[220:223], a[28:31], v[240:243]
  v_mfma_f32_16x16x32_bf16 v[248:251], a[220:223], a[36:39], v[248:251]
  s_waitcnt vmcnt(8) lgkmcnt(0)
  s_barrier
  v_mfma_f32_16x16x32_bf16 v[92:95], a[160:163], v[36:39], v[92:95]
  ds_read_b64_tr_b16 a[192:193], v24 offset:16384
  v_mfma_f32_16x16x32_bf16 v[100:103], a[160:163], v[44:47], v[100:103]
  s_nop 0
  s_add_u32 s50, s82, 32768
  s_and_b32 s50, s50, 0x1ffff
  s_add_u32 s50, s50, s34
  buffer_load_dwordx4 a[112:115], v1, s[12:15], s50 offen offset:0 nt
  v_mfma_f32_16x16x32_bf16 v[108:111], a[160:163], v[52:55], v[108:111]
  ds_read_b64_tr_b16 a[194:195], v24 offset:17408
  v_mfma_f32_16x16x32_bf16 v[116:119], a[160:163], v[60:63], v[116:119]
  v_mfma_f32_16x16x32_bf16 v[124:127], a[160:163], v[68:71], v[124:127]
  ds_read_b64_tr_b16 a[196:197], v24 offset:16392
  v_mfma_f32_16x16x32_bf16 v[96:99], a[164:167], v[36:39], v[96:99]
  v_mfma_f32_16x16x32_bf16 v[104:107], a[164:167], v[44:47], v[104:107]
  ds_read_b64_tr_b16 a[198:199], v24 offset:17416
  buffer_load_dwordx4 a[116:119], v2, s[12:15], s50 offen offset:1024 nt
  v_mfma_f32_16x16x32_bf16 v[112:115], a[164:167], v[52:55], v[112:115]
  v_mfma_f32_16x16x32_bf16 v[120:123], a[164:167], v[60:63], v[120:123]
  ds_read_b64_tr_b16 a[200:201], v25 offset:16384
  v_mfma_f32_16x16x32_bf16 v[128:131], a[164:167], v[68:71], v[128:131]
  v_mfma_f32_16x16x32_bf16 v[132:135], a[168:171], v[36:39], v[132:135]
  ds_read_b64_tr_b16 a[202:203], v25 offset:17408
  v_mfma_f32_16x16x32_bf16 v[140:143], a[168:171], v[44:47], v[140:143]
  buffer_load_dwordx4 a[120:123], v3, s[12:15], s50 offen offset:2048 nt
  v_mfma_f32_16x16x32_bf16 v[148:151], a[168:171], v[52:55], v[148:151]
  ds_read_b64_tr_b16 a[204:205], v25 offset:16392
  v_mfma_f32_16x16x32_bf16 v[156:159], a[168:171], v[60:63], v[156:159]
  v_mfma_f32_16x16x32_bf16 v[164:167], a[168:171], v[68:71], v[164:167]
  ds_read_b64_tr_b16 a[206:207], v25 offset:17416
  v_mfma_f32_16x16x32_bf16 v[136:139], a[172:175], v[36:39], v[136:139]
  v_mfma_f32_16x16x32_bf16 v[144:147], a[172:175], v[44:47], v[144:147]
  ds_read_b64_tr_b16 a[208:209], v26 offset:16384
  buffer_load_dwordx4 a[124:127], v4, s[12:15], s50 offen offset:3072 nt
  v_mfma_f32_16x16x32_bf16 v[152:155], a[172:175], v[52:55], v[152:155]
  v_mfma_f32_16x16x32_bf16 v[160:163], a[172:175], v[60:63], v[160:163]
  ds_read_b64_tr_b16 a[210:211], v26 offset:17408
  v_mfma_f32_16x16x32_bf16 v[168:171], a[172:175], v[68:71], v[168:171]
  v_mfma_f32_16x16x32_bf16 v[172:175], a[176:179], v[36:39], v[172:175]
  ds_read_b64_tr_b16 a[212:213], v26 offset:16392
  v_mfma_f32_16x16x32_bf16 v[180:183], a[176:179], v[44:47], v[180:183]
  v_mfma_f32_16x16x32_bf16 v[188:191], a[176:179], v[52:55], v[188:191]
  ds_read_b64_tr_b16 a[214:215], v26 offset:17416
  v_mfma_f32_16x16x32_bf16 v[196:199], a[176:179], v[60:63], v[196:199]
  v_mfma_f32_16x16x32_bf16 v[204:207], a[176:179], v[68:71], v[204:207]
  ds_read_b64_tr_b16 a[216:217], v27 offset:16384
  v_mfma_f32_16x16x32_bf16 v[176:179], a[180:183], v[36:39], v[176:179]
  v_mfma_f32_16x16x32_bf16 v[184:187], a[180:183], v[44:47], v[184:187]
  ds_read_b64_tr_b16 a[218:219], v27 offset:17408
  v_mfma_f32_16x16x32_bf16 v[192:195], a[180:183], v[52:55], v[192:195]
  v_mfma_f32_16x16x32_bf16 v[200:203], a[180:183], v[60:63], v[200:203]
  ds_read_b64_tr_b16 a[220:221], v27 offset:16392
  v_mfma_f32_16x16x32_bf16 v[208:211], a[180:183], v[68:71], v[208:211]
  v_mfma_f32_16x16x32_bf16 v[212:215], a[184:187], v[36:39], v[212:215]
  ds_read_b64_tr_b16 a[222:223], v27 offset:17416
  v_mfma_f32_16x16x32_bf16 v[220:223], a[184:187], v[44:47], v[220:223]
  v_mfma_f32_16x16x32_bf16 v[228:231], a[184:187], v[52:55], v[228:231]
  v_mfma_f32_16x16x32_bf16 v[236:239], a[184:187], v[60:63], v[236:239]
  v_mfma_f32_16x16x32_bf16 v[244:247], a[184:187], v[68:71], v[244:247]
  v_mfma_f32_16x16x32_bf16 v[216:219], a[188:191], v[36:39], v[216:219]
  v_mfma_f32_16x16x32_bf16 v[224:227], a[188:191], v[44:47], v[224:227]
  v_mfma_f32_16x16x32_bf16 v[232:235], a[188:191], v[52:55], v[232:235]
  v_mfma_f32_16x16x32_bf16 v[240:243], a[188:191], v[60:63], v[240:243]
  v_mfma_f32_16x16x32_bf16 v[248:251], a[188:191], v[68:71], v[248:251]
  s_waitcnt lgkmcnt(0)
  s_barrier
  v_mfma_f32_16x16x32_bf16 v[92:95], a[192:195], v[40:43], v[92:95]
  v_mfma_f32_16x16x32_bf16 v[100:103], a[192:195], v[48:51], v[100:103]
  s_nop 0
  s_add_u32 s50, s82, 40960
  s_and_b32 s50, s50, 0x1ffff
  s_add_u32 s50, s50, s34
  buffer_load_dwordx4 a[128:131], v1, s[12:15], s50 offen offset:0 nt
  v_mfma_f32_16x16x32_bf16 v[108:111], a[192:195], v[56:59], v[108:111]
  v_mfma_f32_16x16x32_bf16 v[116:119], a[192:195], v[64:67], v[116:119]
  v_mfma_f32_16x16x32_bf16 v[124:127], a[192:195], v[72:75], v[124:127]
  buffer_load_dwordx4 a[132:135], v2, s[12:15], s50 offen offset:1024 nt
  v_mfma_f32_16x16x32_bf16 v[96:99], a[196:199], v[40:43], v[96:99]
  v_mfma_f32_16x16x32_bf16 v[104:107], a[196:199], v[48:51], v[104:107]
  v_mfma_f32_16x16x32_bf16 v[112:115], a[196:199], v[56:59], v[112:115]
  buffer_load_dwordx4 a[136:139], v3, s[12:15], s50 offen offset:2048 nt
  v_mfma_f32_16x16x32_bf16 v[120:123], a[196:199], v[64:67], v[120:123]
  v_mfma_f32_16x16x32_bf16 v[128:131], a[196:199], v[72:75], v[128:131]
  v_mfma_f32_16x16x32_bf16 v[132:135], a[200:203], v[40:43], v[132:135]
  buffer_load_dwordx4 a[140:143], v4, s[12:15], s50 offen offset:3072 nt
  v_mfma_f32_16x16x32_bf16 v[140:143], a[200:203], v[48:51], v[140:143]
  v_mfma_f32_16x16x32_bf16 v[148:151], a[200:203], v[56:59], v[148:151]
  v_mfma_f32_16x16x32_bf16 v[156:159], a[200:203], v[64:67], v[156:159]
  s_nop 0
  s_add_u32 s50, s82, 32768
  s_and_b32 s50, s50, 0x1ffff
  s_add_u32 s50, s50, s34
  buffer_load_dwordx4 a[144:147], v5, s[16:19], s50 offen offset:0 nt
  v_mfma_f32_16x16x32_bf16 v[164:167], a[200:203], v[72:75], v[164:167]
  v_mfma_f32_16x16x32_bf16 v[136:139], a[204:207], v[40:43], v[136:139]
  v_mfma_f32_16x16x32_bf16 v[144:147], a[204:207], v[48:51], v[144:147]
  buffer_load_dwordx4 a[148:151], v6, s[16:19], s50 offen offset:1024 nt
  v_mfma_f32_16x16x32_bf16 v[152:155], a[204:207], v[56:59], v[152:155]
  v_mfma_f32_16x16x32_bf16 v[160:163], a[204:207], v[64:67], v[160:163]
  v_mfma_f32_16x16x32_bf16 v[168:171], a[204:207], v[72:75], v[168:171]
  buffer_load_dwordx4 a[152:155], v5, s[16:19], s50 offen offset:2048 nt
  v_mfma_f32_16x16x32_bf16 v[172:175], a[208:211], v[40:43], v[172:175]
  v_mfma_f32_16x16x32_bf16 v[180:183], a[208:211], v[48:51], v[180:183]
  v_mfma_f32_16x16x32_bf16 v[188:191], a[208:211], v[56:59], v[188:191]
  buffer_load_dwordx4 a[156:159], v6, s[16:19], s50 offen offset:3072 nt
  v_mfma_f32_16x16x32_bf16 v[196:199], a[208:211], v[64:67], v[196:199]
  v_mfma_f32_16x16x32_bf16 v[204:207], a[208:211], v[72:75], v[204:207]
  v_mfma_f32_16x16x32_bf16 v[176:179], a[212:215], v[40:43], v[176:179]
  v_mfma_f32_16x16x32_bf16 v[184:187], a[212:215], v[48:51], v[184:187]
  v_mfma_f32_16x16x32_bf16 v[192:195], a[212:215], v[56:59], v[192:195]
  v_mfma_f32_16x16x32_bf16 v[200:203], a[212:215], v[64:67], v[200:203]
  v_mfma_f32_16x16x32_bf16 v[208:211], a[212:215], v[72:75], v[208:211]
  v_mfma_f32_16x16x32_bf16 v[212:215], a[216:219], v[40:43], v[212:215]
  v_mfma_f32_16x16x32_bf16 v[220:223], a[216:219], v[48:51], v[220:223]
  v_mfma_f32_16x16x32_bf16 v[228:231], a[216:219], v[56:59], v[228:231]
  v_mfma_f32_16x16x32_bf16 v[236:239], a[216:219], v[64:67], v[236:239]
  v_mfma_f32_16x16x32_bf16 v[244:247], a[216:219], v[72:75], v[244:247]
  v_mfma_f32_16x16x32_bf16 v[216:219], a[220:223], v[40:43], v[216:219]
  v_mfma_f32_16x16x32_bf16 v[224:227], a[220:223], v[48:51], v[224:227]
  v_mfma_f32_16x16x32_bf16 v[232:235], a[220:223], v[56:59], v[232:235]
  v_mfma_f32_16x16x32_bf16 v[240:243], a[220:223], v[64:67], v[240:243]
  v_mfma_f32_16x16x32_bf16 v[248:251], a[220:223], v[72:75], v[248:251]
  ds_write_b128 v87, a[40:43] offset:24576
  ds_write_b128 v87, a[44:47] offset:25600
  ds_write_b128 v87, a[48:51] offset:26624
  ds_write_b128 v87, a[52:55] offset:27648
  s_nop 7
  v_mul_f32 v92, s48, v92
  v_mul_f32 v93, s48, v93
  v_mul_f32 v94, s48, v94
  v_mul_f32 v95, s48, v95
  v_mul_f32 v96, s48, v96
  v_mul_f32 v97, s48, v97
  v_mul_f32 v98, s48, v98
  v_mul_f32 v99, s48, v99
  v_cvt_pk_bf16_f32 v36, v92, v93
  v_cvt_pk_bf16_f32 v37, v94, v95
  v_cvt_pk_bf16_f32 v38, v96, v97
  v_cvt_pk_bf16_f32 v39, v98, v99
  v_mul_f32 v100, s48, v100
  v_mul_f32 v101, s48, v101
  v_mul_f32 v102, s48, v102
  v_mul_f32 v103, s48, v103
  v_mul_f32 v104, s48, v104
  v_mul_f32 v105, s48, v105
  v_mul_f32 v106, s48, v106
  v_mul_f32 v107, s48, v107
  v_cvt_pk_bf16_f32 v40, v100, v101
  v_cvt_pk_bf16_f32 v41, v102, v103
  v_cvt_pk_bf16_f32 v42, v104, v105
  v_cvt_pk_bf16_f32 v43, v106, v107
  v_mul_f32 v108, s48, v108
  v_mul_f32 v109, s48, v109
  v_mul_f32 v110, s48, v110
  v_mul_f32 v111, s48, v111
  v_mul_f32 v112, s48, v112
  v_mul_f32 v113, s48, v113
  v_mul_f32 v114, s48, v114
  v_mul_f32 v115, s48, v115
  v_cvt_pk_bf16_f32 v44, v108, v109
  v_cvt_pk_bf16_f32 v45, v110, v111
  v_cvt_pk_bf16_f32 v46, v112, v113
  v_cvt_pk_bf16_f32 v47, v114, v115
  v_mul_f32 v116, s48, v116
  v_mul_f32 v117, s48, v117
  v_mul_f32 v118, s48, v118
  v_mul_f32 v119, s48, v119
  v_mul_f32 v120, s48, v120
  v_mul_f32 v121, s48, v121
  v_mul_f32 v122, s48, v122
  v_mul_f32 v123, s48, v123
  v_cvt_pk_bf16_f32 v48, v116, v117
  v_cvt_pk_bf16_f32 v49, v118, v119
  v_cvt_pk_bf16_f32 v50, v120, v121
  v_cvt_pk_bf16_f32 v51, v122, v123
  v_mul_f32 v124, s48, v124
  v_mul_f32 v125, s48, v125
  v_mul_f32 v126, s48, v126
  v_mul_f32 v127, s48, v127
  v_mul_f32 v128, s48, v128
  v_mul_f32 v129, s48, v129
  v_mul_f32 v130, s48, v130
  v_mul_f32 v131, s48, v131
  v_cvt_pk_bf16_f32 v52, v124, v125
  v_cvt_pk_bf16_f32 v53, v126, v127
  v_cvt_pk_bf16_f32 v54, v128, v129
  v_cvt_pk_bf16_f32 v55, v130, v131
  v_mul_f32 v132, s48, v132
  v_mul_f32 v133, s48, v133
  v_mul_f32 v134, s48, v134
  v_mul_f32 v135, s48, v135
  v_mul_f32 v136, s48, v136
  v_mul_f32 v137, s48, v137
  v_mul_f32 v138, s48, v138
  v_mul_f32 v139, s48, v139
  v_cvt_pk_bf16_f32 v56, v132, v133
  v_cvt_pk_bf16_f32 v57, v134, v135
  v_cvt_pk_bf16_f32 v58, v136, v137
  v_cvt_pk_bf16_f32 v59, v138, v139
  v_mul_f32 v140, s48, v140
  v_mul_f32 v141, s48, v141
  v_mul_f32 v142, s48, v142
  v_mul_f32 v143, s48, v143
  v_mul_f32 v144, s48, v144
  v_mul_f32 v145, s48, v145
  v_mul_f32 v146, s48, v146
  v_mul_f32 v147, s48, v147
  v_cvt_pk_bf16_f32 v60, v140, v141
  v_cvt_pk_bf16_f32 v61, v142, v143
  v_cvt_pk_bf16_f32 v62, v144, v145
  v_cvt_pk_bf16_f32 v63, v146, v147
  v_mul_f32 v148, s48, v148
  v_mul_f32 v149, s48, v149
  v_mul_f32 v150, s48, v150
  v_mul_f32 v151, s48, v151
  v_mul_f32 v152, s48, v152
  v_mul_f32 v153, s48, v153
  v_mul_f32 v154, s48, v154
  v_mul_f32 v155, s48, v155
  v_cvt_pk_bf16_f32 v64, v148, v149
  v_cvt_pk_bf16_f32 v65, v150, v151
  v_cvt_pk_bf16_f32 v66, v152, v153
  v_cvt_pk_bf16_f32 v67, v154, v155
  v_mul_f32 v156, s48, v156
  v_mul_f32 v157, s48, v157
  v_mul_f32 v158, s48, v158
  v_mul_f32 v159, s48, v159
  v_mul_f32 v160, s48, v160
  v_mul_f32 v161, s48, v161
  v_mul_f32 v162, s48, v162
  v_mul_f32 v163, s48, v163
  v_cvt_pk_bf16_f32 v68, v156, v157
  v_cvt_pk_bf16_f32 v69, v158, v159
  v_cvt_pk_bf16_f32 v70, v160, v161
  v_cvt_pk_bf16_f32 v71, v162, v163
  v_mul_f32 v164, s48, v164
  v_mul_f32 v165, s48, v165
  v_mul_f32 v166, s48, v166
  v_mul_f32 v167, s48, v167
  v_mul_f32 v168, s48, v168
  v_mul_f32 v169, s48, v169
  v_mul_f32 v170, s48, v170
  v_mul_f32 v171, s48, v171
  v_cvt_pk_bf16_f32 v72, v164, v165
  v_cvt_pk_bf16_f32 v73, v166, v167
  v_cvt_pk_bf16_f32 v74, v168, v169
  v_cvt_pk_bf16_f32 v75, v170, v171
  v_mul_f32 v172, s48, v172
  v_mul_f32 v173, s48, v173
  v_mul_f32 v174, s48, v174
  v_mul_f32 v175, s48, v175
  v_mul_f32 v176, s48, v176
  v_mul_f32 v177, s48, v177
  v_mul_f32 v178, s48, v178
  v_mul_f32 v179, s48, v179
  v_cvt_pk_bf16_f32 v76, v172, v173
  v_cvt_pk_bf16_f32 v77, v174, v175
  v_cvt_pk_bf16_f32 v78, v176, v177
  v_cvt_pk_bf16_f32 v79, v178, v179
  v_mul_f32 v180, s48, v180
  v_mul_f32 v181, s48, v181
  v_mul_f32 v182, s48, v182
  v_mul_f32 v183, s48, v183
  v_mul_f32 v184, s48, v184
  v_mul_f32 v185, s48, v185
  v_mul_f32 v186, s48, v186
  v_mul_f32 v187, s48, v187
  v_cvt_pk_bf16_f32 v80, v180, v181
  v_cvt_pk_bf16_f32 v81, v182, v183
  v_cvt_pk_bf16_f32 v82, v184, v185
  v_cvt_pk_bf16_f32 v83, v186, v187
  v_mul_f32 v188, s48, v188
  v_mul_f32 v189, s48, v189
  v_mul_f32 v190, s48, v190
  v_mul_f32 v191, s48, v191
  v_mul_f32 v192, s48, v192
  v_mul_f32 v193, s48, v193
  v_mul_f32 v194, s48, v194
  v_mul_f32 v195, s48, v195
  v_cvt_pk_bf16_f32 v84, v188, v189
  v_cvt_pk_bf16_f32 v85, v190, v191
  v_cvt_pk_bf16_f32 v86, v192, v193
  v_cvt_pk_bf16_f32 v87, v194, v195
  v_mul_f32 v196, s48, v196
  v_mul_f32 v197, s48, v197
  v_mul_f32 v198, s48, v198
  v_mul_f32 v199, s48, v199
  v_mul_f32 v200, s48, v200
  v_mul_f32 v201, s48, v201
  v_mul_f32 v202, s48, v202
  v_mul_f32 v203, s48, v203
  v_cvt_pk_bf16_f32 v88, v196, v197
  v_cvt_pk_bf16_f32 v89, v198, v199
  v_cvt_pk_bf16_f32 v90, v200, v201
  v_cvt_pk_bf16_f32 v91, v202, v203
  v_mul_f32 v204, s48, v204
  v_mul_f32 v205, s48, v205
  v_mul_f32 v206, s48, v206
  v_mul_f32 v207, s48, v207
  v_mul_f32 v208, s48, v208
  v_mul_f32 v209, s48, v209
  v_mul_f32 v210, s48, v210
  v_mul_f32 v211, s48, v211
  v_cvt_pk_bf16_f32 v92, v204, v205
  v_cvt_pk_bf16_f32 v93, v206, v207
  v_cvt_pk_bf16_f32 v94, v208, v209
  v_cvt_pk_bf16_f32 v95, v210, v211
  v_mul_f32 v212, s48, v212
  v_mul_f32 v213, s48, v213
  v_mul_f32 v214, s48, v214
  v_mul_f32 v215, s48, v215
  v_mul_f32 v216, s48, v216
  v_mul_f32 v217, s48, v217
  v_mul_f32 v218, s48, v218
  v_mul_f32 v219, s48, v219
  v_cvt_pk_bf16_f32 v96, v212, v213
  v_cvt_pk_bf16_f32 v97, v214, v215
  v_cvt_pk_bf16_f32 v98, v216, v217
  v_cvt_pk_bf16_f32 v99, v218, v219
  v_mul_f32 v220, s48, v220
  v_mul_f32 v221, s48, v221
  v_mul_f32 v222, s48, v222
  v_mul_f32 v223, s48, v223
  v_mul_f32 v224, s48, v224
  v_mul_f32 v225, s48, v225
  v_mul_f32 v226, s48, v226
  v_mul_f32 v227, s48, v227
  v_cvt_pk_bf16_f32 v100, v220, v221
  v_cvt_pk_bf16_f32 v101, v222, v223
  v_cvt_pk_bf16_f32 v102, v224, v225
  v_cvt_pk_bf16_f32 v103, v226, v227
  v_mul_f32 v228, s48, v228
  v_mul_f32 v229, s48, v229
  v_mul_f32 v230, s48, v230
  v_mul_f32 v231, s48, v231
  v_mul_f32 v232, s48, v232
  v_mul_f32 v233, s48, v233
  v_mul_f32 v234, s48, v234
  v_mul_f32 v235, s48, v235
  v_cvt_pk_bf16_f32 v104, v228, v229
  v_cvt_pk_bf16_f32 v105, v230, v231
  v_cvt_pk_bf16_f32 v106, v232, v233
  v_cvt_pk_bf16_f32 v107, v234, v235
  v_mul_f32 v236, s48, v236
  v_mul_f32 v237, s48, v237
  v_mul_f32 v238, s48, v238
  v_mul_f32 v239, s48, v239
  v_mul_f32 v240, s48, v240
  v_mul_f32 v241, s48, v241
  v_mul_f32 v242, s48, v242
  v_mul_f32 v243, s48, v243
  v_cvt_pk_bf16_f32 v108, v236, v237
  v_cvt_pk_bf16_f32 v109, v238, v239
  v_cvt_pk_bf16_f32 v110, v240, v241
  v_cvt_pk_bf16_f32 v111, v242, v243
  v_mul_f32 v244, s48, v244
  v_mul_f32 v245, s48, v245
  v_mul_f32 v246, s48, v246
  v_mul_f32 v247, s48, v247
  v_mul_f32 v248, s48, v248
  v_mul_f32 v249, s48, v249
  v_mul_f32 v250, s48, v250
  v_mul_f32 v251, s48, v251
  v_cvt_pk_bf16_f32 v112, v244, v245
  v_cvt_pk_bf16_f32 v113, v246, v247
  v_cvt_pk_bf16_f32 v114, v248, v249
  v_cvt_pk_bf16_f32 v115, v250, v251
  s_branch L_att
L_warm:
  s_lshl_b32 s34, s33, 17
  s_xor_b32 s35, s34, 262144
  s_and_b32 s50, s33, 31
  s_lshl_b32 s36, s50, 8
  s_xor_b32 s52, s36, 512
  s_cmp_eq_u32 s46, 0
  s_cselect_b32 s35, s35, 2130706432
  s_cselect_b32 s52, s52, 2130706432
  s_lshr_b32 s51, s33, 5
  s_mul_i32 s51, s51, 10
  s_mul_i32 s58, s80, 5
  s_add_u32 s51, s51, s58
  s_lshl_b32 s51, s51, 17
  s_lshl_b32 s50, s50, 12
  s_add_u32 s42, s51, s50
  s_lshl_b32 s50, s33, 1
  s_add_u32 s50, s50, s80
  s_lshr_b32 s51, s50, 4
  s_and_b32 s50, s50, 15
  s_mul_i32 s58, s51, 36864
  s_mul_i32 s59, s50, 96
  s_add_u32 s43, s58, s59
  s_add_u32 s44, s43, 18432
  s_mul_i32 s58, s50, 393216
  s_lshl_b32 s59, s51, 10
  s_add_u32 s58, s58, s59
  s_add_u32 s45, s58, 41943040
  s_cmp_lt_u32 s50, 12
  s_cselect_b32 s43, s43, 2130706432
  s_cselect_b32 s44, s44, 2130706432
  s_cselect_b32 s45, s45, 2130706432
  s_cmp_lg_u32 s56, 0
  s_cselect_b64 s[60:61], -1, 0
  v_add_u32 v87, s79, v28
  s_barrier
  ds_read_b64_tr_b16 a[160:161], v24 offset:0
  ds_read_b64_tr_b16 a[162:163], v24 offset:1024
  ds_read_b64_tr_b16 a[164:165], v24 offset:8
  ds_read_b64_tr_b16 a[166:167], v24 offset:1032
  ds_read_b64_tr_b16 a[168:169], v25 offset:0
  ds_read_b64_tr_b16 a[170:171], v25 offset:1024
  ds_read_b64_tr_b16 a[172:173], v25 offset:8
  ds_read_b64_tr_b16 a[174:175], v25 offset:1032
  ds_read_b64_tr_b16 a[176:177], v26 offset:0
  ds_read_b64_tr_b16 a[178:179], v26 offset:1024
  ds_read_b64_tr_b16 a[180:181], v26 offset:8
  ds_read_b64_tr_b16 a[182:183], v26 offset:1032
  ds_read_b64_tr_b16 a[184:185], v27 offset:0
  ds_read_b64_tr_b16 a[186:187], v27 offset:1024
  ds_read_b64_tr_b16 a[188:189], v27 offset:8
  ds_read_b64_tr_b16 a[190:191], v27 offset:1032
  ds_read_b128 v[36:39], v252 offset:0
  ds_read_b128 v[44:47], v252 offset:2048
  ds_read_b128 v[52:55], v252 offset:4096
  ds_read_b128 v[60:63], v252 offset:6144
  ds_read_b128 v[68:71], v252 offset:8192
  ds_read_b128 v[40:43], v253 offset:0
  ds_read_b128 v[48:51], v253 offset:2048
  ds_read_b128 v[56:59], v253 offset:4096
  ds_read_b128 v[64:67], v253 offset:6144
  ds_read_b128 v[72:75], v253 offset:8192
  s_waitcnt lgkmcnt(0)
  s_barrier
  v_mfma_f32_16x16x32_bf16 v[92:95], a[160:163], v[36:39], 0
  ds_read_b64_tr_b16 a[192:193], v24 offset:8192
  v_mfma_f32_16x16x32_bf16 v[100:103], a[160:163], v[44:47], 0
  s_add_u32 m0, s47, 0
  s_add_u32 s51, s37, 256
  buffer_load_dwordx4 v11, s[8:11], s51 offen lds
  v_mfma_f32_16x16x32_bf16 v[108:111], a[160:163], v[52:55], 0
  ds_read_b64_tr_b16 a[194:195], v24 offset:9216
  v_mfma_f32_16x16x32_bf16 v[116:119], a[160:163], v[60:63], 0
  v_mfma_f32_16x16x32_bf16 v[124:127], a[160:163], v[68:71], 0
  ds_read_b64_tr_b16 a[196:197], v24 offset:8200
  v_mfma_f32_16x16x32_bf16 v[96:99], a[164:167], v[36:39], 0
  v_mfma_f32_16x16x32_bf16 v[104:107], a[164:167], v[44:47], 0
  ds_read_b64_tr_b16 a[198:199], v24 offset:9224
  s_add_u32 m0, s47, 2048
  s_add_u32 s51, s38, 256
  buffer_load_dwordx4 v11, s[8:11], s51 offen lds
  v_mfma_f32_16x16x32_bf16 v[112:115], a[164:167], v[52:55], 0
  v_mfma_f32_16x16x32_bf16 v[120:123], a[164:167], v[60:63], 0
  ds_read_b64_tr_b16 a[200:201], v25 offset:8192
  v_mfma_f32_16x16x32_bf16 v[128:131], a[164:167], v[68:71], 0
  v_mfma_f32_16x16x32_bf16 v[132:135], a[168:171], v[36:39], 0
  ds_read_b64_tr_b16 a[202:203], v25 offset:9216
  v_mfma_f32_16x16x32_bf16 v[140:143], a[168:171], v[44:47], 0
  s_add_u32 m0, s47, 4096
  s_add_u32 s51, s39, 256
  buffer_load_dwordx4 v11, s[8:11], s51 offen lds
  v_mfma_f32_16x16x32_bf16 v[148:151], a[168:171], v[52:55], 0
  ds_read_b64_tr_b16 a[204:205], v25 offset:8200
  v_mfma_f32_16x16x32_bf16 v[156:159], a[168:171], v[60:63], 0
  v_mfma_f32_16x16x32_bf16 v[164:167], a[168:171], v[68:71], 0
  ds_read_b64_tr_b16 a[206:207], v25 offset:9224
  v_mfma_f32_16x16x32_bf16 v[136:139], a[172:175], v[36:39], 0
  v_mfma_f32_16x16x32_bf16 v[144:147], a[172:175], v[44:47], 0
  ds_read_b64_tr_b16 a[208:209], v26 offset:8192
  s_add_u32 m0, s79, 0
  s_add_u32 s51, s36, 786432
  buffer_load_dwordx4 v7, s[20:23], s51 offen offset:0 lds
  v_mfma_f32_16x16x32_bf16 v[152:155], a[172:175], v[52:55], 0
  v_mfma_f32_16x16x32_bf16 v[160:163], a[172:175], v[60:63], 0
  ds_read_b64_tr_b16 a[210:211], v26 offset:9216
  v_mfma_f32_16x16x32_bf16 v[168:171], a[172:175], v[68:71], 0
  v_mfma_f32_16x16x32_bf16 v[172:175], a[176:179], v[36:39], 0
  ds_read_b64_tr_b16 a[212:213], v26 offset:8200
  v_mfma_f32_16x16x32_bf16 v[180:183], a[176:179], v[44:47], 0
  buffer_load_dwordx4 v8, s[20:23], s51 offen offset:1024 lds
  v_mfma_f32_16x16x32_bf16 v[188:191], a[176:179], v[52:55], 0
  ds_read_b64_tr_b16 a[214:215], v26 offset:9224
  v_mfma_f32_16x16x32_bf16 v[196:199], a[176:179], v[60:63], 0
  v_mfma_f32_16x16x32_bf16 v[204:207], a[176:179], v[68:71], 0
  ds_read_b64_tr_b16 a[216:217], v27 offset:8192
  v_mfma_f32_16x16x32_bf16 v[176:179], a[180:183], v[36:39], 0
  v_mfma_f32_16x16x32_bf16 v[184:187], a[180:183], v[44:47], 0
  ds_read_b64_tr_b16 a[218:219], v27 offset:9216
  buffer_load_dwordx4 v9, s[20:23], s51 offen offset:2048 lds
  v_mfma_f32_16x16x32_bf16 v[192:195], a[180:183], v[52:55], 0
  v_mfma_f32_16x16x32_bf16 v[200:203], a[180:183], v[60:63], 0
  ds_read_b64_tr_b16 a[220:221], v27 offset:8200
  v_mfma_f32_16x16x32_bf16 v[208:211], a[180:183], v[68:71], 0
  v_mfma_f32_16x16x32_bf16 v[212:215], a[184:187], v[36:39], 0
  ds_read_b64_tr_b16 a[222:223], v27 offset:9224
  v_mfma_f32_16x16x32_bf16 v[220:223], a[184:187], v[44:47], 0
  buffer_load_dwordx4 v10, s[20:23], s51 offen offset:3072 lds
  v_mfma_f32_16x16x32_bf16 v[228:231], a[184:187], v[52:55], 0
  v_mfma_f32_16x16x32_bf16 v[236:239], a[184:187], v[60:63], 0
  v_mfma_f32_16x16x32_bf16 v[244:247], a[184:187], v[68:71], 0
  v_mfma_f32_16x16x32_bf16 v[216:219], a[188:191], v[36:39], 0
  v_mfma_f32_16x16x32_bf16 v[224:227], a[188:191], v[44:47], 0
  v_mfma_f32_16x16x32_bf16 v[232:235], a[188:191], v[52:55], 0
  v_mfma_f32_16x16x32_bf16 v[240:243], a[188:191], v[60:63], 0
  v_mfma_f32_16x16x32_bf16 v[248:251], a[188:191], v[68:71], 0
  s_waitcnt vmcnt(30) lgkmcnt(0)
  s_barrier
  v_mfma_f32_16x16x32_bf16 v[92:95], a[192:195], v[40:43], v[92:95]
  ds_read_b64_tr_b16 a[160:161], v24 offset:16384
  v_mfma_f32_16x16x32_bf16 v[100:103], a[192:195], v[48:51], v[100:103]
  s_add_u32 m0, s47, 6144
  s_add_u32 s51, s40, 256
  buffer_load_dwordx4 v11, s[8:11], s51 offen lds
  v_mfma_f32_16x16x32_bf16 v[108:111], a[192:195], v[56:59], v[108:111]
  ds_read_b64_tr_b16 a[162:163], v24 offset:17408
  v_mfma_f32_16x16x32_bf16 v[116:119], a[192:195], v[64:67], v[116:119]
  ds_read_b128 a[0:3], v254 offset:0
  v_mfma_f32_16x16x32_bf16 v[124:127], a[192:195], v[72:75], v[124:127]
  ds_read_b64_tr_b16 a[164:165], v24 offset:16392
  v_mfma_f32_16x16x32_bf16 v[96:99], a[196:199], v[40:43], v[96:99]
  v_mfma_f32_16x16x32_bf16 v[104:107], a[196:199], v[48:51], v[104:107]
  ds_read_b128 a[8:11], v254 offset:2048
  ds_read_b64_tr_b16 a[166:167], v24 offset:17416
  s_add_u32 m0, s47, 8192
  s_add_u32 s51, s41, 256
  buffer_load_dwordx4 v11, s[8:11], s51 offen lds
  v_mfma_f32_16x16x32_bf16 v[112:115], a[196:199], v[56:59], v[112:115]
  v_mfma_f32_16x16x32_bf16 v[120:123], a[196:199], v[64:67], v[120:123]
  ds_read_b64_tr_b16 a[168:169], v25 offset:16384
  v_mfma_f32_16x16x32_bf16 v[128:131], a[196:199], v[72:75], v[128:131]
  ds_read_b128 a[16:19], v254 offset:4096
  v_mfma_f32_16x16x32_bf16 v[132:135], a[200:203], v[40:43], v[132:135]
  ds_read_b64_tr_b16 a[170:171], v25 offset:17408
  v_mfma_f32_16x16x32_bf16 v[140:143], a[200:203], v[48:51], v[140:143]
  s_add_u32 m0, s79, 8192
  s_add_u32 s51, s36, 1048576
  buffer_load_dwordx4 v7, s[20:23], s51 offen offset:0 lds
  v_mfma_f32_16x16x32_bf16 v[148:151], a[200:203], v[56:59], v[148:151]
  ds_read_b128 a[24:27], v254 offset:6144
  ds_read_b64_tr_b16 a[172:173], v25 offset:16392
  v_mfma_f32_16x16x32_bf16 v[156:159], a[200:203], v[64:67], v[156:159]
  v_mfma_f32_16x16x32_bf16 v[164:167], a[200:203], v[72:75], v[164:167]
  ds_read_b64_tr_b16 a[174:175], v25 offset:17416
  v_mfma_f32_16x16x32_bf16 v[136:139], a[204:207], v[40:43], v[136:139]
  ds_read_b128 a[32:35], v254 offset:8192
  v_mfma_f32_16x16x32_bf16 v[144:147], a[204:207], v[48:51], v[144:147]
  ds_read_b64_tr_b16 a[176:177], v26 offset:16384
  buffer_load_dwordx4 v8, s[20:23], s51 offen offset:1024 lds
  v_mfma_f32_16x16x32_bf16 v[152:155], a[204:207], v[56:59], v[152:155]
  v_mfma_f32_16x16x32_bf16 v[160:163], a[204:207], v[64:67], v[160:163]
  ds_read_b128 a[4:7], v255 offset:0
  ds_read_b64_tr_b16 a[178:179], v26 offset:17408
  v_mfma_f32_16x16x32_bf16 v[168:171], a[204:207], v[72:75], v[168:171]
  v_mfma_f32_16x16x32_bf16 v[172:175], a[208:211], v[40:43], v[172:175]
  ds_read_b64_tr_b16 a[180:181], v26 offset:16392
  v_mfma_f32_16x16x32_bf16 v[180:183], a[208:211], v[48:51], v[180:183]
  ds_read_b128 a[12:15], v255 offset:2048
  buffer_load_dwordx4 v9, s[20:23], s51 offen offset:2048 lds
  v_mfma_f32_16x16x32_bf16 v[188:191], a[208:211], v[56:59], v[188:191]
  ds_read_b64_tr_b16 a[182:183], v26 offset:17416
  v_mfma_f32_16x16x32_bf16 v[196:199], a[208:211], v[64:67], v[196:199]
  v_mfma_f32_16x16x32_bf16 v[204:207], a[208:211], v[72:75], v[204:207]
  ds_read_b128 a[20:23], v255 offset:4096
  ds_read_b64_tr_b16 a[184:185], v27 offset:16384
  v_mfma_f32_16x16x32_bf16 v[176:179], a[212:215], v[40:43], v[176:179]
  v_mfma_f32_16x16x32_bf16 v[184:187], a[212:215], v[48:51], v[184:187]
  ds_read_b64_tr_b16 a[186:187], v27 offset:17408
  buffer_load_dwordx4 v10, s[20:23], s51 offen offset:3072 lds
  v_mfma_f32_16x16x32_bf16 v[192:195], a[212:215], v[56:59], v[192:195]
  ds_read_b128 a[28:31], v255 offset:6144
  v_mfma_f32_16x16x32_bf16 v[200:203], a[212:215], v[64:67], v[200:203]
  ds_read_b64_tr_b16 a[188:189], v27 offset:16392
  v_mfma_f32_16x16x32_bf16 v[208:211], a[212:215], v[72:75], v[208:211]
  v_mfma_f32_16x16x32_bf16 v[212:215], a[216:219], v[40:43], v[212:215]
  ds_read_b128 a[36:39], v255 offset:8192
  ds_read_b64_tr_b16 a[190:191], v27 offset:17416
  v_mfma_f32_16x16x32_bf16 v[220:223], a[216:219], v[48:51], v[220:223]
  v_mfma_f32_16x16x32_bf16 v[228:231], a[216:219], v[56:59], v[228:231]
  v_mfma_f32_16x16x32_bf16 v[236:239], a[216:219], v[64:67], v[236:239]
  v_mfma_f32_16x16x32_bf16 v[244:247], a[216:219], v[72:75], v[244:247]
  v_mfma_f32_16x16x32_bf16 v[216:219], a[220:223], v[40:43], v[216:219]
  v_mfma_f32_16x16x32_bf16 v[224:227], a[220:223], v[48:51], v[224:227]
  v_mfma_f32_16x16x32_bf16 v[232:235], a[220:223], v[56:59], v[232:235]
  v_mfma_f32_16x16x32_bf16 v[240:243], a[220:223], v[64:67], v[240:243]
  v_mfma_f32_16x16x32_bf16 v[248:251], a[220:223], v[72:75], v[248:251]
  s_waitcnt vmcnt(6) lgkmcnt(0)
  s_barrier
  v_mfma_f32_16x16x32_bf16 v[92:95], a[160:163], a[0:3], v[92:95]
  ds_read_b64_tr_b16 a[192:193], v24 offset:0
  v_mfma_f32_16x16x32_bf16 v[100:103], a[160:163], a[8:11], v[100:103]
  s_add_u32 m0, s47, 81920
  s_add_u32 s51, s37, 384
  buffer_load_dwordx4 v11, s[8:11], s51 offen lds
  v_mfma_f32_16x16x32_bf16 v[108:111], a[160:163], a[16:19], v[108:111]
  ds_read_b64_tr_b16 a[194:195], v24 offset:1024
  v_mfma_f32_16x16x32_bf16 v[116:119], a[160:163], a[24:27], v[116:119]
  v_mfma_f32_16x16x32_bf16 v[124:127], a[160:163], a[32:35], v[124:127]
  ds_read_b64_tr_b16 a[196:197], v24 offset:8
  v_mfma_f32_16x16x32_bf16 v[96:99], a[164:167], a[0:3], v[96:99]
  v_mfma_f32_16x16x32_bf16 v[104:107], a[164:167], a[8:11], v[104:107]
  ds_read_b64_tr_b16 a[198:199], v24 offset:1032
  s_add_u32 m0, s47, 83968
  s_add_u32 s51, s38, 384
  buffer_load_dwordx4 v11, s[8:11], s51 offen lds
  v_mfma_f32_16x16x32_bf16 v[112:115], a[164:167], a[16:19], v[112:115]
  v_mfma_f32_16x16x32_bf16 v[120:123], a[164:167], a[24:27], v[120:123]
  ds_read_b64_tr_b16 a[200:201], v25 offset:0
  v_mfma_f32_16x16x32_bf16 v[128:131], a[164:167], a[32:35], v[128:131]
  v_mfma_f32_16x16x32_bf16 v[132:135], a[168:171], a[0:3], v[132:135]
  ds_read_b64_tr_b16 a[202:203], v25 offset:1024
  v_mfma_f32_16x16x32_bf16 v[140:143], a[168:171], a[8:11], v[140:143]
  s_add_u32 m0, s47, 86016
  s_add_u32 s51, s39, 384
  buffer_load_dwordx4 v11, s[8:11], s51 offen lds
  v_mfma_f32_16x16x32_bf16 v[148:151], a[168:171], a[16:19], v[148:151]
  ds_read_b64_tr_b16 a[204:205], v25 offset:8
  v_mfma_f32_16x16x32_bf16 v[156:159], a[168:171], a[24:27], v[156:159]
  v_mfma_f32_16x16x32_bf16 v[164:167], a[168:171], a[32:35], v[164:167]
  ds_read_b64_tr_b16 a[206:207], v25 offset:1032
  v_mfma_f32_16x16x32_bf16 v[136:139], a[172:175], a[0:3], v[136:139]
  v_mfma_f32_16x16x32_bf16 v[144:147], a[172:175], a[8:11], v[144:147]
  ds_read_b64_tr_b16 a[208:209], v26 offset:0
  s_add_u32 m0, s79, 16384
  s_add_u32 s51, s36, 1310720
  buffer_load_dwordx4 v7, s[20:23], s51 offen offset:0 lds
  v_mfma_f32_16x16x32_bf16 v[152:155], a[172:175], a[16:19], v[152:155]
  v_mfma_f32_16x16x32_bf16 v[160:163], a[172:175], a[24:27], v[160:163]
  ds_read_b64_tr_b16 a[210:211], v26 offset:1024
  v_mfma_f32_16x16x32_bf16 v[168:171], a[172:175], a[32:35], v[168:171]
  v_mfma_f32_16x16x32_bf16 v[172:175], a[176:179], a[0:3], v[172:175]
  ds_read_b64_tr_b16 a[212:213], v26 offset:8
  v_mfma_f32_16x16x32_bf16 v[180:183], a[176:179], a[8:11], v[180:183]
  buffer_load_dwordx4 v8, s[20:23], s51 offen offset:1024 lds
  v_mfma_f32_16x16x32_bf16 v[188:191], a[176:179], a[16:19], v[188:191]
  ds_read_b64_tr_b16 a[214:215], v26 offset:1032
  v_mfma_f32_16x16x32_bf16 v[196:199], a[176:179], a[24:27], v[196:199]
  v_mfma_f32_16x16x32_bf16 v[204:207], a[176:179], a[32:35], v[204:207]
  ds_read_b64_tr_b16 a[216:217], v27 offset:0
  v_mfma_f32_16x16x32_bf16 v[176:179], a[180:183], a[0:3], v[176:179]
  v_mfma_f32_16x16x32_bf16 v[184:187], a[180:183], a[8:11], v[184:187]
  ds_read_b64_tr_b16 a[218:219], v27 offset:1024
  buffer_load_dwordx4 v9, s[20:23], s51 offen offset:2048 lds
  v_mfma_f32_16x16x32_bf16 v[192:195], a[180:183], a[16:19], v[192:195]
  v_mfma_f32_16x16x32_bf16 v[200:203], a[180:183], a[24:27], v[200:203]
  ds_read_b64_tr_b16 a[220:221], v27 offset:8
  v_mfma_f32_16x16x32_bf16 v[208:211], a[180:183], a[32:35], v[208:211]
  v_mfma_f32_16x16x32_bf16 v[212:215], a[184:187], a[0:3], v[212:215]
  ds_read_b64_tr_b16 a[222:223], v27 offset:1032
  v_mfma_f32_16x16x32_bf16 v[220:223], a[184:187], a[8:11], v[220:223]
  buffer_load_dwordx4 v10, s[20:23], s51 offen offset:3072 lds
  v_mfma_f32_16x16x32_bf16 v[228:231], a[184:187], a[16:19], v[228:231]
  v_mfma_f32_16x16x32_bf16 v[236:239], a[184:187], a[24:27], v[236:239]
  v_mfma_f32_16x16x32_bf16 v[244:247], a[184:187], a[32:35], v[244:247]
  v_mfma_f32_16x16x32_bf16 v[216:219], a[188:191], a[0:3], v[216:219]
  v_mfma_f32_16x16x32_bf16 v[224:227], a[188:191], a[8:11], v[224:227]
  v_mfma_f32_16x16x32_bf16 v[232:235], a[188:191], a[16:19], v[232:235]
  v_mfma_f32_16x16x32_bf16 v[240:243], a[188:191], a[24:27], v[240:243]
  v_mfma_f32_16x16x32_bf16 v[248:251], a[188:191], a[32:35], v[248:251]
  s_waitcnt vmcnt(7) lgkmcnt(0)
  s_barrier
  v_mfma_f32_16x16x32_bf16 v[92:95], a[192:195], a[4:7], v[92:95]
  ds_read_b64_tr_b16 a[160:161], v24 offset:8192
  v_mfma_f32_16x16x32_bf16 v[100:103], a[192:195], a[12:15], v[100:103]
  s_add_u32 m0, s47, 88064
  s_add_u32 s51, s40, 384
  buffer_load_dwordx4 v11, s[8:11], s51 offen lds
  v_mfma_f32_16x16x32_bf16 v[108:111], a[192:195], a[20:23], v[108:111]
  ds_read_b64_tr_b16 a[162:163], v24 offset:9216
  v_mfma_f32_16x16x32_bf16 v[116:119], a[192:195], a[28:31], v[116:119]
  ds_read_b128 v[36:39], v252 offset:0
  v_mfma_f32_16x16x32_bf16 v[124:127], a[192:195], a[36:39], v[124:127]
  ds_read_b64_tr_b16 a[164:165], v24 offset:8200
  v_mfma_f32_16x16x32_bf16 v[96:99], a[196:199], a[4:7], v[96:99]
  v_mfma_f32_16x16x32_bf16 v[104:107], a[196:199], a[12:15], v[104:107]
  ds_read_b128 v[44:47], v252 offset:2048
  ds_read_b64_tr_b16 a[166:167], v24 offset:9224
  s_add_u32 m0, s47, 90112
  s_add_u32 s51, s41, 384
  buffer_load_dwordx4 v11, s[8:11], s51 offen lds
  v_mfma_f32_16x16x32_bf16 v[112:115], a[196:199], a[20:23], v[112:115]
  v_mfma_f32_16x16x32_bf16 v[120:123], a[196:199], a[28:31], v[120:123]
  ds_read_b64_tr_b16 a[168:169], v25 offset:8192
  v_mfma_f32_16x16x32_bf16 v[128:131], a[196:199], a[36:39], v[128:131]
  ds_read_b128 v[52:55], v252 offset:4096
  v_mfma_f32_16x16x32_bf16 v[132:135], a[200:203], a[4:7], v[132:135]
  ds_read_b64_tr_b16 a[170:171], v25 offset:9216
  v_mfma_f32_16x16x32_bf16 v[140:143], a[200:203], a[12:15], v[140:143]
  s_add_u32 m0, s79, 0
  s_add_u32 s51, s36, 1572864
  buffer_load_dwordx4 v7, s[20:23], s51 offen offset:0 lds
  v_mfma_f32_16x16x32_bf16 v[148:151], a[200:203], a[20:23], v[148:151]
  ds_read_b128 v[60:63], v252 offset:6144
  ds_read_b64_tr_b16 a[172:173], v25 offset:8200
  v_mfma_f32_16x16x32_bf16 v[156:159], a[200:203], a[28:31], v[156:159]
  v_mfma_f32_16x16x32_bf16 v[164:167], a[200:203], a[36:39], v[164:167]
  ds_read_b64_tr_b16 a[174:175], v25 offset:9224
  v_mfma_f32_16x16x32_bf16 v[136:139], a[204:207], a[4:7], v[136:139]
  ds_read_b128 v[68:71], v252 offset:8192
  v_mfma_f32_16x16x32_bf16 v[144:147], a[204:207], a[12:15], v[144:147]
  ds_read_b64_tr_b16 a[176:177], v26 offset:8192
  buffer_load_dwordx4 v8, s[20:23], s51 offen offset:1024 lds
  v_mfma_f32_16x16x32_bf16 v[152:155], a[204:207], a[20:23], v[152:155]
  v_mfma_f32_16x16x32_bf16 v[160:163], a[204:207], a[28:31], v[160:163]
  ds_read_b128 v[40:43], v253 offset:0
  ds_read_b64_tr_b16 a[178:179], v26 offset:9216
  v_mfma_f32_16x16x32_bf16 v[168:171], a[204:207], a[36:39], v[168:171]
  v_mfma_f32_16x16x32_bf16 v[172:175], a[208:211], a[4:7], v[172:175]
  ds_read_b64_tr_b16 a[180:181], v26 offset:8200
  v_mfma_f32_16x16x32_bf16 v[180:183], a[208:211], a[12:15], v[180:183]
  ds_read_b128 v[48:51], v253 offset:2048
  buffer_load_dwordx4 v9, s[20:23], s51 offen offset:2048 lds
  v_mfma_f32_16x16x32_bf16 v[188:191], a[208:211], a[20:23], v[188:191]
  ds_read_b64_tr_b16 a[182:183], v26 offset:9224
  v_mfma_f32_16x16x32_bf16 v[196:199], a[208:211], a[28:31], v[196:199]
  v_mfma_f32_16x16x32_bf16 v[204:207], a[208:211], a[36:39], v[204:207]
  ds_read_b128 v[56:59], v253 offset:4096
  ds_read_b64_tr_b16 a[184:185], v27 offset:8192
  v_mfma_f32_16x16x32_bf16 v[176:179], a[212:215], a[4:7], v[176:179]
  v_mfma_f32_16x16x32_bf16 v[184:187], a[212:215], a[12:15], v[184:187]
  ds_read_b64_tr_b16 a[186:187], v27 offset:9216
  buffer_load_dwordx4 v10, s[20:23], s51 offen offset:3072 lds
  v_mfma_f32_16x16x32_bf16 v[192:195], a[212:215], a[20:23], v[192:195]
  ds_read_b128 v[64:67], v253 offset:6144
  v_mfma_f32_16x16x32_bf16 v[200:203], a[212:215], a[28:31], v[200:203]
  ds_read_b64_tr_b16 a[188:189], v27 offset:8200
  v_mfma_f32_16x16x32_bf16 v[208:211], a[212:215], a[36:39], v[208:211]
  v_mfma_f32_16x16x32_bf16 v[212:215], a[216:219], a[4:7], v[212:215]
  ds_read_b128 v[72:75], v253 offset:8192
  ds_read_b64_tr_b16 a[190:191], v27 offset:9224
  v_mfma_f32_16x16x32_bf16 v[220:223], a[216:219], a[12:15], v[220:223]
  v_mfma_f32_16x16x32_bf16 v[228:231], a[216:219], a[20:23], v[228:231]
  v_mfma_f32_16x16x32_bf16 v[236:239], a[216:219], a[28:31], v[236:239]
  v_mfma_f32_16x16x32_bf16 v[244:247], a[216:219], a[36:39], v[244:247]
  v_mfma_f32_16x16x32_bf16 v[216:219], a[220:223], a[4:7], v[216:219]
  v_mfma_f32_16x16x32_bf16 v[224:227], a[220:223], a[12:15], v[224:227]
  v_mfma_f32_16x16x32_bf16 v[232:235], a[220:223], a[20:23], v[232:235]
  v_mfma_f32_16x16x32_bf16 v[240:243], a[220:223], a[28:31], v[240:243]
  v_mfma_f32_16x16x32_bf16 v[248:251], a[220:223], a[36:39], v[248:251]
  s_waitcnt vmcnt(6) lgkmcnt(0)
  s_barrier
  v_mfma_f32_16x16x32_bf16 v[92:95], a[160:163], v[36:39], v[92:95]
  ds_read_b64_tr_b16 a[192:193], v24 offset:16384
  v_mfma_f32_16x16x32_bf16 v[100:103], a[160:163], v[44:47], v[100:103]
  s_add_u32 m0, s47, 0
  s_add_u32 s51, s37, 512
  buffer_load_dwordx4 v11, s[8:11], s51 offen lds
  v_mfma_f32_16x16x32_bf16 v[108:111], a[160:163], v[52:55], v[108:111]
  ds_read_b64_tr_b16 a[194:195], v24 offset:17408
  v_mfma_f32_16x16x32_bf16 v[116:119], a[160:163], v[60:63], v[116:119]
  v_mfma_f32_16x16x32_bf16 v[124:127], a[160:163], v[68:71], v[124:127]
  ds_read_b64_tr_b16 a[196:197], v24 offset:16392
  v_mfma_f32_16x16x32_bf16 v[96:99], a[164:167], v[36:39], v[96:99]
  v_mfma_f32_16x16x32_bf16 v[104:107], a[164:167], v[44:47], v[104:107]
  ds_read_b64_tr_b16 a[198:199], v24 offset:17416
  s_add_u32 m0, s47, 2048
  s_add_u32 s51, s38, 512
  buffer_load_dwordx4 v11, s[8:11], s51 offen lds
  v_mfma_f32_16x16x32_bf16 v[112:115], a[164:167], v[52:55], v[112:115]
  v_mfma_f32_16x16x32_bf16 v[120:123], a[164:167], v[60:63], v[120:123]
  ds_read_b64_tr_b16 a[200:201], v25 offset:16384
  v_mfma_f32_16x16x32_bf16 v[128:131], a[164:167], v[68:71], v[128:131]
  v_mfma_f32_16x16x32_bf16 v[132:135], a[168:171], v[36:39], v[132:135]
  ds_read_b64_tr_b16 a[202:203], v25 offset:17408
  v_mfma_f32_16x16x32_bf16 v[140:143], a[168:171], v[44:47], v[140:143]
  s_add_u32 m0, s47, 4096
  s_add_u32 s51, s39, 512
  buffer_load_dwordx4 v11, s[8:11], s51 offen lds
  v_mfma_f32_16x16x32_bf16 v[148:151], a[168:171], v[52:55], v[148:151]
  ds_read_b64_tr_b16 a[204:205], v25 offset:16392
  v_mfma_f32_16x16x32_bf16 v[156:159], a[168:171], v[60:63], v[156:159]
  v_mfma_f32_16x16x32_bf16 v[164:167], a[168:171], v[68:71], v[164:167]
  ds_read_b64_tr_b16 a[206:207], v25 offset:17416
  v_mfma_f32_16x16x32_bf16 v[136:139], a[172:175], v[36:39], v[136:139]
  v_mfma_f32_16x16x32_bf16 v[144:147], a[172:175], v[44:47], v[144:147]
  ds_read_b64_tr_b16 a[208:209], v26 offset:16384
  s_add_u32 m0, s79, 8192
  s_add_u32 s51, s36, 1835008
  buffer_load_dwordx4 v7, s[20:23], s51 offen offset:0 lds
  v_mfma_f32_16x16x32_bf16 v[152:155], a[172:175], v[52:55], v[152:155]
  v_mfma_f32_16x16x32_bf16 v[160:163], a[172:175], v[60:63], v[160:163]
  ds_read_b64_tr_b16 a[210:211], v26 offset:17408
  v_mfma_f32_16x16x32_bf16 v[168:171], a[172:175], v[68:71], v[168:171]
  v_mfma_f32_16x16x32_bf16 v[172:175], a[176:179], v[36:39], v[172:175]
  ds_read_b64_tr_b16 a[212:213], v26 offset:16392
  v_mfma_f32_16x16x32_bf16 v[180:183], a[176:179], v[44:47], v[180:183]
  buffer_load_dwordx4 v8, s[20:23], s51 offen offset:1024 lds
  v_mfma_f32_16x16x32_bf16 v[188:191], a[176:179], v[52:55], v[188:191]
  ds_read_b64_tr_b16 a[214:215], v26 offset:17416
  v_mfma_f32_16x16x32_bf16 v[196:199], a[176:179], v[60:63], v[196:199]
  v_mfma_f32_16x16x32_bf16 v[204:207], a[176:179], v[68:71], v[204:207]
  ds_read_b64_tr_b16 a[216:217], v27 offset:16384
  v_mfma_f32_16x16x32_bf16 v[176:179], a[180:183], v[36:39], v[176:179]
  v_mfma_f32_16x16x32_bf16 v[184:187], a[180:183], v[44:47], v[184:187]
  ds_read_b64_tr_b16 a[218:219], v27 offset:17408
  buffer_load_dwordx4 v9, s[20:23], s51 offen offset:2048 lds
  v_mfma_f32_16x16x32_bf16 v[192:195], a[180:183], v[52:55], v[192:195]
  v_mfma_f32_16x16x32_bf16 v[200:203], a[180:183], v[60:63], v[200:203]
  ds_read_b64_tr_b16 a[220:221], v27 offset:16392
  v_mfma_f32_16x16x32_bf16 v[208:211], a[180:183], v[68:71], v[208:211]
  v_mfma_f32_16x16x32_bf16 v[212:215], a[184:187], v[36:39], v[212:215]
  ds_read_b64_tr_b16 a[222:223], v27 offset:17416
  v_mfma_f32_16x16x32_bf16 v[220:223], a[184:187], v[44:47], v[220:223]
  buffer_load_dwordx4 v10, s[20:23], s51 offen offset:3072 lds
  v_mfma_f32_16x16x32_bf16 v[228:231], a[184:187], v[52:55], v[228:231]
  v_mfma_f32_16x16x32_bf16 v[236:239], a[184:187], v[60:63], v[236:239]
  v_mfma_f32_16x16x32_bf16 v[244:247], a[184:187], v[68:71], v[244:247]
  v_mfma_f32_16x16x32_bf16 v[216:219], a[188:191], v[36:39], v[216:219]
  v_mfma_f32_16x16x32_bf16 v[224:227], a[188:191], v[44:47], v[224:227]
  v_mfma_f32_16x16x32_bf16 v[232:235], a[188:191], v[52:55], v[232:235]
  v_mfma_f32_16x16x32_bf16 v[240:243], a[188:191], v[60:63], v[240:243]
  v_mfma_f32_16x16x32_bf16 v[248:251], a[188:191], v[68:71], v[248:251]
  s_waitcnt vmcnt(7) lgkmcnt(0)
  s_barrier
  v_mfma_f32_16x16x32_bf16 v[92:95], a[192:195], v[40:43], v[92:95]
  ds_read_b64_tr_b16 a[160:161], v24 offset:0
  v_mfma_f32_16x16x32_bf16 v[100:103], a[192:195], v[48:51], v[100:103]
  s_add_u32 m0, s47, 6144
  s_add_u32 s51, s40, 512
  buffer_load_dwordx4 v11, s[8:11], s51 offen lds
  v_mfma_f32_16x16x32_bf16 v[108:111], a[192:195], v[56:59], v[108:111]
  ds_read_b64_tr_b16 a[162:163], v24 offset:1024
  v_mfma_f32_16x16x32_bf16 v[116:119], a[192:195], v[64:67], v[116:119]
  ds_read_b128 a[0:3], v254 offset:0
  v_mfma_f32_16x16x32_bf16 v[124:127], a[192:195], v[72:75], v[124:127]
  ds_read_b64_tr_b16 a[164:165], v24 offset:8
  s_add_u32 m0, s47, 8192
  s_add_u32 s51, s41, 512
  buffer_load_dwordx4 v11, s[8:11], s51 offen lds
  v_mfma_f32_16x16x32_bf16 v[96:99], a[196:199], v[40:43], v[96:99]
  v_mfma_f32_16x16x32_bf16 v[104:107], a[196:199], v[48:51], v[104:107]
  ds_read_b128 a[8:11], v254 offset:2048
  ds_read_b64_tr_b16 a[166:167], v24 offset:1032
  v_mfma_f32_16x16x32_bf16 v[112:115], a[196:199], v[56:59], v[112:115]
  s_add_u32 m0, s79, 16384
  s_add_u32 s51, s36, 2097152
  buffer_load_dwordx4 v7, s[20:23], s51 offen offset:0 lds
  v_mfma_f32_16x16x32_bf16 v[120:123], a[196:199], v[64:67], v[120:123]
  ds_read_b64_tr_b16 a[168:169], v25 offset:0
  v_mfma_f32_16x16x32_bf16 v[128:131], a[196:199], v[72:75], v[128:131]
  ds_read_b128 a[16:19], v254 offset:4096
  v_mfma_f32_16x16x32_bf16 v[132:135], a[200:203], v[40:43], v[132:135]
  ds_read_b64_tr_b16 a[170:171], v25 offset:1024
  buffer_load_dwordx4 v8, s[20:23], s51 offen offset:1024 lds
  v_mfma_f32_16x16x32_bf16 v[140:143], a[200:203], v[48:51], v[140:143]
  v_mfma_f32_16x16x32_bf16 v[148:151], a[200:203], v[56:59], v[148:151]
  ds_read_b128 a[24:27], v254 offset:6144
  ds_read_b64_tr_b16 a[172:173], v25 offset:8
  v_mfma_f32_16x16x32_bf16 v[156:159], a[200:203], v[64:67], v[156:159]
  buffer_load_dwordx4 v9, s[20:23], s51 offen offset:2048 lds
  v_mfma_f32_16x16x32_bf16 v[164:167], a[200:203], v[72:75], v[164:167]
  ds_read_b64_tr_b16 a[174:175], v25 offset:1032
  v_mfma_f32_16x16x32_bf16 v[136:139], a[204:207], v[40:43], v[136:139]
  ds_read_b128 a[32:35], v254 offset:8192
  v_mfma_f32_16x16x32_bf16 v[144:147], a[204:207], v[48:51], v[144:147]
  ds_read_b64_tr_b16 a[176:177], v26 offset:0
  buffer_load_dwordx4 v10, s[20:23], s51 offen offset:3072 lds
  v_mfma_f32_16x16x32_bf16 v[152:155], a[204:207], v[56:59], v[152:155]
  v_mfma_f32_16x16x32_bf16 v[160:163], a[204:207], v[64:67], v[160:163]
  ds_read_b128 a[4:7], v255 offset:0
  ds_read_b64_tr_b16 a[178:179], v26 offset:1024
  v_mfma_f32_16x16x32_bf16 v[168:171], a[204:207], v[72:75], v[168:171]
  s_nop 0
  s_add_u32 s50, s82, 0
  s_and_b32 s50, s50, 0x1ffff
  s_add_u32 s50, s50, s34
  buffer_load_dwordx4 a[40:43], v5, s[16:19], s50 offen offset:0 nt
  v_mfma_f32_16x16x32_bf16 v[172:175], a[208:211], v[40:43], v[172:175]
  ds_read_b64_tr_b16 a[180:181], v26 offset:8
  v_mfma_f32_16x16x32_bf16 v[180:183], a[208:211], v[48:51], v[180:183]
  ds_read_b128 a[12:15], v255 offset:2048
  v_mfma_f32_16x16x32_bf16 v[188:191], a[208:211], v[56:59], v[188:191]
  ds_read_b64_tr_b16 a[182:183], v26 offset:1032
  buffer_load_dwordx4 a[44:47], v6, s[16:19], s50 offen offset:1024 nt
  v_mfma_f32_16x16x32_bf16 v[196:199], a[208:211], v[64:67], v[196:199]
  v_mfma_f32_16x16x32_bf16 v[204:207], a[208:211], v[72:75], v[204:207]
  ds_read_b128 a[20:23], v255 offset:4096
  ds_read_b64_tr_b16 a[184:185], v27 offset:0
  v_mfma_f32_16x16x32_bf16 v[176:179], a[212:215], v[40:43], v[176:179]
  buffer_load_dwordx4 a[48:51], v5, s[16:19], s50 offen offset:2048 nt
  v_mfma_f32_16x16x32_bf16 v[184:187], a[212:215], v[48:51], v[184:187]
  ds_read_b64_tr_b16 a[186:187], v27 offset:1024
  v_mfma_f32_16x16x32_bf16 v[192:195], a[212:215], v[56:59], v[192:195]
  ds_read_b128 a[28:31], v255 offset:6144
  v_mfma_f32_16x16x32_bf16 v[200:203], a[212:215], v[64:67], v[200:203]
  ds_read_b64_tr_b16 a[188:189], v27 offset:8
  buffer_load_dwordx4 a[52:55], v6, s[16:19], s50 offen offset:3072 nt
  v_mfma_f32_16x16x32_bf16 v[208:211], a[212:215], v[72:75], v[208:211]
  v_mfma_f32_16x16x32_bf16 v[212:215], a[216:219], v[40:43], v[212:215]
  ds_read_b128 a[36:39], v255 offset:8192
  ds_read_b64_tr_b16 a[190:191], v27 offset:1032
  v_mfma_f32_16x16x32_bf16 v[220:223], a[216:219], v[48:51], v[220:223]
  v_mfma_f32_16x16x32_bf16 v[228:231], a[216:219], v[56:59], v[228:231]
  v_mfma_f32_16x16x32_bf16 v[236:239], a[216:219], v[64:67], v[236:239]
  v_mfma_f32_16x16x32_bf16 v[244:247], a[216:219], v[72:75], v[244:247]
  v_mfma_f32_16x16x32_bf16 v[216:219], a[220:223], v[40:43], v[216:219]
  v_mfma_f32_16x16x32_bf16 v[224:227], a[220:223], v[48:51], v[224:227]
  v_mfma_f32_16x16x32_bf16 v[232:235], a[220:223], v[56:59], v[232:235]
  v_mfma_f32_16x16x32_bf16 v[240:243], a[220:223], v[64:67], v[240:243]
  v_mfma_f32_16x16x32_bf16 v[248:251], a[220:223], v[72:75], v[248:251]
  s_waitcnt vmcnt(10) lgkmcnt(0)
  s_barrier
  v_mfma_f32_16x16x32_bf16 v[92:95], a[160:163], a[0:3], v[92:95]
  ds_read_b64_tr_b16 a[192:193], v24 offset:8192
  v_mfma_f32_16x16x32_bf16 v[100:103], a[160:163], a[8:11], v[100:103]
  s_add_u32 m0, s47, 81920
  s_add_u32 s51, s37, 640
  buffer_load_dwordx4 v11, s[8:11], s51 offen lds
  v_mfma_f32_16x16x32_bf16 v[108:111], a[160:163], a[16:19], v[108:111]
  ds_read_b64_tr_b16 a[194:195], v24 offset:9216
  v_mfma_f32_16x16x32_bf16 v[116:119], a[160:163], a[24:27], v[116:119]
  v_mfma_f32_16x16x32_bf16 v[124:127], a[160:163], a[32:35], v[124:127]
  ds_read_b64_tr_b16 a[196:197], v24 offset:8200
  v_mfma_f32_16x16x32_bf16 v[96:99], a[164:167], a[0:3], v[96:99]
  v_mfma_f32_16x16x32_bf16 v[104:107], a[164:167], a[8:11], v[104:107]
  ds_read_b64_tr_b16 a[198:199], v24 offset:9224
  s_add_u32 m0, s47, 83968
  s_add_u32 s51, s38, 640
  buffer_load_dwordx4 v11, s[8:11], s51 offen lds
  v_mfma_f32_16x16x32_bf16 v[112:115], a[164:167], a[16:19], v[112:115]
  v_mfma_f32_16x16x32_bf16 v[120:123], a[164:167], a[24:27], v[120:123]
  ds_read_b64_tr_b16 a[200:201], v25 offset:8192
  v_mfma_f32_16x16x32_bf16 v[128:131], a[164:167], a[32:35], v[128:131]
  v_mfma_f32_16x16x32_bf16 v[132:135], a[168:171], a[0:3], v[132:135]
  ds_read_b64_tr_b16 a[202:203], v25 offset:9216
  v_mfma_f32_16x16x32_bf16 v[140:143], a[168:171], a[8:11], v[140:143]
  s_add_u32 m0, s47, 86016
  s_add_u32 s51, s39, 640
  buffer_load_dwordx4 v11, s[8:11], s51 offen lds
  v_mfma_f32_16x16x32_bf16 v[148:151], a[168:171], a[16:19], v[148:151]
  ds_read_b64_tr_b16 a[204:205], v25 offset:8200
  v_mfma_f32_16x16x32_bf16 v[156:159], a[168:171], a[24:27], v[156:159]
  v_mfma_f32_16x16x32_bf16 v[164:167], a[168:171], a[32:35], v[164:167]
  ds_read_b64_tr_b16 a[206:207], v25 offset:9224
  v_mfma_f32_16x16x32_bf16 v[136:139], a[172:175], a[0:3], v[136:139]
  v_mfma_f32_16x16x32_bf16 v[144:147], a[172:175], a[8:11], v[144:147]
  ds_read_b64_tr_b16 a[208:209], v26 offset:8192
  s_add_u32 m0, s79, 0
  s_add_u32 s51, s36, 2359296
  buffer_load_dwordx4 v7, s[20:23], s51 offen offset:0 lds
  v_mfma_f32_16x16x32_bf16 v[152:155], a[172:175], a[16:19], v[152:155]
  v_mfma_f32_16x16x32_bf16 v[160:163], a[172:175], a[24:27], v[160:163]
  ds_read_b64_tr_b16 a[210:211], v26 offset:9216
  v_mfma_f32_16x16x32_bf16 v[168:171], a[172:175], a[32:35], v[168:171]
  v_mfma_f32_16x16x32_bf16 v[172:175], a[176:179], a[0:3], v[172:175]
  ds_read_b64_tr_b16 a[212:213], v26 offset:8200
  v_mfma_f32_16x16x32_bf16 v[180:183], a[176:179], a[8:11], v[180:183]
  buffer_load_dwordx4 v8, s[20:23], s51 offen offset:1024 lds
  v_mfma_f32_16x16x32_bf16 v[188:191], a[176:179], a[16:19], v[188:191]
  ds_read_b64_tr_b16 a[214:215], v26 offset:9224
  v_mfma_f32_16x16x32_bf16 v[196:199], a[176:179], a[24:27], v[196:199]
  v_mfma_f32_16x16x32_bf16 v[204:207], a[176:179], a[32:35], v[204:207]
  ds_read_b64_tr_b16 a[216:217], v27 offset:8192
  v_mfma_f32_16x16x32_bf16 v[176:179], a[180:183], a[0:3], v[176:179]
  v_mfma_f32_16x16x32_bf16 v[184:187], a[180:183], a[8:11], v[184:187]
  ds_read_b64_tr_b16 a[218:219], v27 offset:9216
  buffer_load_dwordx4 v9, s[20:23], s51 offen offset:2048 lds
  v_mfma_f32_16x16x32_bf16 v[192:195], a[180:183], a[16:19], v[192:195]
  v_mfma_f32_16x16x32_bf16 v[200:203], a[180:183], a[24:27], v[200:203]
  ds_read_b64_tr_b16 a[220:221], v27 offset:8200
  v_mfma_f32_16x16x32_bf16 v[208:211], a[180:183], a[32:35], v[208:211]
  v_mfma_f32_16x16x32_bf16 v[212:215], a[184:187], a[0:3], v[212:215]
  ds_read_b64_tr_b16 a[222:223], v27 offset:9224
  v_mfma_f32_16x16x32_bf16 v[220:223], a[184:187], a[8:11], v[220:223]
  buffer_load_dwordx4 v10, s[20:23], s51 offen offset:3072 lds
  v_mfma_f32_16x16x32_bf16 v[228:231], a[184:187], a[16:19], v[228:231]
  v_mfma_f32_16x16x32_bf16 v[236:239], a[184:187], a[24:27], v[236:239]
  v_mfma_f32_16x16x32_bf16 v[244:247], a[184:187], a[32:35], v[244:247]
  v_mfma_f32_16x16x32_bf16 v[216:219], a[188:191], a[0:3], v[216:219]
  v_mfma_f32_16x16x32_bf16 v[224:227], a[188:191], a[8:11], v[224:227]
  v_mfma_f32_16x16x32_bf16 v[232:235], a[188:191], a[16:19], v[232:235]
  v_mfma_f32_16x16x32_bf16 v[240:243], a[188:191], a[24:27], v[240:243]
  v_mfma_f32_16x16x32_bf16 v[248:251], a[188:191], a[32:35], v[248:251]
  s_waitcnt vmcnt(11) lgkmcnt(0)
  s_barrier
  v_mfma_f32_16x16x32_bf16 v[92:95], a[192:195], a[4:7], v[92:95]
  ds_read_b64_tr_b16 a[160:161], v24 offset:16384
  v_mfma_f32_16x16x32_bf16 v[100:103], a[192:195], a[12:15], v[100:103]
  s_add_u32 m0, s47, 88064
  s_add_u32 s51, s40, 640
  buffer_load_dwordx4 v11, s[8:11], s51 offen lds
  v_mfma_f32_16x16x32_bf16 v[108:111], a[192:195], a[20:23], v[108:111]
  ds_read_b64_tr_b16 a[162:163], v24 offset:17408
  v_mfma_f32_16x16x32_bf16 v[116:119], a[192:195], a[28:31], v[116:119]
  ds_read_b128 v[36:39], v252 offset:0
  v_mfma_f32_16x16x32_bf16 v[124:127], a[192:195], a[36:39], v[124:127]
  ds_read_b64_tr_b16 a[164:165], v24 offset:16392
  v_mfma_f32_16x16x32_bf16 v[96:99], a[196:199], a[4:7], v[96:99]
  v_mfma_f32_16x16x32_bf16 v[104:107], a[196:199], a[12:15], v[104:107]
  ds_read_b128 v[44:47], v252 offset:2048
  ds_read_b64_tr_b16 a[166:167], v24 offset:17416
  s_add_u32 m0, s47, 90112
  s_add_u32 s51, s41, 640
  buffer_load_dwordx4 v11, s[8:11], s51 offen lds
  v_mfma_f32_16x16x32_bf16 v[112:115], a[196:199], a[20:23], v[112:115]
  v_mfma_f32_16x16x32_bf16 v[120:123], a[196:199], a[28:31], v[120:123]
  ds_read_b64_tr_b16 a[168:169], v25 offset:16384
  v_mfma_f32_16x16x32_bf16 v[128:131], a[196:199], a[36:39], v[128:131]
  ds_read_b128 v[52:55], v252 offset:4096
  v_mfma_f32_16x16x32_bf16 v[132:135], a[200:203], a[4:7], v[132:135]
  ds_read_b64_tr_b16 a[170:171], v25 offset:17408
  v_mfma_f32_16x16x32_bf16 v[140:143], a[200:203], a[12:15], v[140:143]
  s_add_u32 m0, s79, 8192
  s_add_u32 s51, s36, 2621440
  buffer_load_dwordx4 v7, s[20:23], s51 offen offset:0 lds
  v_mfma_f32_16x16x32_bf16 v[148:151], a[200:203], a[20:23], v[148:151]
  ds_read_b128 v[60:63], v252 offset:6144
  ds_read_b64_tr_b16 a[172:173], v25 offset:16392
  v_mfma_f32_16x16x32_bf16 v[156:159], a[200:203], a[28:31], v[156:159]
  v_mfma_f32_16x16x32_bf16 v[164:167], a[200:203], a[36:39], v[164:167]
  ds_read_b64_tr_b16 a[174:175], v25 offset:17416
  v_mfma_f32_16x16x32_bf16 v[136:139], a[204:207], a[4:7], v[136:139]
  ds_read_b128 v[68:71], v252 offset:8192
  v_mfma_f32_16x16x32_bf16 v[144:147], a[204:207], a[12:15], v[144:147]
  ds_read_b64_tr_b16 a[176:177], v26 offset:16384
  buffer_load_dwordx4 v8, s[20:23], s51 offen offset:1024 lds
  v_mfma_f32_16x16x32_bf16 v[152:155], a[204:207], a[20:23], v[152:155]
  v_mfma_f32_16x16x32_bf16 v[160:163], a[204:207], a[28:31], v[160:163]
  ds_read_b128 v[40:43], v253 offset:0
  ds_read_b64_tr_b16 a[178:179], v26 offset:17408
  v_mfma_f32_16x16x32_bf16 v[168:171], a[204:207], a[36:39], v[168:171]
  v_mfma_f32_16x16x32_bf16 v[172:175], a[208:211], a[4:7], v[172:175]
  ds_read_b64_tr_b16 a[180:181], v26 offset:16392
  v_mfma_f32_16x16x32_bf16 v[180:183], a[208:211], a[12:15], v[180:183]
  ds_read_b128 v[48:51], v253 offset:2048
  buffer_load_dwordx4 v9, s[20:23], s51 offen offset:2048 lds
  v_mfma_f32_16x16x32_bf16 v[188:191], a[208:211], a[20:23], v[188:191]
  ds_read_b64_tr_b16 a[182:183], v26 offset:17416
  v_mfma_f32_16x16x32_bf16 v[196:199], a[208:211], a[28:31], v[196:199]
  v_mfma_f32_16x16x32_bf16 v[204:207], a[208:211], a[36:39], v[204:207]
  ds_read_b128 v[56:59], v253 offset:4096
  ds_read_b64_tr_b16 a[184:185], v27 offset:16384
  v_mfma_f32_16x16x32_bf16 v[176:179], a[212:215], a[4:7], v[176:179]
  v_mfma_f32_16x16x32_bf16 v[184:187], a[212:215], a[12:15], v[184:187]
  ds_read_b64_tr_b16 a[186:187], v27 offset:17408
  buffer_load_dwordx4 v10, s[20:23], s51 offen offset:3072 lds
  v_mfma_f32_16x16x32_bf16 v[192:195], a[212:215], a[20:23], v[192:195]
  ds_read_b128 v[64:67], v253 offset:6144
  v_mfma_f32_16x16x32_bf16 v[200:203], a[212:215], a[28:31], v[200:203]
  ds_read_b64_tr_b16 a[188:189], v27 offset:16392
  v_mfma_f32_16x16x32_bf16 v[208:211], a[212:215], a[36:39], v[208:211]
  v_mfma_f32_16x16x32_bf16 v[212:215], a[216:219], a[4:7], v[212:215]
  ds_read_b128 v[72:75], v253 offset:8192
  ds_read_b64_tr_b16 a[190:191], v27 offset:17416
  v_mfma_f32_16x16x32_bf16 v[220:223], a[216:219], a[12:15], v[220:223]
  v_mfma_f32_16x16x32_bf16 v[228:231], a[216:219], a[20:23], v[228:231]
  v_mfma_f32_16x16x32_bf16 v[236:239], a[216:219], a[28:31], v[236:239]
  v_mfma_f32_16x16x32_bf16 v[244:247], a[216:219], a[36:39], v[244:247]
  v_mfma_f32_16x16x32_bf16 v[216:219], a[220:223], a[4:7], v[216:219]
  v_mfma_f32_16x16x32_bf16 v[224:227], a[220:223], a[12:15], v[224:227]
  v_mfma_f32_16x16x32_bf16 v[232:235], a[220:223], a[20:23], v[232:235]
  v_mfma_f32_16x16x32_bf16 v[240:243], a[220:223], a[28:31], v[240:243]
  v_mfma_f32_16x16x32_bf16 v[248:251], a[220:223], a[36:39], v[248:251]
  s_waitcnt vmcnt(6) lgkmcnt(0)
  s_barrier
  v_mfma_f32_16x16x32_bf16 v[92:95], a[160:163], v[36:39], v[92:95]
  ds_read_b64_tr_b16 a[192:193], v24 offset:0
  v_mfma_f32_16x16x32_bf16 v[100:103], a[160:163], v[44:47], v[100:103]
  s_add_u32 m0, s47, 0
  s_add_u32 s51, s37, 768
  buffer_load_dwordx4 v11, s[8:11], s51 offen lds
  v_mfma_f32_16x16x32_bf16 v[108:111], a[160:163], v[52:55], v[108:111]
  ds_read_b64_tr_b16 a[194:195], v24 offset:1024
  v_mfma_f32_16x16x32_bf16 v[116:119], a[160:163], v[60:63], v[116:119]
  v_mfma_f32_16x16x32_bf16 v[124:127], a[160:163], v[68:71], v[124:127]
  ds_read_b64_tr_b16 a[196:197], v24 offset:8
  s_add_u32 m0, s47, 2048
  s_add_u32 s51, s38, 768
  buffer_load_dwordx4 v11, s[8:11], s51 offen lds
  v_mfma_f32_16x16x32_bf16 v[96:99], a[164:167], v[36:39], v[96:99]
  v_mfma_f32_16x16x32_bf16 v[104:107], a[164:167], v[44:47], v[104:107]
  ds_read_b64_tr_b16 a[198:199], v24 offset:1032
  v_mfma_f32_16x16x32_bf16 v[112:115], a[164:167], v[52:55], v[112:115]
  s_add_u32 m0, s47, 4096
  s_add_u32 s51, s39, 768
  buffer_load_dwordx4 v11, s[8:11], s51 offen lds
  v_mfma_f32_16x16x32_bf16 v[120:123], a[164:167], v[60:63], v[120:123]
  ds_read_b64_tr_b16 a[200:201], v25 offset:0
  v_mfma_f32_16x16x32_bf16 v[128:131], a[164:167], v[68:71], v[128:131]
  v_mfma_f32_16x16x32_bf16 v[132:135], a[168:171], v[36:39], v[132:135]
  ds_read_b64_tr_b16 a[202:203], v25 offset:1024
  s_add_u32 m0, s79, 16384
  s_add_u32 s51, s36, 2883584
  buffer_load_dwordx4 v7, s[20:23], s51 offen offset:0 lds
  v_mfma_f32_16x16x32_bf16 v[140:143], a[168:171], v[44:47], v[140:143]
  v_mfma_f32_16x16x32_bf16 v[148:151], a[168:171], v[52:55], v[148:151]
  ds_read_b64_tr_b16 a[204:205], v25 offset:8
  v_mfma_f32_16x16x32_bf16 v[156:159], a[168:171], v[60:63], v[156:159]
  buffer_load_dwordx4 v8, s[20:23], s51 offen offset:1024 lds
  v_mfma_f32_16x16x32_bf16 v[164:167], a[168:171], v[68:71], v[164:167]
  ds_read_b64_tr_b16 a[206:207], v25 offset:1032
  v_mfma_f32_16x16x32_bf16 v[136:139], a[172:175], v[36:39], v[136:139]
  v_mfma_f32_16x16x32_bf16 v[144:147], a[172:175], v[44:47], v[144:147]
  ds_read_b64_tr_b16 a[208:209], v26 offset:0
  buffer_load_dwordx4 v9, s[20:23], s51 offen offset:2048 lds
  v_mfma_f32_16x16x32_bf16 v[152:155], a[172:175], v[52:55], v[152:155]
  v_mfma_f32_16x16x32_bf16 v[160:163], a[172:175], v[60:63], v[160:163]
  ds_read_b64_tr_b16 a[210:211], v26 offset:1024
  v_mfma_f32_16x16x32_bf16 v[168:171], a[172:175], v[68:71], v[168:171]
  buffer_load_dwordx4 v10, s[20:23], s51 offen offset:3072 lds
  v_mfma_f32_16x16x32_bf16 v[172:175], a[176:179], v[36:39], v[172:175]
  ds_read_b64_tr_b16 a[212:213], v26 offset:8
  v_mfma_f32_16x16x32_bf16 v[180:183], a[176:179], v[44:47], v[180:183]
  v_mfma_f32_16x16x32_bf16 v[188:191], a[176:179], v[52:55], v[188:191]
  ds_read_b64_tr_b16 a[214:215], v26 offset:1032
  s_nop 0
  s_add_u32 s50, s82, 8192
  s_and_b32 s50, s50, 0x1ffff
  s_add_u32 s50, s50, s34
  buffer_load_dwordx4 a[56:59], v5, s[16:19], s50 offen offset:0 nt
  v_mfma_f32_16x16x32_bf16 v[196:199], a[176:179], v[60:63], v[196:199]
  v_mfma_f32_16x16x32_bf16 v[204:207], a[176:179], v[68:71], v[204:207]
  ds_read_b64_tr_b16 a[216:217], v27 offset:0
  v_mfma_f32_16x16x32_bf16 v[176:179], a[180:183], v[36:39], v[176:179]
  buffer_load_dwordx4 a[60:63], v6, s[16:19], s50 offen offset:1024 nt
  v_mfma_f32_16x16x32_bf16 v[184:187], a[180:183], v[44:47], v[184:187]
  ds_read_b64_tr_b16 a[218:219], v27 offset:1024
  v_mfma_f32_16x16x32_bf16 v[192:195], a[180:183], v[52:55], v[192:195]
  v_mfma_f32_16x16x32_bf16 v[200:203], a[180:183], v[60:63], v[200:203]
  ds_read_b64_tr_b16 a[220:221], v27 offset:8
  buffer_load_dwordx4 a[64:67], v5, s[16:19], s50 offen offset:2048 nt
  v_mfma_f32_16x16x32_bf16 v[208:211], a[180:183], v[68:71], v[208:211]
  v_mfma_f32_16x16x32_bf16 v[212:215], a[184:187], v[36:39], v[212:215]
  ds_read_b64_tr_b16 a[222:223], v27 offset:1032
  v_mfma_f32_16x16x32_bf16 v[220:223], a[184:187], v[44:47], v[220:223]
  buffer_load_dwordx4 a[68:71], v6, s[16:19], s50 offen offset:3072 nt
  v_mfma_f32_16x16x32_bf16 v[228:231], a[184:187], v[52:55], v[228:231]
  v_mfma_f32_16x16x32_bf16 v[236:239], a[184:187], v[60:63], v[236:239]
  v_mfma_f32_16x16x32_bf16 v[244:247], a[184:187], v[68:71], v[244:247]
  v_mfma_f32_16x16x32_bf16 v[216:219], a[188:191], v[36:39], v[216:219]
  v_mfma_f32_16x16x32_bf16 v[224:227], a[188:191], v[44:47], v[224:227]
  v_mfma_f32_16x16x32_bf16 v[232:235], a[188:191], v[52:55], v[232:235]
  v_mfma_f32_16x16x32_bf16 v[240:243], a[188:191], v[60:63], v[240:243]
  v_mfma_f32_16x16x32_bf16 v[248:251], a[188:191], v[68:71], v[248:251]
  s_waitcnt vmcnt(11) lgkmcnt(0)
  s_barrier
  v_mfma_f32_16x16x32_bf16 v[92:95], a[192:195], v[40:43], v[92:95]
  ds_read_b64_tr_b16 a[160:161], v24 offset:8192
  v_mfma_f32_16x16x32_bf16 v[100:103], a[192:195], v[48:51], v[100:103]
  s_add_u32 m0, s47, 6144
  s_add_u32 s51, s40, 768
  buffer_load_dwordx4 v11, s[8:11], s51 offen lds
  v_mfma_f32_16x16x32_bf16 v[108:111], a[192:195], v[56:59], v[108:111]
  ds_read_b64_tr_b16 a[162:163], v24 offset:9216
  v_mfma_f32_16x16x32_bf16 v[116:119], a[192:195], v[64:67], v[116:119]
  ds_read_b128 a[0:3], v254 offset:0
  v_mfma_f32_16x16x32_bf16 v[124:127], a[192:195], v[72:75], v[124:127]
  ds_read_b64_tr_b16 a[164:165], v24 offset:8200
  v_mfma_f32_16x16x32_bf16 v[96:99], a[196:199], v[40:43], v[96:99]
  v_mfma_f32_16x16x32_bf16 v[104:107], a[196:199], v[48:51], v[104:107]
  ds_read_b128 a[8:11], v254 offset:2048
  ds_read_b64_tr_b16 a[166:167], v24 offset:9224
  s_add_u32 m0, s47, 8192
  s_add_u32 s51, s41, 768
  buffer_load_dwordx4 v11, s[8:11], s51 offen lds
  v_mfma_f32_16x16x32_bf16 v[112:115], a[196:199], v[56:59], v[112:115]
  v_mfma_f32_16x16x32_bf16 v[120:123], a[196:199], v[64:67], v[120:123]
  ds_read_b64_tr_b16 a[168:169], v25 offset:8192
  v_mfma_f32_16x16x32_bf16 v[128:131], a[196:199], v[72:75], v[128:131]
  ds_read_b128 a[16:19], v254 offset:4096
  v_mfma_f32_16x16x32_bf16 v[132:135], a[200:203], v[40:43], v[132:135]
  ds_read_b64_tr_b16 a[170:171], v25 offset:9216
  v_mfma_f32_16x16x32_bf16 v[140:143], a[200:203], v[48:51], v[140:143]
  s_add_u32 m0, s79, 0
  s_add_u32 s51, s36, 3145728
  buffer_load_dwordx4 v7, s[20:23], s51 offen offset:0 lds
  v_mfma_f32_16x16x32_bf16 v[148:151], a[200:203], v[56:59], v[148:151]
  ds_read_b128 a[24:27], v254 offset:6144
  ds_read_b64_tr_b16 a[172:173], v25 offset:8200
  v_mfma_f32_16x16x32_bf16 v[156:159], a[200:203], v[64:67], v[156:159]
  v_mfma_f32_16x16x32_bf16 v[164:167], a[200:203], v[72:75], v[164:167]
  ds_read_b64_tr_b16 a[174:175], v25 offset:9224
  v_mfma_f32_16x16x32_bf16 v[136:139], a[204:207], v[40:43], v[136:139]
  ds_read_b128 a[32:35], v254 offset:8192
  v_mfma_f32_16x16x32_bf16 v[144:147], a[204:207], v[48:51], v[144:147]
  ds_read_b64_tr_b16 a[176:177], v26 offset:8192
  buffer_load_dwordx4 v8, s[20:23], s51 offen offset:1024 lds
  v_mfma_f32_16x16x32_bf16 v[152:155], a[204:207], v[56:59], v[152:155]
  v_mfma_f32_16x16x32_bf16 v[160:163], a[204:207], v[64:67], v[160:163]
  ds_read_b128 a[4:7], v255 offset:0
  ds_read_b64_tr_b16 a[178:179], v26 offset:9216
  v_mfma_f32_16x16x32_bf16 v[168:171], a[204:207], v[72:75], v[168:171]
  v_mfma_f32_16x16x32_bf16 v[172:175], a[208:211], v[40:43], v[172:175]
  ds_read_b64_tr_b16 a[180:181], v26 offset:8200
  v_mfma_f32_16x16x32_bf16 v[180:183], a[208:211], v[48:51], v[180:183]
  ds_read_b128 a[12:15], v255 offset:2048
  buffer_load_dwordx4 v9, s[20:23], s51 offen offset:2048 lds
  v_mfma_f32_16x16x32_bf16 v[188:191], a[208:211], v[56:59], v[188:191]
  ds_read_b64_tr_b16 a[182:183], v26 offset:9224
  v_mfma_f32_16x16x32_bf16 v[196:199], a[208:211], v[64:67], v[196:199]
  v_mfma_f32_16x16x32_bf16 v[204:207], a[208:211], v[72:75], v[204:207]
  ds_read_b128 a[20:23], v255 offset:4096
  ds_read_b64_tr_b16 a[184:185], v27 offset:8192
  v_mfma_f32_16x16x32_bf16 v[176:179], a[212:215], v[40:43], v[176:179]
  v_mfma_f32_16x16x32_bf16 v[184:187], a[212:215], v[48:51], v[184:187]
  ds_read_b64_tr_b16 a[186:187], v27 offset:9216
  buffer_load_dwordx4 v10, s[20:23], s51 offen offset:3072 lds
  v_mfma_f32_16x16x32_bf16 v[192:195], a[212:215], v[56:59], v[192:195]
  ds_read_b128 a[28:31], v255 offset:6144
  v_mfma_f32_16x16x32_bf16 v[200:203], a[212:215], v[64:67], v[200:203]
  ds_read_b64_tr_b16 a[188:189], v27 offset:8200
  v_mfma_f32_16x16x32_bf16 v[208:211], a[212:215], v[72:75], v[208:211]
  v_mfma_f32_16x16x32_bf16 v[212:215], a[216:219], v[40:43], v[212:215]
  ds_read_b128 a[36:39], v255 offset:8192
  ds_read_b64_tr_b16 a[190:191], v27 offset:9224
  v_mfma_f32_16x16x32_bf16 v[220:223], a[216:219], v[48:51], v[220:223]
  v_mfma_f32_16x16x32_bf16 v[228:231], a[216:219], v[56:59], v[228:231]
  v_mfma_f32_16x16x32_bf16 v[236:239], a[216:219], v[64:67], v[236:239]
  v_mfma_f32_16x16x32_bf16 v[244:247], a[216:219], v[72:75], v[244:247]
  v_mfma_f32_16x16x32_bf16 v[216:219], a[220:223], v[40:43], v[216:219]
  v_mfma_f32_16x16x32_bf16 v[224:227], a[220:223], v[48:51], v[224:227]
  v_mfma_f32_16x16x32_bf16 v[232:235], a[220:223], v[56:59], v[232:235]
  v_mfma_f32_16x16x32_bf16 v[240:243], a[220:223], v[64:67], v[240:243]
  v_mfma_f32_16x16x32_bf16 v[248:251], a[220:223], v[72:75], v[248:251]
  s_waitcnt vmcnt(10) lgkmcnt(0)
  s_barrier
  v_mfma_f32_16x16x32_bf16 v[92:95], a[160:163], a[0:3], v[92:95]
  ds_read_b64_tr_b16 a[192:193], v24 offset:16384
  v_mfma_f32_16x16x32_bf16 v[100:103], a[160:163], a[8:11], v[100:103]
  s_add_u32 m0, s47, 81920
  s_add_u32 s51, s37, 896
  buffer_load_dwordx4 v11, s[8:11], s51 offen lds
  v_mfma_f32_16x16x32_bf16 v[108:111], a[160:163], a[16:19], v[108:111]
  ds_read_b64_tr_b16 a[194:195], v24 offset:17408
  v_mfma_f32_16x16x32_bf16 v[116:119], a[160:163], a[24:27], v[116:119]
  v_mfma_f32_16x16x32_bf16 v[124:127], a[160:163], a[32:35], v[124:127]
  ds_read_b64_tr_b16 a[196:197], v24 offset:16392
  v_mfma_f32_16x16x32_bf16 v[96:99], a[164:167], a[0:3], v[96:99]
  v_mfma_f32_16x16x32_bf16 v[104:107], a[164:167], a[8:11], v[104:107]
  ds_read_b64_tr_b16 a[198:199], v24 offset:17416
  s_add_u32 m0, s47, 83968
  s_add_u32 s51, s38, 896
  buffer_load_dwordx4 v11, s[8:11], s51 offen lds
  v_mfma_f32_16x16x32_bf16 v[112:115], a[164:167], a[16:19], v[112:115]
  v_mfma_f32_16x16x32_bf16 v[120:123], a[164:167], a[24:27], v[120:123]
  ds_read_b64_tr_b16 a[200:201], v25 offset:16384
  v_mfma_f32_16x16x32_bf16 v[128:131], a[164:167], a[32:35], v[128:131]
  v_mfma_f32_16x16x32_bf16 v[132:135], a[168:171], a[0:3], v[132:135]
  ds_read_b64_tr_b16 a[202:203], v25 offset:17408
  v_mfma_f32_16x16x32_bf16 v[140:143], a[168:171], a[8:11], v[140:143]
  s_add_u32 m0, s47, 86016
  s_add_u32 s51, s39, 896
  buffer_load_dwordx4 v11, s[8:11], s51 offen lds
  v_mfma_f32_16x16x32_bf16 v[148:151], a[168:171], a[16:19], v[148:151]
  ds_read_b64_tr_b16 a[204:205], v25 offset:16392
  v_mfma_f32_16x16x32_bf16 v[156:159], a[168:171], a[24:27], v[156:159]
  v_mfma_f32_16x16x32_bf16 v[164:167], a[168:171], a[32:35], v[164:167]
  ds_read_b64_tr_b16 a[206:207], v25 offset:17416
  v_mfma_f32_16x16x32_bf16 v[136:139], a[172:175], a[0:3], v[136:139]
  v_mfma_f32_16x16x32_bf16 v[144:147], a[172:175], a[8:11], v[144:147]
  ds_read_b64_tr_b16 a[208:209], v26 offset:16384
  s_add_u32 m0, s79, 8192
  s_add_u32 s51, s36, 3407872
  buffer_load_dwordx4 v7, s[20:23], s51 offen offset:0 lds
  v_mfma_f32_16x16x32_bf16 v[152:155], a[172:175], a[16:19], v[152:155]
  v_mfma_f32_16x16x32_bf16 v[160:163], a[172:175], a[24:27], v[160:163]
  ds_read_b64_tr_b16 a[210:211], v26 offset:17408
  v_mfma_f32_16x16x32_bf16 v[168:171], a[172:175], a[32:35], v[168:171]
  v_mfma_f32_16x16x32_bf16 v[172:175], a[176:179], a[0:3], v[172:175]
  ds_read_b64_tr_b16 a[212:213], v26 offset:16392
  v_mfma_f32_16x16x32_bf16 v[180:183], a[176:179], a[8:11], v[180:183]
  buffer_load_dwordx4 v8, s[20:23], s51 offen offset:1024 lds
  v_mfma_f32_16x16x32_bf16 v[188:191], a[176:179], a[16:19], v[188:191]
  ds_read_b64_tr_b16 a[214:215], v26 offset:17416
  v_mfma_f32_16x16x32_bf16 v[196:199], a[176:179], a[24:27], v[196:199]
  v_mfma_f32_16x16x32_bf16 v[204:207], a[176:179], a[32:35], v[204:207]
  ds_read_b64_tr_b16 a[216:217], v27 offset:16384
  v_mfma_f32_16x16x32_bf16 v[176:179], a[180:183], a[0:3], v[176:179]
  v_mfma_f32_16x16x32_bf16 v[184:187], a[180:183], a[8:11], v[184:187]
  ds_read_b64_tr_b16 a[218:219], v27 offset:17408
  buffer_load_dwordx4 v9, s[20:23], s51 offen offset:2048 lds
  v_mfma_f32_16x16x32_bf16 v[192:195], a[180:183], a[16:19], v[192:195]
  v_mfma_f32_16x16x32_bf16 v[200:203], a[180:183], a[24:27], v[200:203]
  ds_read_b64_tr_b16 a[220:221], v27 offset:16392
  v_mfma_f32_16x16x32_bf16 v[208:211], a[180:183], a[32:35], v[208:211]
  v_mfma_f32_16x16x32_bf16 v[212:215], a[184:187], a[0:3], v[212:215]
  ds_read_b64_tr_b16 a[222:223], v27 offset:17416
  v_mfma_f32_16x16x32_bf16 v[220:223], a[184:187], a[8:11], v[220:223]
  buffer_load_dwordx4 v10, s[20:23], s51 offen offset:3072 lds
  v_mfma_f32_16x16x32_bf16 v[228:231], a[184:187], a[16:19], v[228:231]
  v_mfma_f32_16x16x32_bf16 v[236:239], a[184:187], a[24:27], v[236:239]
  v_mfma_f32_16x16x32_bf16 v[244:247], a[184:187], a[32:35], v[244:247]
  v_mfma_f32_16x16x32_bf16 v[216:219], a[188:191], a[0:3], v[216:219]
  v_mfma_f32_16x16x32_bf16 v[224:227], a[188:191], a[8:11], v[224:227]
  v_mfma_f32_16x16x32_bf16 v[232:235], a[188:191], a[16:19], v[232:235]
  v_mfma_f32_16x16x32_bf16 v[240:243], a[188:191], a[24:27], v[240:243]
  v_mfma_f32_16x16x32_bf16 v[248:251], a[188:191], a[32:35], v[248:251]
  s_waitcnt vmcnt(7) lgkmcnt(0)
  s_barrier
  v_mfma_f32_16x16x32_bf16 v[92:95], a[192:195], a[4:7], v[92:95]
  ds_read_b64_tr_b16 a[160:161], v24 offset:0
  v_mfma_f32_16x16x32_bf16 v[100:103], a[192:195], a[12:15], v[100:103]
  s_add_u32 m0, s47, 88064
  s_add_u32 s51, s40, 896
  buffer_load_dwordx4 v11, s[8:11], s51 offen lds
  v_mfma_f32_16x16x32_bf16 v[108:111], a[192:195], a[20:23], v[108:111]
  ds_read_b64_tr_b16 a[162:163], v24 offset:1024
  v_mfma_f32_16x16x32_bf16 v[116:119], a[192:195], a[28:31], v[116:119]
  ds_read_b128 v[36:39], v252 offset:0
  v_mfma_f32_16x16x32_bf16 v[124:127], a[192:195], a[36:39], v[124:127]
  ds_read_b64_tr_b16 a[164:165], v24 offset:8
  s_add_u32 m0, s47, 90112
  s_add_u32 s51, s41, 896
  buffer_load_dwordx4 v11, s[8:11], s51 offen lds
  v_mfma_f32_16x16x32_bf16 v[96:99], a[196:199], a[4:7], v[96:99]
  v_mfma_f32_16x16x32_bf16 v[104:107], a[196:199], a[12:15], v[104:107]
  ds_read_b128 v[44:47], v252 offset:2048
  ds_read_b64_tr_b16 a[166:167], v24 offset:1032
  v_mfma_f32_16x16x32_bf16 v[112:115], a[196:199], a[20:23], v[112:115]
  s_add_u32 m0, s79, 16384
  s_add_u32 s51, s36, 3670016
  buffer_load_dwordx4 v7, s[20:23], s51 offen offset:0 lds
  v_mfma_f32_16x16x32_bf16 v[120:123], a[196:199], a[28:31], v[120:123]
  ds_read_b64_tr_b16 a[168:169], v25 offset:0
  v_mfma_f32_16x16x32_bf16 v[128:131], a[196:199], a[36:39], v[128:131]
  ds_read_b128 v[52:55], v252 offset:4096
  v_mfma_f32_16x16x32_bf16 v[132:135], a[200:203], a[4:7], v[132:135]
  ds_read_b64_tr_b16 a[170:171], v25 offset:1024
  buffer_load_dwordx4 v8, s[20:23], s51 offen offset:1024 lds
  v_mfma_f32_16x16x32_bf16 v[140:143], a[200:203], a[12:15], v[140:143]
  v_mfma_f32_16x16x32_bf16 v[148:151], a[200:203], a[20:23], v[148:151]
  ds_read_b128 v[60:63], v252 offset:6144
  ds_read_b64_tr_b16 a[172:173], v25 offset:8
  v_mfma_f32_16x16x32_bf16 v[156:159], a[200:203], a[28:31], v[156:159]
  buffer_load_dwordx4 v9, s[20:23], s51 offen offset:2048 lds
  v_mfma_f32_16x16x32_bf16 v[164:167], a[200:203], a[36:39], v[164:167]
  ds_read_b64_tr_b16 a[174:175], v25 offset:1032
  v_mfma_f32_16x16x32_bf16 v[136:139], a[204:207], a[4:7], v[136:139]
  ds_read_b128 v[68:71], v252 offset:8192
  v_mfma_f32_16x16x32_bf16 v[144:147], a[204:207], a[12:15], v[144:147]
  ds_read_b64_tr_b16 a[176:177], v26 offset:0
  buffer_load_dwordx4 v10, s[20:23], s51 offen offset:3072 lds
  v_mfma_f32_16x16x32_bf16 v[152:155], a[204:207], a[20:23], v[152:155]
  v_mfma_f32_16x16x32_bf16 v[160:163], a[204:207], a[28:31], v[160:163]
  ds_read_b128 v[40:43], v253 offset:0
  ds_read_b64_tr_b16 a[178:179], v26 offset:1024
  v_mfma_f32_16x16x32_bf16 v[168:171], a[204:207], a[36:39], v[168:171]
  s_nop 0
  s_add_u32 s50, s82, 16384
  s_and_b32 s50, s50, 0x1ffff
  s_add_u32 s50, s50, s34
  buffer_load_dwordx4 a[72:75], v5, s[16:19], s50 offen offset:0 nt
  v_mfma_f32_16x16x32_bf16 v[172:175], a[208:211], a[4:7], v[172:175]
  ds_read_b64_tr_b16 a[180:181], v26 offset:8
  v_mfma_f32_16x16x32_bf16 v[180:183], a[208:211], a[12:15], v[180:183]
  ds_read_b128 v[48:51], v253 offset:2048
  v_mfma_f32_16x16x32_bf16 v[188:191], a[208:211], a[20:23], v[188:191]
  ds_read_b64_tr_b16 a[182:183], v26 offset:1032
  buffer_load_dwordx4 a[76:79], v6, s[16:19], s50 offen offset:1024 nt
  v_mfma_f32_16x16x32_bf16 v[196:199], a[208:211], a[28:31], v[196:199]
  v_mfma_f32_16x16x32_bf16 v[204:207], a[208:211], a[36:39], v[204:207]
  ds_read_b128 v[56:59], v253 offset:4096
  ds_read_b64_tr_b16 a[184:185], v27 offset:0
  v_mfma_f32_16x16x32_bf16 v[176:179], a[212:215], a[4:7], v[176:179]
  buffer_load_dwordx4 a[80:83], v5, s[16:19], s50 offen offset:2048 nt
  v_mfma_f32_16x16x32_bf16 v[184:187], a[212:215], a[12:15], v[184:187]
  ds_read_b64_tr_b16 a[186:187], v27 offset:1024
  v_mfma_f32_16x16x32_bf16 v[192:195], a[212:215], a[20:23], v[192:195]
  ds_read_b128 v[64:67], v253 offset:6144
  v_mfma_f32_16x16x32_bf16 v[200:203], a[212:215], a[28:31], v[200:203]
  ds_read_b64_tr_b16 a[188:189], v27 offset:8
  buffer_load_dwordx4 a[84:87], v6, s[16:19], s50 offen offset:3072 nt
  v_mfma_f32_16x16x32_bf16 v[208:211], a[212:215], a[36:39], v[208:211]
  v_mfma_f32_16x16x32_bf16 v[212:215], a[216:219], a[4:7], v[212:215]
  ds_read_b128 v[72:75], v253 offset:8192
  ds_read_b64_tr_b16 a[190:191], v27 offset:1032
  v_mfma_f32_16x16x32_bf16 v[220:223], a[216:219], a[12:15], v[220:223]
  v_mfma_f32_16x16x32_bf16 v[228:231], a[216:219], a[20:23], v[228:231]
  v_mfma_f32_16x16x32_bf16 v[236:239], a[216:219], a[28:31], v[236:239]
  v_mfma_f32_16x16x32_bf16 v[244:247], a[216:219], a[36:39], v[244:247]
  v_mfma_f32_16x16x32_bf16 v[216:219], a[220:223], a[4:7], v[216:219]
  v_mfma_f32_16x16x32_bf16 v[224:227], a[220:223], a[12:15], v[224:227]
  v_mfma_f32_16x16x32_bf16 v[232:235], a[220:223], a[20:23], v[232:235]
  v_mfma_f32_16x16x32_bf16 v[240:243], a[220:223], a[28:31], v[240:243]
  v_mfma_f32_16x16x32_bf16 v[248:251], a[220:223], a[36:39], v[248:251]
  s_waitcnt vmcnt(10) lgkmcnt(0)
  s_barrier
  v_mfma_f32_16x16x32_bf16 v[92:95], a[160:163], v[36:39], v[92:95]
  ds_read_b64_tr_b16 a[192:193], v24 offset:8192
  v_mfma_f32_16x16x32_bf16 v[100:103], a[160:163], v[44:47], v[100:103]
  s_add_u32 m0, s47, 0
  s_add_u32 s51, s37, 1024
  buffer_load_dwordx4 v11, s[8:11], s51 offen lds
  v_mfma_f32_16x16x32_bf16 v[108:111], a[160:163], v[52:55], v[108:111]
  ds_read_b64_tr_b16 a[194:195], v24 offset:9216
  v_mfma_f32_16x16x32_bf16 v[116:119], a[160:163], v[60:63], v[116:119]
  v_mfma_f32_16x16x32_bf16 v[124:127], a[160:163], v[68:71], v[124:127]
  ds_read_b64_tr_b16 a[196:197], v24 offset:8200
  v_mfma_f32_16x16x32_bf16 v[96:99], a[164:167], v[36:39], v[96:99]
  v_mfma_f32_16x16x32_bf16 v[104:107], a[164:167], v[44:47], v[104:107]
  ds_read_b64_tr_b16 a[198:199], v24 offset:9224
  s_add_u32 m0, s47, 2048
  s_add_u32 s51, s38, 1024
  buffer_load_dwordx4 v11, s[8:11], s51 offen lds
  v_mfma_f32_16x16x32_bf16 v[112:115], a[164:167], v[52:55], v[112:115]
  v_mfma_f32_16x16x32_bf16 v[120:123], a[164:167], v[60:63], v[120:123]
  ds_read_b64_tr_b16 a[200:201], v25 offset:8192
  v_mfma_f32_16x16x32_bf16 v[128:131], a[164:167], v[68:71], v[128:131]
  v_mfma_f32_16x16x32_bf16 v[132:135], a[168:171], v[36:39], v[132:135]
  ds_read_b64_tr_b16 a[202:203], v25 offset:9216
  v_mfma_f32_16x16x32_bf16 v[140:143], a[168:171], v[44:47], v[140:143]
  s_add_u32 m0, s47, 4096
  s_add_u32 s51, s39, 1024
  buffer_load_dwordx4 v11, s[8:11], s51 offen lds
  v_mfma_f32_16x16x32_bf16 v[148:151], a[168:171], v[52:55], v[148:151]
  ds_read_b64_tr_b16 a[204:205], v25 offset:8200
  v_mfma_f32_16x16x32_bf16 v[156:159], a[168:171], v[60:63], v[156:159]
  v_mfma_f32_16x16x32_bf16 v[164:167], a[168:171], v[68:71], v[164:167]
  ds_read_b64_tr_b16 a[206:207], v25 offset:9224
  v_mfma_f32_16x16x32_bf16 v[136:139], a[172:175], v[36:39], v[136:139]
  v_mfma_f32_16x16x32_bf16 v[144:147], a[172:175], v[44:47], v[144:147]
  ds_read_b64_tr_b16 a[208:209], v26 offset:8192
  s_add_u32 m0, s79, 0
  s_add_u32 s51, s36, 3932160
  buffer_load_dwordx4 v7, s[20:23], s51 offen offset:0 lds
  v_mfma_f32_16x16x32_bf16 v[152:155], a[172:175], v[52:55], v[152:155]
  v_mfma_f32_16x16x32_bf16 v[160:163], a[172:175], v[60:63], v[160:163]
  ds_read_b64_tr_b16 a[210:211], v26 offset:9216
  v_mfma_f32_16x16x32_bf16 v[168:171], a[172:175], v[68:71], v[168:171]
  v_mfma_f32_16x16x32_bf16 v[172:175], a[176:179], v[36:39], v[172:175]
  ds_read_b64_tr_b16 a[212:213], v26 offset:8200
  v_mfma_f32_16x16x32_bf16 v[180:183], a[176:179], v[44:47], v[180:183]
  buffer_load_dwordx4 v8, s[20:23], s51 offen offset:1024 lds
  v_mfma_f32_16x16x32_bf16 v[188:191], a[176:179], v[52:55], v[188:191]
  ds_read_b64_tr_b16 a[214:215], v26 offset:9224
  v_mfma_f32_16x16x32_bf16 v[196:199], a[176:179], v[60:63], v[196:199]
  v_mfma_f32_16x16x32_bf16 v[204:207], a[176:179], v[68:71], v[204:207]
  ds_read_b64_tr_b16 a[216:217], v27 offset:8192
  v_mfma_f32_16x16x32_bf16 v[176:179], a[180:183], v[36:39], v[176:179]
  v_mfma_f32_16x16x32_bf16 v[184:187], a[180:183], v[44:47], v[184:187]
  ds_read_b64_tr_b16 a[218:219], v27 offset:9216
  buffer_load_dwordx4 v9, s[20:23], s51 offen offset:2048 lds
  v_mfma_f32_16x16x32_bf16 v[192:195], a[180:183], v[52:55], v[192:195]
  v_mfma_f32_16x16x32_bf16 v[200:203], a[180:183], v[60:63], v[200:203]
  ds_read_b64_tr_b16 a[220:221], v27 offset:8200
  v_mfma_f32_16x16x32_bf16 v[208:211], a[180:183], v[68:71], v[208:211]
  v_mfma_f32_16x16x32_bf16 v[212:215], a[184:187], v[36:39], v[212:215]
  ds_read_b64_tr_b16 a[222:223], v27 offset:9224
  v_mfma_f32_16x16x32_bf16 v[220:223], a[184:187], v[44:47], v[220:223]
  buffer_load_dwordx4 v10, s[20:23], s51 offen offset:3072 lds
  v_mfma_f32_16x16x32_bf16 v[228:231], a[184:187], v[52:55], v[228:231]
  v_mfma_f32_16x16x32_bf16 v[236:239], a[184:187], v[60:63], v[236:239]
  v_mfma_f32_16x16x32_bf16 v[244:247], a[184:187], v[68:71], v[244:247]
  v_mfma_f32_16x16x32_bf16 v[216:219], a[188:191], v[36:39], v[216:219]
  v_mfma_f32_16x16x32_bf16 v[224:227], a[188:191], v[44:47], v[224:227]
  v_mfma_f32_16x16x32_bf16 v[232:235], a[188:191], v[52:55], v[232:235]
  v_mfma_f32_16x16x32_bf16 v[240:243], a[188:191], v[60:63], v[240:243]
  v_mfma_f32_16x16x32_bf16 v[248:251], a[188:191], v[68:71], v[248:251]
  s_waitcnt vmcnt(11) lgkmcnt(0)
  s_barrier
  v_mfma_f32_16x16x32_bf16 v[92:95], a[192:195], v[40:43], v[92:95]
  ds_read_b64_tr_b16 a[160:161], v24 offset:16384
  v_mfma_f32_16x16x32_bf16 v[100:103], a[192:195], v[48:51], v[100:103]
  s_add_u32 m0, s47, 6144
  s_add_u32 s51, s40, 1024
  buffer_load_dwordx4 v11, s[8:11], s51 offen lds
  v_mfma_f32_16x16x32_bf16 v[108:111], a[192:195], v[56:59], v[108:111]
  ds_read_b64_tr_b16 a[162:163], v24 offset:17408
  v_mfma_f32_16x16x32_bf16 v[116:119], a[192:195], v[64:67], v[116:119]
  ds_read_b128 a[0:3], v254 offset:0
  v_mfma_f32_16x16x32_bf16 v[124:127], a[192:195], v[72:75], v[124:127]
  ds_read_b64_tr_b16 a[164:165], v24 offset:16392
  v_mfma_f32_16x16x32_bf16 v[96:99], a[196:199], v[40:43], v[96:99]
  v_mfma_f32_16x16x32_bf16 v[104:107], a[196:199], v[48:51], v[104:107]
  ds_read_b128 a[8:11], v254 offset:2048
  ds_read_b64_tr_b16 a[166:167], v24 offset:17416
  s_add_u32 m0, s47, 8192
  s_add_u32 s51, s41, 1024
  buffer_load_dwordx4 v11, s[8:11], s51 offen lds
  v_mfma_f32_16x16x32_bf16 v[112:115], a[196:199], v[56:59], v[112:115]
  v_mfma_f32_16x16x32_bf16 v[120:123], a[196:199], v[64:67], v[120:123]
  ds_read_b64_tr_b16 a[168:169], v25 offset:16384
  v_mfma_f32_16x16x32_bf16 v[128:131], a[196:199], v[72:75], v[128:131]
  ds_read_b128 a[16:19], v254 offset:4096
  v_mfma_f32_16x16x32_bf16 v[132:135], a[200:203], v[40:43], v[132:135]
  ds_read_b64_tr_b16 a[170:171], v25 offset:17408
  v_mfma_f32_16x16x32_bf16 v[140:143], a[200:203], v[48:51], v[140:143]
  s_add_u32 m0, s79, 8192
  s_add_u32 s51, s36, 4194304
  buffer_load_dwordx4 v7, s[20:23], s51 offen offset:0 lds
  v_mfma_f32_16x16x32_bf16 v[148:151], a[200:203], v[56:59], v[148:151]
  ds_read_b128 a[24:27], v254 offset:6144
  ds_read_b64_tr_b16 a[172:173], v25 offset:16392
  v_mfma_f32_16x16x32_bf16 v[156:159], a[200:203], v[64:67], v[156:159]
  v_mfma_f32_16x16x32_bf16 v[164:167], a[200:203], v[72:75], v[164:167]
  ds_read_b64_tr_b16 a[174:175], v25 offset:17416
  v_mfma_f32_16x16x32_bf16 v[136:139], a[204:207], v[40:43], v[136:139]
  ds_read_b128 a[32:35], v254 offset:8192
  v_mfma_f32_16x16x32_bf16 v[144:147], a[204:207], v[48:51], v[144:147]
  ds_read_b64_tr_b16 a[176:177], v26 offset:16384
  buffer_load_dwordx4 v8, s[20:23], s51 offen offset:1024 lds
  v_mfma_f32_16x16x32_bf16 v[152:155], a[204:207], v[56:59], v[152:155]
  v_mfma_f32_16x16x32_bf16 v[160:163], a[204:207], v[64:67], v[160:163]
  ds_read_b128 a[4:7], v255 offset:0
  ds_read_b64_tr_b16 a[178:179], v26 offset:17408
  v_mfma_f32_16x16x32_bf16 v[168:171], a[204:207], v[72:75], v[168:171]
  v_mfma_f32_16x16x32_bf16 v[172:175], a[208:211], v[40:43], v[172:175]
  ds_read_b64_tr_b16 a[180:181], v26 offset:16392
  v_mfma_f32_16x16x32_bf16 v[180:183], a[208:211], v[48:51], v[180:183]
  ds_read_b128 a[12:15], v255 offset:2048
  buffer_load_dwordx4 v9, s[20:23], s51 offen offset:2048 lds
  v_mfma_f32_16x16x32_bf16 v[188:191], a[208:211], v[56:59], v[188:191]
  ds_read_b64_tr_b16 a[182:183], v26 offset:17416
  v_mfma_f32_16x16x32_bf16 v[196:199], a[208:211], v[64:67], v[196:199]
  v_mfma_f32_16x16x32_bf16 v[204:207], a[208:211], v[72:75], v[204:207]
  ds_read_b128 a[20:23], v255 offset:4096
  ds_read_b64_tr_b16 a[184:185], v27 offset:16384
  v_mfma_f32_16x16x32_bf16 v[176:179], a[212:215], v[40:43], v[176:179]
  v_mfma_f32_16x16x32_bf16 v[184:187], a[212:215], v[48:51], v[184:187]
  ds_read_b64_tr_b16 a[186:187], v27 offset:17408
  buffer_load_dwordx4 v10, s[20:23], s51 offen offset:3072 lds
  v_mfma_f32_16x16x32_bf16 v[192:195], a[212:215], v[56:59], v[192:195]
  ds_read_b128 a[28:31], v255 offset:6144
  v_mfma_f32_16x16x32_bf16 v[200:203], a[212:215], v[64:67], v[200:203]
  ds_read_b64_tr_b16 a[188:189], v27 offset:16392
  v_mfma_f32_16x16x32_bf16 v[208:211], a[212:215], v[72:75], v[208:211]
  v_mfma_f32_16x16x32_bf16 v[212:215], a[216:219], v[40:43], v[212:215]
  ds_read_b128 a[36:39], v255 offset:8192
  ds_read_b64_tr_b16 a[190:191], v27 offset:17416
  v_mfma_f32_16x16x32_bf16 v[220:223], a[216:219], v[48:51], v[220:223]
  v_mfma_f32_16x16x32_bf16 v[228:231], a[216:219], v[56:59], v[228:231]
  v_mfma_f32_16x16x32_bf16 v[236:239], a[216:219], v[64:67], v[236:239]
  v_mfma_f32_16x16x32_bf16 v[244:247], a[216:219], v[72:75], v[244:247]
  v_mfma_f32_16x16x32_bf16 v[216:219], a[220:223], v[40:43], v[216:219]
  v_mfma_f32_16x16x32_bf16 v[224:227], a[220:223], v[48:51], v[224:227]
  v_mfma_f32_16x16x32_bf16 v[232:235], a[220:223], v[56:59], v[232:235]
  v_mfma_f32_16x16x32_bf16 v[240:243], a[220:223], v[64:67], v[240:243]
  v_mfma_f32_16x16x32_bf16 v[248:251], a[220:223], v[72:75], v[248:251]
  s_waitcnt vmcnt(6) lgkmcnt(0)
  s_barrier
  v_mfma_f32_16x16x32_bf16 v[92:95], a[160:163], a[0:3], v[92:95]
  ds_read_b64_tr_b16 a[192:193], v24 offset:0
  v_mfma_f32_16x16x32_bf16 v[100:103], a[160:163], a[8:11], v[100:103]
  s_add_u32 m0, s79, 16384
  s_add_u32 s51, s36, 4456448
  buffer_load_dwordx4 v7, s[20:23], s51 offen offset:0 lds
  v_mfma_f32_16x16x32_bf16 v[108:111], a[160:163], a[16:19], v[108:111]
  ds_read_b64_tr_b16 a[194:195], v24 offset:1024
  v_mfma_f32_16x16x32_bf16 v[116:119], a[160:163], a[24:27], v[116:119]
  v_mfma_f32_16x16x32_bf16 v[124:127], a[160:163], a[32:35], v[124:127]
  ds_read_b64_tr_b16 a[196:197], v24 offset:8
  buffer_load_dwordx4 v8, s[20:23], s51 offen offset:1024 lds
  v_mfma_f32_16x16x32_bf16 v[96:99], a[164:167], a[0:3], v[96:99]
  v_mfma_f32_16x16x32_bf16 v[104:107], a[164:167], a[8:11], v[104:107]
  ds_read_b64_tr_b16 a[198:199], v24 offset:1032
  v_mfma_f32_16x16x32_bf16 v[112:115], a[164:167], a[16:19], v[112:115]
  buffer_load_dwordx4 v9, s[20:23], s51 offen offset:2048 lds
  v_mfma_f32_16x16x32_bf16 v[120:123], a[164:167], a[24:27], v[120:123]
  ds_read_b64_tr_b16 a[200:201], v25 offset:0
  v_mfma_f32_16x16x32_bf16 v[128:131], a[164:167], a[32:35], v[128:131]
  v_mfma_f32_16x16x32_bf16 v[132:135], a[168:171], a[0:3], v[132:135]
  ds_read_b64_tr_b16 a[202:203], v25 offset:1024
  buffer_load_dwordx4 v10, s[20:23], s51 offen offset:3072 lds
  v_mfma_f32_16x16x32_bf16 v[140:143], a[168:171], a[8:11], v[140:143]
  v_mfma_f32_16x16x32_bf16 v[148:151], a[168:171], a[16:19], v[148:151]
  ds_read_b64_tr_b16 a[204:205], v25 offset:8
  v_mfma_f32_16x16x32_bf16 v[156:159], a[168:171], a[24:27], v[156:159]
  s_nop 0
  s_add_u32 s50, s82, 24576
  s_and_b32 s50, s50, 0x1ffff
  s_add_u32 s50, s50, s34
  buffer_load_dwordx4 a[88:91], v5, s[16:19], s50 offen offset:0 nt
  v_mfma_f32_16x16x32_bf16 v[164:167], a[168:171], a[32:35], v[164:167]
  ds_read_b64_tr_b16 a[206:207], v25 offset:1032
  v_mfma_f32_16x16x32_bf16 v[136:139], a[172:175], a[0:3], v[136:139]
  v_mfma_f32_16x16x32_bf16 v[144:147], a[172:175], a[8:11], v[144:147]
  ds_read_b64_tr_b16 a[208:209], v26 offset:0
  buffer_load_dwordx4 a[92:95], v6, s[16:19], s50 offen offset:1024 nt
  v_mfma_f32_16x16x32_bf16 v[152:155], a[172:175], a[16:19], v[152:155]
  v_mfma_f32_16x16x32_bf16 v[160:163], a[172:175], a[24:27], v[160:163]
  ds_read_b64_tr_b16 a[210:211], v26 offset:1024
  v_mfma_f32_16x16x32_bf16 v[168:171], a[172:175], a[32:35], v[168:171]
  buffer_load_dwordx4 a[96:99], v5, s[16:19], s50 offen offset:2048 nt
  v_mfma_f32_16x16x32_bf16 v[172:175], a[176:179], a[0:3], v[172:175]
  ds_read_b64_tr_b16 a[212:213], v26 offset:8
  v_mfma_f32_16x16x32_bf16 v[180:183], a[176:179], a[8:11], v[180:183]
  v_mfma_f32_16x16x32_bf16 v[188:191], a[176:179], a[16:19], v[188:191]
  ds_read_b64_tr_b16 a[214:215], v26 offset:1032
  buffer_load_dwordx4 a[100:103], v6, s[16:19], s50 offen offset:3072 nt
  v_mfma_f32_16x16x32_bf16 v[196:199], a[176:179], a[24:27], v[196:199]
  v_mfma_f32_16x16x32_bf16 v[204:207], a[176:179], a[32:35], v[204:207]
  ds_read_b64_tr_b16 a[216:217], v27 offset:0
  v_mfma_f32_16x16x32_bf16 v[176:179], a[180:183], a[0:3], v[176:179]
  v_mfma_f32_16x16x32_bf16 v[184:187], a[180:183], a[8:11], v[184:187]
  ds_read_b64_tr_b16 a[218:219], v27 offset:1024
  v_mfma_f32_16x16x32_bf16 v[192:195], a[180:183], a[16:19], v[192:195]
  v_mfma_f32_16x16x32_bf16 v[200:203], a[180:183], a[24:27], v[200:203]
  ds_read_b64_tr_b16 a[220:221], v27 offset:8
  v_mfma_f32_16x16x32_bf16 v[208:211], a[180:183], a[32:35], v[208:211]
  v_mfma_f32_16x16x32_bf16 v[212:215], a[184:187], a[0:3], v[212:215]
  ds_read_b64_tr_b16 a[222:223], v27 offset:1032
  v_mfma_f32_16x16x32_bf16 v[220:223], a[184:187], a[8:11], v[220:223]
  v_mfma_f32_16x16x32_bf16 v[228:231], a[184:187], a[16:19], v[228:231]
  v_mfma_f32_16x16x32_bf16 v[236:239], a[184:187], a[24:27], v[236:239]
  v_mfma_f32_16x16x32_bf16 v[244:247], a[184:187], a[32:35], v[244:247]
  v_mfma_f32_16x16x32_bf16 v[216:219], a[188:191], a[0:3], v[216:219]
  v_mfma_f32_16x16x32_bf16 v[224:227], a[188:191], a[8:11], v[224:227]
  v_mfma_f32_16x16x32_bf16 v[232:235], a[188:191], a[16:19], v[232:235]
  v_mfma_f32_16x16x32_bf16 v[240:243], a[188:191], a[24:27], v[240:243]
  v_mfma_f32_16x16x32_bf16 v[248:251], a[188:191], a[32:35], v[248:251]
  s_waitcnt vmcnt(8) lgkmcnt(0)
  s_barrier
  v_mfma_f32_16x16x32_bf16 v[92:95], a[192:195], a[4:7], v[92:95]
  ds_read_b64_tr_b16 a[160:161], v24 offset:8192
  v_mfma_f32_16x16x32_bf16 v[100:103], a[192:195], a[12:15], v[100:103]
  s_nop 0
  s_add_u32 s50, s82, 32768
  s_and_b32 s50, s50, 0x1ffff
  s_add_u32 s50, s50, s34
  buffer_load_dwordx4 a[112:115], v1, s[12:15], s50 offen offset:0 nt
  v_mfma_f32_16x16x32_bf16 v[108:111], a[192:195], a[20:23], v[108:111]
  ds_read_b64_tr_b16 a[162:163], v24 offset:9216
  v_mfma_f32_16x16x32_bf16 v[116:119], a[192:195], a[28:31], v[116:119]
  ds_read_b128 v[36:39], v252 offset:0
  v_mfma_f32_16x16x32_bf16 v[124:127], a[192:195], a[36:39], v[124:127]
  ds_read_b64_tr_b16 a[164:165], v24 offset:8200
  v_mfma_f32_16x16x32_bf16 v[96:99], a[196:199], a[4:7], v[96:99]
  v_mfma_f32_16x16x32_bf16 v[104:107], a[196:199], a[12:15], v[104:107]
  ds_read_b128 v[44:47], v252 offset:2048
  ds_read_b64_tr_b16 a[166:167], v24 offset:9224
  buffer_load_dwordx4 a[116:119], v2, s[12:15], s50 offen offset:1024 nt
  v_mfma_f32_16x16x32_bf16 v[112:115], a[196:199], a[20:23], v[112:115]
  v_mfma_f32_16x16x32_bf16 v[120:123], a[196:199], a[28:31], v[120:123]
  ds_read_b64_tr_b16 a[168:169], v25 offset:8192
  v_mfma_f32_16x16x32_bf16 v[128:131], a[196:199], a[36:39], v[128:131]
  ds_read_b128 v[52:55], v252 offset:4096
  v_mfma_f32_16x16x32_bf16 v[132:135], a[200:203], a[4:7], v[132:135]
  ds_read_b64_tr_b16 a[170:171], v25 offset:9216
  v_mfma_f32_16x16x32_bf16 v[140:143], a[200:203], a[12:15], v[140:143]
  buffer_load_dwordx4 a[120:123], v3, s[12:15], s50 offen offset:2048 nt
  v_mfma_f32_16x16x32_bf16 v[148:151], a[200:203], a[20:23], v[148:151]
  ds_read_b128 v[60:63], v252 offset:6144
  ds_read_b64_tr_b16 a[172:173], v25 offset:8200
  v_mfma_f32_16x16x32_bf16 v[156:159], a[200:203], a[28:31], v[156:159]
  v_mfma_f32_16x16x32_bf16 v[164:167], a[200:203], a[36:39], v[164:167]
  ds_read_b64_tr_b16 a[174:175], v25 offset:9224
  v_mfma_f32_16x16x32_bf16 v[136:139], a[204:207], a[4:7], v[136:139]
  ds_read_b128 v[68:71], v252 offset:8192
  v_mfma_f32_16x16x32_bf16 v[144:147], a[204:207], a[12:15], v[144:147]
  ds_read_b64_tr_b16 a[176:177], v26 offset:8192
  buffer_load_dwordx4 a[124:127], v4, s[12:15], s50 offen offset:3072 nt
  v_mfma_f32_16x16x32_bf16 v[152:155], a[204:207], a[20:23], v[152:155]
  v_mfma_f32_16x16x32_bf16 v[160:163], a[204:207], a[28:31], v[160:163]
  ds_read_b128 v[40:43], v253 offset:0
  ds_read_b64_tr_b16 a[178:179], v26 offset:9216
  v_mfma_f32_16x16x32_bf16 v[168:171], a[204:207], a[36:39], v[168:171]
  v_mfma_f32_16x16x32_bf16 v[172:175], a[208:211], a[4:7], v[172:175]
  ds_read_b64_tr_b16 a[180:181], v26 offset:8200
  v_mfma_f32_16x16x32_bf16 v[180:183], a[208:211], a[12:15], v[180:183]
  ds_read_b128 v[48:51], v253 offset:2048
  v_mfma_f32_16x16x32_bf16 v[188:191], a[208:211], a[20:23], v[188:191]
  ds_read_b64_tr_b16 a[182:183], v26 offset:9224
  v_mfma_f32_16x16x32_bf16 v[196:199], a[208:211], a[28:31], v[196:199]
  v_mfma_f32_16x16x32_bf16 v[204:207], a[208:211], a[36:39], v[204:207]
  ds_read_b128 v[56:59], v253 offset:4096
  ds_read_b64_tr_b16 a[184:185], v27 offset:8192
  v_mfma_f32_16x16x32_bf16 v[176:179], a[212:215], a[4:7], v[176:179]
  v_mfma_f32_16x16x32_bf16 v[184:187], a[212:215], a[12:15], v[184:187]
  ds_read_b64_tr_b16 a[186:187], v27 offset:9216
  v_mfma_f32_16x16x32_bf16 v[192:195], a[212:215], a[20:23], v[192:195]
  ds_read_b128 v[64:67], v253 offset:6144
  v_mfma_f32_16x16x32_bf16 v[200:203], a[212:215], a[28:31], v[200:203]
  ds_read_b64_tr_b16 a[188:189], v27 offset:8200
  v_mfma_f32_16x16x32_bf16 v[208:211], a[212:215], a[36:39], v[208:211]
  v_mfma_f32_16x16x32_bf16 v[212:215], a[216:219], a[4:7], v[212:215]
  ds_read_b128 v[72:75], v253 offset:8192
  ds_read_b64_tr_b16 a[190:191], v27 offset:9224
  v_mfma_f32_16x16x32_bf16 v[220:223], a[216:219], a[12:15], v[220:223]
  v_mfma_f32_16x16x32_bf16 v[228:231], a[216:219], a[20:23], v[228:231]
  v_mfma_f32_16x16x32_bf16 v[236:239], a[216:219], a[28:31], v[236:239]
  v_mfma_f32_16x16x32_bf16 v[244:247], a[216:219], a[36:39], v[244:247]
  v_mfma_f32_16x16x32_bf16 v[216:219], a[220:223], a[4:7], v[216:219]
  v_mfma_f32_16x16x32_bf16 v[224:227], a[220:223], a[12:15], v[224:227]
  v_mfma_f32_16x16x32_bf16 v[232:235], a[220:223], a[20:23], v[232:235]
  v_mfma_f32_16x16x32_bf16 v[240:243], a[220:223], a[28:31], v[240:243]
  v_mfma_f32_16x16x32_bf16 v[248:251], a[220:223], a[36:39], v[248:251]
  s_waitcnt vmcnt(8) lgkmcnt(0)
  s_barrier
  v_mfma_f32_16x16x32_bf16 v[92:95], a[160:163], v[36:39], v[92:95]
  ds_read_b64_tr_b16 a[192:193], v24 offset:16384
  v_mfma_f32_16x16x32_bf16 v[100:103], a[160:163], v[44:47], v[100:103]
  s_nop 0
  s_add_u32 s50, s82, 40960
  s_and_b32 s50, s50, 0x1ffff
  s_add_u32 s50, s50, s34
  buffer_load_dwordx4 a[128:131], v1, s[12:15], s50 offen offset:0 nt
  v_mfma_f32_16x16x32_bf16 v[108:111], a[160:163], v[52:55], v[108:111]
  ds_read_b64_tr_b16 a[194:195], v24 offset:17408
  v_mfma_f32_16x16x32_bf16 v[116:119], a[160:163], v[60:63], v[116:119]
  v_mfma_f32_16x16x32_bf16 v[124:127], a[160:163], v[68:71], v[124:127]
  ds_read_b64_tr_b16 a[196:197], v24 offset:16392
  v_mfma_f32_16x16x32_bf16 v[96:99], a[164:167], v[36:39], v[96:99]
  v_mfma_f32_16x16x32_bf16 v[104:107], a[164:167], v[44:47], v[104:107]
  ds_read_b64_tr_b16 a[198:199], v24 offset:17416
  buffer_load_dwordx4 a[132:135], v2, s[12:15], s50 offen offset:1024 nt
  v_mfma_f32_16x16x32_bf16 v[112:115], a[164:167], v[52:55], v[112:115]
  v_mfma_f32_16x16x32_bf16 v[120:123], a[164:167], v[60:63], v[120:123]
  ds_read_b64_tr_b16 a[200:201], v25 offset:16384
  v_mfma_f32_16x16x32_bf16 v[128:131], a[164:167], v[68:71], v[128:131]
  v_mfma_f32_16x16x32_bf16 v[132:135], a[168:171], v[36:39], v[132:135]
  ds_read_b64_tr_b16 a[202:203], v25 offset:17408
  v_mfma_f32_16x16x32_bf16 v[140:143], a[168:171], v[44:47], v[140:143]
  buffer_load_dwordx4 a[136:139], v3, s[12:15], s50 offen offset:2048 nt
  v_mfma_f32_16x16x32_bf16 v[148:151], a[168:171], v[52:55], v[148:151]
  ds_read_b64_tr_b16 a[204:205], v25 offset:16392
  v_mfma_f32_16x16x32_bf16 v[156:159], a[168:171], v[60:63], v[156:159]
  v_mfma_f32_16x16x32_bf16 v[164:167], a[168:171], v[68:71], v[164:167]
  ds_read_b64_tr_b16 a[206:207], v25 offset:17416
  v_mfma_f32_16x16x32_bf16 v[136:139], a[172:175], v[36:39], v[136:139]
  v_mfma_f32_16x16x32_bf16 v[144:147], a[172:175], v[44:47], v[144:147]
  ds_read_b64_tr_b16 a[208:209], v26 offset:16384
  buffer_load_dwordx4 a[140:143], v4, s[12:15], s50 offen offset:3072 nt
  v_mfma_f32_16x16x32_bf16 v[152:155], a[172:175], v[52:55], v[152:155]
  v_mfma_f32_16x16x32_bf16 v[160:163], a[172:175], v[60:63], v[160:163]
  ds_read_b64_tr_b16 a[210:211], v26 offset:17408
  v_mfma_f32_16x16x32_bf16 v[168:171], a[172:175], v[68:71], v[168:171]
  v_mfma_f32_16x16x32_bf16 v[172:175], a[176:179], v[36:39], v[172:175]
  ds_read_b64_tr_b16 a[212:213], v26 offset:16392
  v_mfma_f32_16x16x32_bf16 v[180:183], a[176:179], v[44:47], v[180:183]
  v_mfma_f32_16x16x32_bf16 v[188:191], a[176:179], v[52:55], v[188:191]
  ds_read_b64_tr_b16 a[214:215], v26 offset:17416
  v_mfma_f32_16x16x32_bf16 v[196:199], a[176:179], v[60:63], v[196:199]
  v_mfma_f32_16x16x32_bf16 v[204:207], a[176:179], v[68:71], v[204:207]
  ds_read_b64_tr_b16 a[216:217], v27 offset:16384
  v_mfma_f32_16x16x32_bf16 v[176:179], a[180:183], v[36:39], v[176:179]
  v_mfma_f32_16x16x32_bf16 v[184:187], a[180:183], v[44:47], v[184:187]
  ds_read_b64_tr_b16 a[218:219], v27 offset:17408
  v_mfma_f32_16x16x32_bf16 v[192:195], a[180:183], v[52:55], v[192:195]
  v_mfma_f32_16x16x32_bf16 v[200:203], a[180:183], v[60:63], v[200:203]
  ds_read_b64_tr_b16 a[220:221], v27 offset:16392
  v_mfma_f32_16x16x32_bf16 v[208:211], a[180:183], v[68:71], v[208:211]
  v_mfma_f32_16x16x32_bf16 v[212:215], a[184:187], v[36:39], v[212:215]
  ds_read_b64_tr_b16 a[222:223], v27 offset:17416
  v_mfma_f32_16x16x32_bf16 v[220:223], a[184:187], v[44:47], v[220:223]
  v_mfma_f32_16x16x32_bf16 v[228:231], a[184:187], v[52:55], v[228:231]
  v_mfma_f32_16x16x32_bf16 v[236:239], a[184:187], v[60:63], v[236:239]
  v_mfma_f32_16x16x32_bf16 v[244:247], a[184:187], v[68:71], v[244:247]
  v_mfma_f32_16x16x32_bf16 v[216:219], a[188:191], v[36:39], v[216:219]
  v_mfma_f32_16x16x32_bf16 v[224:227], a[188:191], v[44:47], v[224:227]
  v_mfma_f32_16x16x32_bf16 v[232:235], a[188:191], v[52:55], v[232:235]
  v_mfma_f32_16x16x32_bf16 v[240:243], a[188:191], v[60:63], v[240:243]
  v_mfma_f32_16x16x32_bf16 v[248:251], a[188:191], v[68:71], v[248:251]
  s_waitcnt lgkmcnt(0)
  s_barrier
  v_mfma_f32_16x16x32_bf16 v[92:95], a[192:195], v[40:43], v[92:95]
  v_mfma_f32_16x16x32_bf16 v[100:103], a[192:195], v[48:51], v[100:103]
  s_nop 0
  s_add_u32 s50, s82, 32768
  s_and_b32 s50, s50, 0x1ffff
  s_add_u32 s50, s50, s34
  buffer_load_dwordx4 a[144:147], v5, s[16:19], s50 offen offset:0 nt
  v_mfma_f32_16x16x32_bf16 v[108:111], a[192:195], v[56:59], v[108:111]
  v_mfma_f32_16x16x32_bf16 v[116:119], a[192:195], v[64:67], v[116:119]
  v_mfma_f32_16x16x32_bf16 v[124:127], a[192:195], v[72:75], v[124:127]
  v_mfma_f32_16x16x32_bf16 v[96:99], a[196:199], v[40:43], v[96:99]
  v_mfma_f32_16x16x32_bf16 v[104:107], a[196:199], v[48:51], v[104:107]
  buffer_load_dwordx4 a[148:151], v6, s[16:19], s50 offen offset:1024 nt
  v_mfma_f32_16x16x32_bf16 v[112:115], a[196:199], v[56:59], v[112:115]
  v_mfma_f32_16x16x32_bf16 v[120:123], a[196:199], v[64:67], v[120:123]
  v_mfma_f32_16x16x32_bf16 v[128:131], a[196:199], v[72:75], v[128:131]
  v_mfma_f32_16x16x32_bf16 v[132:135], a[200:203], v[40:43], v[132:135]
  v_mfma_f32_16x16x32_bf16 v[140:143], a[200:203], v[48:51], v[140:143]
  buffer_load_dwordx4 a[152:155], v5, s[16:19], s50 offen offset:2048 nt
  v_mfma_f32_16x16x32_bf16 v[148:151], a[200:203], v[56:59], v[148:151]
  v_mfma_f32_16x16x32_bf16 v[156:159], a[200:203], v[64:67], v[156:159]
  v_mfma_f32_16x16x32_bf16 v[164:167], a[200:203], v[72:75], v[164:167]
  v_mfma_f32_16x16x32_bf16 v[136:139], a[204:207], v[40:43], v[136:139]
  v_mfma_f32_16x16x32_bf16 v[144:147], a[204:207], v[48:51], v[144:147]
  buffer_load_dwordx4 a[156:159], v6, s[16:19], s50 offen offset:3072 nt
  v_mfma_f32_16x16x32_bf16 v[152:155], a[204:207], v[56:59], v[152:155]
  v_mfma_f32_16x16x32_bf16 v[160:163], a[204:207], v[64:67], v[160:163]
  v_mfma_f32_16x16x32_bf16 v[168:171], a[204:207], v[72:75], v[168:171]
  v_mfma_f32_16x16x32_bf16 v[172:175], a[208:211], v[40:43], v[172:175]
  v_mfma_f32_16x16x32_bf16 v[180:183], a[208:211], v[48:51], v[180:183]
  v_mfma_f32_16x16x32_bf16 v[188:191], a[208:211], v[56:59], v[188:191]
  v_mfma_f32_16x16x32_bf16 v[196:199], a[208:211], v[64:67], v[196:199]
  v_mfma_f32_16x16x32_bf16 v[204:207], a[208:211], v[72:75], v[204:207]
  v_mfma_f32_16x16x32_bf16 v[176:179], a[212:215], v[40:43], v[176:179]
  v_mfma_f32_16x16x32_bf16 v[184:187], a[212:215], v[48:51], v[184:187]
  v_mfma_f32_16x16x32_bf16 v[192:195], a[212:215], v[56:59], v[192:195]
  v_mfma_f32_16x16x32_bf16 v[200:203], a[212:215], v[64:67], v[200:203]
  v_mfma_f32_16x16x32_bf16 v[208:211], a[212:215], v[72:75], v[208:211]
  v_mfma_f32_16x16x32_bf16 v[212:215], a[216:219], v[40:43], v[212:215]
  v_mfma_f32_16x16x32_bf16 v[220:223], a[216:219], v[48:51], v[220:223]
  v_mfma_f32_16x16x32_bf16 v[228:231], a[216:219], v[56:59], v[228:231]
  v_mfma_f32_16x16x32_bf16 v[236:239], a[216:219], v[64:67], v[236:239]
  v_mfma_f32_16x16x32_bf16 v[244:247], a[216:219], v[72:75], v[244:247]
  v_mfma_f32_16x16x32_bf16 v[216:219], a[220:223], v[40:43], v[216:219]
  v_mfma_f32_16x16x32_bf16 v[224:227], a[220:223], v[48:51], v[224:227]
  v_mfma_f32_16x16x32_bf16 v[232:235], a[220:223], v[56:59], v[232:235]
  v_mfma_f32_16x16x32_bf16 v[240:243], a[220:223], v[64:67], v[240:243]
  v_mfma_f32_16x16x32_bf16 v[248:251], a[220:223], v[72:75], v[248:251]
  ds_write_b128 v87, a[40:43] offset:24576
  ds_write_b128 v87, a[44:47] offset:25600
  ds_write_b128 v87, a[48:51] offset:26624
  ds_write_b128 v87, a[52:55] offset:27648
  s_nop 7
  v_mul_f32 v92, s48, v92
  v_mul_f32 v93, s48, v93
  v_mul_f32 v94, s48, v94
  v_mul_f32 v95, s48, v95
  v_mul_f32 v96, s48, v96
  v_mul_f32 v97, s48, v97
  v_mul_f32 v98, s48, v98
  v_mul_f32 v99, s48, v99
  v_cvt_pk_bf16_f32 v36, v92, v93
  v_cvt_pk_bf16_f32 v37, v94, v95
  v_cvt_pk_bf16_f32 v38, v96, v97
  v_cvt_pk_bf16_f32 v39, v98, v99
  v_mul_f32 v100, s48, v100
  v_mul_f32 v101, s48, v101
  v_mul_f32 v102, s48, v102
  v_mul_f32 v103, s48, v103
  v_mul_f32 v104, s48, v104
  v_mul_f32 v105, s48, v105
  v_mul_f32 v106, s48, v106
  v_mul_f32 v107, s48, v107
  v_cvt_pk_bf16_f32 v40, v100, v101
  v_cvt_pk_bf16_f32 v41, v102, v103
  v_cvt_pk_bf16_f32 v42, v104, v105
  v_cvt_pk_bf16_f32 v43, v106, v107
  v_mul_f32 v108, s48, v108
  v_mul_f32 v109, s48, v109
  v_mul_f32 v110, s48, v110
  v_mul_f32 v111, s48, v111
  v_mul_f32 v112, s48, v112
  v_mul_f32 v113, s48, v113
  v_mul_f32 v114, s48, v114
  v_mul_f32 v115, s48, v115
  v_cvt_pk_bf16_f32 v44, v108, v109
  v_cvt_pk_bf16_f32 v45, v110, v111
  v_cvt_pk_bf16_f32 v46, v112, v113
  v_cvt_pk_bf16_f32 v47, v114, v115
  v_mul_f32 v116, s48, v116
  v_mul_f32 v117, s48, v117
  v_mul_f32 v118, s48, v118
  v_mul_f32 v119, s48, v119
  v_mul_f32 v120, s48, v120
  v_mul_f32 v121, s48, v121
  v_mul_f32 v122, s48, v122
  v_mul_f32 v123, s48, v123
  v_cvt_pk_bf16_f32 v48, v116, v117
  v_cvt_pk_bf16_f32 v49, v118, v119
  v_cvt_pk_bf16_f32 v50, v120, v121
  v_cvt_pk_bf16_f32 v51, v122, v123
  v_mul_f32 v124, s48, v124
  v_mul_f32 v125, s48, v125
  v_mul_f32 v126, s48, v126
  v_mul_f32 v127, s48, v127
  v_mul_f32 v128, s48, v128
  v_mul_f32 v129, s48, v129
  v_mul_f32 v130, s48, v130
  v_mul_f32 v131, s48, v131
  v_cvt_pk_bf16_f32 v52, v124, v125
  v_cvt_pk_bf16_f32 v53, v126, v127
  v_cvt_pk_bf16_f32 v54, v128, v129
  v_cvt_pk_bf16_f32 v55, v130, v131
  v_mul_f32 v132, s48, v132
  v_mul_f32 v133, s48, v133
  v_mul_f32 v134, s48, v134
  v_mul_f32 v135, s48, v135
  v_mul_f32 v136, s48, v136
  v_mul_f32 v137, s48, v137
  v_mul_f32 v138, s48, v138
  v_mul_f32 v139, s48, v139
  v_cvt_pk_bf16_f32 v56, v132, v133
  v_cvt_pk_bf16_f32 v57, v134, v135
  v_cvt_pk_bf16_f32 v58, v136, v137
  v_cvt_pk_bf16_f32 v59, v138, v139
  v_mul_f32 v140, s48, v140
  v_mul_f32 v141, s48, v141
  v_mul_f32 v142, s48, v142
  v_mul_f32 v143, s48, v143
  v_mul_f32 v144, s48, v144
  v_mul_f32 v145, s48, v145
  v_mul_f32 v146, s48, v146
  v_mul_f32 v147, s48, v147
  v_cvt_pk_bf16_f32 v60, v140, v141
  v_cvt_pk_bf16_f32 v61, v142, v143
  v_cvt_pk_bf16_f32 v62, v144, v145
  v_cvt_pk_bf16_f32 v63, v146, v147
  v_mul_f32 v148, s48, v148
  v_mul_f32 v149, s48, v149
  v_mul_f32 v150, s48, v150
  v_mul_f32 v151, s48, v151
  v_mul_f32 v152, s48, v152
  v_mul_f32 v153, s48, v153
  v_mul_f32 v154, s48, v154
  v_mul_f32 v155, s48, v155
  v_cvt_pk_bf16_f32 v64, v148, v149
  v_cvt_pk_bf16_f32 v65, v150, v151
  v_cvt_pk_bf16_f32 v66, v152, v153
  v_cvt_pk_bf16_f32 v67, v154, v155
  v_mul_f32 v156, s48, v156
  v_mul_f32 v157, s48, v157
  v_mul_f32 v158, s48, v158
  v_mul_f32 v159, s48, v159
  v_mul_f32 v160, s48, v160
  v_mul_f32 v161, s48, v161
  v_mul_f32 v162, s48, v162
  v_mul_f32 v163, s48, v163
  v_cvt_pk_bf16_f32 v68, v156, v157
  v_cvt_pk_bf16_f32 v69, v158, v159
  v_cvt_pk_bf16_f32 v70, v160, v161
  v_cvt_pk_bf16_f32 v71, v162, v163
  v_mul_f32 v164, s48, v164
  v_mul_f32 v165, s48, v165
  v_mul_f32 v166, s48, v166
  v_mul_f32 v167, s48, v167
  v_mul_f32 v168, s48, v168
  v_mul_f32 v169, s48, v169
  v_mul_f32 v170, s48, v170
  v_mul_f32 v171, s48, v171
  v_cvt_pk_bf16_f32 v72, v164, v165
  v_cvt_pk_bf16_f32 v73, v166, v167
  v_cvt_pk_bf16_f32 v74, v168, v169
  v_cvt_pk_bf16_f32 v75, v170, v171
  v_mul_f32 v172, s48, v172
  v_mul_f32 v173, s48, v173
  v_mul_f32 v174, s48, v174
  v_mul_f32 v175, s48, v175
  v_mul_f32 v176, s48, v176
  v_mul_f32 v177, s48, v177
  v_mul_f32 v178, s48, v178
  v_mul_f32 v179, s48, v179
  v_cvt_pk_bf16_f32 v76, v172, v173
  v_cvt_pk_bf16_f32 v77, v174, v175
  v_cvt_pk_bf16_f32 v78, v176, v177
  v_cvt_pk_bf16_f32 v79, v178, v179
  v_mul_f32 v180, s48, v180
  v_mul_f32 v181, s48, v181
  v_mul_f32 v182, s48, v182
  v_mul_f32 v183, s48, v183
  v_mul_f32 v184, s48, v184
  v_mul_f32 v185, s48, v185
  v_mul_f32 v186, s48, v186
  v_mul_f32 v187, s48, v187
  v_cvt_pk_bf16_f32 v80, v180, v181
  v_cvt_pk_bf16_f32 v81, v182, v183
  v_cvt_pk_bf16_f32 v82, v184, v185
  v_cvt_pk_bf16_f32 v83, v186, v187
  v_mul_f32 v188, s48, v188
  v_mul_f32 v189, s48, v189
  v_mul_f32 v190, s48, v190
  v_mul_f32 v191, s48, v191
  v_mul_f32 v192, s48, v192
  v_mul_f32 v193, s48, v193
  v_mul_f32 v194, s48, v194
  v_mul_f32 v195, s48, v195
  v_cvt_pk_bf16_f32 v84, v188, v189
  v_cvt_pk_bf16_f32 v85, v190, v191
  v_cvt_pk_bf16_f32 v86, v192, v193
  v_cvt_pk_bf16_f32 v87, v194, v195
  v_mul_f32 v196, s48, v196
  v_mul_f32 v197, s48, v197
  v_mul_f32 v198, s48, v198
  v_mul_f32 v199, s48, v199
  v_mul_f32 v200, s48, v200
  v_mul_f32 v201, s48, v201
  v_mul_f32 v202, s48, v202
  v_mul_f32 v203, s48, v203
  v_cvt_pk_bf16_f32 v88, v196, v197
  v_cvt_pk_bf16_f32 v89, v198, v199
  v_cvt_pk_bf16_f32 v90, v200, v201
  v_cvt_pk_bf16_f32 v91, v202, v203
  v_mul_f32 v204, s48, v204
  v_mul_f32 v205, s48, v205
  v_mul_f32 v206, s48, v206
  v_mul_f32 v207, s48, v207
  v_mul_f32 v208, s48, v208
  v_mul_f32 v209, s48, v209
  v_mul_f32 v210, s48, v210
  v_mul_f32 v211, s48, v211
  v_cvt_pk_bf16_f32 v92, v204, v205
  v_cvt_pk_bf16_f32 v93, v206, v207
  v_cvt_pk_bf16_f32 v94, v208, v209
  v_cvt_pk_bf16_f32 v95, v210, v211
  v_mul_f32 v212, s48, v212
  v_mul_f32 v213, s48, v213
  v_mul_f32 v214, s48, v214
  v_mul_f32 v215, s48, v215
  v_mul_f32 v216, s48, v216
  v_mul_f32 v217, s48, v217
  v_mul_f32 v218, s48, v218
  v_mul_f32 v219, s48, v219
  v_cvt_pk_bf16_f32 v96, v212, v213
  v_cvt_pk_bf16_f32 v97, v214, v215
  v_cvt_pk_bf16_f32 v98, v216, v217
  v_cvt_pk_bf16_f32 v99, v218, v219
  v_mul_f32 v220, s48, v220
  v_mul_f32 v221, s48, v221
  v_mul_f32 v222, s48, v222
  v_mul_f32 v223, s48, v223
  v_mul_f32 v224, s48, v224
  v_mul_f32 v225, s48, v225
  v_mul_f32 v226, s48, v226
  v_mul_f32 v227, s48, v227
  v_cvt_pk_bf16_f32 v100, v220, v221
  v_cvt_pk_bf16_f32 v101, v222, v223
  v_cvt_pk_bf16_f32 v102, v224, v225
  v_cvt_pk_bf16_f32 v103, v226, v227
  v_mul_f32 v228, s48, v228
  v_mul_f32 v229, s48, v229
  v_mul_f32 v230, s48, v230
  v_mul_f32 v231, s48, v231
  v_mul_f32 v232, s48, v232
  v_mul_f32 v233, s48, v233
  v_mul_f32 v234, s48, v234
  v_mul_f32 v235, s48, v235
  v_cvt_pk_bf16_f32 v104, v228, v229
  v_cvt_pk_bf16_f32 v105, v230, v231
  v_cvt_pk_bf16_f32 v106, v232, v233
  v_cvt_pk_bf16_f32 v107, v234, v235
  v_mul_f32 v236, s48, v236
  v_mul_f32 v237, s48, v237
  v_mul_f32 v238, s48, v238
  v_mul_f32 v239, s48, v239
  v_mul_f32 v240, s48, v240
  v_mul_f32 v241, s48, v241
  v_mul_f32 v242, s48, v242
  v_mul_f32 v243, s48, v243
  v_cvt_pk_bf16_f32 v108, v236, v237
  v_cvt_pk_bf16_f32 v109, v238, v239
  v_cvt_pk_bf16_f32 v110, v240, v241
  v_cvt_pk_bf16_f32 v111, v242, v243
  v_mul_f32 v244, s48, v244
  v_mul_f32 v245, s48, v245
  v_mul_f32 v246, s48, v246
  v_mul_f32 v247, s48, v247
  v_mul_f32 v248, s48, v248
  v_mul_f32 v249, s48, v249
  v_mul_f32 v250, s48, v250
  v_mul_f32 v251, s48, v251
  v_cvt_pk_bf16_f32 v112, v244, v245
  v_cvt_pk_bf16_f32 v113, v246, v247
  v_cvt_pk_bf16_f32 v114, v248, v249
  v_cvt_pk_bf16_f32 v115, v250, v251
L_att:
  s_cmp_eq_u32 s56, 0
  s_cbranch_scc1 L_nomax
  v_mov_b32 v236, 0xff800000
  v_mov_b32 v237, 0xff800000
  v_mov_b32 v238, 0xff800000
  v_mov_b32 v239, 0xff800000
  v_mov_b32 v240, 0xff800000
  s_mov_b32 s58, s34
  s_add_u32 s59, s34, 131072
L_maxloop:
  s_barrier
  s_add_u32 m0, s79, 0
  s_nop 0
  buffer_load_dwordx4 v1, s[12:15], s58 offen offset:0 lds
  buffer_load_dwordx4 v2, s[12:15], s58 offen offset:1024 lds
  buffer_load_dwordx4 v3, s[12:15], s58 offen offset:2048 lds
  buffer_load_dwordx4 v4, s[12:15], s58 offen offset:3072 lds
  s_waitcnt vmcnt(0)
  s_barrier
  v_subrev_u32 v30, 49152, v12
  v_subrev_u32 v31, 49152, v13
  v_subrev_u32 v32, 49152, v14
  v_subrev_u32 v33, 49152, v15
  ds_read_b128 v[116:119], v30 offset:0
  ds_read_b128 v[120:123], v31 offset:0
  ds_read_b128 v[124:127], v32 offset:0
  ds_read_b128 v[128:131], v33 offset:0
  ds_read_b128 v[132:135], v30 offset:4096
  ds_read_b128 v[136:139], v31 offset:4096
  ds_read_b128 v[140:143], v32 offset:4096
  ds_read_b128 v[144:147], v33 offset:4096
  s_waitcnt lgkmcnt(0)
  v_mfma_f32_16x16x32_bf16 v[180:183], v[116:119], v[36:39], 0
  v_mfma_f32_16x16x32_bf16 v[184:187], v[132:135], v[36:39], 0
  v_mfma_f32_16x16x32_bf16 v[180:183], v[120:123], v[56:59], v[180:183]
  v_mfma_f32_16x16x32_bf16 v[184:187], v[136:139], v[56:59], v[184:187]
  v_mfma_f32_16x16x32_bf16 v[180:183], v[124:127], v[76:79], v[180:183]
  v_mfma_f32_16x16x32_bf16 v[184:187], v[140:143], v[76:79], v[184:187]
  v_mfma_f32_16x16x32_bf16 v[180:183], v[128:131], v[96:99], v[180:183]
  v_mfma_f32_16x16x32_bf16 v[184:187], v[144:147], v[96:99], v[184:187]
  s_nop 7
  v_max3_f32 v236, v180, v181, v236
  v_max3_f32 v236, v182, v183, v236
  v_max3_f32 v236, v184, v185, v236
  v_max3_f32 v236, v186, v187, v236
  s_nop 3
  v_mfma_f32_16x16x32_bf16 v[180:183], v[116:119], v[40:43], 0
  v_mfma_f32_16x16x32_bf16 v[184:187], v[132:135], v[40:43], 0
  v_mfma_f32_16x16x32_bf16 v[180:183], v[120:123], v[60:63], v[180:183]
  v_mfma_f32_16x16x32_bf16 v[184:187], v[136:139], v[60:63], v[184:187]
  v_mfma_f32_16x16x32_bf16 v[180:183], v[124:127], v[80:83], v[180:183]
  v_mfma_f32_16x16x32_bf16 v[184:187], v[140:143], v[80:83], v[184:187]
  v_mfma_f32_16x16x32_bf16 v[180:183], v[128:131], v[100:103], v[180:183]
  v_mfma_f32_16x16x32_bf16 v[184:187], v[144:147], v[100:103], v[184:187]
  s_nop 7
  v_max3_f32 v237, v180, v181, v237
  v_max3_f32 v237, v182, v183, v237
  v_max3_f32 v237, v184, v185, v237
  v_max3_f32 v237, v186, v187, v237
  s_nop 3
  v_mfma_f32_16x16x32_bf16 v[180:183], v[116:119], v[44:47], 0
  v_mfma_f32_16x16x32_bf16 v[184:187], v[132:135], v[44:47], 0
  v_mfma_f32_16x16x32_bf16 v[180:183], v[120:123], v[64:67], v[180:183]
  v_mfma_f32_16x16x32_bf16 v[184:187], v[136:139], v[64:67], v[184:187]
  v_mfma_f32_16x16x32_bf16 v[180:183], v[124:127], v[84:87], v[180:183]
  v_mfma_f32_16x16x32_bf16 v[184:187], v[140:143], v[84:87], v[184:187]
  v_mfma_f32_16x16x32_bf16 v[180:183], v[128:131], v[104:107], v[180:183]
  v_mfma_f32_16x16x32_bf16 v[184:187], v[144:147], v[104:107], v[184:187]
  s_nop 7
  v_max3_f32 v238, v180, v181, v238
  v_max3_f32 v238, v182, v183, v238
  v_max3_f32 v238, v184, v185, v238
  v_max3_f32 v238, v186, v187, v238
  s_nop 3
  v_mfma_f32_16x16x32_bf16 v[180:183], v[116:119], v[48:51], 0
  v_mfma_f32_16x16x32_bf16 v[184:187], v[132:135], v[48:51], 0
  v_mfma_f32_16x16x32_bf16 v[180:183], v[120:123], v[68:71], v[180:183]
  v_mfma_f32_16x16x32_bf16 v[184:187], v[136:139], v[68:71], v[184:187]
  v_mfma_f32_16x16x32_bf16 v[180:183], v[124:127], v[88:91], v[180:183]
  v_mfma_f32_16x16x32_bf16 v[184:187], v[140:143], v[88:91], v[184:187]
  v_mfma_f32_16x16x32_bf16 v[180:183], v[128:131], v[108:111], v[180:183]
  v_mfma_f32_16x16x32_bf16 v[184:187], v[144:147], v[108:111], v[184:187]
  s_nop 7
  v_max3_f32 v239, v180, v181, v239
  v_max3_f32 v239, v182, v183, v239
  v_max3_f32 v239, v184, v185, v239
  v_max3_f32 v239, v186, v187, v239
  s_nop 3
  v_mfma_f32_16x16x32_bf16 v[180:183], v[116:119], v[52:55], 0
  v_mfma_f32_16x16x32_bf16 v[184:187], v[132:135], v[52:55], 0
  v_mfma_f32_16x16x32_bf16 v[180:183], v[120:123], v[72:75], v[180:183]
  v_mfma_f32_16x16x32_bf16 v[184:187], v[136:139], v[72:75], v[184:187]
  v_mfma_f32_16x16x32_bf16 v[180:183], v[124:127], v[92:95], v[180:183]
  v_mfma_f32_16x16x32_bf16 v[184:187], v[140:143], v[92:95], v[184:187]
  v_mfma_f32_16x16x32_bf16 v[180:183], v[128:131], v[112:115], v[180:183]
  v_mfma_f32_16x16x32_bf16 v[184:187], v[144:147], v[112:115], v[184:187]
  s_nop 7
  v_max3_f32 v240, v180, v181, v240
  v_max3_f32 v240, v182, v183, v240
  v_max3_f32 v240, v184, v185, v240
  v_max3_f32 v240, v186, v187, v240
  s_nop 3
  s_add_u32 s58, s58, 8192
  s_cmp_lt_u32 s58, s59
  s_cbranch_scc1 L_maxloop
  v_mov_b32 v30, v236
  s_nop 1
  v_permlane32_swap_b32 v30, v236
  s_nop 1
  v_max_f32 v236, v30, v236
  v_mov_b32 v30, v236
  s_nop 1
  v_permlane16_swap_b32 v30, v236
  s_nop 1
  v_max_f32 v236, v30, v236
  v_sub_f32 v216, 0, v236
  v_sub_f32 v217, 0, v236
  v_sub_f32 v218, 0, v236
  v_sub_f32 v219, 0, v236
  v_mov_b32 v30, v237
  s_nop 1
  v_permlane32_swap_b32 v30, v237
  s_nop 1
  v_max_f32 v237, v30, v237
  v_mov_b32 v30, v237
  s_nop 1
  v_permlane16_swap_b32 v30, v237
  s_nop 1
  v_max_f32 v237, v30, v237
  v_sub_f32 v220, 0, v237
  v_sub_f32 v221, 0, v237
  v_sub_f32 v222, 0, v237
  v_sub_f32 v223, 0, v237
  v_mov_b32 v30, v238
  s_nop 1
  v_permlane32_swap_b32 v30, v238
  s_nop 1
  v_max_f32 v238, v30, v238
  v_mov_b32 v30, v238
  s_nop 1
  v_permlane16_swap_b32 v30, v238
  s_nop 1
  v_max_f32 v238, v30, v238
  v_sub_f32 v224, 0, v238
  v_sub_f32 v225, 0, v238
  v_sub_f32 v226, 0, v238
  v_sub_f32 v227, 0, v238
  v_mov_b32 v30, v239
  s_nop 1
  v_permlane32_swap_b32 v30, v239
  s_nop 1
  v_max_f32 v239, v30, v239
  v_mov_b32 v30, v239
  s_nop 1
  v_permlane16_swap_b32 v30, v239
  s_nop 1
  v_max_f32 v239, v30, v239
  v_sub_f32 v228, 0, v239
  v_sub_f32 v229, 0, v239
  v_sub_f32 v230, 0, v239
  v_sub_f32 v231, 0, v239
  v_mov_b32 v30, v240
  s_nop 1
  v_permlane32_swap_b32 v30, v240
  s_nop 1
  v_max_f32 v240, v30, v240
  v_mov_b32 v30, v240
  s_nop 1
  v_permlane16_swap_b32 v30, v240
  s_nop 1
  v_max_f32 v240, v30, v240
  v_sub_f32 v232, 0, v240
  v_sub_f32 v233, 0, v240
  v_sub_f32 v234, 0, v240
  v_sub_f32 v235, 0, v240
  s_barrier
L_nomax:
  ds_read_b128 v[116:119], v12 offset:0
  ds_read_b128 v[120:123], v13 offset:0
  ds_read_b128 v[124:127], v14 offset:0
  ds_read_b128 v[128:131], v15 offset:0
  ds_read_b128 v[132:135], v12 offset:4096
  ds_read_b128 v[136:139], v13 offset:4096
  ds_read_b128 v[140:143], v14 offset:4096
  ds_read_b128 v[144:147], v15 offset:4096
  ds_read_b128 v[148:151], v12 offset:8192
  ds_read_b128 v[152:155], v13 offset:8192
  ds_read_b128 v[156:159], v14 offset:8192
  ds_read_b128 v[160:163], v15 offset:8192
  ds_read_b128 v[164:167], v12 offset:12288
  ds_read_b128 v[168:171], v13 offset:12288
  ds_read_b128 v[172:175], v14 offset:12288
  ds_read_b128 v[176:179], v15 offset:12288
  s_waitcnt lgkmcnt(8)
  v_mfma_f32_16x16x32_bf16 v[188:191], v[116:119], v[36:39], 0
  v_mfma_f32_16x16x32_bf16 v[192:195], v[132:135], v[36:39], 0
  v_mfma_f32_16x16x32_bf16 v[188:191], v[120:123], v[56:59], v[188:191]
  v_mfma_f32_16x16x32_bf16 v[192:195], v[136:139], v[56:59], v[192:195]
  v_mfma_f32_16x16x32_bf16 v[188:191], v[124:127], v[76:79], v[188:191]
  v_mfma_f32_16x16x32_bf16 v[192:195], v[140:143], v[76:79], v[192:195]
  v_mfma_f32_16x16x32_bf16 v[188:191], v[128:131], v[96:99], v[188:191]
  v_mfma_f32_16x16x32_bf16 v[192:195], v[144:147], v[96:99], v[192:195]
  v_mfma_f32_16x16x32_bf16 v[180:183], v[116:119], v[40:43], 0
  v_mfma_f32_16x16x32_bf16 v[184:187], v[132:135], v[40:43], 0
  v_mfma_f32_16x16x32_bf16 v[180:183], v[120:123], v[60:63], v[180:183]
  v_mfma_f32_16x16x32_bf16 v[184:187], v[136:139], v[60:63], v[184:187]
  v_mfma_f32_16x16x32_bf16 v[180:183], v[124:127], v[80:83], v[180:183]
  v_mfma_f32_16x16x32_bf16 v[184:187], v[140:143], v[80:83], v[184:187]
  v_mfma_f32_16x16x32_bf16 v[180:183], v[128:131], v[100:103], v[180:183]
  v_mfma_f32_16x16x32_bf16 v[184:187], v[144:147], v[100:103], v[184:187]
  v_max3_f32 v30, v188, v189, v190
  v_max3_f32 v30, v191, v192, v30
  v_max3_f32 v30, v193, v194, v30
  v_max_f32 v30, v195, v30
  v_mov_b32 v31, v30
  s_nop 1
  v_permlane32_swap_b32 v31, v30
  s_nop 1
  v_max_f32 v30, v31, v30
  v_mov_b32 v31, v30
  s_nop 1
  v_permlane16_swap_b32 v31, v30
  s_nop 1
  v_max_f32 v30, v31, v30
  v_sub_f32 v30, 0, v30
  v_cndmask_b32 v216, v30, v216, s[60:61]
  v_cndmask_b32 v217, v30, v217, s[60:61]
  v_cndmask_b32 v218, v30, v218, s[60:61]
  v_cndmask_b32 v219, v30, v219, s[60:61]
  v_add_f32 v188, v188, v216
  v_add_f32 v189, v189, v216
  v_add_f32 v190, v190, v216
  v_add_f32 v191, v191, v216
  v_add_f32 v192, v192, v216
  v_add_f32 v193, v193, v216
  v_add_f32 v194, v194, v216
  v_add_f32 v195, v195, v216
  v_exp_f32 v188, v188
  v_exp_f32 v189, v189
  v_exp_f32 v190, v190
  v_exp_f32 v191, v191
  v_exp_f32 v192, v192
  v_exp_f32 v193, v193
  v_exp_f32 v194, v194
  v_exp_f32 v195, v195
  s_nop 0
  v_cvt_pk_bf16_f32 v196, v188, v189
  v_cvt_pk_bf16_f32 v197, v190, v191
  v_cvt_pk_bf16_f32 v198, v192, v193
  v_cvt_pk_bf16_f32 v199, v194, v195
  v_mfma_f32_16x16x32_bf16 v[188:191], v[116:119], v[44:47], 0
  v_mfma_f32_16x16x32_bf16 v[192:195], v[132:135], v[44:47], 0
  v_mfma_f32_16x16x32_bf16 v[188:191], v[120:123], v[64:67], v[188:191]
  v_mfma_f32_16x16x32_bf16 v[192:195], v[136:139], v[64:67], v[192:195]
  v_mfma_f32_16x16x32_bf16 v[188:191], v[124:127], v[84:87], v[188:191]
  v_mfma_f32_16x16x32_bf16 v[192:195], v[140:143], v[84:87], v[192:195]
  v_mfma_f32_16x16x32_bf16 v[188:191], v[128:131], v[104:107], v[188:191]
  v_mfma_f32_16x16x32_bf16 v[192:195], v[144:147], v[104:107], v[192:195]
  v_max3_f32 v30, v180, v181, v182
  v_max3_f32 v30, v183, v184, v30
  v_max3_f32 v30, v185, v186, v30
  v_max_f32 v30, v187, v30
  v_mov_b32 v31, v30
  s_nop 1
  v_permlane32_swap_b32 v31, v30
  s_nop 1
  v_max_f32 v30, v31, v30
  v_mov_b32 v31, v30
  s_nop 1
  v_permlane16_swap_b32 v31, v30
  s_nop 1
  v_max_f32 v30, v31, v30
  v_sub_f32 v30, 0, v30
  v_cndmask_b32 v220, v30, v220, s[60:61]
  v_cndmask_b32 v221, v30, v221, s[60:61]
  v_cndmask_b32 v222, v30, v222, s[60:61]
  v_cndmask_b32 v223, v30, v223, s[60:61]
  v_add_f32 v180, v180, v220
  v_add_f32 v181, v181, v220
  v_add_f32 v182, v182, v220
  v_add_f32 v183, v183, v220
  v_add_f32 v184, v184, v220
  v_add_f32 v185, v185, v220
  v_add_f32 v186, v186, v220
  v_add_f32 v187, v187, v220
  v_exp_f32 v180, v180
  v_exp_f32 v181, v181
  v_exp_f32 v182, v182
  v_exp_f32 v183, v183
  v_exp_f32 v184, v184
  v_exp_f32 v185, v185
  v_exp_f32 v186, v186
  v_exp_f32 v187, v187
  s_nop 0
  v_cvt_pk_bf16_f32 v200, v180, v181
  v_cvt_pk_bf16_f32 v201, v182, v183
  v_cvt_pk_bf16_f32 v202, v184, v185
  v_cvt_pk_bf16_f32 v203, v186, v187
  v_mfma_f32_16x16x32_bf16 v[180:183], v[116:119], v[48:51], 0
  v_mfma_f32_16x16x32_bf16 v[184:187], v[132:135], v[48:51], 0
  v_mfma_f32_16x16x32_bf16 v[180:183], v[120:123], v[68:71], v[180:183]
  v_mfma_f32_16x16x32_bf16 v[184:187], v[136:139], v[68:71], v[184:187]
  v_mfma_f32_16x16x32_bf16 v[180:183], v[124:127], v[88:91], v[180:183]
  v_mfma_f32_16x16x32_bf16 v[184:187], v[140:143], v[88:91], v[184:187]
  v_mfma_f32_16x16x32_bf16 v[180:183], v[128:131], v[108:111], v[180:183]
  v_mfma_f32_16x16x32_bf16 v[184:187], v[144:147], v[108:111], v[184:187]
  v_max3_f32 v30, v188, v189, v190
  v_max3_f32 v30, v191, v192, v30
  v_max3_f32 v30, v193, v194, v30
  v_max_f32 v30, v195, v30
  v_mov_b32 v31, v30
  s_nop 1
  v_permlane32_swap_b32 v31, v30
  s_nop 1
  v_max_f32 v30, v31, v30
  v_mov_b32 v31, v30
  s_nop 1
  v_permlane16_swap_b32 v31, v30
  s_nop 1
  v_max_f32 v30, v31, v30
  v_sub_f32 v30, 0, v30
  v_cndmask_b32 v224, v30, v224, s[60:61]
  v_cndmask_b32 v225, v30, v225, s[60:61]
  v_cndmask_b32 v226, v30, v226, s[60:61]
  v_cndmask_b32 v227, v30, v227, s[60:61]
  v_add_f32 v188, v188, v224
  v_add_f32 v189, v189, v224
  v_add_f32 v190, v190, v224
  v_add_f32 v191, v191, v224
  v_add_f32 v192, v192, v224
  v_add_f32 v193, v193, v224
  v_add_f32 v194, v194, v224
  v_add_f32 v195, v195, v224
  v_exp_f32 v188, v188
  v_exp_f32 v189, v189
  v_exp_f32 v190, v190
  v_exp_f32 v191, v191
  v_exp_f32 v192, v192
  v_exp_f32 v193, v193
  v_exp_f32 v194, v194
  v_exp_f32 v195, v195
  s_nop 0
  v_cvt_pk_bf16_f32 v204, v188, v189
  v_cvt_pk_bf16_f32 v205, v190, v191
  v_cvt_pk_bf16_f32 v206, v192, v193
  v_cvt_pk_bf16_f32 v207, v194, v195
  v_mfma_f32_16x16x32_bf16 v[188:191], v[116:119], v[52:55], 0
  v_mfma_f32_16x16x32_bf16 v[192:195], v[132:135], v[52:55], 0
  v_mfma_f32_16x16x32_bf16 v[188:191], v[120:123], v[72:75], v[188:191]
  v_mfma_f32_16x16x32_bf16 v[192:195], v[136:139], v[72:75], v[192:195]
  v_mfma_f32_16x16x32_bf16 v[188:191], v[124:127], v[92:95], v[188:191]
  v_mfma_f32_16x16x32_bf16 v[192:195], v[140:143], v[92:95], v[192:195]
  v_mfma_f32_16x16x32_bf16 v[188:191], v[128:131], v[112:115], v[188:191]
  v_mfma_f32_16x16x32_bf16 v[192:195], v[144:147], v[112:115], v[192:195]
  v_max3_f32 v30, v180, v181, v182
  v_max3_f32 v30, v183, v184, v30
  v_max3_f32 v30, v185, v186, v30
  v_max_f32 v30, v187, v30
  v_mov_b32 v31, v30
  s_nop 1
  v_permlane32_swap_b32 v31, v30
  s_nop 1
  v_max_f32 v30, v31, v30
  v_mov_b32 v31, v30
  s_nop 1
  v_permlane16_swap_b32 v31, v30
  s_nop 1
  v_max_f32 v30, v31, v30
  v_sub_f32 v30, 0, v30
  v_cndmask_b32 v228, v30, v228, s[60:61]
  v_cndmask_b32 v229, v30, v229, s[60:61]
  v_cndmask_b32 v230, v30, v230, s[60:61]
  v_cndmask_b32 v231, v30, v231, s[60:61]
  v_add_f32 v180, v180, v228
  v_add_f32 v181, v181, v228
  v_add_f32 v182, v182, v228
  v_add_f32 v183, v183, v228
  v_add_f32 v184, v184, v228
  v_add_f32 v185, v185, v228
  v_add_f32 v186, v186, v228
  v_add_f32 v187, v187, v228
  v_exp_f32 v180, v180
  v_exp_f32 v181, v181
  v_exp_f32 v182, v182
  v_exp_f32 v183, v183
  v_exp_f32 v184, v184
  v_exp_f32 v185, v185
  v_exp_f32 v186, v186
  v_exp_f32 v187, v187
  s_nop 0
  v_cvt_pk_bf16_f32 v208, v180, v181
  v_cvt_pk_bf16_f32 v209, v182, v183
  v_cvt_pk_bf16_f32 v210, v184, v185
  v_cvt_pk_bf16_f32 v211, v186, v187
  s_barrier
  ds_read_b64_tr_b16 a[160:161], v16 offset:24576
  ds_read_b64_tr_b16 a[162:163], v16 offset:28672
  ds_read_b64_tr_b16 a[164:165], v17 offset:24576
  ds_read_b64_tr_b16 a[166:167], v17 offset:28672
  ds_read_b64_tr_b16 a[168:169], v18 offset:24576
  ds_read_b64_tr_b16 a[170:171], v18 offset:28672
  ds_read_b64_tr_b16 a[172:173], v19 offset:24576
  ds_read_b64_tr_b16 a[174:175], v19 offset:28672
  ds_read_b64_tr_b16 a[176:177], v20 offset:24576
  ds_read_b64_tr_b16 a[178:179], v20 offset:28672
  ds_read_b64_tr_b16 a[180:181], v21 offset:24576
  ds_read_b64_tr_b16 a[182:183], v21 offset:28672
  ds_read_b64_tr_b16 a[184:185], v22 offset:24576
  ds_read_b64_tr_b16 a[186:187], v22 offset:28672
  ds_read_b64_tr_b16 a[188:189], v23 offset:24576
  ds_read_b64_tr_b16 a[190:191], v23 offset:28672
  v_add_u32 v34, s79, v28
  s_waitcnt vmcnt(12)
  ds_write_b128 v34, a[56:59] offset:32768
  ds_write_b128 v34, a[60:63] offset:33792
  ds_write_b128 v34, a[64:67] offset:34816
  ds_write_b128 v34, a[68:71] offset:35840
  ds_write_b128 v34, a[72:75] offset:40960
  ds_write_b128 v34, a[76:79] offset:41984
  ds_write_b128 v34, a[80:83] offset:43008
  ds_write_b128 v34, a[84:87] offset:44032
  ds_write_b128 v34, a[88:91] offset:16384
  ds_write_b128 v34, a[92:95] offset:17408
  ds_write_b128 v34, a[96:99] offset:18432
  ds_write_b128 v34, a[100:103] offset:19456
  v_max3_f32 v30, v188, v189, v190
  v_max3_f32 v30, v191, v192, v30
  v_max3_f32 v30, v193, v194, v30
  v_max_f32 v30, v195, v30
  v_mov_b32 v31, v30
  s_nop 1
  v_permlane32_swap_b32 v31, v30
  s_nop 1
  v_max_f32 v30, v31, v30
  v_mov_b32 v31, v30
  s_nop 1
  v_permlane16_swap_b32 v31, v30
  s_nop 1
  v_max_f32 v30, v31, v30
  v_sub_f32 v30, 0, v30
  v_cndmask_b32 v232, v30, v232, s[60:61]
  v_cndmask_b32 v233, v30, v233, s[60:61]
  v_cndmask_b32 v234, v30, v234, s[60:61]
  v_cndmask_b32 v235, v30, v235, s[60:61]
  v_add_f32 v188, v188, v232
  v_add_f32 v189, v189, v232
  v_add_f32 v190, v190, v232
  v_add_f32 v191, v191, v232
  v_add_f32 v192, v192, v232
  v_add_f32 v193, v193, v232
  v_add_f32 v194, v194, v232
  v_add_f32 v195, v195, v232
  s_waitcnt lgkmcnt(0)
  s_barrier
  v_mfma_f32_16x16x32_bf16 v[180:183], v[148:151], v[36:39], v[216:219]
  v_exp_f32 v188, v188
  v_mfma_f32_16x16x32_bf16 v[184:187], v[164:167], v[36:39], v[216:219]
  ds_read_b128 v[116:119], v12 offset:16384
  v_mfma_f32_16x16x32_bf16 v[180:183], v[152:155], v[56:59], v[180:183]
  v_exp_f32 v189, v189
  v_mfma_f32_16x16x32_bf16 v[184:187], v[168:171], v[56:59], v[184:187]
  ds_read_b128 v[120:123], v13 offset:16384
  v_mfma_f32_16x16x32_bf16 v[180:183], v[156:159], v[76:79], v[180:183]
  v_exp_f32 v190, v190
  v_mfma_f32_16x16x32_bf16 v[184:187], v[172:175], v[76:79], v[184:187]
  ds_read_b128 v[124:127], v14 offset:16384
  v_mfma_f32_16x16x32_bf16 v[180:183], v[160:163], v[96:99], v[180:183]
  v_exp_f32 v191, v191
  v_mfma_f32_16x16x32_bf16 v[184:187], v[176:179], v[96:99], v[184:187]
  ds_read_b128 v[128:131], v15 offset:16384
  v_mfma_f32_16x16x32_bf16 a[0:3], a[160:163], v[196:199], 0
  v_exp_f32 v192, v192
  v_mfma_f32_16x16x32_bf16 a[4:7], a[164:167], v[196:199], 0
  ds_read_b128 v[132:135], v12 offset:20480
  v_mfma_f32_16x16x32_bf16 a[8:11], a[168:171], v[196:199], 0
  v_exp_f32 v193, v193
  v_mfma_f32_16x16x32_bf16 a[12:15], a[172:175], v[196:199], 0
  ds_read_b128 v[136:139], v13 offset:20480
  v_mfma_f32_16x16x32_bf16 a[16:19], a[176:179], v[196:199], 0
  v_exp_f32 v194, v194
  v_mfma_f32_16x16x32_bf16 a[20:23], a[180:183], v[196:199], 0
  v_exp_f32 v195, v195
  v_mfma_f32_16x16x32_bf16 a[24:27], a[184:187], v[196:199], 0
  v_cvt_pk_bf16_f32 v212, v188, v189
  v_cvt_pk_bf16_f32 v213, v190, v191
  v_mfma_f32_16x16x32_bf16 a[28:31], a[188:191], v[196:199], 0
  v_cvt_pk_bf16_f32 v214, v192, v193
  v_cvt_pk_bf16_f32 v215, v194, v195
  v_mfma_f32_16x16x32_bf16 a[224:227], a[244:247], v[196:199], 0
  ds_read_b128 v[140:143], v14 offset:20480
  v_mfma_f32_16x16x32_bf16 v[188:191], v[148:151], v[40:43], v[220:223]
  v_exp_f32 v180, v180
  v_mfma_f32_16x16x32_bf16 v[192:195], v[164:167], v[40:43], v[220:223]
  ds_read_b128 v[144:147], v15 offset:20480
  v_mfma_f32_16x16x32_bf16 v[188:191], v[152:155], v[60:63], v[188:191]
  v_exp_f32 v181, v181
  v_mfma_f32_16x16x32_bf16 v[192:195], v[168:171], v[60:63], v[192:195]
  ds_read_b64_tr_b16 a[192:193], v16 offset:32768
  v_mfma_f32_16x16x32_bf16 v[188:191], v[156:159], v[80:83], v[188:191]
  v_exp_f32 v182, v182
  v_mfma_f32_16x16x32_bf16 v[192:195], v[172:175], v[80:83], v[192:195]
  ds_read_b64_tr_b16 a[194:195], v16 offset:36864
  v_mfma_f32_16x16x32_bf16 v[188:191], v[160:163], v[100:103], v[188:191]
  v_exp_f32 v183, v183
  v_mfma_f32_16x16x32_bf16 v[192:195], v[176:179], v[100:103], v[192:195]
  ds_read_b64_tr_b16 a[196:197], v17 offset:32768
  v_mfma_f32_16x16x32_bf16 a[32:35], a[160:163], v[200:203], 0
  v_exp_f32 v184, v184
  v_mfma_f32_16x16x32_bf16 a[36:39], a[164:167], v[200:203], 0
  ds_read_b64_tr_b16 a[198:199], v17 offset:36864
  v_mfma_f32_16x16x32_bf16 a[40:43], a[168:171], v[200:203], 0
  v_exp_f32 v185, v185
  v_mfma_f32_16x16x32_bf16 a[44:47], a[172:175], v[200:203], 0
  ds_read_b64_tr_b16 a[200:201], v18 offset:32768
  v_mfma_f32_16x16x32_bf16 a[48:51], a[176:179], v[200:203], 0
  v_exp_f32 v186, v186
  v_mfma_f32_16x16x32_bf16 a[52:55], a[180:183], v[200:203], 0
  v_exp_f32 v187, v187
  v_mfma_f32_16x16x32_bf16 a[56:59], a[184:187], v[200:203], 0
  v_cvt_pk_bf16_f32 v196, v180, v181
  v_cvt_pk_bf16_f32 v197, v182, v183
  v_mfma_f32_16x16x32_bf16 a[60:63], a[188:191], v[200:203], 0
  v_cvt_pk_bf16_f32 v198, v184, v185
  v_cvt_pk_bf16_f32 v199, v186, v187
  v_mfma_f32_16x16x32_bf16 a[228:231], a[244:247], v[200:203], 0
  ds_read_b64_tr_b16 a[202:203], v18 offset:36864
  s_waitcnt vmcnt(0)
  ds_write_b128 v34, a[112:115] offset:49152
  ds_write_b128 v34, a[116:119] offset:50176
  ds_write_b128 v34, a[120:123] offset:51200
  ds_write_b128 v34, a[124:127] offset:52224
  ds_write_b128 v34, a[128:131] offset:57344
  ds_write_b128 v34, a[132:135] offset:58368
  ds_write_b128 v34, a[136:139] offset:59392
  ds_write_b128 v34, a[140:143] offset:60416
  ds_write_b128 v34, a[144:147] offset:24576
  ds_write_b128 v34, a[148:151] offset:25600
  ds_write_b128 v34, a[152:155] offset:26624
  ds_write_b128 v34, a[156:159] offset:27648
  v_mfma_f32_16x16x32_bf16 v[180:183], v[148:151], v[44:47], v[224:227]
  v_exp_f32 v188, v188
  v_mfma_f32_16x16x32_bf16 v[184:187], v[164:167], v[44:47], v[224:227]
  ds_read_b64_tr_b16 a[204:205], v19 offset:32768
  v_mfma_f32_16x16x32_bf16 v[180:183], v[152:155], v[64:67], v[180:183]
  v_exp_f32 v189, v189
  v_mfma_f32_16x16x32_bf16 v[184:187], v[168:171], v[64:67], v[184:187]
  ds_read_b64_tr_b16 a[206:207], v19 offset:36864
  v_mfma_f32_16x16x32_bf16 v[180:183], v[156:159], v[84:87], v[180:183]
  v_exp_f32 v190, v190
  v_mfma_f32_16x16x32_bf16 v[184:187], v[172:175], v[84:87], v[184:187]
  ds_read_b64_tr_b16 a[208:209], v20 offset:32768
  v_mfma_f32_16x16x32_bf16 v[180:183], v[160:163], v[104:107], v[180:183]
  v_exp_f32 v191, v191
  v_mfma_f32_16x16x32_bf16 v[184:187], v[176:179], v[104:107], v[184:187]
  ds_read_b64_tr_b16 a[210:211], v20 offset:36864
  v_mfma_f32_16x16x32_bf16 a[64:67], a[160:163], v[204:207], 0
  v_exp_f32 v192, v192
  v_mfma_f32_16x16x32_bf16 a[68:71], a[164:167], v[204:207], 0
  ds_read_b64_tr_b16 a[212:213], v21 offset:32768
  v_mfma_f32_16x16x32_bf16 a[72:75], a[168:171], v[204:207], 0
  v_exp_f32 v193, v193
  v_mfma_f32_16x16x32_bf16 a[76:79], a[172:175], v[204:207], 0
  ds_read_b64_tr_b16 a[214:215], v21 offset:36864
  v_mfma_f32_16x16x32_bf16 a[80:83], a[176:179], v[204:207], 0
  v_exp_f32 v194, v194
  v_mfma_f32_16x16x32_bf16 a[84:87], a[180:183], v[204:207], 0
  v_exp_f32 v195, v195
  v_mfma_f32_16x16x32_bf16 a[88:91], a[184:187], v[204:207], 0
  v_cvt_pk_bf16_f32 v200, v188, v189
  v_cvt_pk_bf16_f32 v201, v190, v191
  v_mfma_f32_16x16x32_bf16 a[92:95], a[188:191], v[204:207], 0
  v_cvt_pk_bf16_f32 v202, v192, v193
  v_cvt_pk_bf16_f32 v203, v194, v195
  v_mfma_f32_16x16x32_bf16 a[232:235], a[244:247], v[204:207], 0
  ds_read_b64_tr_b16 a[216:217], v22 offset:32768
  v_mfma_f32_16x16x32_bf16 v[188:191], v[148:151], v[48:51], v[228:231]
  v_exp_f32 v180, v180
  v_mfma_f32_16x16x32_bf16 v[192:195], v[164:167], v[48:51], v[228:231]
  ds_read_b64_tr_b16 a[218:219], v22 offset:36864
  v_mfma_f32_16x16x32_bf16 v[188:191], v[152:155], v[68:71], v[188:191]
  v_exp_f32 v181, v181
  v_mfma_f32_16x16x32_bf16 v[192:195], v[168:171], v[68:71], v[192:195]
  ds_read_b64_tr_b16 a[220:221], v23 offset:32768
  v_mfma_f32_16x16x32_bf16 v[188:191], v[156:159], v[88:91], v[188:191]
  v_exp_f32 v182, v182
  v_mfma_f32_16x16x32_bf16 v[192:195], v[172:175], v[88:91], v[192:195]
  ds_read_b64_tr_b16 a[222:223], v23 offset:36864
  v_mfma_f32_16x16x32_bf16 v[188:191], v[160:163], v[108:111], v[188:191]
  v_exp_f32 v183, v183
  v_mfma_f32_16x16x32_bf16 v[192:195], v[176:179], v[108:111], v[192:195]
  v_mfma_f32_16x16x32_bf16 a[96:99], a[160:163], v[208:211], 0
  v_exp_f32 v184, v184
  v_mfma_f32_16x16x32_bf16 a[100:103], a[164:167], v[208:211], 0
  v_mfma_f32_16x16x32_bf16 a[104:107], a[168:171], v[208:211], 0
  v_exp_f32 v185, v185
  v_mfma_f32_16x16x32_bf16 a[108:111], a[172:175], v[208:211], 0
  v_mfma_f32_16x16x32_bf16 a[112:115], a[176:179], v[208:211], 0
  v_exp_f32 v186, v186
  v_mfma_f32_16x16x32_bf16 a[116:119], a[180:183], v[208:211], 0
  v_exp_f32 v187, v187
  v_mfma_f32_16x16x32_bf16 a[120:123], a[184:187], v[208:211], 0
  v_cvt_pk_bf16_f32 v204, v180, v181
  v_cvt_pk_bf16_f32 v205, v182, v183
  v_mfma_f32_16x16x32_bf16 a[124:127], a[188:191], v[208:211], 0
  v_cvt_pk_bf16_f32 v206, v184, v185
  v_cvt_pk_bf16_f32 v207, v186, v187
  v_mfma_f32_16x16x32_bf16 a[236:239], a[244:247], v[208:211], 0
  v_mfma_f32_16x16x32_bf16 v[180:183], v[148:151], v[52:55], v[232:235]
  v_exp_f32 v188, v188
  v_mfma_f32_16x16x32_bf16 v[184:187], v[164:167], v[52:55], v[232:235]
  v_mfma_f32_16x16x32_bf16 v[180:183], v[152:155], v[72:75], v[180:183]
  v_exp_f32 v189, v189
  v_mfma_f32_16x16x32_bf16 v[184:187], v[168:171], v[72:75], v[184:187]
  v_mfma_f32_16x16x32_bf16 v[180:183], v[156:159], v[92:95], v[180:183]
  v_exp_f32 v190, v190
  v_mfma_f32_16x16x32_bf16 v[184:187], v[172:175], v[92:95], v[184:187]
  v_mfma_f32_16x16x32_bf16 v[180:183], v[160:163], v[112:115], v[180:183]
  v_exp_f32 v191, v191
  v_mfma_f32_16x16x32_bf16 v[184:187], v[176:179], v[112:115], v[184:187]
  v_mfma_f32_16x16x32_bf16 a[128:131], a[160:163], v[212:215], 0
  v_exp_f32 v192, v192
  v_mfma_f32_16x16x32_bf16 a[132:135], a[164:167], v[212:215], 0
  v_mfma_f32_16x16x32_bf16 a[136:139], a[168:171], v[212:215], 0
  v_exp_f32 v193, v193
  v_mfma_f32_16x16x32_bf16 a[140:143], a[172:175], v[212:215], 0
  v_mfma_f32_16x16x32_bf16 a[144:147], a[176:179], v[212:215], 0
  v_exp_f32 v194, v194
  v_mfma_f32_16x16x32_bf16 a[148:151], a[180:183], v[212:215], 0
  v_exp_f32 v195, v195
  v_mfma_f32_16x16x32_bf16 a[152:155], a[184:187], v[212:215], 0
  v_cvt_pk_bf16_f32 v208, v188, v189
  v_cvt_pk_bf16_f32 v209, v190, v191
  v_mfma_f32_16x16x32_bf16 a[156:159], a[188:191], v[212:215], 0
  v_cvt_pk_bf16_f32 v210, v192, v193
  v_cvt_pk_bf16_f32 v211, v194, v195
  v_mfma_f32_16x16x32_bf16 a[240:243], a[244:247], v[212:215], 0
  s_waitcnt lgkmcnt(0)
  s_barrier
  v_mfma_f32_16x16x32_bf16 v[188:191], v[116:119], v[36:39], v[216:219]
  v_exp_f32 v180, v180
  v_mfma_f32_16x16x32_bf16 v[192:195], v[132:135], v[36:39], v[216:219]
  ds_read_b128 v[148:151], v12 offset:24576
  v_mfma_f32_16x16x32_bf16 v[188:191], v[120:123], v[56:59], v[188:191]
  v_exp_f32 v181, v181
  v_mfma_f32_16x16x32_bf16 v[192:195], v[136:139], v[56:59], v[192:195]
  s_add_u32 m0, s79, 65536
  s_add_u32 s50, s82, 49152
  s_and_b32 s50, s50, 0x1ffff
  s_add_u32 s50, s50, s34
  buffer_load_dwordx4 v1, s[12:15], s50 offen offset:0 nt lds
  v_mfma_f32_16x16x32_bf16 v[188:191], v[124:127], v[76:79], v[188:191]
  v_exp_f32 v182, v182
  v_mfma_f32_16x16x32_bf16 v[192:195], v[140:143], v[76:79], v[192:195]
  ds_read_b128 v[152:155], v13 offset:24576
  v_mfma_f32_16x16x32_bf16 v[188:191], v[128:131], v[96:99], v[188:191]
  v_exp_f32 v183, v183
  v_mfma_f32_16x16x32_bf16 v[192:195], v[144:147], v[96:99], v[192:195]
  buffer_load_dwordx4 v2, s[12:15], s50 offen offset:1024 nt lds
  v_mfma_f32_16x16x32_bf16 a[0:3], a[192:195], v[196:199], a[0:3]
  v_exp_f32 v184, v184
  v_mfma_f32_16x16x32_bf16 a[4:7], a[196:199], v[196:199], a[4:7]
  ds_read_b128 v[156:159], v14 offset:24576
  v_mfma_f32_16x16x32_bf16 a[8:11], a[200:203], v[196:199], a[8:11]
  v_exp_f32 v185, v185
  v_mfma_f32_16x16x32_bf16 a[12:15], a[204:207], v[196:199], a[12:15]
  buffer_load_dwordx4 v3, s[12:15], s50 offen offset:2048 nt lds
  v_mfma_f32_16x16x32_bf16 a[16:19], a[208:211], v[196:199], a[16:19]
  v_exp_f32 v186, v186
  v_mfma_f32_16x16x32_bf16 a[20:23], a[212:215], v[196:199], a[20:23]
  v_exp_f32 v187, v187
  v_mfma_f32_16x16x32_bf16 a[24:27], a[216:219], v[196:199], a[24:27]
  v_cvt_pk_bf16_f32 v212, v180, v181
  v_cvt_pk_bf16_f32 v213, v182, v183
  v_mfma_f32_16x16x32_bf16 a[28:31], a[220:223], v[196:199], a[28:31]
  v_cvt_pk_bf16_f32 v214, v184, v185
  v_cvt_pk_bf16_f32 v215, v186, v187
  v_mfma_f32_16x16x32_bf16 a[224:227], a[244:247], v[196:199], a[224:227]
  ds_read_b128 v[160:163], v15 offset:24576
  v_mfma_f32_16x16x32_bf16 v[180:183], v[116:119], v[40:43], v[220:223]
  v_exp_f32 v188, v188
  v_mfma_f32_16x16x32_bf16 v[184:187], v[132:135], v[40:43], v[220:223]
  buffer_load_dwordx4 v4, s[12:15], s50 offen offset:3072 nt lds
  v_mfma_f32_16x16x32_bf16 v[180:183], v[120:123], v[60:63], v[180:183]
  v_exp_f32 v189, v189
  v_mfma_f32_16x16x32_bf16 v[184:187], v[136:139], v[60:63], v[184:187]
  ds_read_b128 v[164:167], v12 offset:28672
  v_mfma_f32_16x16x32_bf16 v[180:183], v[124:127], v[80:83], v[180:183]
  v_exp_f32 v190, v190
  v_mfma_f32_16x16x32_bf16 v[184:187], v[140:143], v[80:83], v[184:187]
  s_add_u32 m0, s79, 32768
  s_add_u32 s50, s82, 40960
  s_and_b32 s50, s50, 0x1ffff
  s_add_u32 s50, s50, s34
  buffer_load_dwordx4 v5, s[16:19], s50 offen offset:0 nt lds
  v_mfma_f32_16x16x32_bf16 v[180:183], v[128:131], v[100:103], v[180:183]
  v_exp_f32 v191, v191
  v_mfma_f32_16x16x32_bf16 v[184:187], v[144:147], v[100:103], v[184:187]
  ds_read_b128 v[168:171], v13 offset:28672
  v_mfma_f32_16x16x32_bf16 a[32:35], a[192:195], v[200:203], a[32:35]
  v_exp_f32 v192, v192
  v_mfma_f32_16x16x32_bf16 a[36:39], a[196:199], v[200:203], a[36:39]
  buffer_load_dwordx4 v6, s[16:19], s50 offen offset:1024 nt lds
  v_mfma_f32_16x16x32_bf16 a[40:43], a[200:203], v[200:203], a[40:43]
  v_exp_f32 v193, v193
  v_mfma_f32_16x16x32_bf16 a[44:47], a[204:207], v[200:203], a[44:47]
  ds_read_b128 v[172:175], v14 offset:28672
  v_mfma_f32_16x16x32_bf16 a[48:51], a[208:211], v[200:203], a[48:51]
  v_exp_f32 v194, v194
  v_mfma_f32_16x16x32_bf16 a[52:55], a[212:215], v[200:203], a[52:55]
  v_exp_f32 v195, v195
  v_mfma_f32_16x16x32_bf16 a[56:59], a[216:219], v[200:203], a[56:59]
  v_cvt_pk_bf16_f32 v196, v188, v189
  v_cvt_pk_bf16_f32 v197, v190, v191
  v_mfma_f32_16x16x32_bf16 a[60:63], a[220:223], v[200:203], a[60:63]
  v_cvt_pk_bf16_f32 v198, v192, v193
  v_cvt_pk_bf16_f32 v199, v194, v195
  v_mfma_f32_16x16x32_bf16 a[228:231], a[244:247], v[200:203], a[228:231]
  buffer_load_dwordx4 v5, s[16:19], s50 offen offset:2048 nt lds
  v_mfma_f32_16x16x32_bf16 v[188:191], v[116:119], v[44:47], v[224:227]
  v_exp_f32 v180, v180
  v_mfma_f32_16x16x32_bf16 v[192:195], v[132:135], v[44:47], v[224:227]
  ds_read_b128 v[176:179], v15 offset:28672
  v_mfma_f32_16x16x32_bf16 v[188:191], v[120:123], v[64:67], v[188:191]
  v_exp_f32 v181, v181
  v_mfma_f32_16x16x32_bf16 v[192:195], v[136:139], v[64:67], v[192:195]
  buffer_load_dwordx4 v6, s[16:19], s50 offen offset:3072 nt lds
  v_mfma_f32_16x16x32_bf16 v[188:191], v[124:127], v[84:87], v[188:191]
  v_exp_f32 v182, v182
  v_mfma_f32_16x16x32_bf16 v[192:195], v[140:143], v[84:87], v[192:195]
  ds_read_b64_tr_b16 a[160:161], v16 offset:40960
  v_mfma_f32_16x16x32_bf16 v[188:191], v[128:131], v[104:107], v[188:191]
  v_exp_f32 v183, v183
  v_mfma_f32_16x16x32_bf16 v[192:195], v[144:147], v[104:107], v[192:195]
  ds_read_b64_tr_b16 a[162:163], v16 offset:45056
  v_mfma_f32_16x16x32_bf16 a[64:67], a[192:195], v[204:207], a[64:67]
  v_exp_f32 v184, v184
  v_mfma_f32_16x16x32_bf16 a[68:71], a[196:199], v[204:207], a[68:71]
  ds_read_b64_tr_b16 a[164:165], v17 offset:40960
  v_mfma_f32_16x16x32_bf16 a[72:75], a[200:203], v[204:207], a[72:75]
  v_exp_f32 v185, v185
  v_mfma_f32_16x16x32_bf16 a[76:79], a[204:207], v[204:207], a[76:79]
  ds_read_b64_tr_b16 a[166:167], v17 offset:45056
  v_mfma_f32_16x16x32_bf16 a[80:83], a[208:211], v[204:207], a[80:83]
  v_exp_f32 v186, v186
  v_mfma_f32_16x16x32_bf16 a[84:87], a[212:215], v[204:207], a[84:87]
  v_exp_f32 v187, v187
  v_mfma_f32_16x16x32_bf16 a[88:91], a[216:219], v[204:207], a[88:91]
  v_cvt_pk_bf16_f32 v200, v180, v181
  v_cvt_pk_bf16_f32 v201, v182, v183
  v_mfma_f32_16x16x32_bf16 a[92:95], a[220:223], v[204:207], a[92:95]
  v_cvt_pk_bf16_f32 v202, v184, v185
  v_cvt_pk_bf16_f32 v203, v186, v187
  v_mfma_f32_16x16x32_bf16 a[232:235], a[244:247], v[204:207], a[232:235]
  ds_read_b64_tr_b16 a[168:169], v18 offset:40960
  v_mfma_f32_16x16x32_bf16 v[180:183], v[116:119], v[48:51], v[228:231]
  v_exp_f32 v188, v188
  v_mfma_f32_16x16x32_bf16 v[184:187], v[132:135], v[48:51], v[228:231]
  ds_read_b64_tr_b16 a[170:171], v18 offset:45056
  v_mfma_f32_16x16x32_bf16 v[180:183], v[120:123], v[68:71], v[180:183]
  v_exp_f32 v189, v189
  v_mfma_f32_16x16x32_bf16 v[184:187], v[136:139], v[68:71], v[184:187]
  ds_read_b64_tr_b16 a[172:173], v19 offset:40960
  v_mfma_f32_16x16x32_bf16 v[180:183], v[124:127], v[88:91], v[180:183]
  v_exp_f32 v190, v190
  v_mfma_f32_16x16x32_bf16 v[184:187], v[140:143], v[88:91], v[184:187]
  ds_read_b64_tr_b16 a[174:175], v19 offset:45056
  v_mfma_f32_16x16x32_bf16 v[180:183], v[128:131], v[108:111], v[180:183]
  v_exp_f32 v191, v191
  v_mfma_f32_16x16x32_bf16 v[184:187], v[144:147], v[108:111], v[184:187]
  ds_read_b64_tr_b16 a[176:177], v20 offset:40960
  v_mfma_f32_16x16x32_bf16 a[96:99], a[192:195], v[208:211], a[96:99]
  v_exp_f32 v192, v192
  v_mfma_f32_16x16x32_bf16 a[100:103], a[196:199], v[208:211], a[100:103]
  ds_read_b64_tr_b16 a[178:179], v20 offset:45056
  v_mfma_f32_16x16x32_bf16 a[104:107], a[200:203], v[208:211], a[104:107]
  v_exp_f32 v193, v193
  v_mfma_f32_16x16x32_bf16 a[108:111], a[204:207], v[208:211], a[108:111]
  ds_read_b64_tr_b16 a[180:181], v21 offset:40960
  v_mfma_f32_16x16x32_bf16 a[112:115], a[208:211], v[208:211], a[112:115]
  v_exp_f32 v194, v194
  v_mfma_f32_16x16x32_bf16 a[116:119], a[212:215], v[208:211], a[116:119]
  v_exp_f32 v195, v195
  v_mfma_f32_16x16x32_bf16 a[120:123], a[216:219], v[208:211], a[120:123]
  v_cvt_pk_bf16_f32 v204, v188, v189
  v_cvt_pk_bf16_f32 v205, v190, v191
  v_mfma_f32_16x16x32_bf16 a[124:127], a[220:223], v[208:211], a[124:127]
  v_cvt_pk_bf16_f32 v206, v192, v193
  v_cvt_pk_bf16_f32 v207, v194, v195
  v_mfma_f32_16x16x32_bf16 a[236:239], a[244:247], v[208:211], a[236:239]
  ds_read_b64_tr_b16 a[182:183], v21 offset:45056
  v_mfma_f32_16x16x32_bf16 v[188:191], v[116:119], v[52:55], v[232:235]
  v_exp_f32 v180, v180
  v_mfma_f32_16x16x32_bf16 v[192:195], v[132:135], v[52:55], v[232:235]
  ds_read_b64_tr_b16 a[184:185], v22 offset:40960
  v_mfma_f32_16x16x32_bf16 v[188:191], v[120:123], v[72:75], v[188:191]
  v_exp_f32 v181, v181
  v_mfma_f32_16x16x32_bf16 v[192:195], v[136:139], v[72:75], v[192:195]
  ds_read_b64_tr_b16 a[186:187], v22 offset:45056
  v_mfma_f32_16x16x32_bf16 v[188:191], v[124:127], v[92:95], v[188:191]
  v_exp_f32 v182, v182
  v_mfma_f32_16x16x32_bf16 v[192:195], v[140:143], v[92:95], v[192:195]
  ds_read_b64_tr_b16 a[188:189], v23 offset:40960
  v_mfma_f32_16x16x32_bf16 v[188:191], v[128:131], v[112:115], v[188:191]
  v_exp_f32 v183, v183
  v_mfma_f32_16x16x32_bf16 v[192:195], v[144:147], v[112:115], v[192:195]
  ds_read_b64_tr_b16 a[190:191], v23 offset:45056
  v_mfma_f32_16x16x32_bf16 a[128:131], a[192:195], v[212:215], a[128:131]
  v_exp_f32 v184, v184
  v_mfma_f32_16x16x32_bf16 a[132:135], a[196:199], v[212:215], a[132:135]
  v_mfma_f32_16x16x32_bf16 a[136:139], a[200:203], v[212:215], a[136:139]
  v_exp_f32 v185, v185
  v_mfma_f32_16x16x32_bf16 a[140:143], a[204:207], v[212:215], a[140:143]
  v_mfma_f32_16x16x32_bf16 a[144:147], a[208:211], v[212:215], a[144:147]
  v_exp_f32 v186, v186
  v_mfma_f32_16x16x32_bf16 a[148:151], a[212:215], v[212:215], a[148:151]
  v_exp_f32 v187, v187
  v_mfma_f32_16x16x32_bf16 a[152:155], a[216:219], v[212:215], a[152:155]
  v_cvt_pk_bf16_f32 v208, v180, v181
  v_cvt_pk_bf16_f32 v209, v182, v183
  v_mfma_f32_16x16x32_bf16 a[156:159], a[220:223], v[212:215], a[156:159]
  v_cvt_pk_bf16_f32 v210, v184, v185
  v_cvt_pk_bf16_f32 v211, v186, v187
  v_mfma_f32_16x16x32_bf16 a[240:243], a[244:247], v[212:215], a[240:243]
  s_waitcnt lgkmcnt(0)
  s_barrier
  v_mfma_f32_16x16x32_bf16 v[180:183], v[148:151], v[36:39], v[216:219]
  v_exp_f32 v188, v188
  v_mfma_f32_16x16x32_bf16 v[184:187], v[164:167], v[36:39], v[216:219]
  ds_read_b128 v[116:119], v12 offset:0
  v_mfma_f32_16x16x32_bf16 v[180:183], v[152:155], v[56:59], v[180:183]
  v_exp_f32 v189, v189
  v_mfma_f32_16x16x32_bf16 v[184:187], v[168:171], v[56:59], v[184:187]
  s_add_u32 m0, s79, 73728
  s_add_u32 s50, s82, 57344
  s_and_b32 s50, s50, 0x1ffff
  s_add_u32 s50, s50, s34
  buffer_load_dwordx4 v1, s[12:15], s50 offen offset:0 nt lds
  v_mfma_f32_16x16x32_bf16 v[180:183], v[156:159], v[76:79], v[180:183]
  v_exp_f32 v190, v190
  v_mfma_f32_16x16x32_bf16 v[184:187], v[172:175], v[76:79], v[184:187]
  ds_read_b128 v[120:123], v13 offset:0
  v_mfma_f32_16x16x32_bf16 v[180:183], v[160:163], v[96:99], v[180:183]
  v_exp_f32 v191, v191
  v_mfma_f32_16x16x32_bf16 v[184:187], v[176:179], v[96:99], v[184:187]
  buffer_load_dwordx4 v2, s[12:15], s50 offen offset:1024 nt lds
  v_mfma_f32_16x16x32_bf16 a[0:3], a[160:163], v[196:199], a[0:3]
  v_exp_f32 v192, v192
  v_mfma_f32_16x16x32_bf16 a[4:7], a[164:167], v[196:199], a[4:7]
  ds_read_b128 v[124:127], v14 offset:0
  v_mfma_f32_16x16x32_bf16 a[8:11], a[168:171], v[196:199], a[8:11]
  v_exp_f32 v193, v193
  v_mfma_f32_16x16x32_bf16 a[12:15], a[172:175], v[196:199], a[12:15]
  buffer_load_dwordx4 v3, s[12:15], s50 offen offset:2048 nt lds
  v_mfma_f32_16x16x32_bf16 a[16:19], a[176:179], v[196:199], a[16:19]
  v_exp_f32 v194, v194
  v_mfma_f32_16x16x32_bf16 a[20:23], a[180:183], v[196:199], a[20:23]
  v_exp_f32 v195, v195
  v_mfma_f32_16x16x32_bf16 a[24:27], a[184:187], v[196:199], a[24:27]
  v_cvt_pk_bf16_f32 v212, v188, v189
  v_cvt_pk_bf16_f32 v213, v190, v191
  v_mfma_f32_16x16x32_bf16 a[28:31], a[188:191], v[196:199], a[28:31]
  v_cvt_pk_bf16_f32 v214, v192, v193
  v_cvt_pk_bf16_f32 v215, v194, v195
  v_mfma_f32_16x16x32_bf16 a[224:227], a[244:247], v[196:199], a[224:227]
  ds_read_b128 v[128:131], v15 offset:0
  v_mfma_f32_16x16x32_bf16 v[188:191], v[148:151], v[40:43], v[220:223]
  v_exp_f32 v180, v180
  v_mfma_f32_16x16x32_bf16 v[192:195], v[164:167], v[40:43], v[220:223]
  buffer_load_dwordx4 v4, s[12:15], s50 offen offset:3072 nt lds
  v_mfma_f32_16x16x32_bf16 v[188:191], v[152:155], v[60:63], v[188:191]
  v_exp_f32 v181, v181
  v_mfma_f32_16x16x32_bf16 v[192:195], v[168:171], v[60:63], v[192:195]
  ds_read_b128 v[132:135], v12 offset:4096
  v_mfma_f32_16x16x32_bf16 v[188:191], v[156:159], v[80:83], v[188:191]
  v_exp_f32 v182, v182
  v_mfma_f32_16x16x32_bf16 v[192:195], v[172:175], v[80:83], v[192:195]
  s_add_u32 m0, s79, 40960
  s_add_u32 s50, s82, 49152
  s_and_b32 s50, s50, 0x1ffff
  s_add_u32 s50, s50, s34
  buffer_load_dwordx4 v5, s[16:19], s50 offen offset:0 nt lds
  v_mfma_f32_16x16x32_bf16 v[188:191], v[160:163], v[100:103], v[188:191]
  v_exp_f32 v183, v183
  v_mfma_f32_16x16x32_bf16 v[192:195], v[176:179], v[100:103], v[192:195]
  ds_read_b128 v[136:139], v13 offset:4096
  v_mfma_f32_16x16x32_bf16 a[32:35], a[160:163], v[200:203], a[32:35]
  v_exp_f32 v184, v184
  v_mfma_f32_16x16x32_bf16 a[36:39], a[164:167], v[200:203], a[36:39]
  buffer_load_dwordx4 v6, s[16:19], s50 offen offset:1024 nt lds
  v_mfma_f32_16x16x32_bf16 a[40:43], a[168:171], v[200:203], a[40:43]
  v_exp_f32 v185, v185
  v_mfma_f32_16x16x32_bf16 a[44:47], a[172:175], v[200:203], a[44:47]
  ds_read_b128 v[140:143], v14 offset:4096
  v_mfma_f32_16x16x32_bf16 a[48:51], a[176:179], v[200:203], a[48:51]
  v_exp_f32 v186, v186
  v_mfma_f32_16x16x32_bf16 a[52:55], a[180:183], v[200:203], a[52:55]
  v_exp_f32 v187, v187
  v_mfma_f32_16x16x32_bf16 a[56:59], a[184:187], v[200:203], a[56:59]
  v_cvt_pk_bf16_f32 v196, v180, v181
  v_cvt_pk_bf16_f32 v197, v182, v183
  v_mfma_f32_16x16x32_bf16 a[60:63], a[188:191], v[200:203], a[60:63]
  v_cvt_pk_bf16_f32 v198, v184, v185
  v_cvt_pk_bf16_f32 v199, v186, v187
  v_mfma_f32_16x16x32_bf16 a[228:231], a[244:247], v[200:203], a[228:231]
  buffer_load_dwordx4 v5, s[16:19], s50 offen offset:2048 nt lds
  v_mfma_f32_16x16x32_bf16 v[180:183], v[148:151], v[44:47], v[224:227]
  v_exp_f32 v188, v188
  v_mfma_f32_16x16x32_bf16 v[184:187], v[164:167], v[44:47], v[224:227]
  ds_read_b128 v[144:147], v15 offset:4096
  v_mfma_f32_16x16x32_bf16 v[180:183], v[152:155], v[64:67], v[180:183]
  v_exp_f32 v189, v189
  v_mfma_f32_16x16x32_bf16 v[184:187], v[168:171], v[64:67], v[184:187]
  buffer_load_dwordx4 v6, s[16:19], s50 offen offset:3072 nt lds
  v_mfma_f32_16x16x32_bf16 v[180:183], v[156:159], v[84:87], v[180:183]
  v_exp_f32 v190, v190
  v_mfma_f32_16x16x32_bf16 v[184:187], v[172:175], v[84:87], v[184:187]
  ds_read_b64_tr_b16 a[192:193], v16 offset:16384
  v_mfma_f32_16x16x32_bf16 v[180:183], v[160:163], v[104:107], v[180:183]
  v_exp_f32 v191, v191
  v_mfma_f32_16x16x32_bf16 v[184:187], v[176:179], v[104:107], v[184:187]
  ds_read_b64_tr_b16 a[194:195], v16 offset:20480
  v_mfma_f32_16x16x32_bf16 a[64:67], a[160:163], v[204:207], a[64:67]
  v_exp_f32 v192, v192
  v_mfma_f32_16x16x32_bf16 a[68:71], a[164:167], v[204:207], a[68:71]
  ds_read_b64_tr_b16 a[196:197], v17 offset:16384
  v_mfma_f32_16x16x32_bf16 a[72:75], a[168:171], v[204:207], a[72:75]
  v_exp_f32 v193, v193
  v_mfma_f32_16x16x32_bf16 a[76:79], a[172:175], v[204:207], a[76:79]
  ds_read_b64_tr_b16 a[198:199], v17 offset:20480
  v_mfma_f32_16x16x32_bf16 a[80:83], a[176:179], v[204:207], a[80:83]
  v_exp_f32 v194, v194
  v_mfma_f32_16x16x32_bf16 a[84:87], a[180:183], v[204:207], a[84:87]
  v_exp_f32 v195, v195
  v_mfma_f32_16x16x32_bf16 a[88:91], a[184:187], v[204:207], a[88:91]
  v_cvt_pk_bf16_f32 v200, v188, v189
  v_cvt_pk_bf16_f32 v201, v190, v191
  v_mfma_f32_16x16x32_bf16 a[92:95], a[188:191], v[204:207], a[92:95]
  v_cvt_pk_bf16_f32 v202, v192, v193
  v_cvt_pk_bf16_f32 v203, v194, v195
  v_mfma_f32_16x16x32_bf16 a[232:235], a[244:247], v[204:207], a[232:235]
  ds_read_b64_tr_b16 a[200:201], v18 offset:16384
  v_mfma_f32_16x16x32_bf16 v[188:191], v[148:151], v[48:51], v[228:231]
  v_exp_f32 v180, v180
  v_mfma_f32_16x16x32_bf16 v[192:195], v[164:167], v[48:51], v[228:231]
  ds_read_b64_tr_b16 a[202:203], v18 offset:20480
  v_mfma_f32_16x16x32_bf16 v[188:191], v[152:155], v[68:71], v[188:191]
  v_exp_f32 v181, v181
  v_mfma_f32_16x16x32_bf16 v[192:195], v[168:171], v[68:71], v[192:195]
  ds_read_b64_tr_b16 a[204:205], v19 offset:16384
  v_mfma_f32_16x16x32_bf16 v[188:191], v[156:159], v[88:91], v[188:191]
  v_exp_f32 v182, v182
  v_mfma_f32_16x16x32_bf16 v[192:195], v[172:175], v[88:91], v[192:195]
  ds_read_b64_tr_b16 a[206:207], v19 offset:20480
  v_mfma_f32_16x16x32_bf16 v[188:191], v[160:163], v[108:111], v[188:191]
  v_exp_f32 v183, v183
  v_mfma_f32_16x16x32_bf16 v[192:195], v[176:179], v[108:111], v[192:195]
  ds_read_b64_tr_b16 a[208:209], v20 offset:16384
  v_mfma_f32_16x16x32_bf16 a[96:99], a[160:163], v[208:211], a[96:99]
  v_exp_f32 v184, v184
  v_mfma_f32_16x16x32_bf16 a[100:103], a[164:167], v[208:211], a[100:103]
  ds_read_b64_tr_b16 a[210:211], v20 offset:20480
  v_mfma_f32_16x16x32_bf16 a[104:107], a[168:171], v[208:211], a[104:107]
  v_exp_f32 v185, v185
  v_mfma_f32_16x16x32_bf16 a[108:111], a[172:175], v[208:211], a[108:111]
  ds_read_b64_tr_b16 a[212:213], v21 offset:16384
  v_mfma_f32_16x16x32_bf16 a[112:115], a[176:179], v[208:211], a[112:115]
  v_exp_f32 v186, v186
  v_mfma_f32_16x16x32_bf16 a[116:119], a[180:183], v[208:211], a[116:119]
  v_exp_f32 v187, v187
  v_mfma_f32_16x16x32_bf16 a[120:123], a[184:187], v[208:211], a[120:123]
  v_cvt_pk_bf16_f32 v204, v180, v181
  v_cvt_pk_bf16_f32 v205, v182, v183
  v_mfma_f32_16x16x32_bf16 a[124:127], a[188:191], v[208:211], a[124:127]
  v_cvt_pk_bf16_f32 v206, v184, v185
  v_cvt_pk_bf16_f32 v207, v186, v187
  v_mfma_f32_16x16x32_bf16 a[236:239], a[244:247], v[208:211], a[236:239]
  ds_read_b64_tr_b16 a[214:215], v21 offset:20480
  v_mfma_f32_16x16x32_bf16 v[180:183], v[148:151], v[52:55], v[232:235]
  v_exp_f32 v188, v188
  v_mfma_f32_16x16x32_bf16 v[184:187], v[164:167], v[52:55], v[232:235]
  ds_read_b64_tr_b16 a[216:217], v22 offset:16384
  v_mfma_f32_16x16x32_bf16 v[180:183], v[152:155], v[72:75], v[180:183]
  v_exp_f32 v189, v189
  v_mfma_f32_16x16x32_bf16 v[184:187], v[168:171], v[72:75], v[184:187]
  ds_read_b64_tr_b16 a[218:219], v22 offset:20480
  v_mfma_f32_16x16x32_bf16 v[180:183], v[156:159], v[92:95], v[180:183]
  v_exp_f32 v190, v190
  v_mfma_f32_16x16x32_bf16 v[184:187], v[172:175], v[92:95], v[184:187]
  ds_read_b64_tr_b16 a[220:221], v23 offset:16384
  v_mfma_f32_16x16x32_bf16 v[180:183], v[160:163], v[112:115], v[180:183]
  v_exp_f32 v191, v191
  v_mfma_f32_16x16x32_bf16 v[184:187], v[176:179], v[112:115], v[184:187]
  ds_read_b64_tr_b16 a[222:223], v23 offset:20480
  v_mfma_f32_16x16x32_bf16 a[128:131], a[160:163], v[212:215], a[128:131]
  v_exp_f32 v192, v192
  v_mfma_f32_16x16x32_bf16 a[132:135], a[164:167], v[212:215], a[132:135]
  v_mfma_f32_16x16x32_bf16 a[136:139], a[168:171], v[212:215], a[136:139]
  v_exp_f32 v193, v193
  v_mfma_f32_16x16x32_bf16 a[140:143], a[172:175], v[212:215], a[140:143]
  v_mfma_f32_16x16x32_bf16 a[144:147], a[176:179], v[212:215], a[144:147]
  v_exp_f32 v194, v194
  v_mfma_f32_16x16x32_bf16 a[148:151], a[180:183], v[212:215], a[148:151]
  v_exp_f32 v195, v195
  v_mfma_f32_16x16x32_bf16 a[152:155], a[184:187], v[212:215], a[152:155]
  v_cvt_pk_bf16_f32 v208, v188, v189
  v_cvt_pk_bf16_f32 v209, v190, v191
  v_mfma_f32_16x16x32_bf16 a[156:159], a[188:191], v[212:215], a[156:159]
  v_cvt_pk_bf16_f32 v210, v192, v193
  v_cvt_pk_bf16_f32 v211, v194, v195
  v_mfma_f32_16x16x32_bf16 a[240:243], a[244:247], v[212:215], a[240:243]
  s_waitcnt lgkmcnt(0)
  s_barrier
  v_mfma_f32_16x16x32_bf16 v[188:191], v[116:119], v[36:39], v[216:219]
  v_exp_f32 v180, v180
  v_mfma_f32_16x16x32_bf16 v[192:195], v[132:135], v[36:39], v[216:219]
  ds_read_b128 v[148:151], v12 offset:8192
  v_mfma_f32_16x16x32_bf16 v[188:191], v[120:123], v[56:59], v[188:191]
  v_exp_f32 v181, v181
  v_mfma_f32_16x16x32_bf16 v[192:195], v[136:139], v[56:59], v[192:195]
  s_add_u32 m0, s79, 49152
  s_add_u32 s50, s82, 65536
  s_and_b32 s50, s50, 0x1ffff
  s_add_u32 s50, s50, s34
  buffer_load_dwordx4 v1, s[12:15], s50 offen offset:0 nt lds
  v_mfma_f32_16x16x32_bf16 v[188:191], v[124:127], v[76:79], v[188:191]
  v_exp_f32 v182, v182
  v_mfma_f32_16x16x32_bf16 v[192:195], v[140:143], v[76:79], v[192:195]
  ds_read_b128 v[152:155], v13 offset:8192
  v_mfma_f32_16x16x32_bf16 v[188:191], v[128:131], v[96:99], v[188:191]
  v_exp_f32 v183, v183
  v_mfma_f32_16x16x32_bf16 v[192:195], v[144:147], v[96:99], v[192:195]
  buffer_load_dwordx4 v2, s[12:15], s50 offen offset:1024 nt lds
  v_mfma_f32_16x16x32_bf16 a[0:3], a[192:195], v[196:199], a[0:3]
  v_exp_f32 v184, v184
  v_mfma_f32_16x16x32_bf16 a[4:7], a[196:199], v[196:199], a[4:7]
  ds_read_b128 v[156:159], v14 offset:8192
  v_mfma_f32_16x16x32_bf16 a[8:11], a[200:203], v[196:199], a[8:11]
  v_exp_f32 v185, v185
  v_mfma_f32_16x16x32_bf16 a[12:15], a[204:207], v[196:199], a[12:15]
  buffer_load_dwordx4 v3, s[12:15], s50 offen offset:2048 nt lds
  v_mfma_f32_16x16x32_bf16 a[16:19], a[208:211], v[196:199], a[16:19]
  v_exp_f32 v186, v186
  v_mfma_f32_16x16x32_bf16 a[20:23], a[212:215], v[196:199], a[20:23]
  v_exp_f32 v187, v187
  v_mfma_f32_16x16x32_bf16 a[24:27], a[216:219], v[196:199], a[24:27]
  v_cvt_pk_bf16_f32 v212, v180, v181
  v_cvt_pk_bf16_f32 v213, v182, v183
  v_mfma_f32_16x16x32_bf16 a[28:31], a[220:223], v[196:199], a[28:31]
  v_cvt_pk_bf16_f32 v214, v184, v185
  v_cvt_pk_bf16_f32 v215, v186, v187
  v_mfma_f32_16x16x32_bf16 a[224:227], a[244:247], v[196:199], a[224:227]
  ds_read_b128 v[160:163], v15 offset:8192
  v_mfma_f32_16x16x32_bf16 v[180:183], v[116:119], v[40:43], v[220:223]
  v_exp_f32 v188, v188
  v_mfma_f32_16x16x32_bf16 v[184:187], v[132:135], v[40:43], v[220:223]
  buffer_load_dwordx4 v4, s[12:15], s50 offen offset:3072 nt lds
  v_mfma_f32_16x16x32_bf16 v[180:183], v[120:123], v[60:63], v[180:183]
  v_exp_f32 v189, v189
  v_mfma_f32_16x16x32_bf16 v[184:187], v[136:139], v[60:63], v[184:187]
  ds_read_b128 v[164:167], v12 offset:12288
  v_mfma_f32_16x16x32_bf16 v[180:183], v[124:127], v[80:83], v[180:183]
  v_exp_f32 v190, v190
  v_mfma_f32_16x16x32_bf16 v[184:187], v[140:143], v[80:83], v[184:187]
  s_add_u32 m0, s79, 16384
  s_add_u32 s50, s82, 57344
  s_and_b32 s50, s50, 0x1ffff
  s_add_u32 s50, s50, s34
  buffer_load_dwordx4 v5, s[16:19], s50 offen offset:0 nt lds
  v_mfma_f32_16x16x32_bf16 v[180:183], v[128:131], v[100:103], v[180:183]
  v_exp_f32 v191, v191
  v_mfma_f32_16x16x32_bf16 v[184:187], v[144:147], v[100:103], v[184:187]
  ds_read_b128 v[168:171], v13 offset:12288
  v_mfma_f32_16x16x32_bf16 a[32:35], a[192:195], v[200:203], a[32:35]
  v_exp_f32 v192, v192
  v_mfma_f32_16x16x32_bf16 a[36:39], a[196:199], v[200:203], a[36:39]
  buffer_load_dwordx4 v6, s[16:19], s50 offen offset:1024 nt lds
  v_mfma_f32_16x16x32_bf16 a[40:43], a[200:203], v[200:203], a[40:43]
  v_exp_f32 v193, v193
  v_mfma_f32_16x16x32_bf16 a[44:47], a[204:207], v[200:203], a[44:47]
  ds_read_b128 v[172:175], v14 offset:12288
  v_mfma_f32_16x16x32_bf16 a[48:51], a[208:211], v[200:203], a[48:51]
  v_exp_f32 v194, v194
  v_mfma_f32_16x16x32_bf16 a[52:55], a[212:215], v[200:203], a[52:55]
  v_exp_f32 v195, v195
  v_mfma_f32_16x16x32_bf16 a[56:59], a[216:219], v[200:203], a[56:59]
  v_cvt_pk_bf16_f32 v196, v188, v189
  v_cvt_pk_bf16_f32 v197, v190, v191
  v_mfma_f32_16x16x32_bf16 a[60:63], a[220:223], v[200:203], a[60:63]
  v_cvt_pk_bf16_f32 v198, v192, v193
  v_cvt_pk_bf16_f32 v199, v194, v195
  v_mfma_f32_16x16x32_bf16 a[228:231], a[244:247], v[200:203], a[228:231]
  buffer_load_dwordx4 v5, s[16:19], s50 offen offset:2048 nt lds
  v_mfma_f32_16x16x32_bf16 v[188:191], v[116:119], v[44:47], v[224:227]
  v_exp_f32 v180, v180
  v_mfma_f32_16x16x32_bf16 v[192:195], v[132:135], v[44:47], v[224:227]
  ds_read_b128 v[176:179], v15 offset:12288
  v_mfma_f32_16x16x32_bf16 v[188:191], v[120:123], v[64:67], v[188:191]
  v_exp_f32 v181, v181
  v_mfma_f32_16x16x32_bf16 v[192:195], v[136:139], v[64:67], v[192:195]
  buffer_load_dwordx4 v6, s[16:19], s50 offen offset:3072 nt lds
  v_mfma_f32_16x16x32_bf16 v[188:191], v[124:127], v[84:87], v[188:191]
  v_exp_f32 v182, v182
  v_mfma_f32_16x16x32_bf16 v[192:195], v[140:143], v[84:87], v[192:195]
  ds_read_b64_tr_b16 a[160:161], v16 offset:24576
  v_mfma_f32_16x16x32_bf16 v[188:191], v[128:131], v[104:107], v[188:191]
  v_exp_f32 v183, v183
  v_mfma_f32_16x16x32_bf16 v[192:195], v[144:147], v[104:107], v[192:195]
  ds_read_b64_tr_b16 a[162:163], v16 offset:28672
  v_mfma_f32_16x16x32_bf16 a[64:67], a[192:195], v[204:207], a[64:67]
  v_exp_f32 v184, v184
  v_mfma_f32_16x16x32_bf16 a[68:71], a[196:199], v[204:207], a[68:71]
  ds_read_b64_tr_b16 a[164:165], v17 offset:24576
  v_mfma_f32_16x16x32_bf16 a[72:75], a[200:203], v[204:207], a[72:75]
  v_exp_f32 v185, v185
  v_mfma_f32_16x16x32_bf16 a[76:79], a[204:207], v[204:207], a[76:79]
  ds_read_b64_tr_b16 a[166:167], v17 offset:28672
  v_mfma_f32_16x16x32_bf16 a[80:83], a[208:211], v[204:207], a[80:83]
  v_exp_f32 v186, v186
  v_mfma_f32_16x16x32_bf16 a[84:87], a[212:215], v[204:207], a[84:87]
  v_exp_f32 v187, v187
  v_mfma_f32_16x16x32_bf16 a[88:91], a[216:219], v[204:207], a[88:91]
  v_cvt_pk_bf16_f32 v200, v180, v181
  v_cvt_pk_bf16_f32 v201, v182, v183
  v_mfma_f32_16x16x32_bf16 a[92:95], a[220:223], v[204:207], a[92:95]
  v_cvt_pk_bf16_f32 v202, v184, v185
  v_cvt_pk_bf16_f32 v203, v186, v187
  v_mfma_f32_16x16x32_bf16 a[232:235], a[244:247], v[204:207], a[232:235]
  ds_read_b64_tr_b16 a[168:169], v18 offset:24576
  v_mfma_f32_16x16x32_bf16 v[180:183], v[116:119], v[48:51], v[228:231]
  v_exp_f32 v188, v188
  v_mfma_f32_16x16x32_bf16 v[184:187], v[132:135], v[48:51], v[228:231]
  ds_read_b64_tr_b16 a[170:171], v18 offset:28672
  v_mfma_f32_16x16x32_bf16 v[180:183], v[120:123], v[68:71], v[180:183]
  v_exp_f32 v189, v189
  v_mfma_f32_16x16x32_bf16 v[184:187], v[136:139], v[68:71], v[184:187]
  ds_read_b64_tr_b16 a[172:173], v19 offset:24576
  v_mfma_f32_16x16x32_bf16 v[180:183], v[124:127], v[88:91], v[180:183]
  v_exp_f32 v190, v190
  v_mfma_f32_16x16x32_bf16 v[184:187], v[140:143], v[88:91], v[184:187]
  ds_read_b64_tr_b16 a[174:175], v19 offset:28672
  v_mfma_f32_16x16x32_bf16 v[180:183], v[128:131], v[108:111], v[180:183]
  v_exp_f32 v191, v191
  v_mfma_f32_16x16x32_bf16 v[184:187], v[144:147], v[108:111], v[184:187]
  ds_read_b64_tr_b16 a[176:177], v20 offset:24576
  v_mfma_f32_16x16x32_bf16 a[96:99], a[192:195], v[208:211], a[96:99]
  v_exp_f32 v192, v192
  v_mfma_f32_16x16x32_bf16 a[100:103], a[196:199], v[208:211], a[100:103]
  ds_read_b64_tr_b16 a[178:179], v20 offset:28672
  v_mfma_f32_16x16x32_bf16 a[104:107], a[200:203], v[208:211], a[104:107]
  v_exp_f32 v193, v193
  v_mfma_f32_16x16x32_bf16 a[108:111], a[204:207], v[208:211], a[108:111]
  ds_read_b64_tr_b16 a[180:181], v21 offset:24576
  v_mfma_f32_16x16x32_bf16 a[112:115], a[208:211], v[208:211], a[112:115]
  v_exp_f32 v194, v194
  v_mfma_f32_16x16x32_bf16 a[116:119], a[212:215], v[208:211], a[116:119]
  v_exp_f32 v195, v195
  v_mfma_f32_16x16x32_bf16 a[120:123], a[216:219], v[208:211], a[120:123]
  v_cvt_pk_bf16_f32 v204, v188, v189
  v_cvt_pk_bf16_f32 v205, v190, v191
  v_mfma_f32_16x16x32_bf16 a[124:127], a[220:223], v[208:211], a[124:127]
  v_cvt_pk_bf16_f32 v206, v192, v193
  v_cvt_pk_bf16_f32 v207, v194, v195
  v_mfma_f32_16x16x32_bf16 a[236:239], a[244:247], v[208:211], a[236:239]
  ds_read_b64_tr_b16 a[182:183], v21 offset:28672
  v_mfma_f32_16x16x32_bf16 v[188:191], v[116:119], v[52:55], v[232:235]
  v_exp_f32 v180, v180
  v_mfma_f32_16x16x32_bf16 v[192:195], v[132:135], v[52:55], v[232:235]
  ds_read_b64_tr_b16 a[184:185], v22 offset:24576
  v_mfma_f32_16x16x32_bf16 v[188:191], v[120:123], v[72:75], v[188:191]
  v_exp_f32 v181, v181
  v_mfma_f32_16x16x32_bf16 v[192:195], v[136:139], v[72:75], v[192:195]
  ds_read_b64_tr_b16 a[186:187], v22 offset:28672
  v_mfma_f32_16x16x32_bf16 v[188:191], v[124:127], v[92:95], v[188:191]
  v_exp_f32 v182, v182
  v_mfma_f32_16x16x32_bf16 v[192:195], v[140:143], v[92:95], v[192:195]
  ds_read_b64_tr_b16 a[188:189], v23 offset:24576
  v_mfma_f32_16x16x32_bf16 v[188:191], v[128:131], v[112:115], v[188:191]
  v_exp_f32 v183, v183
  v_mfma_f32_16x16x32_bf16 v[192:195], v[144:147], v[112:115], v[192:195]
  ds_read_b64_tr_b16 a[190:191], v23 offset:28672
  v_mfma_f32_16x16x32_bf16 a[128:131], a[192:195], v[212:215], a[128:131]
  v_exp_f32 v184, v184
  v_mfma_f32_16x16x32_bf16 a[132:135], a[196:199], v[212:215], a[132:135]
  v_mfma_f32_16x16x32_bf16 a[136:139], a[200:203], v[212:215], a[136:139]
  v_exp_f32 v185, v185
  v_mfma_f32_16x16x32_bf16 a[140:143], a[204:207], v[212:215], a[140:143]
  v_mfma_f32_16x16x32_bf16 a[144:147], a[208:211], v[212:215], a[144:147]
  v_exp_f32 v186, v186
  v_mfma_f32_16x16x32_bf16 a[148:151], a[212:215], v[212:215], a[148:151]
  v_exp_f32 v187, v187
  v_mfma_f32_16x16x32_bf16 a[152:155], a[216:219], v[212:215], a[152:155]
  v_cvt_pk_bf16_f32 v208, v180, v181
  v_cvt_pk_bf16_f32 v209, v182, v183
  v_mfma_f32_16x16x32_bf16 a[156:159], a[220:223], v[212:215], a[156:159]
  v_cvt_pk_bf16_f32 v210, v184, v185
  v_cvt_pk_bf16_f32 v211, v186, v187
  v_mfma_f32_16x16x32_bf16 a[240:243], a[244:247], v[212:215], a[240:243]
  s_waitcnt vmcnt(16) lgkmcnt(0)
  s_barrier
  v_mfma_f32_16x16x32_bf16 v[180:183], v[148:151], v[36:39], v[216:219]
  v_exp_f32 v188, v188
  v_mfma_f32_16x16x32_bf16 v[184:187], v[164:167], v[36:39], v[216:219]
  ds_read_b128 v[116:119], v12 offset:16384
  v_mfma_f32_16x16x32_bf16 v[180:183], v[152:155], v[56:59], v[180:183]
  v_exp_f32 v189, v189
  v_mfma_f32_16x16x32_bf16 v[184:187], v[168:171], v[56:59], v[184:187]
  s_add_u32 m0, s79, 57344
  s_add_u32 s50, s82, 73728
  s_and_b32 s50, s50, 0x1ffff
  s_add_u32 s50, s50, s34
  buffer_load_dwordx4 v1, s[12:15], s50 offen offset:0 nt lds
  v_mfma_f32_16x16x32_bf16 v[180:183], v[156:159], v[76:79], v[180:183]
  v_exp_f32 v190, v190
  v_mfma_f32_16x16x32_bf16 v[184:187], v[172:175], v[76:79], v[184:187]
  ds_read_b128 v[120:123], v13 offset:16384
  v_mfma_f32_16x16x32_bf16 v[180:183], v[160:163], v[96:99], v[180:183]
  v_exp_f32 v191, v191
  v_mfma_f32_16x16x32_bf16 v[184:187], v[176:179], v[96:99], v[184:187]
  buffer_load_dwordx4 v2, s[12:15], s50 offen offset:1024 nt lds
  v_mfma_f32_16x16x32_bf16 a[0:3], a[160:163], v[196:199], a[0:3]
  v_exp_f32 v192, v192
  v_mfma_f32_16x16x32_bf16 a[4:7], a[164:167], v[196:199], a[4:7]
  ds_read_b128 v[124:127], v14 offset:16384
  v_mfma_f32_16x16x32_bf16 a[8:11], a[168:171], v[196:199], a[8:11]
  v_exp_f32 v193, v193
  v_mfma_f32_16x16x32_bf16 a[12:15], a[172:175], v[196:199], a[12:15]
  buffer_load_dwordx4 v3, s[12:15], s50 offen offset:2048 nt lds
  v_mfma_f32_16x16x32_bf16 a[16:19], a[176:179], v[196:199], a[16:19]
  v_exp_f32 v194, v194
  v_mfma_f32_16x16x32_bf16 a[20:23], a[180:183], v[196:199], a[20:23]
  v_exp_f32 v195, v195
  v_mfma_f32_16x16x32_bf16 a[24:27], a[184:187], v[196:199], a[24:27]
  v_cvt_pk_bf16_f32 v212, v188, v189
  v_cvt_pk_bf16_f32 v213, v190, v191
  v_mfma_f32_16x16x32_bf16 a[28:31], a[188:191], v[196:199], a[28:31]
  v_cvt_pk_bf16_f32 v214, v192, v193
  v_cvt_pk_bf16_f32 v215, v194, v195
  v_mfma_f32_16x16x32_bf16 a[224:227], a[244:247], v[196:199], a[224:227]
  ds_read_b128 v[128:131], v15 offset:16384
  v_mfma_f32_16x16x32_bf16 v[188:191], v[148:151], v[40:43], v[220:223]
  v_exp_f32 v180, v180
  v_mfma_f32_16x16x32_bf16 v[192:195], v[164:167], v[40:43], v[220:223]
  buffer_load_dwordx4 v4, s[12:15], s50 offen offset:3072 nt lds
  v_mfma_f32_16x16x32_bf16 v[188:191], v[152:155], v[60:63], v[188:191]
  v_exp_f32 v181, v181
  v_mfma_f32_16x16x32_bf16 v[192:195], v[168:171], v[60:63], v[192:195]
  ds_read_b128 v[132:135], v12 offset:20480
  v_mfma_f32_16x16x32_bf16 v[188:191], v[156:159], v[80:83], v[188:191]
  v_exp_f32 v182, v182
  v_mfma_f32_16x16x32_bf16 v[192:195], v[172:175], v[80:83], v[192:195]
  s_add_u32 m0, s79, 24576
  s_add_u32 s50, s82, 65536
  s_and_b32 s50, s50, 0x1ffff
  s_add_u32 s50, s50, s34
  buffer_load_dwordx4 v5, s[16:19], s50 offen offset:0 nt lds
  v_mfma_f32_16x16x32_bf16 v[188:191], v[160:163], v[100:103], v[188:191]
  v_exp_f32 v183, v183
  v_mfma_f32_16x16x32_bf16 v[192:195], v[176:179], v[100:103], v[192:195]
  ds_read_b128 v[136:139], v13 offset:20480
  v_mfma_f32_16x16x32_bf16 a[32:35], a[160:163], v[200:203], a[32:35]
  v_exp_f32 v184, v184
  v_mfma_f32_16x16x32_bf16 a[36:39], a[164:167], v[200:203], a[36:39]
  buffer_load_dwordx4 v6, s[16:19], s50 offen offset:1024 nt lds
  v_mfma_f32_16x16x32_bf16 a[40:43], a[168:171], v[200:203], a[40:43]
  v_exp_f32 v185, v185
  v_mfma_f32_16x16x32_bf16 a[44:47], a[172:175], v[200:203], a[44:47]
  ds_read_b128 v[140:143], v14 offset:20480
  v_mfma_f32_16x16x32_bf16 a[48:51], a[176:179], v[200:203], a[48:51]
  v_exp_f32 v186, v186
  v_mfma_f32_16x16x32_bf16 a[52:55], a[180:183], v[200:203], a[52:55]
  v_exp_f32 v187, v187
  v_mfma_f32_16x16x32_bf16 a[56:59], a[184:187], v[200:203], a[56:59]
  v_cvt_pk_bf16_f32 v196, v180, v181
  v_cvt_pk_bf16_f32 v197, v182, v183
  v_mfma_f32_16x16x32_bf16 a[60:63], a[188:191], v[200:203], a[60:63]
  v_cvt_pk_bf16_f32 v198, v184, v185
  v_cvt_pk_bf16_f32 v199, v186, v187
  v_mfma_f32_16x16x32_bf16 a[228:231], a[244:247], v[200:203], a[228:231]
  buffer_load_dwordx4 v5, s[16:19], s50 offen offset:2048 nt lds
  v_mfma_f32_16x16x32_bf16 v[180:183], v[148:151], v[44:47], v[224:227]
  v_exp_f32 v188, v188
  v_mfma_f32_16x16x32_bf16 v[184:187], v[164:167], v[44:47], v[224:227]
  ds_read_b128 v[144:147], v15 offset:20480
  v_mfma_f32_16x16x32_bf16 v[180:183], v[152:155], v[64:67], v[180:183]
  v_exp_f32 v189, v189
  v_mfma_f32_16x16x32_bf16 v[184:187], v[168:171], v[64:67], v[184:187]
  buffer_load_dwordx4 v6, s[16:19], s50 offen offset:3072 nt lds
  v_mfma_f32_16x16x32_bf16 v[180:183], v[156:159], v[84:87], v[180:183]
  v_exp_f32 v190, v190
  v_mfma_f32_16x16x32_bf16 v[184:187], v[172:175], v[84:87], v[184:187]
  ds_read_b64_tr_b16 a[192:193], v16 offset:32768
  v_mfma_f32_16x16x32_bf16 v[180:183], v[160:163], v[104:107], v[180:183]
  v_exp_f32 v191, v191
  v_mfma_f32_16x16x32_bf16 v[184:187], v[176:179], v[104:107], v[184:187]
  ds_read_b64_tr_b16 a[194:195], v16 offset:36864
  v_mfma_f32_16x16x32_bf16 a[64:67], a[160:163], v[204:207], a[64:67]
  v_exp_f32 v192, v192
  v_mfma_f32_16x16x32_bf16 a[68:71], a[164:167], v[204:207], a[68:71]
  ds_read_b64_tr_b16 a[196:197], v17 offset:32768
  v_mfma_f32_16x16x32_bf16 a[72:75], a[168:171], v[204:207], a[72:75]
  v_exp_f32 v193, v193
  v_mfma_f32_16x16x32_bf16 a[76:79], a[172:175], v[204:207], a[76:79]
  ds_read_b64_tr_b16 a[198:199], v17 offset:36864
  v_mfma_f32_16x16x32_bf16 a[80:83], a[176:179], v[204:207], a[80:83]
  v_exp_f32 v194, v194
  v_mfma_f32_16x16x32_bf16 a[84:87], a[180:183], v[204:207], a[84:87]
  v_exp_f32 v195, v195
  v_mfma_f32_16x16x32_bf16 a[88:91], a[184:187], v[204:207], a[88:91]
  v_cvt_pk_bf16_f32 v200, v188, v189
  v_cvt_pk_bf16_f32 v201, v190, v191
  v_mfma_f32_16x16x32_bf16 a[92:95], a[188:191], v[204:207], a[92:95]
  v_cvt_pk_bf16_f32 v202, v192, v193
  v_cvt_pk_bf16_f32 v203, v194, v195
  v_mfma_f32_16x16x32_bf16 a[232:235], a[244:247], v[204:207], a[232:235]
  ds_read_b64_tr_b16 a[200:201], v18 offset:32768
  v_mfma_f32_16x16x32_bf16 v[188:191], v[148:151], v[48:51], v[228:231]
  v_exp_f32 v180, v180
  v_mfma_f32_16x16x32_bf16 v[192:195], v[164:167], v[48:51], v[228:231]
  ds_read_b64_tr_b16 a[202:203], v18 offset:36864
  v_mfma_f32_16x16x32_bf16 v[188:191], v[152:155], v[68:71], v[188:191]
  v_exp_f32 v181, v181
  v_mfma_f32_16x16x32_bf16 v[192:195], v[168:171], v[68:71], v[192:195]
  ds_read_b64_tr_b16 a[204:205], v19 offset:32768
  v_mfma_f32_16x16x32_bf16 v[188:191], v[156:159], v[88:91], v[188:191]
  v_exp_f32 v182, v182
  v_mfma_f32_16x16x32_bf16 v[192:195], v[172:175], v[88:91], v[192:195]
  ds_read_b64_tr_b16 a[206:207], v19 offset:36864
  v_mfma_f32_16x16x32_bf16 v[188:191], v[160:163], v[108:111], v[188:191]
  v_exp_f32 v183, v183
  v_mfma_f32_16x16x32_bf16 v[192:195], v[176:179], v[108:111], v[192:195]
  ds_read_b64_tr_b16 a[208:209], v20 offset:32768
  v_mfma_f32_16x16x32_bf16 a[96:99], a[160:163], v[208:211], a[96:99]
  v_exp_f32 v184, v184
  v_mfma_f32_16x16x32_bf16 a[100:103], a[164:167], v[208:211], a[100:103]
  ds_read_b64_tr_b16 a[210:211], v20 offset:36864
  v_mfma_f32_16x16x32_bf16 a[104:107], a[168:171], v[208:211], a[104:107]
  v_exp_f32 v185, v185
  v_mfma_f32_16x16x32_bf16 a[108:111], a[172:175], v[208:211], a[108:111]
  ds_read_b64_tr_b16 a[212:213], v21 offset:32768
  v_mfma_f32_16x16x32_bf16 a[112:115], a[176:179], v[208:211], a[112:115]
  v_exp_f32 v186, v186
  v_mfma_f32_16x16x32_bf16 a[116:119], a[180:183], v[208:211], a[116:119]
  v_exp_f32 v187, v187
  v_mfma_f32_16x16x32_bf16 a[120:123], a[184:187], v[208:211], a[120:123]
  v_cvt_pk_bf16_f32 v204, v180, v181
  v_cvt_pk_bf16_f32 v205, v182, v183
  v_mfma_f32_16x16x32_bf16 a[124:127], a[188:191], v[208:211], a[124:127]
  v_cvt_pk_bf16_f32 v206, v184, v185
  v_cvt_pk_bf16_f32 v207, v186, v187
  v_mfma_f32_16x16x32_bf16 a[236:239], a[244:247], v[208:211], a[236:239]
  ds_read_b64_tr_b16 a[214:215], v21 offset:36864
  v_mfma_f32_16x16x32_bf16 v[180:183], v[148:151], v[52:55], v[232:235]
  v_exp_f32 v188, v188
  v_mfma_f32_16x16x32_bf16 v[184:187], v[164:167], v[52:55], v[232:235]
  ds_read_b64_tr_b16 a[216:217], v22 offset:32768
  v_mfma_f32_16x16x32_bf16 v[180:183], v[152:155], v[72:75], v[180:183]
  v_exp_f32 v189, v189
  v_mfma_f32_16x16x32_bf16 v[184:187], v[168:171], v[72:75], v[184:187]
  ds_read_b64_tr_b16 a[218:219], v22 offset:36864
  v_mfma_f32_16x16x32_bf16 v[180:183], v[156:159], v[92:95], v[180:183]
  v_exp_f32 v190, v190
  v_mfma_f32_16x16x32_bf16 v[184:187], v[172:175], v[92:95], v[184:187]
  ds_read_b64_tr_b16 a[220:221], v23 offset:32768
  v_mfma_f32_16x16x32_bf16 v[180:183], v[160:163], v[112:115], v[180:183]
  v_exp_f32 v191, v191
  v_mfma_f32_16x16x32_bf16 v[184:187], v[176:179], v[112:115], v[184:187]
  ds_read_b64_tr_b16 a[222:223], v23 offset:36864
  v_mfma_f32_16x16x32_bf16 a[128:131], a[160:163], v[212:215], a[128:131]
  v_exp_f32 v192, v192
  v_mfma_f32_16x16x32_bf16 a[132:135], a[164:167], v[212:215], a[132:135]
  v_mfma_f32_16x16x32_bf16 a[136:139], a[168:171], v[212:215], a[136:139]
  v_exp_f32 v193, v193
  v_mfma_f32_16x16x32_bf16 a[140:143], a[172:175], v[212:215], a[140:143]
  v_mfma_f32_16x16x32_bf16 a[144:147], a[176:179], v[212:215], a[144:147]
  v_exp_f32 v194, v194
  v_mfma_f32_16x16x32_bf16 a[148:151], a[180:183], v[212:215], a[148:151]
  v_exp_f32 v195, v195
  v_mfma_f32_16x16x32_bf16 a[152:155], a[184:187], v[212:215], a[152:155]
  v_cvt_pk_bf16_f32 v208, v188, v189
  v_cvt_pk_bf16_f32 v209, v190, v191
  v_mfma_f32_16x16x32_bf16 a[156:159], a[188:191], v[212:215], a[156:159]
  v_cvt_pk_bf16_f32 v210, v192, v193
  v_cvt_pk_bf16_f32 v211, v194, v195
  v_mfma_f32_16x16x32_bf16 a[240:243], a[244:247], v[212:215], a[240:243]
  s_waitcnt vmcnt(16) lgkmcnt(0)
  s_barrier
  v_mfma_f32_16x16x32_bf16 v[188:191], v[116:119], v[36:39], v[216:219]
  v_exp_f32 v180, v180
  v_mfma_f32_16x16x32_bf16 v[192:195], v[132:135], v[36:39], v[216:219]
  ds_read_b128 v[148:151], v12 offset:24576
  v_mfma_f32_16x16x32_bf16 v[188:191], v[120:123], v[56:59], v[188:191]
  v_exp_f32 v181, v181
  v_mfma_f32_16x16x32_bf16 v[192:195], v[136:139], v[56:59], v[192:195]
  s_add_u32 m0, s79, 65536
  s_add_u32 s50, s82, 81920
  s_and_b32 s50, s50, 0x1ffff
  s_add_u32 s50, s50, s34
  buffer_load_dwordx4 v1, s[12:15], s50 offen offset:0 nt lds
  v_mfma_f32_16x16x32_bf16 v[188:191], v[124:127], v[76:79], v[188:191]
  v_exp_f32 v182, v182
  v_mfma_f32_16x16x32_bf16 v[192:195], v[140:143], v[76:79], v[192:195]
  ds_read_b128 v[152:155], v13 offset:24576
  v_mfma_f32_16x16x32_bf16 v[188:191], v[128:131], v[96:99], v[188:191]
  v_exp_f32 v183, v183
  v_mfma_f32_16x16x32_bf16 v[192:195], v[144:147], v[96:99], v[192:195]
  buffer_load_dwordx4 v2, s[12:15], s50 offen offset:1024 nt lds
  v_mfma_f32_16x16x32_bf16 a[0:3], a[192:195], v[196:199], a[0:3]
  v_exp_f32 v184, v184
  v_mfma_f32_16x16x32_bf16 a[4:7], a[196:199], v[196:199], a[4:7]
  ds_read_b128 v[156:159], v14 offset:24576
  v_mfma_f32_16x16x32_bf16 a[8:11], a[200:203], v[196:199], a[8:11]
  v_exp_f32 v185, v185
  v_mfma_f32_16x16x32_bf16 a[12:15], a[204:207], v[196:199], a[12:15]
  buffer_load_dwordx4 v3, s[12:15], s50 offen offset:2048 nt lds
  v_mfma_f32_16x16x32_bf16 a[16:19], a[208:211], v[196:199], a[16:19]
  v_exp_f32 v186, v186
  v_mfma_f32_16x16x32_bf16 a[20:23], a[212:215], v[196:199], a[20:23]
  v_exp_f32 v187, v187
  v_mfma_f32_16x16x32_bf16 a[24:27], a[216:219], v[196:199], a[24:27]
  v_cvt_pk_bf16_f32 v212, v180, v181
  v_cvt_pk_bf16_f32 v213, v182, v183
  v_mfma_f32_16x16x32_bf16 a[28:31], a[220:223], v[196:199], a[28:31]
  v_cvt_pk_bf16_f32 v214, v184, v185
  v_cvt_pk_bf16_f32 v215, v186, v187
  v_mfma_f32_16x16x32_bf16 a[224:227], a[244:247], v[196:199], a[224:227]
  ds_read_b128 v[160:163], v15 offset:24576
  v_mfma_f32_16x16x32_bf16 v[180:183], v[116:119], v[40:43], v[220:223]
  v_exp_f32 v188, v188
  v_mfma_f32_16x16x32_bf16 v[184:187], v[132:135], v[40:43], v[220:223]
  buffer_load_dwordx4 v4, s[12:15], s50 offen offset:3072 nt lds
  v_mfma_f32_16x16x32_bf16 v[180:183], v[120:123], v[60:63], v[180:183]
  v_exp_f32 v189, v189
  v_mfma_f32_16x16x32_bf16 v[184:187], v[136:139], v[60:63], v[184:187]
  ds_read_b128 v[164:167], v12 offset:28672
  v_mfma_f32_16x16x32_bf16 v[180:183], v[124:127], v[80:83], v[180:183]
  v_exp_f32 v190, v190
  v_mfma_f32_16x16x32_bf16 v[184:187], v[140:143], v[80:83], v[184:187]
  s_add_u32 m0, s79, 32768
  s_add_u32 s50, s82, 73728
  s_and_b32 s50, s50, 0x1ffff
  s_add_u32 s50, s50, s34
  buffer_load_dwordx4 v5, s[16:19], s50 offen offset:0 nt lds
  v_mfma_f32_16x16x32_bf16 v[180:183], v[128:131], v[100:103], v[180:183]
  v_exp_f32 v191, v191
  v_mfma_f32_16x16x32_bf16 v[184:187], v[144:147], v[100:103], v[184:187]
  ds_read_b128 v[168:171], v13 offset:28672
  v_mfma_f32_16x16x32_bf16 a[32:35], a[192:195], v[200:203], a[32:35]
  v_exp_f32 v192, v192
  v_mfma_f32_16x16x32_bf16 a[36:39], a[196:199], v[200:203], a[36:39]
  buffer_load_dwordx4 v6, s[16:19], s50 offen offset:1024 nt lds
  v_mfma_f32_16x16x32_bf16 a[40:43], a[200:203], v[200:203], a[40:43]
  v_exp_f32 v193, v193
  v_mfma_f32_16x16x32_bf16 a[44:47], a[204:207], v[200:203], a[44:47]
  ds_read_b128 v[172:175], v14 offset:28672
  v_mfma_f32_16x16x32_bf16 a[48:51], a[208:211], v[200:203], a[48:51]
  v_exp_f32 v194, v194
  v_mfma_f32_16x16x32_bf16 a[52:55], a[212:215], v[200:203], a[52:55]
  v_exp_f32 v195, v195
  v_mfma_f32_16x16x32_bf16 a[56:59], a[216:219], v[200:203], a[56:59]
  v_cvt_pk_bf16_f32 v196, v188, v189
  v_cvt_pk_bf16_f32 v197, v190, v191
  v_mfma_f32_16x16x32_bf16 a[60:63], a[220:223], v[200:203], a[60:63]
  v_cvt_pk_bf16_f32 v198, v192, v193
  v_cvt_pk_bf16_f32 v199, v194, v195
  v_mfma_f32_16x16x32_bf16 a[228:231], a[244:247], v[200:203], a[228:231]
  buffer_load_dwordx4 v5, s[16:19], s50 offen offset:2048 nt lds
  v_mfma_f32_16x16x32_bf16 v[188:191], v[116:119], v[44:47], v[224:227]
  v_exp_f32 v180, v180
  v_mfma_f32_16x16x32_bf16 v[192:195], v[132:135], v[44:47], v[224:227]
  ds_read_b128 v[176:179], v15 offset:28672
  v_mfma_f32_16x16x32_bf16 v[188:191], v[120:123], v[64:67], v[188:191]
  v_exp_f32 v181, v181
  v_mfma_f32_16x16x32_bf16 v[192:195], v[136:139], v[64:67], v[192:195]
  buffer_load_dwordx4 v6, s[16:19], s50 offen offset:3072 nt lds
  v_mfma_f32_16x16x32_bf16 v[188:191], v[124:127], v[84:87], v[188:191]
  v_exp_f32 v182, v182
  v_mfma_f32_16x16x32_bf16 v[192:195], v[140:143], v[84:87], v[192:195]
  ds_read_b64_tr_b16 a[160:161], v16 offset:40960
  v_mfma_f32_16x16x32_bf16 v[188:191], v[128:131], v[104:107], v[188:191]
  v_exp_f32 v183, v183
  v_mfma_f32_16x16x32_bf16 v[192:195], v[144:147], v[104:107], v[192:195]
  ds_read_b64_tr_b16 a[162:163], v16 offset:45056
  v_mfma_f32_16x16x32_bf16 a[64:67], a[192:195], v[204:207], a[64:67]
  v_exp_f32 v184, v184
  v_mfma_f32_16x16x32_bf16 a[68:71], a[196:199], v[204:207], a[68:71]
  ds_read_b64_tr_b16 a[164:165], v17 offset:40960
  v_mfma_f32_16x16x32_bf16 a[72:75], a[200:203], v[204:207], a[72:75]
  v_exp_f32 v185, v185
  v_mfma_f32_16x16x32_bf16 a[76:79], a[204:207], v[204:207], a[76:79]
  ds_read_b64_tr_b16 a[166:167], v17 offset:45056
  v_mfma_f32_16x16x32_bf16 a[80:83], a[208:211], v[204:207], a[80:83]
  v_exp_f32 v186, v186
  v_mfma_f32_16x16x32_bf16 a[84:87], a[212:215], v[204:207], a[84:87]
  v_exp_f32 v187, v187
  v_mfma_f32_16x16x32_bf16 a[88:91], a[216:219], v[204:207], a[88:91]
  v_cvt_pk_bf16_f32 v200, v180, v181
  v_cvt_pk_bf16_f32 v201, v182, v183
  v_mfma_f32_16x16x32_bf16 a[92:95], a[220:223], v[204:207], a[92:95]
  v_cvt_pk_bf16_f32 v202, v184, v185
  v_cvt_pk_bf16_f32 v203, v186, v187
  v_mfma_f32_16x16x32_bf16 a[232:235], a[244:247], v[204:207], a[232:235]
  ds_read_b64_tr_b16 a[168:169], v18 offset:40960
  v_mfma_f32_16x16x32_bf16 v[180:183], v[116:119], v[48:51], v[228:231]
  v_exp_f32 v188, v188
  v_mfma_f32_16x16x32_bf16 v[184:187], v[132:135], v[48:51], v[228:231]
  ds_read_b64_tr_b16 a[170:171], v18 offset:45056
  v_mfma_f32_16x16x32_bf16 v[180:183], v[120:123], v[68:71], v[180:183]
  v_exp_f32 v189, v189
  v_mfma_f32_16x16x32_bf16 v[184:187], v[136:139], v[68:71], v[184:187]
  ds_read_b64_tr_b16 a[172:173], v19 offset:40960
  v_mfma_f32_16x16x32_bf16 v[180:183], v[124:127], v[88:91], v[180:183]
  v_exp_f32 v190, v190
  v_mfma_f32_16x16x32_bf16 v[184:187], v[140:143], v[88:91], v[184:187]
  ds_read_b64_tr_b16 a[174:175], v19 offset:45056
  v_mfma_f32_16x16x32_bf16 v[180:183], v[128:131], v[108:111], v[180:183]
  v_exp_f32 v191, v191
  v_mfma_f32_16x16x32_bf16 v[184:187], v[144:147], v[108:111], v[184:187]
  ds_read_b64_tr_b16 a[176:177], v20 offset:40960
  v_mfma_f32_16x16x32_bf16 a[96:99], a[192:195], v[208:211], a[96:99]
  v_exp_f32 v192, v192
  v_mfma_f32_16x16x32_bf16 a[100:103], a[196:199], v[208:211], a[100:103]
  ds_read_b64_tr_b16 a[178:179], v20 offset:45056
  v_mfma_f32_16x16x32_bf16 a[104:107], a[200:203], v[208:211], a[104:107]
  v_exp_f32 v193, v193
  v_mfma_f32_16x16x32_bf16 a[108:111], a[204:207], v[208:211], a[108:111]
  ds_read_b64_tr_b16 a[180:181], v21 offset:40960
  v_mfma_f32_16x16x32_bf16 a[112:115], a[208:211], v[208:211], a[112:115]
  v_exp_f32 v194, v194
  v_mfma_f32_16x16x32_bf16 a[116:119], a[212:215], v[208:211], a[116:119]
  v_exp_f32 v195, v195
  v_mfma_f32_16x16x32_bf16 a[120:123], a[216:219], v[208:211], a[120:123]
  v_cvt_pk_bf16_f32 v204, v188, v189
  v_cvt_pk_bf16_f32 v205, v190, v191
  v_mfma_f32_16x16x32_bf16 a[124:127], a[220:223], v[208:211], a[124:127]
  v_cvt_pk_bf16_f32 v206, v192, v193
  v_cvt_pk_bf16_f32 v207, v194, v195
  v_mfma_f32_16x16x32_bf16 a[236:239], a[244:247], v[208:211], a[236:239]
  ds_read_b64_tr_b16 a[182:183], v21 offset:45056
  v_mfma_f32_16x16x32_bf16 v[188:191], v[116:119], v[52:55], v[232:235]
  v_exp_f32 v180, v180
  v_mfma_f32_16x16x32_bf16 v[192:195], v[132:135], v[52:55], v[232:235]
  ds_read_b64_tr_b16 a[184:185], v22 offset:40960
  v_mfma_f32_16x16x32_bf16 v[188:191], v[120:123], v[72:75], v[188:191]
  v_exp_f32 v181, v181
  v_mfma_f32_16x16x32_bf16 v[192:195], v[136:139], v[72:75], v[192:195]
  ds_read_b64_tr_b16 a[186:187], v22 offset:45056
  v_mfma_f32_16x16x32_bf16 v[188:191], v[124:127], v[92:95], v[188:191]
  v_exp_f32 v182, v182
  v_mfma_f32_16x16x32_bf16 v[192:195], v[140:143], v[92:95], v[192:195]
  ds_read_b64_tr_b16 a[188:189], v23 offset:40960
  v_mfma_f32_16x16x32_bf16 v[188:191], v[128:131], v[112:115], v[188:191]
  v_exp_f32 v183, v183
  v_mfma_f32_16x16x32_bf16 v[192:195], v[144:147], v[112:115], v[192:195]
  ds_read_b64_tr_b16 a[190:191], v23 offset:45056
  v_mfma_f32_16x16x32_bf16 a[128:131], a[192:195], v[212:215], a[128:131]
  v_exp_f32 v184, v184
  v_mfma_f32_16x16x32_bf16 a[132:135], a[196:199], v[212:215], a[132:135]
  v_mfma_f32_16x16x32_bf16 a[136:139], a[200:203], v[212:215], a[136:139]
  v_exp_f32 v185, v185
  v_mfma_f32_16x16x32_bf16 a[140:143], a[204:207], v[212:215], a[140:143]
  v_mfma_f32_16x16x32_bf16 a[144:147], a[208:211], v[212:215], a[144:147]
  v_exp_f32 v186, v186
  v_mfma_f32_16x16x32_bf16 a[148:151], a[212:215], v[212:215], a[148:151]
  v_exp_f32 v187, v187
  v_mfma_f32_16x16x32_bf16 a[152:155], a[216:219], v[212:215], a[152:155]
  v_cvt_pk_bf16_f32 v208, v180, v181
  v_cvt_pk_bf16_f32 v209, v182, v183
  v_mfma_f32_16x16x32_bf16 a[156:159], a[220:223], v[212:215], a[156:159]
  v_cvt_pk_bf16_f32 v210, v184, v185
  v_cvt_pk_bf16_f32 v211, v186, v187
  v_mfma_f32_16x16x32_bf16 a[240:243], a[244:247], v[212:215], a[240:243]
  s_waitcnt vmcnt(16) lgkmcnt(0)
  s_barrier
  v_mfma_f32_16x16x32_bf16 v[180:183], v[148:151], v[36:39], v[216:219]
  v_exp_f32 v188, v188
  v_mfma_f32_16x16x32_bf16 v[184:187], v[164:167], v[36:39], v[216:219]
  ds_read_b128 v[116:119], v12 offset:0
  v_mfma_f32_16x16x32_bf16 v[180:183], v[152:155], v[56:59], v[180:183]
  v_exp_f32 v189, v189
  v_mfma_f32_16x16x32_bf16 v[184:187], v[168:171], v[56:59], v[184:187]
  s_add_u32 m0, s79, 73728
  s_add_u32 s50, s82, 90112
  s_and_b32 s50, s50, 0x1ffff
  s_add_u32 s50, s50, s34
  buffer_load_dwordx4 v1, s[12:15], s50 offen offset:0 nt lds
  v_mfma_f32_16x16x32_bf16 v[180:183], v[156:159], v[76:79], v[180:183]
  v_exp_f32 v190, v190
  v_mfma_f32_16x16x32_bf16 v[184:187], v[172:175], v[76:79], v[184:187]
  ds_read_b128 v[120:123], v13 offset:0
  v_mfma_f32_16x16x32_bf16 v[180:183], v[160:163], v[96:99], v[180:183]
  v_exp_f32 v191, v191
  v_mfma_f32_16x16x32_bf16 v[184:187], v[176:179], v[96:99], v[184:187]
  buffer_load_dwordx4 v2, s[12:15], s50 offen offset:1024 nt lds
  v_mfma_f32_16x16x32_bf16 a[0:3], a[160:163], v[196:199], a[0:3]
  v_exp_f32 v192, v192
  v_mfma_f32_16x16x32_bf16 a[4:7], a[164:167], v[196:199], a[4:7]
  ds_read_b128 v[124:127], v14 offset:0
  v_mfma_f32_16x16x32_bf16 a[8:11], a[168:171], v[196:199], a[8:11]
  v_exp_f32 v193, v193
  v_mfma_f32_16x16x32_bf16 a[12:15], a[172:175], v[196:199], a[12:15]
  buffer_load_dwordx4 v3, s[12:15], s50 offen offset:2048 nt lds
  v_mfma_f32_16x16x32_bf16 a[16:19], a[176:179], v[196:199], a[16:19]
  v_exp_f32 v194, v194
  v_mfma_f32_16x16x32_bf16 a[20:23], a[180:183], v[196:199], a[20:23]
  v_exp_f32 v195, v195
  v_mfma_f32_16x16x32_bf16 a[24:27], a[184:187], v[196:199], a[24:27]
  v_cvt_pk_bf16_f32 v212, v188, v189
  v_cvt_pk_bf16_f32 v213, v190, v191
  v_mfma_f32_16x16x32_bf16 a[28:31], a[188:191], v[196:199], a[28:31]
  v_cvt_pk_bf16_f32 v214, v192, v193
  v_cvt_pk_bf16_f32 v215, v194, v195
  v_mfma_f32_16x16x32_bf16 a[224:227], a[244:247], v[196:199], a[224:227]
  ds_read_b128 v[128:131], v15 offset:0
  v_mfma_f32_16x16x32_bf16 v[188:191], v[148:151], v[40:43], v[220:223]
  v_exp_f32 v180, v180
  v_mfma_f32_16x16x32_bf16 v[192:195], v[164:167], v[40:43], v[220:223]
  buffer_load_dwordx4 v4, s[12:15], s50 offen offset:3072 nt lds
  v_mfma_f32_16x16x32_bf16 v[188:191], v[152:155], v[60:63], v[188:191]
  v_exp_f32 v181, v181
  v_mfma_f32_16x16x32_bf16 v[192:195], v[168:171], v[60:63], v[192:195]
  ds_read_b128 v[132:135], v12 offset:4096
  v_mfma_f32_16x16x32_bf16 v[188:191], v[156:159], v[80:83], v[188:191]
  v_exp_f32 v182, v182
  v_mfma_f32_16x16x32_bf16 v[192:195], v[172:175], v[80:83], v[192:195]
  s_add_u32 m0, s79, 40960
  s_add_u32 s50, s82, 81920
  s_and_b32 s50, s50, 0x1ffff
  s_add_u32 s50, s50, s34
  buffer_load_dwordx4 v5, s[16:19], s50 offen offset:0 nt lds
  v_mfma_f32_16x16x32_bf16 v[188:191], v[160:163], v[100:103], v[188:191]
  v_exp_f32 v183, v183
  v_mfma_f32_16x16x32_bf16 v[192:195], v[176:179], v[100:103], v[192:195]
  ds_read_b128 v[136:139], v13 offset:4096
  v_mfma_f32_16x16x32_bf16 a[32:35], a[160:163], v[200:203], a[32:35]
  v_exp_f32 v184, v184
  v_mfma_f32_16x16x32_bf16 a[36:39], a[164:167], v[200:203], a[36:39]
  buffer_load_dwordx4 v6, s[16:19], s50 offen offset:1024 nt lds
  v_mfma_f32_16x16x32_bf16 a[40:43], a[168:171], v[200:203], a[40:43]
  v_exp_f32 v185, v185
  v_mfma_f32_16x16x32_bf16 a[44:47], a[172:175], v[200:203], a[44:47]
  ds_read_b128 v[140:143], v14 offset:4096
  v_mfma_f32_16x16x32_bf16 a[48:51], a[176:179], v[200:203], a[48:51]
  v_exp_f32 v186, v186
  v_mfma_f32_16x16x32_bf16 a[52:55], a[180:183], v[200:203], a[52:55]
  v_exp_f32 v187, v187
  v_mfma_f32_16x16x32_bf16 a[56:59], a[184:187], v[200:203], a[56:59]
  v_cvt_pk_bf16_f32 v196, v180, v181
  v_cvt_pk_bf16_f32 v197, v182, v183
  v_mfma_f32_16x16x32_bf16 a[60:63], a[188:191], v[200:203], a[60:63]
  v_cvt_pk_bf16_f32 v198, v184, v185
  v_cvt_pk_bf16_f32 v199, v186, v187
  v_mfma_f32_16x16x32_bf16 a[228:231], a[244:247], v[200:203], a[228:231]
  buffer_load_dwordx4 v5, s[16:19], s50 offen offset:2048 nt lds
  v_mfma_f32_16x16x32_bf16 v[180:183], v[148:151], v[44:47], v[224:227]
  v_exp_f32 v188, v188
  v_mfma_f32_16x16x32_bf16 v[184:187], v[164:167], v[44:47], v[224:227]
  ds_read_b128 v[144:147], v15 offset:4096
  v_mfma_f32_16x16x32_bf16 v[180:183], v[152:155], v[64:67], v[180:183]
  v_exp_f32 v189, v189
  v_mfma_f32_16x16x32_bf16 v[184:187], v[168:171], v[64:67], v[184:187]
  buffer_load_dwordx4 v6, s[16:19], s50 offen offset:3072 nt lds
  v_mfma_f32_16x16x32_bf16 v[180:183], v[156:159], v[84:87], v[180:183]
  v_exp_f32 v190, v190
  v_mfma_f32_16x16x32_bf16 v[184:187], v[172:175], v[84:87], v[184:187]
  ds_read_b64_tr_b16 a[192:193], v16 offset:16384
  v_mfma_f32_16x16x32_bf16 v[180:183], v[160:163], v[104:107], v[180:183]
  v_exp_f32 v191, v191
  v_mfma_f32_16x16x32_bf16 v[184:187], v[176:179], v[104:107], v[184:187]
  ds_read_b64_tr_b16 a[194:195], v16 offset:20480
  v_mfma_f32_16x16x32_bf16 a[64:67], a[160:163], v[204:207], a[64:67]
  v_exp_f32 v192, v192
  v_mfma_f32_16x16x32_bf16 a[68:71], a[164:167], v[204:207], a[68:71]
  ds_read_b64_tr_b16 a[196:197], v17 offset:16384
  v_mfma_f32_16x16x32_bf16 a[72:75], a[168:171], v[204:207], a[72:75]
  v_exp_f32 v193, v193
  v_mfma_f32_16x16x32_bf16 a[76:79], a[172:175], v[204:207], a[76:79]
  ds_read_b64_tr_b16 a[198:199], v17 offset:20480
  v_mfma_f32_16x16x32_bf16 a[80:83], a[176:179], v[204:207], a[80:83]
  v_exp_f32 v194, v194
  v_mfma_f32_16x16x32_bf16 a[84:87], a[180:183], v[204:207], a[84:87]
  v_exp_f32 v195, v195
  v_mfma_f32_16x16x32_bf16 a[88:91], a[184:187], v[204:207], a[88:91]
  v_cvt_pk_bf16_f32 v200, v188, v189
  v_cvt_pk_bf16_f32 v201, v190, v191
  v_mfma_f32_16x16x32_bf16 a[92:95], a[188:191], v[204:207], a[92:95]
  v_cvt_pk_bf16_f32 v202, v192, v193
  v_cvt_pk_bf16_f32 v203, v194, v195
  v_mfma_f32_16x16x32_bf16 a[232:235], a[244:247], v[204:207], a[232:235]
  ds_read_b64_tr_b16 a[200:201], v18 offset:16384
  v_mfma_f32_16x16x32_bf16 v[188:191], v[148:151], v[48:51], v[228:231]
  v_exp_f32 v180, v180
  v_mfma_f32_16x16x32_bf16 v[192:195], v[164:167], v[48:51], v[228:231]
  ds_read_b64_tr_b16 a[202:203], v18 offset:20480
  v_mfma_f32_16x16x32_bf16 v[188:191], v[152:155], v[68:71], v[188:191]
  v_exp_f32 v181, v181
  v_mfma_f32_16x16x32_bf16 v[192:195], v[168:171], v[68:71], v[192:195]
  ds_read_b64_tr_b16 a[204:205], v19 offset:16384
  v_mfma_f32_16x16x32_bf16 v[188:191], v[156:159], v[88:91], v[188:191]
  v_exp_f32 v182, v182
  v_mfma_f32_16x16x32_bf16 v[192:195], v[172:175], v[88:91], v[192:195]
  ds_read_b64_tr_b16 a[206:207], v19 offset:20480
  v_mfma_f32_16x16x32_bf16 v[188:191], v[160:163], v[108:111], v[188:191]
  v_exp_f32 v183, v183
  v_mfma_f32_16x16x32_bf16 v[192:195], v[176:179], v[108:111], v[192:195]
  ds_read_b64_tr_b16 a[208:209], v20 offset:16384
  v_mfma_f32_16x16x32_bf16 a[96:99], a[160:163], v[208:211], a[96:99]
  v_exp_f32 v184, v184
  v_mfma_f32_16x16x32_bf16 a[100:103], a[164:167], v[208:211], a[100:103]
  ds_read_b64_tr_b16 a[210:211], v20 offset:20480
  v_mfma_f32_16x16x32_bf16 a[104:107], a[168:171], v[208:211], a[104:107]
  v_exp_f32 v185, v185
  v_mfma_f32_16x16x32_bf16 a[108:111], a[172:175], v[208:211], a[108:111]
  ds_read_b64_tr_b16 a[212:213], v21 offset:16384
  v_mfma_f32_16x16x32_bf16 a[112:115], a[176:179], v[208:211], a[112:115]
  v_exp_f32 v186, v186
  v_mfma_f32_16x16x32_bf16 a[116:119], a[180:183], v[208:211], a[116:119]
  v_exp_f32 v187, v187
  v_mfma_f32_16x16x32_bf16 a[120:123], a[184:187], v[208:211], a[120:123]
  v_cvt_pk_bf16_f32 v204, v180, v181
  v_cvt_pk_bf16_f32 v205, v182, v183
  v_mfma_f32_16x16x32_bf16 a[124:127], a[188:191], v[208:211], a[124:127]
  v_cvt_pk_bf16_f32 v206, v184, v185
  v_cvt_pk_bf16_f32 v207, v186, v187
  v_mfma_f32_16x16x32_bf16 a[236:239], a[244:247], v[208:211], a[236:239]
  ds_read_b64_tr_b16 a[214:215], v21 offset:20480
  v_mfma_f32_16x16x32_bf16 v[180:183], v[148:151], v[52:55], v[232:235]
  v_exp_f32 v188, v188
  v_mfma_f32_16x16x32_bf16 v[184:187], v[164:167], v[52:55], v[232:235]
  ds_read_b64_tr_b16 a[216:217], v22 offset:16384
  v_mfma_f32_16x16x32_bf16 v[180:183], v[152:155], v[72:75], v[180:183]
  v_exp_f32 v189, v189
  v_mfma_f32_16x16x32_bf16 v[184:187], v[168:171], v[72:75], v[184:187]
  ds_read_b64_tr_b16 a[218:219], v22 offset:20480
  v_mfma_f32_16x16x32_bf16 v[180:183], v[156:159], v[92:95], v[180:183]
  v_exp_f32 v190, v190
  v_mfma_f32_16x16x32_bf16 v[184:187], v[172:175], v[92:95], v[184:187]
  ds_read_b64_tr_b16 a[220:221], v23 offset:16384
  v_mfma_f32_16x16x32_bf16 v[180:183], v[160:163], v[112:115], v[180:183]
  v_exp_f32 v191, v191
  v_mfma_f32_16x16x32_bf16 v[184:187], v[176:179], v[112:115], v[184:187]
  ds_read_b64_tr_b16 a[222:223], v23 offset:20480
  v_mfma_f32_16x16x32_bf16 a[128:131], a[160:163], v[212:215], a[128:131]
  v_exp_f32 v192, v192
  v_mfma_f32_16x16x32_bf16 a[132:135], a[164:167], v[212:215], a[132:135]
  v_mfma_f32_16x16x32_bf16 a[136:139], a[168:171], v[212:215], a[136:139]
  v_exp_f32 v193, v193
  v_mfma_f32_16x16x32_bf16 a[140:143], a[172:175], v[212:215], a[140:143]
  v_mfma_f32_16x16x32_bf16 a[144:147], a[176:179], v[212:215], a[144:147]
  v_exp_f32 v194, v194
  v_mfma_f32_16x16x32_bf16 a[148:151], a[180:183], v[212:215], a[148:151]
  v_exp_f32 v195, v195
  v_mfma_f32_16x16x32_bf16 a[152:155], a[184:187], v[212:215], a[152:155]
  v_cvt_pk_bf16_f32 v208, v188, v189
  v_cvt_pk_bf16_f32 v209, v190, v191
  v_mfma_f32_16x16x32_bf16 a[156:159], a[188:191], v[212:215], a[156:159]
  v_cvt_pk_bf16_f32 v210, v192, v193
  v_cvt_pk_bf16_f32 v211, v194, v195
  v_mfma_f32_16x16x32_bf16 a[240:243], a[244:247], v[212:215], a[240:243]
  s_waitcnt vmcnt(16) lgkmcnt(0)
  s_barrier
  v_mfma_f32_16x16x32_bf16 v[188:191], v[116:119], v[36:39], v[216:219]
  v_exp_f32 v180, v180
  v_mfma_f32_16x16x32_bf16 v[192:195], v[132:135], v[36:39], v[216:219]
  ds_read_b128 v[148:151], v12 offset:8192
  v_mfma_f32_16x16x32_bf16 v[188:191], v[120:123], v[56:59], v[188:191]
  v_exp_f32 v181, v181
  v_mfma_f32_16x16x32_bf16 v[192:195], v[136:139], v[56:59], v[192:195]
  s_add_u32 m0, s79, 49152
  s_add_u32 s50, s82, 98304
  s_and_b32 s50, s50, 0x1ffff
  s_add_u32 s50, s50, s34
  buffer_load_dwordx4 v1, s[12:15], s50 offen offset:0 nt lds
  v_mfma_f32_16x16x32_bf16 v[188:191], v[124:127], v[76:79], v[188:191]
  v_exp_f32 v182, v182
  v_mfma_f32_16x16x32_bf16 v[192:195], v[140:143], v[76:79], v[192:195]
  ds_read_b128 v[152:155], v13 offset:8192
  v_mfma_f32_16x16x32_bf16 v[188:191], v[128:131], v[96:99], v[188:191]
  v_exp_f32 v183, v183
  v_mfma_f32_16x16x32_bf16 v[192:195], v[144:147], v[96:99], v[192:195]
  buffer_load_dwordx4 v2, s[12:15], s50 offen offset:1024 nt lds
  v_mfma_f32_16x16x32_bf16 a[0:3], a[192:195], v[196:199], a[0:3]
  v_exp_f32 v184, v184
  v_mfma_f32_16x16x32_bf16 a[4:7], a[196:199], v[196:199], a[4:7]
  ds_read_b128 v[156:159], v14 offset:8192
  v_mfma_f32_16x16x32_bf16 a[8:11], a[200:203], v[196:199], a[8:11]
  v_exp_f32 v185, v185
  v_mfma_f32_16x16x32_bf16 a[12:15], a[204:207], v[196:199], a[12:15]
  buffer_load_dwordx4 v3, s[12:15], s50 offen offset:2048 nt lds
  v_mfma_f32_16x16x32_bf16 a[16:19], a[208:211], v[196:199], a[16:19]
  v_exp_f32 v186, v186
  v_mfma_f32_16x16x32_bf16 a[20:23], a[212:215], v[196:199], a[20:23]
  v_exp_f32 v187, v187
  v_mfma_f32_16x16x32_bf16 a[24:27], a[216:219], v[196:199], a[24:27]
  v_cvt_pk_bf16_f32 v212, v180, v181
  v_cvt_pk_bf16_f32 v213, v182, v183
  v_mfma_f32_16x16x32_bf16 a[28:31], a[220:223], v[196:199], a[28:31]
  v_cvt_pk_bf16_f32 v214, v184, v185
  v_cvt_pk_bf16_f32 v215, v186, v187
  v_mfma_f32_16x16x32_bf16 a[224:227], a[244:247], v[196:199], a[224:227]
  ds_read_b128 v[160:163], v15 offset:8192
  v_mfma_f32_16x16x32_bf16 v[180:183], v[116:119], v[40:43], v[220:223]
  v_exp_f32 v188, v188
  v_mfma_f32_16x16x32_bf16 v[184:187], v[132:135], v[40:43], v[220:223]
  buffer_load_dwordx4 v4, s[12:15], s50 offen offset:3072 nt lds
  v_mfma_f32_16x16x32_bf16 v[180:183], v[120:123], v[60:63], v[180:183]
  v_exp_f32 v189, v189
  v_mfma_f32_16x16x32_bf16 v[184:187], v[136:139], v[60:63], v[184:187]
  ds_read_b128 v[164:167], v12 offset:12288
  v_mfma_f32_16x16x32_bf16 v[180:183], v[124:127], v[80:83], v[180:183]
  v_exp_f32 v190, v190
  v_mfma_f32_16x16x32_bf16 v[184:187], v[140:143], v[80:83], v[184:187]
  s_add_u32 m0, s79, 16384
  s_add_u32 s50, s82, 90112
  s_and_b32 s50, s50, 0x1ffff
  s_add_u32 s50, s50, s34
  buffer_load_dwordx4 v5, s[16:19], s50 offen offset:0 nt lds
  v_mfma_f32_16x16x32_bf16 v[180:183], v[128:131], v[100:103], v[180:183]
  v_exp_f32 v191, v191
  v_mfma_f32_16x16x32_bf16 v[184:187], v[144:147], v[100:103], v[184:187]
  ds_read_b128 v[168:171], v13 offset:12288
  v_mfma_f32_16x16x32_bf16 a[32:35], a[192:195], v[200:203], a[32:35]
  v_exp_f32 v192, v192
  v_mfma_f32_16x16x32_bf16 a[36:39], a[196:199], v[200:203], a[36:39]
  buffer_load_dwordx4 v6, s[16:19], s50 offen offset:1024 nt lds
  v_mfma_f32_16x16x32_bf16 a[40:43], a[200:203], v[200:203], a[40:43]
  v_exp_f32 v193, v193
  v_mfma_f32_16x16x32_bf16 a[44:47], a[204:207], v[200:203], a[44:47]
  ds_read_b128 v[172:175], v14 offset:12288
  v_mfma_f32_16x16x32_bf16 a[48:51], a[208:211], v[200:203], a[48:51]
  v_exp_f32 v194, v194
  v_mfma_f32_16x16x32_bf16 a[52:55], a[212:215], v[200:203], a[52:55]
  v_exp_f32 v195, v195
  v_mfma_f32_16x16x32_bf16 a[56:59], a[216:219], v[200:203], a[56:59]
  v_cvt_pk_bf16_f32 v196, v188, v189
  v_cvt_pk_bf16_f32 v197, v190, v191
  v_mfma_f32_16x16x32_bf16 a[60:63], a[220:223], v[200:203], a[60:63]
  v_cvt_pk_bf16_f32 v198, v192, v193
  v_cvt_pk_bf16_f32 v199, v194, v195
  v_mfma_f32_16x16x32_bf16 a[228:231], a[244:247], v[200:203], a[228:231]
  buffer_load_dwordx4 v5, s[16:19], s50 offen offset:2048 nt lds
  v_mfma_f32_16x16x32_bf16 v[188:191], v[116:119], v[44:47], v[224:227]
  v_exp_f32 v180, v180
  v_mfma_f32_16x16x32_bf16 v[192:195], v[132:135], v[44:47], v[224:227]
  ds_read_b128 v[176:179], v15 offset:12288
  v_mfma_f32_16x16x32_bf16 v[188:191], v[120:123], v[64:67], v[188:191]
  v_exp_f32 v181, v181
  v_mfma_f32_16x16x32_bf16 v[192:195], v[136:139], v[64:67], v[192:195]
  buffer_load_dwordx4 v6, s[16:19], s50 offen offset:3072 nt lds
  v_mfma_f32_16x16x32_bf16 v[188:191], v[124:127], v[84:87], v[188:191]
  v_exp_f32 v182, v182
  v_mfma_f32_16x16x32_bf16 v[192:195], v[140:143], v[84:87], v[192:195]
  ds_read_b64_tr_b16 a[160:161], v16 offset:24576
  v_mfma_f32_16x16x32_bf16 v[188:191], v[128:131], v[104:107], v[188:191]
  v_exp_f32 v183, v183
  v_mfma_f32_16x16x32_bf16 v[192:195], v[144:147], v[104:107], v[192:195]
  ds_read_b64_tr_b16 a[162:163], v16 offset:28672
  v_mfma_f32_16x16x32_bf16 a[64:67], a[192:195], v[204:207], a[64:67]
  v_exp_f32 v184, v184
  v_mfma_f32_16x16x32_bf16 a[68:71], a[196:199], v[204:207], a[68:71]
  ds_read_b64_tr_b16 a[164:165], v17 offset:24576
  v_mfma_f32_16x16x32_bf16 a[72:75], a[200:203], v[204:207], a[72:75]
  v_exp_f32 v185, v185
  v_mfma_f32_16x16x32_bf16 a[76:79], a[204:207], v[204:207], a[76:79]
  ds_read_b64_tr_b16 a[166:167], v17 offset:28672
  v_mfma_f32_16x16x32_bf16 a[80:83], a[208:211], v[204:207], a[80:83]
  v_exp_f32 v186, v186
  v_mfma_f32_16x16x32_bf16 a[84:87], a[212:215], v[204:207], a[84:87]
  v_exp_f32 v187, v187
  v_mfma_f32_16x16x32_bf16 a[88:91], a[216:219], v[204:207], a[88:91]
  v_cvt_pk_bf16_f32 v200, v180, v181
  v_cvt_pk_bf16_f32 v201, v182, v183
  v_mfma_f32_16x16x32_bf16 a[92:95], a[220:223], v[204:207], a[92:95]
  v_cvt_pk_bf16_f32 v202, v184, v185
  v_cvt_pk_bf16_f32 v203, v186, v187
  v_mfma_f32_16x16x32_bf16 a[232:235], a[244:247], v[204:207], a[232:235]
  ds_read_b64_tr_b16 a[168:169], v18 offset:24576
  v_mfma_f32_16x16x32_bf16 v[180:183], v[116:119], v[48:51], v[228:231]
  v_exp_f32 v188, v188
  v_mfma_f32_16x16x32_bf16 v[184:187], v[132:135], v[48:51], v[228:231]
  ds_read_b64_tr_b16 a[170:171], v18 offset:28672
  v_mfma_f32_16x16x32_bf16 v[180:183], v[120:123], v[68:71], v[180:183]
  v_exp_f32 v189, v189
  v_mfma_f32_16x16x32_bf16 v[184:187], v[136:139], v[68:71], v[184:187]
  ds_read_b64_tr_b16 a[172:173], v19 offset:24576
  v_mfma_f32_16x16x32_bf16 v[180:183], v[124:127], v[88:91], v[180:183]
  v_exp_f32 v190, v190
  v_mfma_f32_16x16x32_bf16 v[184:187], v[140:143], v[88:91], v[184:187]
  ds_read_b64_tr_b16 a[174:175], v19 offset:28672
  v_mfma_f32_16x16x32_bf16 v[180:183], v[128:131], v[108:111], v[180:183]
  v_exp_f32 v191, v191
  v_mfma_f32_16x16x32_bf16 v[184:187], v[144:147], v[108:111], v[184:187]
  ds_read_b64_tr_b16 a[176:177], v20 offset:24576
  v_mfma_f32_16x16x32_bf16 a[96:99], a[192:195], v[208:211], a[96:99]
  v_exp_f32 v192, v192
  v_mfma_f32_16x16x32_bf16 a[100:103], a[196:199], v[208:211], a[100:103]
  ds_read_b64_tr_b16 a[178:179], v20 offset:28672
  v_mfma_f32_16x16x32_bf16 a[104:107], a[200:203], v[208:211], a[104:107]
  v_exp_f32 v193, v193
  v_mfma_f32_16x16x32_bf16 a[108:111], a[204:207], v[208:211], a[108:111]
  ds_read_b64_tr_b16 a[180:181], v21 offset:24576
  v_mfma_f32_16x16x32_bf16 a[112:115], a[208:211], v[208:211], a[112:115]
  v_exp_f32 v194, v194
  v_mfma_f32_16x16x32_bf16 a[116:119], a[212:215], v[208:211], a[116:119]
  v_exp_f32 v195, v195
  v_mfma_f32_16x16x32_bf16 a[120:123], a[216:219], v[208:211], a[120:123]
  v_cvt_pk_bf16_f32 v204, v188, v189
  v_cvt_pk_bf16_f32 v205, v190, v191
  v_mfma_f32_16x16x32_bf16 a[124:127], a[220:223], v[208:211], a[124:127]
  v_cvt_pk_bf16_f32 v206, v192, v193
  v_cvt_pk_bf16_f32 v207, v194, v195
  v_mfma_f32_16x16x32_bf16 a[236:239], a[244:247], v[208:211], a[236:239]
  ds_read_b64_tr_b16 a[182:183], v21 offset:28672
  v_mfma_f32_16x16x32_bf16 v[188:191], v[116:119], v[52:55], v[232:235]
  v_exp_f32 v180, v180
  v_mfma_f32_16x16x32_bf16 v[192:195], v[132:135], v[52:55], v[232:235]
  ds_read_b64_tr_b16 a[184:185], v22 offset:24576
  v_mfma_f32_16x16x32_bf16 v[188:191], v[120:123], v[72:75], v[188:191]
  v_exp_f32 v181, v181
  v_mfma_f32_16x16x32_bf16 v[192:195], v[136:139], v[72:75], v[192:195]
  ds_read_b64_tr_b16 a[186:187], v22 offset:28672
  v_mfma_f32_16x16x32_bf16 v[188:191], v[124:127], v[92:95], v[188:191]
  v_exp_f32 v182, v182
  v_mfma_f32_16x16x32_bf16 v[192:195], v[140:143], v[92:95], v[192:195]
  ds_read_b64_tr_b16 a[188:189], v23 offset:24576
  v_mfma_f32_16x16x32_bf16 v[188:191], v[128:131], v[112:115], v[188:191]
  v_exp_f32 v183, v183
  v_mfma_f32_16x16x32_bf16 v[192:195], v[144:147], v[112:115], v[192:195]
  ds_read_b64_tr_b16 a[190:191], v23 offset:28672
  v_mfma_f32_16x16x32_bf16 a[128:131], a[192:195], v[212:215], a[128:131]
  v_exp_f32 v184, v184
  v_mfma_f32_16x16x32_bf16 a[132:135], a[196:199], v[212:215], a[132:135]
  v_mfma_f32_16x16x32_bf16 a[136:139], a[200:203], v[212:215], a[136:139]
  v_exp_f32 v185, v185
  v_mfma_f32_16x16x32_bf16 a[140:143], a[204:207], v[212:215], a[140:143]
  v_mfma_f32_16x16x32_bf16 a[144:147], a[208:211], v[212:215], a[144:147]
  v_exp_f32 v186, v186
  v_mfma_f32_16x16x32_bf16 a[148:151], a[212:215], v[212:215], a[148:151]
  v_exp_f32 v187, v187
  v_mfma_f32_16x16x32_bf16 a[152:155], a[216:219], v[212:215], a[152:155]
  v_cvt_pk_bf16_f32 v208, v180, v181
  v_cvt_pk_bf16_f32 v209, v182, v183
  v_mfma_f32_16x16x32_bf16 a[156:159], a[220:223], v[212:215], a[156:159]
  v_cvt_pk_bf16_f32 v210, v184, v185
  v_cvt_pk_bf16_f32 v211, v186, v187
  v_mfma_f32_16x16x32_bf16 a[240:243], a[244:247], v[212:215], a[240:243]
  s_waitcnt vmcnt(16) lgkmcnt(0)
  s_barrier
  v_mfma_f32_16x16x32_bf16 v[180:183], v[148:151], v[36:39], v[216:219]
  v_exp_f32 v188, v188
  v_mfma_f32_16x16x32_bf16 v[184:187], v[164:167], v[36:39], v[216:219]
  ds_read_b128 v[116:119], v12 offset:16384
  v_mfma_f32_16x16x32_bf16 v[180:183], v[152:155], v[56:59], v[180:183]
  v_exp_f32 v189, v189
  v_mfma_f32_16x16x32_bf16 v[184:187], v[168:171], v[56:59], v[184:187]
  s_add_u32 m0, s79, 57344
  s_add_u32 s50, s82, 106496
  s_and_b32 s50, s50, 0x1ffff
  s_add_u32 s50, s50, s34
  buffer_load_dwordx4 v1, s[12:15], s50 offen offset:0 nt lds
  v_mfma_f32_16x16x32_bf16 v[180:183], v[156:159], v[76:79], v[180:183]
  v_exp_f32 v190, v190
  v_mfma_f32_16x16x32_bf16 v[184:187], v[172:175], v[76:79], v[184:187]
  ds_read_b128 v[120:123], v13 offset:16384
  v_mfma_f32_16x16x32_bf16 v[180:183], v[160:163], v[96:99], v[180:183]
  v_exp_f32 v191, v191
  v_mfma_f32_16x16x32_bf16 v[184:187], v[176:179], v[96:99], v[184:187]
  buffer_load_dwordx4 v2, s[12:15], s50 offen offset:1024 nt lds
  v_mfma_f32_16x16x32_bf16 a[0:3], a[160:163], v[196:199], a[0:3]
  v_exp_f32 v192, v192
  v_mfma_f32_16x16x32_bf16 a[4:7], a[164:167], v[196:199], a[4:7]
  ds_read_b128 v[124:127], v14 offset:16384
  v_mfma_f32_16x16x32_bf16 a[8:11], a[168:171], v[196:199], a[8:11]
  v_exp_f32 v193, v193
  v_mfma_f32_16x16x32_bf16 a[12:15], a[172:175], v[196:199], a[12:15]
  buffer_load_dwordx4 v3, s[12:15], s50 offen offset:2048 nt lds
  v_mfma_f32_16x16x32_bf16 a[16:19], a[176:179], v[196:199], a[16:19]
  v_exp_f32 v194, v194
  v_mfma_f32_16x16x32_bf16 a[20:23], a[180:183], v[196:199], a[20:23]
  v_exp_f32 v195, v195
  v_mfma_f32_16x16x32_bf16 a[24:27], a[184:187], v[196:199], a[24:27]
  v_cvt_pk_bf16_f32 v212, v188, v189
  v_cvt_pk_bf16_f32 v213, v190, v191
  v_mfma_f32_16x16x32_bf16 a[28:31], a[188:191], v[196:199], a[28:31]
  v_cvt_pk_bf16_f32 v214, v192, v193
  v_cvt_pk_bf16_f32 v215, v194, v195
  v_mfma_f32_16x16x32_bf16 a[224:227], a[244:247], v[196:199], a[224:227]
  ds_read_b128 v[128:131], v15 offset:16384
  v_mfma_f32_16x16x32_bf16 v[188:191], v[148:151], v[40:43], v[220:223]
  v_exp_f32 v180, v180
  v_mfma_f32_16x16x32_bf16 v[192:195], v[164:167], v[40:43], v[220:223]
  buffer_load_dwordx4 v4, s[12:15], s50 offen offset:3072 nt lds
  v_mfma_f32_16x16x32_bf16 v[188:191], v[152:155], v[60:63], v[188:191]
  v_exp_f32 v181, v181
  v_mfma_f32_16x16x32_bf16 v[192:195], v[168:171], v[60:63], v[192:195]
  ds_read_b128 v[132:135], v12 offset:20480
  v_mfma_f32_16x16x32_bf16 v[188:191], v[156:159], v[80:83], v[188:191]
  v_exp_f32 v182, v182
  v_mfma_f32_16x16x32_bf16 v[192:195], v[172:175], v[80:83], v[192:195]
  s_add_u32 m0, s79, 24576
  s_add_u32 s50, s82, 98304
  s_and_b32 s50, s50, 0x1ffff
  s_add_u32 s50, s50, s34
  buffer_load_dwordx4 v5, s[16:19], s50 offen offset:0 nt lds
  v_mfma_f32_16x16x32_bf16 v[188:191], v[160:163], v[100:103], v[188:191]
  v_exp_f32 v183, v183
  v_mfma_f32_16x16x32_bf16 v[192:195], v[176:179], v[100:103], v[192:195]
  ds_read_b128 v[136:139], v13 offset:20480
  v_mfma_f32_16x16x32_bf16 a[32:35], a[160:163], v[200:203], a[32:35]
  v_exp_f32 v184, v184
  v_mfma_f32_16x16x32_bf16 a[36:39], a[164:167], v[200:203], a[36:39]
  buffer_load_dwordx4 v6, s[16:19], s50 offen offset:1024 nt lds
  v_mfma_f32_16x16x32_bf16 a[40:43], a[168:171], v[200:203], a[40:43]
  v_exp_f32 v185, v185
  v_mfma_f32_16x16x32_bf16 a[44:47], a[172:175], v[200:203], a[44:47]
  ds_read_b128 v[140:143], v14 offset:20480
  v_mfma_f32_16x16x32_bf16 a[48:51], a[176:179], v[200:203], a[48:51]
  v_exp_f32 v186, v186
  v_mfma_f32_16x16x32_bf16 a[52:55], a[180:183], v[200:203], a[52:55]
  v_exp_f32 v187, v187
  v_mfma_f32_16x16x32_bf16 a[56:59], a[184:187], v[200:203], a[56:59]
  v_cvt_pk_bf16_f32 v196, v180, v181
  v_cvt_pk_bf16_f32 v197, v182, v183
  v_mfma_f32_16x16x32_bf16 a[60:63], a[188:191], v[200:203], a[60:63]
  v_cvt_pk_bf16_f32 v198, v184, v185
  v_cvt_pk_bf16_f32 v199, v186, v187
  v_mfma_f32_16x16x32_bf16 a[228:231], a[244:247], v[200:203], a[228:231]
  buffer_load_dwordx4 v5, s[16:19], s50 offen offset:2048 nt lds
  v_mfma_f32_16x16x32_bf16 v[180:183], v[148:151], v[44:47], v[224:227]
  v_exp_f32 v188, v188
  v_mfma_f32_16x16x32_bf16 v[184:187], v[164:167], v[44:47], v[224:227]
  ds_read_b128 v[144:147], v15 offset:20480
  v_mfma_f32_16x16x32_bf16 v[180:183], v[152:155], v[64:67], v[180:183]
  v_exp_f32 v189, v189
  v_mfma_f32_16x16x32_bf16 v[184:187], v[168:171], v[64:67], v[184:187]
  buffer_load_dwordx4 v6, s[16:19], s50 offen offset:3072 nt lds
  v_mfma_f32_16x16x32_bf16 v[180:183], v[156:159], v[84:87], v[180:183]
  v_exp_f32 v190, v190
  v_mfma_f32_16x16x32_bf16 v[184:187], v[172:175], v[84:87], v[184:187]
  ds_read_b64_tr_b16 a[192:193], v16 offset:32768
  v_mfma_f32_16x16x32_bf16 v[180:183], v[160:163], v[104:107], v[180:183]
  v_exp_f32 v191, v191
  v_mfma_f32_16x16x32_bf16 v[184:187], v[176:179], v[104:107], v[184:187]
  ds_read_b64_tr_b16 a[194:195], v16 offset:36864
  v_mfma_f32_16x16x32_bf16 a[64:67], a[160:163], v[204:207], a[64:67]
  v_exp_f32 v192, v192
  v_mfma_f32_16x16x32_bf16 a[68:71], a[164:167], v[204:207], a[68:71]
  ds_read_b64_tr_b16 a[196:197], v17 offset:32768
  v_mfma_f32_16x16x32_bf16 a[72:75], a[168:171], v[204:207], a[72:75]
  v_exp_f32 v193, v193
  v_mfma_f32_16x16x32_bf16 a[76:79], a[172:175], v[204:207], a[76:79]
  ds_read_b64_tr_b16 a[198:199], v17 offset:36864
  v_mfma_f32_16x16x32_bf16 a[80:83], a[176:179], v[204:207], a[80:83]
  v_exp_f32 v194, v194
  v_mfma_f32_16x16x32_bf16 a[84:87], a[180:183], v[204:207], a[84:87]
  v_exp_f32 v195, v195
  v_mfma_f32_16x16x32_bf16 a[88:91], a[184:187], v[204:207], a[88:91]
  v_cvt_pk_bf16_f32 v200, v188, v189
  v_cvt_pk_bf16_f32 v201, v190, v191
  v_mfma_f32_16x16x32_bf16 a[92:95], a[188:191], v[204:207], a[92:95]
  v_cvt_pk_bf16_f32 v202, v192, v193
  v_cvt_pk_bf16_f32 v203, v194, v195
  v_mfma_f32_16x16x32_bf16 a[232:235], a[244:247], v[204:207], a[232:235]
  ds_read_b64_tr_b16 a[200:201], v18 offset:32768
  v_mfma_f32_16x16x32_bf16 v[188:191], v[148:151], v[48:51], v[228:231]
  v_exp_f32 v180, v180
  v_mfma_f32_16x16x32_bf16 v[192:195], v[164:167], v[48:51], v[228:231]
  ds_read_b64_tr_b16 a[202:203], v18 offset:36864
  v_mfma_f32_16x16x32_bf16 v[188:191], v[152:155], v[68:71], v[188:191]
  v_exp_f32 v181, v181
  v_mfma_f32_16x16x32_bf16 v[192:195], v[168:171], v[68:71], v[192:195]
  ds_read_b64_tr_b16 a[204:205], v19 offset:32768
  v_mfma_f32_16x16x32_bf16 v[188:191], v[156:159], v[88:91], v[188:191]
  v_exp_f32 v182, v182
  v_mfma_f32_16x16x32_bf16 v[192:195], v[172:175], v[88:91], v[192:195]
  ds_read_b64_tr_b16 a[206:207], v19 offset:36864
  v_mfma_f32_16x16x32_bf16 v[188:191], v[160:163], v[108:111], v[188:191]
  v_exp_f32 v183, v183
  v_mfma_f32_16x16x32_bf16 v[192:195], v[176:179], v[108:111], v[192:195]
  ds_read_b64_tr_b16 a[208:209], v20 offset:32768
  v_mfma_f32_16x16x32_bf16 a[96:99], a[160:163], v[208:211], a[96:99]
  v_exp_f32 v184, v184
  v_mfma_f32_16x16x32_bf16 a[100:103], a[164:167], v[208:211], a[100:103]
  ds_read_b64_tr_b16 a[210:211], v20 offset:36864
  v_mfma_f32_16x16x32_bf16 a[104:107], a[168:171], v[208:211], a[104:107]
  v_exp_f32 v185, v185
  v_mfma_f32_16x16x32_bf16 a[108:111], a[172:175], v[208:211], a[108:111]
  ds_read_b64_tr_b16 a[212:213], v21 offset:32768
  v_mfma_f32_16x16x32_bf16 a[112:115], a[176:179], v[208:211], a[112:115]
  v_exp_f32 v186, v186
  v_mfma_f32_16x16x32_bf16 a[116:119], a[180:183], v[208:211], a[116:119]
  v_exp_f32 v187, v187
  v_mfma_f32_16x16x32_bf16 a[120:123], a[184:187], v[208:211], a[120:123]
  v_cvt_pk_bf16_f32 v204, v180, v181
  v_cvt_pk_bf16_f32 v205, v182, v183
  v_mfma_f32_16x16x32_bf16 a[124:127], a[188:191], v[208:211], a[124:127]
  v_cvt_pk_bf16_f32 v206, v184, v185
  v_cvt_pk_bf16_f32 v207, v186, v187
  v_mfma_f32_16x16x32_bf16 a[236:239], a[244:247], v[208:211], a[236:239]
  ds_read_b64_tr_b16 a[214:215], v21 offset:36864
  v_mfma_f32_16x16x32_bf16 v[180:183], v[148:151], v[52:55], v[232:235]
  v_exp_f32 v188, v188
  v_mfma_f32_16x16x32_bf16 v[184:187], v[164:167], v[52:55], v[232:235]
  ds_read_b64_tr_b16 a[216:217], v22 offset:32768
  v_mfma_f32_16x16x32_bf16 v[180:183], v[152:155], v[72:75], v[180:183]
  v_exp_f32 v189, v189
  v_mfma_f32_16x16x32_bf16 v[184:187], v[168:171], v[72:75], v[184:187]
  ds_read_b64_tr_b16 a[218:219], v22 offset:36864
  v_mfma_f32_16x16x32_bf16 v[180:183], v[156:159], v[92:95], v[180:183]
  v_exp_f32 v190, v190
  v_mfma_f32_16x16x32_bf16 v[184:187], v[172:175], v[92:95], v[184:187]
  ds_read_b64_tr_b16 a[220:221], v23 offset:32768
  v_mfma_f32_16x16x32_bf16 v[180:183], v[160:163], v[112:115], v[180:183]
  v_exp_f32 v191, v191
  v_mfma_f32_16x16x32_bf16 v[184:187], v[176:179], v[112:115], v[184:187]
  ds_read_b64_tr_b16 a[222:223], v23 offset:36864
  v_mfma_f32_16x16x32_bf16 a[128:131], a[160:163], v[212:215], a[128:131]
  v_exp_f32 v192, v192
  v_mfma_f32_16x16x32_bf16 a[132:135], a[164:167], v[212:215], a[132:135]
  v_mfma_f32_16x16x32_bf16 a[136:139], a[168:171], v[212:215], a[136:139]
  v_exp_f32 v193, v193
  v_mfma_f32_16x16x32_bf16 a[140:143], a[172:175], v[212:215], a[140:143]
  v_mfma_f32_16x16x32_bf16 a[144:147], a[176:179], v[212:215], a[144:147]
  v_exp_f32 v194, v194
  v_mfma_f32_16x16x32_bf16 a[148:151], a[180:183], v[212:215], a[148:151]
  v_exp_f32 v195, v195
  v_mfma_f32_16x16x32_bf16 a[152:155], a[184:187], v[212:215], a[152:155]
  v_cvt_pk_bf16_f32 v208, v188, v189
  v_cvt_pk_bf16_f32 v209, v190, v191
  v_mfma_f32_16x16x32_bf16 a[156:159], a[188:191], v[212:215], a[156:159]
  v_cvt_pk_bf16_f32 v210, v192, v193
  v_cvt_pk_bf16_f32 v211, v194, v195
  v_mfma_f32_16x16x32_bf16 a[240:243], a[244:247], v[212:215], a[240:243]
  s_waitcnt vmcnt(16) lgkmcnt(0)
  s_barrier
  v_mfma_f32_16x16x32_bf16 v[188:191], v[116:119], v[36:39], v[216:219]
  v_exp_f32 v180, v180
  v_mfma_f32_16x16x32_bf16 v[192:195], v[132:135], v[36:39], v[216:219]
  ds_read_b128 v[148:151], v12 offset:24576
  v_mfma_f32_16x16x32_bf16 v[188:191], v[120:123], v[56:59], v[188:191]
  v_exp_f32 v181, v181
  v_mfma_f32_16x16x32_bf16 v[192:195], v[136:139], v[56:59], v[192:195]
  s_add_u32 m0, s79, 65536
  s_add_u32 s50, s82, 114688
  s_and_b32 s50, s50, 0x1ffff
  s_add_u32 s50, s50, s34
  buffer_load_dwordx4 v1, s[12:15], s50 offen offset:0 nt lds
  v_mfma_f32_16x16x32_bf16 v[188:191], v[124:127], v[76:79], v[188:191]
  v_exp_f32 v182, v182
  v_mfma_f32_16x16x32_bf16 v[192:195], v[140:143], v[76:79], v[192:195]
  ds_read_b128 v[152:155], v13 offset:24576
  v_mfma_f32_16x16x32_bf16 v[188:191], v[128:131], v[96:99], v[188:191]
  v_exp_f32 v183, v183
  v_mfma_f32_16x16x32_bf16 v[192:195], v[144:147], v[96:99], v[192:195]
  buffer_load_dwordx4 v2, s[12:15], s50 offen offset:1024 nt lds
  v_mfma_f32_16x16x32_bf16 a[0:3], a[192:195], v[196:199], a[0:3]
  v_exp_f32 v184, v184
  v_mfma_f32_16x16x32_bf16 a[4:7], a[196:199], v[196:199], a[4:7]
  ds_read_b128 v[156:159], v14 offset:24576
  v_mfma_f32_16x16x32_bf16 a[8:11], a[200:203], v[196:199], a[8:11]
  v_exp_f32 v185, v185
  v_mfma_f32_16x16x32_bf16 a[12:15], a[204:207], v[196:199], a[12:15]
  buffer_load_dwordx4 v3, s[12:15], s50 offen offset:2048 nt lds
  v_mfma_f32_16x16x32_bf16 a[16:19], a[208:211], v[196:199], a[16:19]
  v_exp_f32 v186, v186
  v_mfma_f32_16x16x32_bf16 a[20:23], a[212:215], v[196:199], a[20:23]
  v_exp_f32 v187, v187
  v_mfma_f32_16x16x32_bf16 a[24:27], a[216:219], v[196:199], a[24:27]
  v_cvt_pk_bf16_f32 v212, v180, v181
  v_cvt_pk_bf16_f32 v213, v182, v183
  v_mfma_f32_16x16x32_bf16 a[28:31], a[220:223], v[196:199], a[28:31]
  v_cvt_pk_bf16_f32 v214, v184, v185
  v_cvt_pk_bf16_f32 v215, v186, v187
  v_mfma_f32_16x16x32_bf16 a[224:227], a[244:247], v[196:199], a[224:227]
  ds_read_b128 v[160:163], v15 offset:24576
  v_mfma_f32_16x16x32_bf16 v[180:183], v[116:119], v[40:43], v[220:223]
  v_exp_f32 v188, v188
  v_mfma_f32_16x16x32_bf16 v[184:187], v[132:135], v[40:43], v[220:223]
  buffer_load_dwordx4 v4, s[12:15], s50 offen offset:3072 nt lds
  v_mfma_f32_16x16x32_bf16 v[180:183], v[120:123], v[60:63], v[180:183]
  v_exp_f32 v189, v189
  v_mfma_f32_16x16x32_bf16 v[184:187], v[136:139], v[60:63], v[184:187]
  ds_read_b128 v[164:167], v12 offset:28672
  v_mfma_f32_16x16x32_bf16 v[180:183], v[124:127], v[80:83], v[180:183]
  v_exp_f32 v190, v190
  v_mfma_f32_16x16x32_bf16 v[184:187], v[140:143], v[80:83], v[184:187]
  s_add_u32 m0, s79, 32768
  s_add_u32 s50, s82, 106496
  s_and_b32 s50, s50, 0x1ffff
  s_add_u32 s50, s50, s34
  buffer_load_dwordx4 v5, s[16:19], s50 offen offset:0 nt lds
  v_mfma_f32_16x16x32_bf16 v[180:183], v[128:131], v[100:103], v[180:183]
  v_exp_f32 v191, v191
  v_mfma_f32_16x16x32_bf16 v[184:187], v[144:147], v[100:103], v[184:187]
  ds_read_b128 v[168:171], v13 offset:28672
  v_mfma_f32_16x16x32_bf16 a[32:35], a[192:195], v[200:203], a[32:35]
  v_exp_f32 v192, v192
  v_mfma_f32_16x16x32_bf16 a[36:39], a[196:199], v[200:203], a[36:39]
  buffer_load_dwordx4 v6, s[16:19], s50 offen offset:1024 nt lds
  v_mfma_f32_16x16x32_bf16 a[40:43], a[200:203], v[200:203], a[40:43]
  v_exp_f32 v193, v193
  v_mfma_f32_16x16x32_bf16 a[44:47], a[204:207], v[200:203], a[44:47]
  ds_read_b128 v[172:175], v14 offset:28672
  v_mfma_f32_16x16x32_bf16 a[48:51], a[208:211], v[200:203], a[48:51]
  v_exp_f32 v194, v194
  v_mfma_f32_16x16x32_bf16 a[52:55], a[212:215], v[200:203], a[52:55]
  v_exp_f32 v195, v195
  v_mfma_f32_16x16x32_bf16 a[56:59], a[216:219], v[200:203], a[56:59]
  v_cvt_pk_bf16_f32 v196, v188, v189
  v_cvt_pk_bf16_f32 v197, v190, v191
  v_mfma_f32_16x16x32_bf16 a[60:63], a[220:223], v[200:203], a[60:63]
  v_cvt_pk_bf16_f32 v198, v192, v193
  v_cvt_pk_bf16_f32 v199, v194, v195
  v_mfma_f32_16x16x32_bf16 a[228:231], a[244:247], v[200:203], a[228:231]
  buffer_load_dwordx4 v5, s[16:19], s50 offen offset:2048 nt lds
  v_mfma_f32_16x16x32_bf16 v[188:191], v[116:119], v[44:47], v[224:227]
  v_exp_f32 v180, v180
  v_mfma_f32_16x16x32_bf16 v[192:195], v[132:135], v[44:47], v[224:227]
  ds_read_b128 v[176:179], v15 offset:28672
  v_mfma_f32_16x16x32_bf16 v[188:191], v[120:123], v[64:67], v[188:191]
  v_exp_f32 v181, v181
  v_mfma_f32_16x16x32_bf16 v[192:195], v[136:139], v[64:67], v[192:195]
  buffer_load_dwordx4 v6, s[16:19], s50 offen offset:3072 nt lds
  v_mfma_f32_16x16x32_bf16 v[188:191], v[124:127], v[84:87], v[188:191]
  v_exp_f32 v182, v182
  v_mfma_f32_16x16x32_bf16 v[192:195], v[140:143], v[84:87], v[192:195]
  ds_read_b64_tr_b16 a[160:161], v16 offset:40960
  v_mfma_f32_16x16x32_bf16 v[188:191], v[128:131], v[104:107], v[188:191]
  v_exp_f32 v183, v183
  v_mfma_f32_16x16x32_bf16 v[192:195], v[144:147], v[104:107], v[192:195]
  ds_read_b64_tr_b16 a[162:163], v16 offset:45056
  v_mfma_f32_16x16x32_bf16 a[64:67], a[192:195], v[204:207], a[64:67]
  v_exp_f32 v184, v184
  v_mfma_f32_16x16x32_bf16 a[68:71], a[196:199], v[204:207], a[68:71]
  ds_read_b64_tr_b16 a[164:165], v17 offset:40960
  v_mfma_f32_16x16x32_bf16 a[72:75], a[200:203], v[204:207], a[72:75]
  v_exp_f32 v185, v185
  v_mfma_f32_16x16x32_bf16 a[76:79], a[204:207], v[204:207], a[76:79]
  ds_read_b64_tr_b16 a[166:167], v17 offset:45056
  v_mfma_f32_16x16x32_bf16 a[80:83], a[208:211], v[204:207], a[80:83]
  v_exp_f32 v186, v186
  v_mfma_f32_16x16x32_bf16 a[84:87], a[212:215], v[204:207], a[84:87]
  v_exp_f32 v187, v187
  v_mfma_f32_16x16x32_bf16 a[88:91], a[216:219], v[204:207], a[88:91]
  v_cvt_pk_bf16_f32 v200, v180, v181
  v_cvt_pk_bf16_f32 v201, v182, v183
  v_mfma_f32_16x16x32_bf16 a[92:95], a[220:223], v[204:207], a[92:95]
  v_cvt_pk_bf16_f32 v202, v184, v185
  v_cvt_pk_bf16_f32 v203, v186, v187
  v_mfma_f32_16x16x32_bf16 a[232:235], a[244:247], v[204:207], a[232:235]
  ds_read_b64_tr_b16 a[168:169], v18 offset:40960
  v_mfma_f32_16x16x32_bf16 v[180:183], v[116:119], v[48:51], v[228:231]
  v_exp_f32 v188, v188
  v_mfma_f32_16x16x32_bf16 v[184:187], v[132:135], v[48:51], v[228:231]
  ds_read_b64_tr_b16 a[170:171], v18 offset:45056
  v_mfma_f32_16x16x32_bf16 v[180:183], v[120:123], v[68:71], v[180:183]
  v_exp_f32 v189, v189
  v_mfma_f32_16x16x32_bf16 v[184:187], v[136:139], v[68:71], v[184:187]
  ds_read_b64_tr_b16 a[172:173], v19 offset:40960
  v_mfma_f32_16x16x32_bf16 v[180:183], v[124:127], v[88:91], v[180:183]
  v_exp_f32 v190, v190
  v_mfma_f32_16x16x32_bf16 v[184:187], v[140:143], v[88:91], v[184:187]
  ds_read_b64_tr_b16 a[174:175], v19 offset:45056
  v_mfma_f32_16x16x32_bf16 v[180:183], v[128:131], v[108:111], v[180:183]
  v_exp_f32 v191, v191
  v_mfma_f32_16x16x32_bf16 v[184:187], v[144:147], v[108:111], v[184:187]
  ds_read_b64_tr_b16 a[176:177], v20 offset:40960
  v_mfma_f32_16x16x32_bf16 a[96:99], a[192:195], v[208:211], a[96:99]
  v_exp_f32 v192, v192
  v_mfma_f32_16x16x32_bf16 a[100:103], a[196:199], v[208:211], a[100:103]
  ds_read_b64_tr_b16 a[178:179], v20 offset:45056
  v_mfma_f32_16x16x32_bf16 a[104:107], a[200:203], v[208:211], a[104:107]
  v_exp_f32 v193, v193
  v_mfma_f32_16x16x32_bf16 a[108:111], a[204:207], v[208:211], a[108:111]
  ds_read_b64_tr_b16 a[180:181], v21 offset:40960
  v_mfma_f32_16x16x32_bf16 a[112:115], a[208:211], v[208:211], a[112:115]
  v_exp_f32 v194, v194
  v_mfma_f32_16x16x32_bf16 a[116:119], a[212:215], v[208:211], a[116:119]
  v_exp_f32 v195, v195
  v_mfma_f32_16x16x32_bf16 a[120:123], a[216:219], v[208:211], a[120:123]
  v_cvt_pk_bf16_f32 v204, v188, v189
  v_cvt_pk_bf16_f32 v205, v190, v191
  v_mfma_f32_16x16x32_bf16 a[124:127], a[220:223], v[208:211], a[124:127]
  v_cvt_pk_bf16_f32 v206, v192, v193
  v_cvt_pk_bf16_f32 v207, v194, v195
  v_mfma_f32_16x16x32_bf16 a[236:239], a[244:247], v[208:211], a[236:239]
  ds_read_b64_tr_b16 a[182:183], v21 offset:45056
  v_mfma_f32_16x16x32_bf16 v[188:191], v[116:119], v[52:55], v[232:235]
  v_exp_f32 v180, v180
  v_mfma_f32_16x16x32_bf16 v[192:195], v[132:135], v[52:55], v[232:235]
  ds_read_b64_tr_b16 a[184:185], v22 offset:40960
  v_mfma_f32_16x16x32_bf16 v[188:191], v[120:123], v[72:75], v[188:191]
  v_exp_f32 v181, v181
  v_mfma_f32_16x16x32_bf16 v[192:195], v[136:139], v[72:75], v[192:195]
  ds_read_b64_tr_b16 a[186:187], v22 offset:45056
  v_mfma_f32_16x16x32_bf16 v[188:191], v[124:127], v[92:95], v[188:191]
  v_exp_f32 v182, v182
  v_mfma_f32_16x16x32_bf16 v[192:195], v[140:143], v[92:95], v[192:195]
  ds_read_b64_tr_b16 a[188:189], v23 offset:40960
  v_mfma_f32_16x16x32_bf16 v[188:191], v[128:131], v[112:115], v[188:191]
  v_exp_f32 v183, v183
  v_mfma_f32_16x16x32_bf16 v[192:195], v[144:147], v[112:115], v[192:195]
  ds_read_b64_tr_b16 a[190:191], v23 offset:45056
  v_mfma_f32_16x16x32_bf16 a[128:131], a[192:195], v[212:215], a[128:131]
  v_exp_f32 v184, v184
  v_mfma_f32_16x16x32_bf16 a[132:135], a[196:199], v[212:215], a[132:135]
  v_mfma_f32_16x16x32_bf16 a[136:139], a[200:203], v[212:215], a[136:139]
  v_exp_f32 v185, v185
  v_mfma_f32_16x16x32_bf16 a[140:143], a[204:207], v[212:215], a[140:143]
  v_mfma_f32_16x16x32_bf16 a[144:147], a[208:211], v[212:215], a[144:147]
  v_exp_f32 v186, v186
  v_mfma_f32_16x16x32_bf16 a[148:151], a[212:215], v[212:215], a[148:151]
  v_exp_f32 v187, v187
  v_mfma_f32_16x16x32_bf16 a[152:155], a[216:219], v[212:215], a[152:155]
  v_cvt_pk_bf16_f32 v208, v180, v181
  v_cvt_pk_bf16_f32 v209, v182, v183
  v_mfma_f32_16x16x32_bf16 a[156:159], a[220:223], v[212:215], a[156:159]
  v_cvt_pk_bf16_f32 v210, v184, v185
  v_cvt_pk_bf16_f32 v211, v186, v187
  v_mfma_f32_16x16x32_bf16 a[240:243], a[244:247], v[212:215], a[240:243]
  s_waitcnt vmcnt(16) lgkmcnt(0)
  s_barrier
  v_mfma_f32_16x16x32_bf16 v[180:183], v[148:151], v[36:39], v[216:219]
  v_exp_f32 v188, v188
  v_mfma_f32_16x16x32_bf16 v[184:187], v[164:167], v[36:39], v[216:219]
  ds_read_b128 v[116:119], v12 offset:0
  v_mfma_f32_16x16x32_bf16 v[180:183], v[152:155], v[56:59], v[180:183]
  v_exp_f32 v189, v189
  v_mfma_f32_16x16x32_bf16 v[184:187], v[168:171], v[56:59], v[184:187]
  s_add_u32 m0, s79, 73728
  s_add_u32 s50, s82, 122880
  s_and_b32 s50, s50, 0x1ffff
  s_add_u32 s50, s50, s34
  buffer_load_dwordx4 v1, s[12:15], s50 offen offset:0 nt lds
  v_mfma_f32_16x16x32_bf16 v[180:183], v[156:159], v[76:79], v[180:183]
  v_exp_f32 v190, v190
  v_mfma_f32_16x16x32_bf16 v[184:187], v[172:175], v[76:79], v[184:187]
  ds_read_b128 v[120:123], v13 offset:0
  v_mfma_f32_16x16x32_bf16 v[180:183], v[160:163], v[96:99], v[180:183]
  v_exp_f32 v191, v191
  v_mfma_f32_16x16x32_bf16 v[184:187], v[176:179], v[96:99], v[184:187]
  buffer_load_dwordx4 v2, s[12:15], s50 offen offset:1024 nt lds
  v_mfma_f32_16x16x32_bf16 a[0:3], a[160:163], v[196:199], a[0:3]
  v_exp_f32 v192, v192
  v_mfma_f32_16x16x32_bf16 a[4:7], a[164:167], v[196:199], a[4:7]
  ds_read_b128 v[124:127], v14 offset:0
  v_mfma_f32_16x16x32_bf16 a[8:11], a[168:171], v[196:199], a[8:11]
  v_exp_f32 v193, v193
  v_mfma_f32_16x16x32_bf16 a[12:15], a[172:175], v[196:199], a[12:15]
  buffer_load_dwordx4 v3, s[12:15], s50 offen offset:2048 nt lds
  v_mfma_f32_16x16x32_bf16 a[16:19], a[176:179], v[196:199], a[16:19]
  v_exp_f32 v194, v194
  v_mfma_f32_16x16x32_bf16 a[20:23], a[180:183], v[196:199], a[20:23]
  v_exp_f32 v195, v195
  v_mfma_f32_16x16x32_bf16 a[24:27], a[184:187], v[196:199], a[24:27]
  v_cvt_pk_bf16_f32 v212, v188, v189
  v_cvt_pk_bf16_f32 v213, v190, v191
  v_mfma_f32_16x16x32_bf16 a[28:31], a[188:191], v[196:199], a[28:31]
  v_cvt_pk_bf16_f32 v214, v192, v193
  v_cvt_pk_bf16_f32 v215, v194, v195
  v_mfma_f32_16x16x32_bf16 a[224:227], a[244:247], v[196:199], a[224:227]
  ds_read_b128 v[128:131], v15 offset:0
  v_mfma_f32_16x16x32_bf16 v[188:191], v[148:151], v[40:43], v[220:223]
  v_exp_f32 v180, v180
  v_mfma_f32_16x16x32_bf16 v[192:195], v[164:167], v[40:43], v[220:223]
  buffer_load_dwordx4 v4, s[12:15], s50 offen offset:3072 nt lds
  v_mfma_f32_16x16x32_bf16 v[188:191], v[152:155], v[60:63], v[188:191]
  v_exp_f32 v181, v181
  v_mfma_f32_16x16x32_bf16 v[192:195], v[168:171], v[60:63], v[192:195]
  ds_read_b128 v[132:135], v12 offset:4096
  v_mfma_f32_16x16x32_bf16 v[188:191], v[156:159], v[80:83], v[188:191]
  v_exp_f32 v182, v182
  v_mfma_f32_16x16x32_bf16 v[192:195], v[172:175], v[80:83], v[192:195]
  s_add_u32 m0, s79, 40960
  s_add_u32 s50, s82, 114688
  s_and_b32 s50, s50, 0x1ffff
  s_add_u32 s50, s50, s34
  buffer_load_dwordx4 v5, s[16:19], s50 offen offset:0 nt lds
  v_mfma_f32_16x16x32_bf16 v[188:191], v[160:163], v[100:103], v[188:191]
  v_exp_f32 v183, v183
  v_mfma_f32_16x16x32_bf16 v[192:195], v[176:179], v[100:103], v[192:195]
  ds_read_b128 v[136:139], v13 offset:4096
  v_mfma_f32_16x16x32_bf16 a[32:35], a[160:163], v[200:203], a[32:35]
  v_exp_f32 v184, v184
  v_mfma_f32_16x16x32_bf16 a[36:39], a[164:167], v[200:203], a[36:39]
  buffer_load_dwordx4 v6, s[16:19], s50 offen offset:1024 nt lds
  v_mfma_f32_16x16x32_bf16 a[40:43], a[168:171], v[200:203], a[40:43]
  v_exp_f32 v185, v185
  v_mfma_f32_16x16x32_bf16 a[44:47], a[172:175], v[200:203], a[44:47]
  ds_read_b128 v[140:143], v14 offset:4096
  v_mfma_f32_16x16x32_bf16 a[48:51], a[176:179], v[200:203], a[48:51]
  v_exp_f32 v186, v186
  v_mfma_f32_16x16x32_bf16 a[52:55], a[180:183], v[200:203], a[52:55]
  v_exp_f32 v187, v187
  v_mfma_f32_16x16x32_bf16 a[56:59], a[184:187], v[200:203], a[56:59]
  v_cvt_pk_bf16_f32 v196, v180, v181
  v_cvt_pk_bf16_f32 v197, v182, v183
  v_mfma_f32_16x16x32_bf16 a[60:63], a[188:191], v[200:203], a[60:63]
  v_cvt_pk_bf16_f32 v198, v184, v185
  v_cvt_pk_bf16_f32 v199, v186, v187
  v_mfma_f32_16x16x32_bf16 a[228:231], a[244:247], v[200:203], a[228:231]
  buffer_load_dwordx4 v5, s[16:19], s50 offen offset:2048 nt lds
  v_mfma_f32_16x16x32_bf16 v[180:183], v[148:151], v[44:47], v[224:227]
  v_exp_f32 v188, v188
  v_mfma_f32_16x16x32_bf16 v[184:187], v[164:167], v[44:47], v[224:227]
  ds_read_b128 v[144:147], v15 offset:4096
  v_mfma_f32_16x16x32_bf16 v[180:183], v[152:155], v[64:67], v[180:183]
  v_exp_f32 v189, v189
  v_mfma_f32_16x16x32_bf16 v[184:187], v[168:171], v[64:67], v[184:187]
  buffer_load_dwordx4 v6, s[16:19], s50 offen offset:3072 nt lds
  v_mfma_f32_16x16x32_bf16 v[180:183], v[156:159], v[84:87], v[180:183]
  v_exp_f32 v190, v190
  v_mfma_f32_16x16x32_bf16 v[184:187], v[172:175], v[84:87], v[184:187]
  ds_read_b64_tr_b16 a[192:193], v16 offset:16384
  v_mfma_f32_16x16x32_bf16 v[180:183], v[160:163], v[104:107], v[180:183]
  v_exp_f32 v191, v191
  v_mfma_f32_16x16x32_bf16 v[184:187], v[176:179], v[104:107], v[184:187]
  ds_read_b64_tr_b16 a[194:195], v16 offset:20480
  v_mfma_f32_16x16x32_bf16 a[64:67], a[160:163], v[204:207], a[64:67]
  v_exp_f32 v192, v192
  v_mfma_f32_16x16x32_bf16 a[68:71], a[164:167], v[204:207], a[68:71]
  ds_read_b64_tr_b16 a[196:197], v17 offset:16384
  v_mfma_f32_16x16x32_bf16 a[72:75], a[168:171], v[204:207], a[72:75]
  v_exp_f32 v193, v193
  v_mfma_f32_16x16x32_bf16 a[76:79], a[172:175], v[204:207], a[76:79]
  ds_read_b64_tr_b16 a[198:199], v17 offset:20480
  v_mfma_f32_16x16x32_bf16 a[80:83], a[176:179], v[204:207], a[80:83]
  v_exp_f32 v194, v194
  v_mfma_f32_16x16x32_bf16 a[84:87], a[180:183], v[204:207], a[84:87]
  v_exp_f32 v195, v195
  v_mfma_f32_16x16x32_bf16 a[88:91], a[184:187], v[204:207], a[88:91]
  v_cvt_pk_bf16_f32 v200, v188, v189
  v_cvt_pk_bf16_f32 v201, v190, v191
  v_mfma_f32_16x16x32_bf16 a[92:95], a[188:191], v[204:207], a[92:95]
  v_cvt_pk_bf16_f32 v202, v192, v193
  v_cvt_pk_bf16_f32 v203, v194, v195
  v_mfma_f32_16x16x32_bf16 a[232:235], a[244:247], v[204:207], a[232:235]
  ds_read_b64_tr_b16 a[200:201], v18 offset:16384
  v_mfma_f32_16x16x32_bf16 v[188:191], v[148:151], v[48:51], v[228:231]
  v_exp_f32 v180, v180
  v_mfma_f32_16x16x32_bf16 v[192:195], v[164:167], v[48:51], v[228:231]
  ds_read_b64_tr_b16 a[202:203], v18 offset:20480
  v_mfma_f32_16x16x32_bf16 v[188:191], v[152:155], v[68:71], v[188:191]
  v_exp_f32 v181, v181
  v_mfma_f32_16x16x32_bf16 v[192:195], v[168:171], v[68:71], v[192:195]
  ds_read_b64_tr_b16 a[204:205], v19 offset:16384
  v_mfma_f32_16x16x32_bf16 v[188:191], v[156:159], v[88:91], v[188:191]
  v_exp_f32 v182, v182
  v_mfma_f32_16x16x32_bf16 v[192:195], v[172:175], v[88:91], v[192:195]
  ds_read_b64_tr_b16 a[206:207], v19 offset:20480
  v_mfma_f32_16x16x32_bf16 v[188:191], v[160:163], v[108:111], v[188:191]
  v_exp_f32 v183, v183
  v_mfma_f32_16x16x32_bf16 v[192:195], v[176:179], v[108:111], v[192:195]
  ds_read_b64_tr_b16 a[208:209], v20 offset:16384
  v_mfma_f32_16x16x32_bf16 a[96:99], a[160:163], v[208:211], a[96:99]
  v_exp_f32 v184, v184
  v_mfma_f32_16x16x32_bf16 a[100:103], a[164:167], v[208:211], a[100:103]
  ds_read_b64_tr_b16 a[210:211], v20 offset:20480
  v_mfma_f32_16x16x32_bf16 a[104:107], a[168:171], v[208:211], a[104:107]
  v_exp_f32 v185, v185
  v_mfma_f32_16x16x32_bf16 a[108:111], a[172:175], v[208:211], a[108:111]
  ds_read_b64_tr_b16 a[212:213], v21 offset:16384
  v_mfma_f32_16x16x32_bf16 a[112:115], a[176:179], v[208:211], a[112:115]
  v_exp_f32 v186, v186
  v_mfma_f32_16x16x32_bf16 a[116:119], a[180:183], v[208:211], a[116:119]
  v_exp_f32 v187, v187
  v_mfma_f32_16x16x32_bf16 a[120:123], a[184:187], v[208:211], a[120:123]
  v_cvt_pk_bf16_f32 v204, v180, v181
  v_cvt_pk_bf16_f32 v205, v182, v183
  v_mfma_f32_16x16x32_bf16 a[124:127], a[188:191], v[208:211], a[124:127]
  v_cvt_pk_bf16_f32 v206, v184, v185
  v_cvt_pk_bf16_f32 v207, v186, v187
  v_mfma_f32_16x16x32_bf16 a[236:239], a[244:247], v[208:211], a[236:239]
  ds_read_b64_tr_b16 a[214:215], v21 offset:20480
  v_mfma_f32_16x16x32_bf16 v[180:183], v[148:151], v[52:55], v[232:235]
  v_exp_f32 v188, v188
  v_mfma_f32_16x16x32_bf16 v[184:187], v[164:167], v[52:55], v[232:235]
  ds_read_b64_tr_b16 a[216:217], v22 offset:16384
  v_mfma_f32_16x16x32_bf16 v[180:183], v[152:155], v[72:75], v[180:183]
  v_exp_f32 v189, v189
  v_mfma_f32_16x16x32_bf16 v[184:187], v[168:171], v[72:75], v[184:187]
  ds_read_b64_tr_b16 a[218:219], v22 offset:20480
  v_mfma_f32_16x16x32_bf16 v[180:183], v[156:159], v[92:95], v[180:183]
  v_exp_f32 v190, v190
  v_mfma_f32_16x16x32_bf16 v[184:187], v[172:175], v[92:95], v[184:187]
  ds_read_b64_tr_b16 a[220:221], v23 offset:16384
  v_mfma_f32_16x16x32_bf16 v[180:183], v[160:163], v[112:115], v[180:183]
  v_exp_f32 v191, v191
  v_mfma_f32_16x16x32_bf16 v[184:187], v[176:179], v[112:115], v[184:187]
  ds_read_b64_tr_b16 a[222:223], v23 offset:20480
  v_mfma_f32_16x16x32_bf16 a[128:131], a[160:163], v[212:215], a[128:131]
  v_exp_f32 v192, v192
  v_mfma_f32_16x16x32_bf16 a[132:135], a[164:167], v[212:215], a[132:135]
  v_mfma_f32_16x16x32_bf16 a[136:139], a[168:171], v[212:215], a[136:139]
  v_exp_f32 v193, v193
  v_mfma_f32_16x16x32_bf16 a[140:143], a[172:175], v[212:215], a[140:143]
  v_mfma_f32_16x16x32_bf16 a[144:147], a[176:179], v[212:215], a[144:147]
  v_exp_f32 v194, v194
  v_mfma_f32_16x16x32_bf16 a[148:151], a[180:183], v[212:215], a[148:151]
  v_exp_f32 v195, v195
  v_mfma_f32_16x16x32_bf16 a[152:155], a[184:187], v[212:215], a[152:155]
  v_cvt_pk_bf16_f32 v208, v188, v189
  v_cvt_pk_bf16_f32 v209, v190, v191
  v_mfma_f32_16x16x32_bf16 a[156:159], a[188:191], v[212:215], a[156:159]
  v_cvt_pk_bf16_f32 v210, v192, v193
  v_cvt_pk_bf16_f32 v211, v194, v195
  v_mfma_f32_16x16x32_bf16 a[240:243], a[244:247], v[212:215], a[240:243]
  s_waitcnt vmcnt(16) lgkmcnt(0)
  s_barrier
  v_mfma_f32_16x16x32_bf16 v[188:191], v[116:119], v[36:39], v[216:219]
  v_exp_f32 v180, v180
  v_mfma_f32_16x16x32_bf16 v[192:195], v[132:135], v[36:39], v[216:219]
  ds_read_b128 v[148:151], v12 offset:8192
  v_mfma_f32_16x16x32_bf16 v[188:191], v[120:123], v[56:59], v[188:191]
  v_exp_f32 v181, v181
  v_mfma_f32_16x16x32_bf16 v[192:195], v[136:139], v[56:59], v[192:195]
  s_add_u32 m0, s79, 49152
  s_add_u32 s50, s82, 0
  s_and_b32 s50, s50, 0x1ffff
  s_add_u32 s50, s50, s35
  buffer_load_dwordx4 v1, s[12:15], s50 offen offset:0 nt lds
  v_mfma_f32_16x16x32_bf16 v[188:191], v[124:127], v[76:79], v[188:191]
  v_exp_f32 v182, v182
  v_mfma_f32_16x16x32_bf16 v[192:195], v[140:143], v[76:79], v[192:195]
  ds_read_b128 v[152:155], v13 offset:8192
  v_mfma_f32_16x16x32_bf16 v[188:191], v[128:131], v[96:99], v[188:191]
  v_exp_f32 v183, v183
  v_mfma_f32_16x16x32_bf16 v[192:195], v[144:147], v[96:99], v[192:195]
  buffer_load_dwordx4 v2, s[12:15], s50 offen offset:1024 nt lds
  v_mfma_f32_16x16x32_bf16 a[0:3], a[192:195], v[196:199], a[0:3]
  v_exp_f32 v184, v184
  v_mfma_f32_16x16x32_bf16 a[4:7], a[196:199], v[196:199], a[4:7]
  ds_read_b128 v[156:159], v14 offset:8192
  v_mfma_f32_16x16x32_bf16 a[8:11], a[200:203], v[196:199], a[8:11]
  v_exp_f32 v185, v185
  v_mfma_f32_16x16x32_bf16 a[12:15], a[204:207], v[196:199], a[12:15]
  buffer_load_dwordx4 v3, s[12:15], s50 offen offset:2048 nt lds
  v_mfma_f32_16x16x32_bf16 a[16:19], a[208:211], v[196:199], a[16:19]
  v_exp_f32 v186, v186
  v_mfma_f32_16x16x32_bf16 a[20:23], a[212:215], v[196:199], a[20:23]
  v_exp_f32 v187, v187
  v_mfma_f32_16x16x32_bf16 a[24:27], a[216:219], v[196:199], a[24:27]
  v_cvt_pk_bf16_f32 v212, v180, v181
  v_cvt_pk_bf16_f32 v213, v182, v183
  v_mfma_f32_16x16x32_bf16 a[28:31], a[220:223], v[196:199], a[28:31]
  v_cvt_pk_bf16_f32 v214, v184, v185
  v_cvt_pk_bf16_f32 v215, v186, v187
  v_mfma_f32_16x16x32_bf16 a[224:227], a[244:247], v[196:199], a[224:227]
  ds_read_b128 v[160:163], v15 offset:8192
  v_mfma_f32_16x16x32_bf16 v[180:183], v[116:119], v[40:43], v[220:223]
  v_exp_f32 v188, v188
  v_mfma_f32_16x16x32_bf16 v[184:187], v[132:135], v[40:43], v[220:223]
  buffer_load_dwordx4 v4, s[12:15], s50 offen offset:3072 nt lds
  v_mfma_f32_16x16x32_bf16 v[180:183], v[120:123], v[60:63], v[180:183]
  v_exp_f32 v189, v189
  v_mfma_f32_16x16x32_bf16 v[184:187], v[136:139], v[60:63], v[184:187]
  ds_read_b128 v[164:167], v12 offset:12288
  v_mfma_f32_16x16x32_bf16 v[180:183], v[124:127], v[80:83], v[180:183]
  v_exp_f32 v190, v190
  v_mfma_f32_16x16x32_bf16 v[184:187], v[140:143], v[80:83], v[184:187]
  s_add_u32 m0, s79, 16384
  s_add_u32 s50, s82, 122880
  s_and_b32 s50, s50, 0x1ffff
  s_add_u32 s50, s50, s34
  buffer_load_dwordx4 v5, s[16:19], s50 offen offset:0 nt lds
  v_mfma_f32_16x16x32_bf16 v[180:183], v[128:131], v[100:103], v[180:183]
  v_exp_f32 v191, v191
  v_mfma_f32_16x16x32_bf16 v[184:187], v[144:147], v[100:103], v[184:187]
  ds_read_b128 v[168:171], v13 offset:12288
  v_mfma_f32_16x16x32_bf16 a[32:35], a[192:195], v[200:203], a[32:35]
  v_exp_f32 v192, v192
  v_mfma_f32_16x16x32_bf16 a[36:39], a[196:199], v[200:203], a[36:39]
  buffer_load_dwordx4 v6, s[16:19], s50 offen offset:1024 nt lds
  v_mfma_f32_16x16x32_bf16 a[40:43], a[200:203], v[200:203], a[40:43]
  v_exp_f32 v193, v193
  v_mfma_f32_16x16x32_bf16 a[44:47], a[204:207], v[200:203], a[44:47]
  ds_read_b128 v[172:175], v14 offset:12288
  v_mfma_f32_16x16x32_bf16 a[48:51], a[208:211], v[200:203], a[48:51]
  v_exp_f32 v194, v194
  v_mfma_f32_16x16x32_bf16 a[52:55], a[212:215], v[200:203], a[52:55]
  v_exp_f32 v195, v195
  v_mfma_f32_16x16x32_bf16 a[56:59], a[216:219], v[200:203], a[56:59]
  v_cvt_pk_bf16_f32 v196, v188, v189
  v_cvt_pk_bf16_f32 v197, v190, v191
  v_mfma_f32_16x16x32_bf16 a[60:63], a[220:223], v[200:203], a[60:63]
  v_cvt_pk_bf16_f32 v198, v192, v193
  v_cvt_pk_bf16_f32 v199, v194, v195
  v_mfma_f32_16x16x32_bf16 a[228:231], a[244:247], v[200:203], a[228:231]
  buffer_load_dwordx4 v5, s[16:19], s50 offen offset:2048 nt lds
  v_mfma_f32_16x16x32_bf16 v[188:191], v[116:119], v[44:47], v[224:227]
  v_exp_f32 v180, v180
  v_mfma_f32_16x16x32_bf16 v[192:195], v[132:135], v[44:47], v[224:227]
  ds_read_b128 v[176:179], v15 offset:12288
  v_mfma_f32_16x16x32_bf16 v[188:191], v[120:123], v[64:67], v[188:191]
  v_exp_f32 v181, v181
  v_mfma_f32_16x16x32_bf16 v[192:195], v[136:139], v[64:67], v[192:195]
  buffer_load_dwordx4 v6, s[16:19], s50 offen offset:3072 nt lds
  v_mfma_f32_16x16x32_bf16 v[188:191], v[124:127], v[84:87], v[188:191]
  v_exp_f32 v182, v182
  v_mfma_f32_16x16x32_bf16 v[192:195], v[140:143], v[84:87], v[192:195]
  ds_read_b64_tr_b16 a[160:161], v16 offset:24576
  v_mfma_f32_16x16x32_bf16 v[188:191], v[128:131], v[104:107], v[188:191]
  v_exp_f32 v183, v183
  v_mfma_f32_16x16x32_bf16 v[192:195], v[144:147], v[104:107], v[192:195]
  ds_read_b64_tr_b16 a[162:163], v16 offset:28672
  v_mfma_f32_16x16x32_bf16 a[64:67], a[192:195], v[204:207], a[64:67]
  v_exp_f32 v184, v184
  v_mfma_f32_16x16x32_bf16 a[68:71], a[196:199], v[204:207], a[68:71]
  ds_read_b64_tr_b16 a[164:165], v17 offset:24576
  v_mfma_f32_16x16x32_bf16 a[72:75], a[200:203], v[204:207], a[72:75]
  v_exp_f32 v185, v185
  v_mfma_f32_16x16x32_bf16 a[76:79], a[204:207], v[204:207], a[76:79]
  ds_read_b64_tr_b16 a[166:167], v17 offset:28672
  v_mfma_f32_16x16x32_bf16 a[80:83], a[208:211], v[204:207], a[80:83]
  v_exp_f32 v186, v186
  v_mfma_f32_16x16x32_bf16 a[84:87], a[212:215], v[204:207], a[84:87]
  v_exp_f32 v187, v187
  v_mfma_f32_16x16x32_bf16 a[88:91], a[216:219], v[204:207], a[88:91]
  v_cvt_pk_bf16_f32 v200, v180, v181
  v_cvt_pk_bf16_f32 v201, v182, v183
  v_mfma_f32_16x16x32_bf16 a[92:95], a[220:223], v[204:207], a[92:95]
  v_cvt_pk_bf16_f32 v202, v184, v185
  v_cvt_pk_bf16_f32 v203, v186, v187
  v_mfma_f32_16x16x32_bf16 a[232:235], a[244:247], v[204:207], a[232:235]
  ds_read_b64_tr_b16 a[168:169], v18 offset:24576
  v_mfma_f32_16x16x32_bf16 v[180:183], v[116:119], v[48:51], v[228:231]
  v_exp_f32 v188, v188
  v_mfma_f32_16x16x32_bf16 v[184:187], v[132:135], v[48:51], v[228:231]
  ds_read_b64_tr_b16 a[170:171], v18 offset:28672
  v_mfma_f32_16x16x32_bf16 v[180:183], v[120:123], v[68:71], v[180:183]
  v_exp_f32 v189, v189
  v_mfma_f32_16x16x32_bf16 v[184:187], v[136:139], v[68:71], v[184:187]
  ds_read_b64_tr_b16 a[172:173], v19 offset:24576
  v_mfma_f32_16x16x32_bf16 v[180:183], v[124:127], v[88:91], v[180:183]
  v_exp_f32 v190, v190
  v_mfma_f32_16x16x32_bf16 v[184:187], v[140:143], v[88:91], v[184:187]
  ds_read_b64_tr_b16 a[174:175], v19 offset:28672
  v_mfma_f32_16x16x32_bf16 v[180:183], v[128:131], v[108:111], v[180:183]
  v_exp_f32 v191, v191
  v_mfma_f32_16x16x32_bf16 v[184:187], v[144:147], v[108:111], v[184:187]
  ds_read_b64_tr_b16 a[176:177], v20 offset:24576
  v_mfma_f32_16x16x32_bf16 a[96:99], a[192:195], v[208:211], a[96:99]
  v_exp_f32 v192, v192
  v_mfma_f32_16x16x32_bf16 a[100:103], a[196:199], v[208:211], a[100:103]
  ds_read_b64_tr_b16 a[178:179], v20 offset:28672
  v_mfma_f32_16x16x32_bf16 a[104:107], a[200:203], v[208:211], a[104:107]
  v_exp_f32 v193, v193
  v_mfma_f32_16x16x32_bf16 a[108:111], a[204:207], v[208:211], a[108:111]
  ds_read_b64_tr_b16 a[180:181], v21 offset:24576
  v_mfma_f32_16x16x32_bf16 a[112:115], a[208:211], v[208:211], a[112:115]
  v_exp_f32 v194, v194
  v_mfma_f32_16x16x32_bf16 a[116:119], a[212:215], v[208:211], a[116:119]
  v_exp_f32 v195, v195
  v_mfma_f32_16x16x32_bf16 a[120:123], a[216:219], v[208:211], a[120:123]
  v_cvt_pk_bf16_f32 v204, v188, v189
  v_cvt_pk_bf16_f32 v205, v190, v191
  v_mfma_f32_16x16x32_bf16 a[124:127], a[220:223], v[208:211], a[124:127]
  v_cvt_pk_bf16_f32 v206, v192, v193
  v_cvt_pk_bf16_f32 v207, v194, v195
  v_mfma_f32_16x16x32_bf16 a[236:239], a[244:247], v[208:211], a[236:239]
  ds_read_b64_tr_b16 a[182:183], v21 offset:28672
  v_mfma_f32_16x16x32_bf16 v[188:191], v[116:119], v[52:55], v[232:235]
  v_exp_f32 v180, v180
  v_mfma_f32_16x16x32_bf16 v[192:195], v[132:135], v[52:55], v[232:235]
  ds_read_b64_tr_b16 a[184:185], v22 offset:24576
  v_mfma_f32_16x16x32_bf16 v[188:191], v[120:123], v[72:75], v[188:191]
  v_exp_f32 v181, v181
  v_mfma_f32_16x16x32_bf16 v[192:195], v[136:139], v[72:75], v[192:195]
  ds_read_b64_tr_b16 a[186:187], v22 offset:28672
  v_mfma_f32_16x16x32_bf16 v[188:191], v[124:127], v[92:95], v[188:191]
  v_exp_f32 v182, v182
  v_mfma_f32_16x16x32_bf16 v[192:195], v[140:143], v[92:95], v[192:195]
  ds_read_b64_tr_b16 a[188:189], v23 offset:24576
  v_mfma_f32_16x16x32_bf16 v[188:191], v[128:131], v[112:115], v[188:191]
  v_exp_f32 v183, v183
  v_mfma_f32_16x16x32_bf16 v[192:195], v[144:147], v[112:115], v[192:195]
  ds_read_b64_tr_b16 a[190:191], v23 offset:28672
  v_mfma_f32_16x16x32_bf16 a[128:131], a[192:195], v[212:215], a[128:131]
  v_exp_f32 v184, v184
  v_mfma_f32_16x16x32_bf16 a[132:135], a[196:199], v[212:215], a[132:135]
  v_mfma_f32_16x16x32_bf16 a[136:139], a[200:203], v[212:215], a[136:139]
  v_exp_f32 v185, v185
  v_mfma_f32_16x16x32_bf16 a[140:143], a[204:207], v[212:215], a[140:143]
  v_mfma_f32_16x16x32_bf16 a[144:147], a[208:211], v[212:215], a[144:147]
  v_exp_f32 v186, v186
  v_mfma_f32_16x16x32_bf16 a[148:151], a[212:215], v[212:215], a[148:151]
  v_exp_f32 v187, v187
  v_mfma_f32_16x16x32_bf16 a[152:155], a[216:219], v[212:215], a[152:155]
  v_cvt_pk_bf16_f32 v208, v180, v181
  v_cvt_pk_bf16_f32 v209, v182, v183
  v_mfma_f32_16x16x32_bf16 a[156:159], a[220:223], v[212:215], a[156:159]
  v_cvt_pk_bf16_f32 v210, v184, v185
  v_cvt_pk_bf16_f32 v211, v186, v187
  v_mfma_f32_16x16x32_bf16 a[240:243], a[244:247], v[212:215], a[240:243]
  s_waitcnt vmcnt(16) lgkmcnt(0)
  s_barrier
  v_mfma_f32_16x16x32_bf16 v[180:183], v[148:151], v[36:39], v[216:219]
  v_exp_f32 v188, v188
  v_mfma_f32_16x16x32_bf16 v[184:187], v[164:167], v[36:39], v[216:219]
  ds_read_b128 v[116:119], v12 offset:16384
  v_mfma_f32_16x16x32_bf16 v[180:183], v[152:155], v[56:59], v[180:183]
  v_exp_f32 v189, v189
  v_mfma_f32_16x16x32_bf16 v[184:187], v[168:171], v[56:59], v[184:187]
  s_add_u32 m0, s79, 57344
  s_add_u32 s50, s82, 8192
  s_and_b32 s50, s50, 0x1ffff
  s_add_u32 s50, s50, s35
  buffer_load_dwordx4 v1, s[12:15], s50 offen offset:0 nt lds
  v_mfma_f32_16x16x32_bf16 v[180:183], v[156:159], v[76:79], v[180:183]
  v_exp_f32 v190, v190
  v_mfma_f32_16x16x32_bf16 v[184:187], v[172:175], v[76:79], v[184:187]
  ds_read_b128 v[120:123], v13 offset:16384
  v_mfma_f32_16x16x32_bf16 v[180:183], v[160:163], v[96:99], v[180:183]
  v_exp_f32 v191, v191
  v_mfma_f32_16x16x32_bf16 v[184:187], v[176:179], v[96:99], v[184:187]
  buffer_load_dwordx4 v2, s[12:15], s50 offen offset:1024 nt lds
  v_mfma_f32_16x16x32_bf16 a[0:3], a[160:163], v[196:199], a[0:3]
  v_exp_f32 v192, v192
  v_mfma_f32_16x16x32_bf16 a[4:7], a[164:167], v[196:199], a[4:7]
  ds_read_b128 v[124:127], v14 offset:16384
  v_mfma_f32_16x16x32_bf16 a[8:11], a[168:171], v[196:199], a[8:11]
  v_exp_f32 v193, v193
  v_mfma_f32_16x16x32_bf16 a[12:15], a[172:175], v[196:199], a[12:15]
  buffer_load_dwordx4 v3, s[12:15], s50 offen offset:2048 nt lds
  v_mfma_f32_16x16x32_bf16 a[16:19], a[176:179], v[196:199], a[16:19]
  v_exp_f32 v194, v194
  v_mfma_f32_16x16x32_bf16 a[20:23], a[180:183], v[196:199], a[20:23]
  v_exp_f32 v195, v195
  v_mfma_f32_16x16x32_bf16 a[24:27], a[184:187], v[196:199], a[24:27]
  v_cvt_pk_bf16_f32 v212, v188, v189
  v_cvt_pk_bf16_f32 v213, v190, v191
  v_mfma_f32_16x16x32_bf16 a[28:31], a[188:191], v[196:199], a[28:31]
  v_cvt_pk_bf16_f32 v214, v192, v193
  v_cvt_pk_bf16_f32 v215, v194, v195
  v_mfma_f32_16x16x32_bf16 a[224:227], a[244:247], v[196:199], a[224:227]
  ds_read_b128 v[128:131], v15 offset:16384
  v_mfma_f32_16x16x32_bf16 v[188:191], v[148:151], v[40:43], v[220:223]
  v_exp_f32 v180, v180
  v_mfma_f32_16x16x32_bf16 v[192:195], v[164:167], v[40:43], v[220:223]
  buffer_load_dwordx4 v4, s[12:15], s50 offen offset:3072 nt lds
  v_mfma_f32_16x16x32_bf16 v[188:191], v[152:155], v[60:63], v[188:191]
  v_exp_f32 v181, v181
  v_mfma_f32_16x16x32_bf16 v[192:195], v[168:171], v[60:63], v[192:195]
  ds_read_b128 v[132:135], v12 offset:20480
  v_mfma_f32_16x16x32_bf16 v[188:191], v[156:159], v[80:83], v[188:191]
  v_exp_f32 v182, v182
  v_mfma_f32_16x16x32_bf16 v[192:195], v[172:175], v[80:83], v[192:195]
  s_add_u32 m0, s79, 0
  s_add_u32 s51, s52, 0
  buffer_load_dwordx4 v7, s[20:23], s51 offen offset:0 lds
  v_mfma_f32_16x16x32_bf16 v[188:191], v[160:163], v[100:103], v[188:191]
  v_exp_f32 v183, v183
  v_mfma_f32_16x16x32_bf16 v[192:195], v[176:179], v[100:103], v[192:195]
  ds_read_b128 v[136:139], v13 offset:20480
  v_mfma_f32_16x16x32_bf16 a[32:35], a[160:163], v[200:203], a[32:35]
  v_exp_f32 v184, v184
  v_mfma_f32_16x16x32_bf16 a[36:39], a[164:167], v[200:203], a[36:39]
  buffer_load_dwordx4 v8, s[20:23], s51 offen offset:1024 lds
  v_mfma_f32_16x16x32_bf16 a[40:43], a[168:171], v[200:203], a[40:43]
  v_exp_f32 v185, v185
  v_mfma_f32_16x16x32_bf16 a[44:47], a[172:175], v[200:203], a[44:47]
  ds_read_b128 v[140:143], v14 offset:20480
  v_mfma_f32_16x16x32_bf16 a[48:51], a[176:179], v[200:203], a[48:51]
  v_exp_f32 v186, v186
  v_mfma_f32_16x16x32_bf16 a[52:55], a[180:183], v[200:203], a[52:55]
  v_exp_f32 v187, v187
  v_mfma_f32_16x16x32_bf16 a[56:59], a[184:187], v[200:203], a[56:59]
  v_cvt_pk_bf16_f32 v196, v180, v181
  v_cvt_pk_bf16_f32 v197, v182, v183
  v_mfma_f32_16x16x32_bf16 a[60:63], a[188:191], v[200:203], a[60:63]
  v_cvt_pk_bf16_f32 v198, v184, v185
  v_cvt_pk_bf16_f32 v199, v186, v187
  v_mfma_f32_16x16x32_bf16 a[228:231], a[244:247], v[200:203], a[228:231]
  buffer_load_dwordx4 v9, s[20:23], s51 offen offset:2048 lds
  v_mfma_f32_16x16x32_bf16 v[180:183], v[148:151], v[44:47], v[224:227]
  v_exp_f32 v188, v188
  v_mfma_f32_16x16x32_bf16 v[184:187], v[164:167], v[44:47], v[224:227]
  ds_read_b128 v[144:147], v15 offset:20480
  v_mfma_f32_16x16x32_bf16 v[180:183], v[152:155], v[64:67], v[180:183]
  v_exp_f32 v189, v189
  v_mfma_f32_16x16x32_bf16 v[184:187], v[168:171], v[64:67], v[184:187]
  buffer_load_dwordx4 v10, s[20:23], s51 offen offset:3072 lds
  v_mfma_f32_16x16x32_bf16 v[180:183], v[156:159], v[84:87], v[180:183]
  v_exp_f32 v190, v190
  v_mfma_f32_16x16x32_bf16 v[184:187], v[172:175], v[84:87], v[184:187]
  ds_read_b64_tr_b16 a[192:193], v16 offset:32768
  v_mfma_f32_16x16x32_bf16 v[180:183], v[160:163], v[104:107], v[180:183]
  v_exp_f32 v191, v191
  v_mfma_f32_16x16x32_bf16 v[184:187], v[176:179], v[104:107], v[184:187]
  ds_read_b64_tr_b16 a[194:195], v16 offset:36864
  v_mfma_f32_16x16x32_bf16 a[64:67], a[160:163], v[204:207], a[64:67]
  v_exp_f32 v192, v192
  v_mfma_f32_16x16x32_bf16 a[68:71], a[164:167], v[204:207], a[68:71]
  ds_read_b64_tr_b16 a[196:197], v17 offset:32768
  v_mfma_f32_16x16x32_bf16 a[72:75], a[168:171], v[204:207], a[72:75]
  v_exp_f32 v193, v193
  v_mfma_f32_16x16x32_bf16 a[76:79], a[172:175], v[204:207], a[76:79]
  ds_read_b64_tr_b16 a[198:199], v17 offset:36864
  v_mfma_f32_16x16x32_bf16 a[80:83], a[176:179], v[204:207], a[80:83]
  v_exp_f32 v194, v194
  v_mfma_f32_16x16x32_bf16 a[84:87], a[180:183], v[204:207], a[84:87]
  v_exp_f32 v195, v195
  v_mfma_f32_16x16x32_bf16 a[88:91], a[184:187], v[204:207], a[88:91]
  v_cvt_pk_bf16_f32 v200, v188, v189
  v_cvt_pk_bf16_f32 v201, v190, v191
  v_mfma_f32_16x16x32_bf16 a[92:95], a[188:191], v[204:207], a[92:95]
  v_cvt_pk_bf16_f32 v202, v192, v193
  v_cvt_pk_bf16_f32 v203, v194, v195
  v_mfma_f32_16x16x32_bf16 a[232:235], a[244:247], v[204:207], a[232:235]
  ds_read_b64_tr_b16 a[200:201], v18 offset:32768
  v_mfma_f32_16x16x32_bf16 v[188:191], v[148:151], v[48:51], v[228:231]
  v_exp_f32 v180, v180
  v_mfma_f32_16x16x32_bf16 v[192:195], v[164:167], v[48:51], v[228:231]
  ds_read_b64_tr_b16 a[202:203], v18 offset:36864
  v_mfma_f32_16x16x32_bf16 v[188:191], v[152:155], v[68:71], v[188:191]
  v_exp_f32 v181, v181
  v_mfma_f32_16x16x32_bf16 v[192:195], v[168:171], v[68:71], v[192:195]
  ds_read_b64_tr_b16 a[204:205], v19 offset:32768
  v_mfma_f32_16x16x32_bf16 v[188:191], v[156:159], v[88:91], v[188:191]
  v_exp_f32 v182, v182
  v_mfma_f32_16x16x32_bf16 v[192:195], v[172:175], v[88:91], v[192:195]
  ds_read_b64_tr_b16 a[206:207], v19 offset:36864
  v_mfma_f32_16x16x32_bf16 v[188:191], v[160:163], v[108:111], v[188:191]
  v_exp_f32 v183, v183
  v_mfma_f32_16x16x32_bf16 v[192:195], v[176:179], v[108:111], v[192:195]
  ds_read_b64_tr_b16 a[208:209], v20 offset:32768
  v_mfma_f32_16x16x32_bf16 a[96:99], a[160:163], v[208:211], a[96:99]
  v_exp_f32 v184, v184
  v_mfma_f32_16x16x32_bf16 a[100:103], a[164:167], v[208:211], a[100:103]
  ds_read_b64_tr_b16 a[210:211], v20 offset:36864
  v_mfma_f32_16x16x32_bf16 a[104:107], a[168:171], v[208:211], a[104:107]
  v_exp_f32 v185, v185
  v_mfma_f32_16x16x32_bf16 a[108:111], a[172:175], v[208:211], a[108:111]
  ds_read_b64_tr_b16 a[212:213], v21 offset:32768
  v_mfma_f32_16x16x32_bf16 a[112:115], a[176:179], v[208:211], a[112:115]
  v_exp_f32 v186, v186
  v_mfma_f32_16x16x32_bf16 a[116:119], a[180:183], v[208:211], a[116:119]
  v_exp_f32 v187, v187
  v_mfma_f32_16x16x32_bf16 a[120:123], a[184:187], v[208:211], a[120:123]
  v_cvt_pk_bf16_f32 v204, v180, v181
  v_cvt_pk_bf16_f32 v205, v182, v183
  v_mfma_f32_16x16x32_bf16 a[124:127], a[188:191], v[208:211], a[124:127]
  v_cvt_pk_bf16_f32 v206, v184, v185
  v_cvt_pk_bf16_f32 v207, v186, v187
  v_mfma_f32_16x16x32_bf16 a[236:239], a[244:247], v[208:211], a[236:239]
  ds_read_b64_tr_b16 a[214:215], v21 offset:36864
  v_mfma_f32_16x16x32_bf16 v[180:183], v[148:151], v[52:55], v[232:235]
  v_exp_f32 v188, v188
  v_mfma_f32_16x16x32_bf16 v[184:187], v[164:167], v[52:55], v[232:235]
  ds_read_b64_tr_b16 a[216:217], v22 offset:32768
  v_mfma_f32_16x16x32_bf16 v[180:183], v[152:155], v[72:75], v[180:183]
  v_exp_f32 v189, v189
  v_mfma_f32_16x16x32_bf16 v[184:187], v[168:171], v[72:75], v[184:187]
  ds_read_b64_tr_b16 a[218:219], v22 offset:36864
  v_mfma_f32_16x16x32_bf16 v[180:183], v[156:159], v[92:95], v[180:183]
  v_exp_f32 v190, v190
  v_mfma_f32_16x16x32_bf16 v[184:187], v[172:175], v[92:95], v[184:187]
  ds_read_b64_tr_b16 a[220:221], v23 offset:32768
  v_mfma_f32_16x16x32_bf16 v[180:183], v[160:163], v[112:115], v[180:183]
  v_exp_f32 v191, v191
  v_mfma_f32_16x16x32_bf16 v[184:187], v[176:179], v[112:115], v[184:187]
  ds_read_b64_tr_b16 a[222:223], v23 offset:36864
  v_mfma_f32_16x16x32_bf16 a[128:131], a[160:163], v[212:215], a[128:131]
  v_exp_f32 v192, v192
  v_mfma_f32_16x16x32_bf16 a[132:135], a[164:167], v[212:215], a[132:135]
  v_mfma_f32_16x16x32_bf16 a[136:139], a[168:171], v[212:215], a[136:139]
  v_exp_f32 v193, v193
  v_mfma_f32_16x16x32_bf16 a[140:143], a[172:175], v[212:215], a[140:143]
  v_mfma_f32_16x16x32_bf16 a[144:147], a[176:179], v[212:215], a[144:147]
  v_exp_f32 v194, v194
  v_mfma_f32_16x16x32_bf16 a[148:151], a[180:183], v[212:215], a[148:151]
  v_exp_f32 v195, v195
  v_mfma_f32_16x16x32_bf16 a[152:155], a[184:187], v[212:215], a[152:155]
  v_cvt_pk_bf16_f32 v208, v188, v189
  v_cvt_pk_bf16_f32 v209, v190, v191
  v_mfma_f32_16x16x32_bf16 a[156:159], a[188:191], v[212:215], a[156:159]
  v_cvt_pk_bf16_f32 v210, v192, v193
  v_cvt_pk_bf16_f32 v211, v194, v195
  v_mfma_f32_16x16x32_bf16 a[240:243], a[244:247], v[212:215], a[240:243]
  s_waitcnt vmcnt(16) lgkmcnt(0)
  s_barrier
  v_mfma_f32_16x16x32_bf16 v[188:191], v[116:119], v[36:39], v[216:219]
  v_exp_f32 v180, v180
  v_mfma_f32_16x16x32_bf16 v[192:195], v[132:135], v[36:39], v[216:219]
  ds_read_b128 v[148:151], v12 offset:24576
  v_mfma_f32_16x16x32_bf16 v[188:191], v[120:123], v[56:59], v[188:191]
  v_exp_f32 v181, v181
  v_mfma_f32_16x16x32_bf16 v[192:195], v[136:139], v[56:59], v[192:195]
  s_add_u32 m0, s79, 65536
  s_add_u32 s50, s82, 16384
  s_and_b32 s50, s50, 0x1ffff
  s_add_u32 s50, s50, s35
  buffer_load_dwordx4 v1, s[12:15], s50 offen offset:0 nt lds
  v_mfma_f32_16x16x32_bf16 v[188:191], v[124:127], v[76:79], v[188:191]
  v_exp_f32 v182, v182
  v_mfma_f32_16x16x32_bf16 v[192:195], v[140:143], v[76:79], v[192:195]
  ds_read_b128 v[152:155], v13 offset:24576
  v_mfma_f32_16x16x32_bf16 v[188:191], v[128:131], v[96:99], v[188:191]
  v_exp_f32 v183, v183
  v_mfma_f32_16x16x32_bf16 v[192:195], v[144:147], v[96:99], v[192:195]
  buffer_load_dwordx4 v2, s[12:15], s50 offen offset:1024 nt lds
  v_mfma_f32_16x16x32_bf16 a[0:3], a[192:195], v[196:199], a[0:3]
  v_exp_f32 v184, v184
  v_mfma_f32_16x16x32_bf16 a[4:7], a[196:199], v[196:199], a[4:7]
  ds_read_b128 v[156:159], v14 offset:24576
  v_mfma_f32_16x16x32_bf16 a[8:11], a[200:203], v[196:199], a[8:11]
  v_exp_f32 v185, v185
  v_mfma_f32_16x16x32_bf16 a[12:15], a[204:207], v[196:199], a[12:15]
  buffer_load_dwordx4 v3, s[12:15], s50 offen offset:2048 nt lds
  v_mfma_f32_16x16x32_bf16 a[16:19], a[208:211], v[196:199], a[16:19]
  v_exp_f32 v186, v186
  v_mfma_f32_16x16x32_bf16 a[20:23], a[212:215], v[196:199], a[20:23]
  v_exp_f32 v187, v187
  v_mfma_f32_16x16x32_bf16 a[24:27], a[216:219], v[196:199], a[24:27]
  v_cvt_pk_bf16_f32 v212, v180, v181
  v_cvt_pk_bf16_f32 v213, v182, v183
  v_mfma_f32_16x16x32_bf16 a[28:31], a[220:223], v[196:199], a[28:31]
  v_cvt_pk_bf16_f32 v214, v184, v185
  v_cvt_pk_bf16_f32 v215, v186, v187
  v_mfma_f32_16x16x32_bf16 a[224:227], a[244:247], v[196:199], a[224:227]
  ds_read_b128 v[160:163], v15 offset:24576
  v_mfma_f32_16x16x32_bf16 v[180:183], v[116:119], v[40:43], v[220:223]
  v_exp_f32 v188, v188
  v_mfma_f32_16x16x32_bf16 v[184:187], v[132:135], v[40:43], v[220:223]
  buffer_load_dwordx4 v4, s[12:15], s50 offen offset:3072 nt lds
  v_mfma_f32_16x16x32_bf16 v[180:183], v[120:123], v[60:63], v[180:183]
  v_exp_f32 v189, v189
  v_mfma_f32_16x16x32_bf16 v[184:187], v[136:139], v[60:63], v[184:187]
  ds_read_b128 v[164:167], v12 offset:28672
  v_mfma_f32_16x16x32_bf16 v[180:183], v[124:127], v[80:83], v[180:183]
  v_exp_f32 v190, v190
  v_mfma_f32_16x16x32_bf16 v[184:187], v[140:143], v[80:83], v[184:187]
  s_add_u32 m0, s79, 8192
  s_add_u32 s51, s52, 262144
  buffer_load_dwordx4 v7, s[20:23], s51 offen offset:0 lds
  v_mfma_f32_16x16x32_bf16 v[180:183], v[128:131], v[100:103], v[180:183]
  v_exp_f32 v191, v191
  v_mfma_f32_16x16x32_bf16 v[184:187], v[144:147], v[100:103], v[184:187]
  ds_read_b128 v[168:171], v13 offset:28672
  v_mfma_f32_16x16x32_bf16 a[32:35], a[192:195], v[200:203], a[32:35]
  v_exp_f32 v192, v192
  v_mfma_f32_16x16x32_bf16 a[36:39], a[196:199], v[200:203], a[36:39]
  buffer_load_dwordx4 v8, s[20:23], s51 offen offset:1024 lds
  v_mfma_f32_16x16x32_bf16 a[40:43], a[200:203], v[200:203], a[40:43]
  v_exp_f32 v193, v193
  v_mfma_f32_16x16x32_bf16 a[44:47], a[204:207], v[200:203], a[44:47]
  ds_read_b128 v[172:175], v14 offset:28672
  v_mfma_f32_16x16x32_bf16 a[48:51], a[208:211], v[200:203], a[48:51]
  v_exp_f32 v194, v194
  v_mfma_f32_16x16x32_bf16 a[52:55], a[212:215], v[200:203], a[52:55]
  v_exp_f32 v195, v195
  v_mfma_f32_16x16x32_bf16 a[56:59], a[216:219], v[200:203], a[56:59]
  v_cvt_pk_bf16_f32 v196, v188, v189
  v_cvt_pk_bf16_f32 v197, v190, v191
  v_mfma_f32_16x16x32_bf16 a[60:63], a[220:223], v[200:203], a[60:63]
  v_cvt_pk_bf16_f32 v198, v192, v193
  v_cvt_pk_bf16_f32 v199, v194, v195
  v_mfma_f32_16x16x32_bf16 a[228:231], a[244:247], v[200:203], a[228:231]
  buffer_load_dwordx4 v9, s[20:23], s51 offen offset:2048 lds
  v_mfma_f32_16x16x32_bf16 v[188:191], v[116:119], v[44:47], v[224:227]
  v_exp_f32 v180, v180
  v_mfma_f32_16x16x32_bf16 v[192:195], v[132:135], v[44:47], v[224:227]
  ds_read_b128 v[176:179], v15 offset:28672
  v_mfma_f32_16x16x32_bf16 v[188:191], v[120:123], v[64:67], v[188:191]
  v_exp_f32 v181, v181
  v_mfma_f32_16x16x32_bf16 v[192:195], v[136:139], v[64:67], v[192:195]
  buffer_load_dwordx4 v10, s[20:23], s51 offen offset:3072 lds
  v_mfma_f32_16x16x32_bf16 v[188:191], v[124:127], v[84:87], v[188:191]
  v_exp_f32 v182, v182
  v_mfma_f32_16x16x32_bf16 v[192:195], v[140:143], v[84:87], v[192:195]
  ds_read_b64_tr_b16 a[160:161], v16 offset:40960
  v_mfma_f32_16x16x32_bf16 v[188:191], v[128:131], v[104:107], v[188:191]
  v_exp_f32 v183, v183
  v_mfma_f32_16x16x32_bf16 v[192:195], v[144:147], v[104:107], v[192:195]
  ds_read_b64_tr_b16 a[162:163], v16 offset:45056
  v_mfma_f32_16x16x32_bf16 a[64:67], a[192:195], v[204:207], a[64:67]
  v_exp_f32 v184, v184
  v_mfma_f32_16x16x32_bf16 a[68:71], a[196:199], v[204:207], a[68:71]
  ds_read_b64_tr_b16 a[164:165], v17 offset:40960
  v_mfma_f32_16x16x32_bf16 a[72:75], a[200:203], v[204:207], a[72:75]
  v_exp_f32 v185, v185
  v_mfma_f32_16x16x32_bf16 a[76:79], a[204:207], v[204:207], a[76:79]
  ds_read_b64_tr_b16 a[166:167], v17 offset:45056
  v_mfma_f32_16x16x32_bf16 a[80:83], a[208:211], v[204:207], a[80:83]
  v_exp_f32 v186, v186
  v_mfma_f32_16x16x32_bf16 a[84:87], a[212:215], v[204:207], a[84:87]
  v_exp_f32 v187, v187
  v_mfma_f32_16x16x32_bf16 a[88:91], a[216:219], v[204:207], a[88:91]
  v_cvt_pk_bf16_f32 v200, v180, v181
  v_cvt_pk_bf16_f32 v201, v182, v183
  v_mfma_f32_16x16x32_bf16 a[92:95], a[220:223], v[204:207], a[92:95]
  v_cvt_pk_bf16_f32 v202, v184, v185
  v_cvt_pk_bf16_f32 v203, v186, v187
  v_mfma_f32_16x16x32_bf16 a[232:235], a[244:247], v[204:207], a[232:235]
  ds_read_b64_tr_b16 a[168:169], v18 offset:40960
  v_mfma_f32_16x16x32_bf16 v[180:183], v[116:119], v[48:51], v[228:231]
  v_exp_f32 v188, v188
  v_mfma_f32_16x16x32_bf16 v[184:187], v[132:135], v[48:51], v[228:231]
  ds_read_b64_tr_b16 a[170:171], v18 offset:45056
  v_mfma_f32_16x16x32_bf16 v[180:183], v[120:123], v[68:71], v[180:183]
  v_exp_f32 v189, v189
  v_mfma_f32_16x16x32_bf16 v[184:187], v[136:139], v[68:71], v[184:187]
  ds_read_b64_tr_b16 a[172:173], v19 offset:40960
  v_mfma_f32_16x16x32_bf16 v[180:183], v[124:127], v[88:91], v[180:183]
  v_exp_f32 v190, v190
  v_mfma_f32_16x16x32_bf16 v[184:187], v[140:143], v[88:91], v[184:187]
  ds_read_b64_tr_b16 a[174:175], v19 offset:45056
  v_mfma_f32_16x16x32_bf16 v[180:183], v[128:131], v[108:111], v[180:183]
  v_exp_f32 v191, v191
  v_mfma_f32_16x16x32_bf16 v[184:187], v[144:147], v[108:111], v[184:187]
  ds_read_b64_tr_b16 a[176:177], v20 offset:40960
  v_mfma_f32_16x16x32_bf16 a[96:99], a[192:195], v[208:211], a[96:99]
  v_exp_f32 v192, v192
  v_mfma_f32_16x16x32_bf16 a[100:103], a[196:199], v[208:211], a[100:103]
  ds_read_b64_tr_b16 a[178:179], v20 offset:45056
  v_mfma_f32_16x16x32_bf16 a[104:107], a[200:203], v[208:211], a[104:107]
  v_exp_f32 v193, v193
  v_mfma_f32_16x16x32_bf16 a[108:111], a[204:207], v[208:211], a[108:111]
  ds_read_b64_tr_b16 a[180:181], v21 offset:40960
  v_mfma_f32_16x16x32_bf16 a[112:115], a[208:211], v[208:211], a[112:115]
  v_exp_f32 v194, v194
  v_mfma_f32_16x16x32_bf16 a[116:119], a[212:215], v[208:211], a[116:119]
  v_exp_f32 v195, v195
  v_mfma_f32_16x16x32_bf16 a[120:123], a[216:219], v[208:211], a[120:123]
  v_cvt_pk_bf16_f32 v204, v188, v189
  v_cvt_pk_bf16_f32 v205, v190, v191
  v_mfma_f32_16x16x32_bf16 a[124:127], a[220:223], v[208:211], a[124:127]
  v_cvt_pk_bf16_f32 v206, v192, v193
  v_cvt_pk_bf16_f32 v207, v194, v195
  v_mfma_f32_16x16x32_bf16 a[236:239], a[244:247], v[208:211], a[236:239]
  ds_read_b64_tr_b16 a[182:183], v21 offset:45056
  v_mfma_f32_16x16x32_bf16 v[188:191], v[116:119], v[52:55], v[232:235]
  v_exp_f32 v180, v180
  v_mfma_f32_16x16x32_bf16 v[192:195], v[132:135], v[52:55], v[232:235]
  ds_read_b64_tr_b16 a[184:185], v22 offset:40960
  v_mfma_f32_16x16x32_bf16 v[188:191], v[120:123], v[72:75], v[188:191]
  v_exp_f32 v181, v181
  v_mfma_f32_16x16x32_bf16 v[192:195], v[136:139], v[72:75], v[192:195]
  ds_read_b64_tr_b16 a[186:187], v22 offset:45056
  v_mfma_f32_16x16x32_bf16 v[188:191], v[124:127], v[92:95], v[188:191]
  v_exp_f32 v182, v182
  v_mfma_f32_16x16x32_bf16 v[192:195], v[140:143], v[92:95], v[192:195]
  ds_read_b64_tr_b16 a[188:189], v23 offset:40960
  v_mfma_f32_16x16x32_bf16 v[188:191], v[128:131], v[112:115], v[188:191]
  v_exp_f32 v183, v183
  v_mfma_f32_16x16x32_bf16 v[192:195], v[144:147], v[112:115], v[192:195]
  ds_read_b64_tr_b16 a[190:191], v23 offset:45056
  v_mfma_f32_16x16x32_bf16 a[128:131], a[192:195], v[212:215], a[128:131]
  v_exp_f32 v184, v184
  v_mfma_f32_16x16x32_bf16 a[132:135], a[196:199], v[212:215], a[132:135]
  v_mfma_f32_16x16x32_bf16 a[136:139], a[200:203], v[212:215], a[136:139]
  v_exp_f32 v185, v185
  v_mfma_f32_16x16x32_bf16 a[140:143], a[204:207], v[212:215], a[140:143]
  v_mfma_f32_16x16x32_bf16 a[144:147], a[208:211], v[212:215], a[144:147]
  v_exp_f32 v186, v186
  v_mfma_f32_16x16x32_bf16 a[148:151], a[212:215], v[212:215], a[148:151]
  v_exp_f32 v187, v187
  v_mfma_f32_16x16x32_bf16 a[152:155], a[216:219], v[212:215], a[152:155]
  v_cvt_pk_bf16_f32 v208, v180, v181
  v_cvt_pk_bf16_f32 v209, v182, v183
  v_mfma_f32_16x16x32_bf16 a[156:159], a[220:223], v[212:215], a[156:159]
  v_cvt_pk_bf16_f32 v210, v184, v185
  v_cvt_pk_bf16_f32 v211, v186, v187
  v_mfma_f32_16x16x32_bf16 a[240:243], a[244:247], v[212:215], a[240:243]
  s_waitcnt vmcnt(16) lgkmcnt(0)
  s_barrier
  v_mfma_f32_16x16x32_bf16 v[180:183], v[148:151], v[36:39], v[216:219]
  v_exp_f32 v188, v188
  v_mfma_f32_16x16x32_bf16 v[184:187], v[164:167], v[36:39], v[216:219]
  ds_read_b64_tr_b16 a[192:193], v16 offset:16384
  s_add_u32 m0, s47, 0
  s_add_u32 s51, s37, 0
  buffer_load_dwordx4 v11, s[8:11], s51 offen lds
  v_mfma_f32_16x16x32_bf16 v[180:183], v[152:155], v[56:59], v[180:183]
  v_exp_f32 v189, v189
  v_mfma_f32_16x16x32_bf16 v[184:187], v[168:171], v[56:59], v[184:187]
  ds_read_b64_tr_b16 a[194:195], v16 offset:20480
  v_mfma_f32_16x16x32_bf16 v[180:183], v[156:159], v[76:79], v[180:183]
  v_exp_f32 v190, v190
  v_mfma_f32_16x16x32_bf16 v[184:187], v[172:175], v[76:79], v[184:187]
  s_add_u32 m0, s47, 2048
  s_add_u32 s51, s38, 0
  buffer_load_dwordx4 v11, s[8:11], s51 offen lds
  ds_read_b64_tr_b16 a[196:197], v17 offset:16384
  v_mfma_f32_16x16x32_bf16 v[180:183], v[160:163], v[96:99], v[180:183]
  v_exp_f32 v191, v191
  v_mfma_f32_16x16x32_bf16 v[184:187], v[176:179], v[96:99], v[184:187]
  s_add_u32 m0, s47, 4096
  s_add_u32 s51, s39, 0
  buffer_load_dwordx4 v11, s[8:11], s51 offen lds
  v_mfma_f32_16x16x32_bf16 a[0:3], a[160:163], v[196:199], a[0:3]
  v_exp_f32 v192, v192
  v_mfma_f32_16x16x32_bf16 a[4:7], a[164:167], v[196:199], a[4:7]
  ds_read_b64_tr_b16 a[198:199], v17 offset:20480
  s_add_u32 m0, s47, 6144
  s_add_u32 s51, s40, 0
  buffer_load_dwordx4 v11, s[8:11], s51 offen lds
  v_mfma_f32_16x16x32_bf16 a[8:11], a[168:171], v[196:199], a[8:11]
  v_exp_f32 v193, v193
  v_mfma_f32_16x16x32_bf16 a[12:15], a[172:175], v[196:199], a[12:15]
  ds_read_b64_tr_b16 a[200:201], v18 offset:16384
  v_mfma_f32_16x16x32_bf16 a[16:19], a[176:179], v[196:199], a[16:19]
  v_exp_f32 v194, v194
  v_mfma_f32_16x16x32_bf16 a[20:23], a[180:183], v[196:199], a[20:23]
  v_exp_f32 v195, v195
  v_mfma_f32_16x16x32_bf16 a[24:27], a[184:187], v[196:199], a[24:27]
  v_cvt_pk_bf16_f32 v212, v188, v189
  v_cvt_pk_bf16_f32 v213, v190, v191
  v_mfma_f32_16x16x32_bf16 a[28:31], a[188:191], v[196:199], a[28:31]
  v_cvt_pk_bf16_f32 v214, v192, v193
  v_cvt_pk_bf16_f32 v215, v194, v195
  v_mfma_f32_16x16x32_bf16 a[224:227], a[244:247], v[196:199], a[224:227]
  s_add_u32 m0, s47, 8192
  s_add_u32 s51, s41, 0
  buffer_load_dwordx4 v11, s[8:11], s51 offen lds
  v_mfma_f32_16x16x32_bf16 v[188:191], v[148:151], v[40:43], v[220:223]
  v_exp_f32 v180, v180
  v_mfma_f32_16x16x32_bf16 v[192:195], v[164:167], v[40:43], v[220:223]
  ds_read_b64_tr_b16 a[202:203], v18 offset:20480
  s_add_u32 m0, s79, 73728
  s_add_u32 s50, s82, 24576
  s_and_b32 s50, s50, 0x1ffff
  s_add_u32 s50, s50, s35
  buffer_load_dwordx4 v1, s[12:15], s50 offen offset:0 nt lds
  v_mfma_f32_16x16x32_bf16 v[188:191], v[152:155], v[60:63], v[188:191]
  v_exp_f32 v181, v181
  v_mfma_f32_16x16x32_bf16 v[192:195], v[168:171], v[60:63], v[192:195]
  ds_read_b64_tr_b16 a[204:205], v19 offset:16384
  v_mfma_f32_16x16x32_bf16 v[188:191], v[156:159], v[80:83], v[188:191]
  v_exp_f32 v182, v182
  v_mfma_f32_16x16x32_bf16 v[192:195], v[172:175], v[80:83], v[192:195]
  buffer_load_dwordx4 v2, s[12:15], s50 offen offset:1024 nt lds
  ds_read_b64_tr_b16 a[206:207], v19 offset:20480
  v_mfma_f32_16x16x32_bf16 v[188:191], v[160:163], v[100:103], v[188:191]
  v_exp_f32 v183, v183
  v_mfma_f32_16x16x32_bf16 v[192:195], v[176:179], v[100:103], v[192:195]
  buffer_load_dwordx4 v3, s[12:15], s50 offen offset:2048 nt lds
  v_mfma_f32_16x16x32_bf16 a[32:35], a[160:163], v[200:203], a[32:35]
  v_exp_f32 v184, v184
  v_mfma_f32_16x16x32_bf16 a[36:39], a[164:167], v[200:203], a[36:39]
  ds_read_b64_tr_b16 a[208:209], v20 offset:16384
  buffer_load_dwordx4 v4, s[12:15], s50 offen offset:3072 nt lds
  v_mfma_f32_16x16x32_bf16 a[40:43], a[168:171], v[200:203], a[40:43]
  v_exp_f32 v185, v185
  v_mfma_f32_16x16x32_bf16 a[44:47], a[172:175], v[200:203], a[44:47]
  ds_read_b64_tr_b16 a[210:211], v20 offset:20480
  v_mfma_f32_16x16x32_bf16 a[48:51], a[176:179], v[200:203], a[48:51]
  v_exp_f32 v186, v186
  v_mfma_f32_16x16x32_bf16 a[52:55], a[180:183], v[200:203], a[52:55]
  v_exp_f32 v187, v187
  v_mfma_f32_16x16x32_bf16 a[56:59], a[184:187], v[200:203], a[56:59]
  v_cvt_pk_bf16_f32 v196, v180, v181
  v_cvt_pk_bf16_f32 v197, v182, v183
  v_mfma_f32_16x16x32_bf16 a[60:63], a[188:191], v[200:203], a[60:63]
  v_cvt_pk_bf16_f32 v198, v184, v185
  v_cvt_pk_bf16_f32 v199, v186, v187
  v_mfma_f32_16x16x32_bf16 a[228:231], a[244:247], v[200:203], a[228:231]
  buffer_load_ushort v116, v29, s[28:31], s43 offen offset:0
  v_mfma_f32_16x16x32_bf16 v[180:183], v[148:151], v[44:47], v[224:227]
  v_exp_f32 v188, v188
  v_mfma_f32_16x16x32_bf16 v[184:187], v[164:167], v[44:47], v[224:227]
  ds_read_b64_tr_b16 a[212:213], v21 offset:16384
  buffer_load_ushort v117, v29, s[28:31], s43 offen offset:1152
  v_mfma_f32_16x16x32_bf16 v[180:183], v[152:155], v[64:67], v[180:183]
  v_exp_f32 v189, v189
  v_mfma_f32_16x16x32_bf16 v[184:187], v[168:171], v[64:67], v[184:187]
  ds_read_b64_tr_b16 a[214:215], v21 offset:20480
  v_mfma_f32_16x16x32_bf16 v[180:183], v[156:159], v[84:87], v[180:183]
  v_exp_f32 v190, v190
  v_mfma_f32_16x16x32_bf16 v[184:187], v[172:175], v[84:87], v[184:187]
  buffer_load_ushort v118, v29, s[28:31], s43 offen offset:2304
  ds_read_b64_tr_b16 a[216:217], v22 offset:16384
  v_mfma_f32_16x16x32_bf16 v[180:183], v[160:163], v[104:107], v[180:183]
  v_exp_f32 v191, v191
  v_mfma_f32_16x16x32_bf16 v[184:187], v[176:179], v[104:107], v[184:187]
  buffer_load_ushort v119, v29, s[28:31], s43 offen offset:3456
  v_mfma_f32_16x16x32_bf16 a[64:67], a[160:163], v[204:207], a[64:67]
  v_exp_f32 v192, v192
  v_mfma_f32_16x16x32_bf16 a[68:71], a[164:167], v[204:207], a[68:71]
  ds_read_b64_tr_b16 a[218:219], v22 offset:20480
  buffer_load_ushort v120, v29, s[28:31], s44 offen offset:0
  v_mfma_f32_16x16x32_bf16 a[72:75], a[168:171], v[204:207], a[72:75]
  v_exp_f32 v193, v193
  v_mfma_f32_16x16x32_bf16 a[76:79], a[172:175], v[204:207], a[76:79]
  ds_read_b64_tr_b16 a[220:221], v23 offset:16384
  v_mfma_f32_16x16x32_bf16 a[80:83], a[176:179], v[204:207], a[80:83]
  v_exp_f32 v194, v194
  v_mfma_f32_16x16x32_bf16 a[84:87], a[180:183], v[204:207], a[84:87]
  v_exp_f32 v195, v195
  v_mfma_f32_16x16x32_bf16 a[88:91], a[184:187], v[204:207], a[88:91]
  v_cvt_pk_bf16_f32 v200, v188, v189
  v_cvt_pk_bf16_f32 v201, v190, v191
  v_mfma_f32_16x16x32_bf16 a[92:95], a[188:191], v[204:207], a[92:95]
  v_cvt_pk_bf16_f32 v202, v192, v193
  v_cvt_pk_bf16_f32 v203, v194, v195
  v_mfma_f32_16x16x32_bf16 a[232:235], a[244:247], v[204:207], a[232:235]
  buffer_load_ushort v121, v29, s[28:31], s44 offen offset:1152
  v_mfma_f32_16x16x32_bf16 v[188:191], v[148:151], v[48:51], v[228:231]
  v_exp_f32 v180, v180
  v_mfma_f32_16x16x32_bf16 v[192:195], v[164:167], v[48:51], v[228:231]
  ds_read_b64_tr_b16 a[222:223], v23 offset:20480
  buffer_load_ushort v122, v29, s[28:31], s44 offen offset:2304
  v_mfma_f32_16x16x32_bf16 v[188:191], v[152:155], v[68:71], v[188:191]
  v_exp_f32 v181, v181
  v_mfma_f32_16x16x32_bf16 v[192:195], v[168:171], v[68:71], v[192:195]
  buffer_load_ushort v123, v29, s[28:31], s44 offen offset:3456
  v_mfma_f32_16x16x32_bf16 v[188:191], v[156:159], v[88:91], v[188:191]
  v_exp_f32 v182, v182
  v_mfma_f32_16x16x32_bf16 v[192:195], v[172:175], v[88:91], v[192:195]
  buffer_load_ushort v124, v29, s[28:31], s43 offen offset:32
  buffer_load_ushort v125, v29, s[28:31], s43 offen offset:1184
  v_mfma_f32_16x16x32_bf16 v[188:191], v[160:163], v[108:111], v[188:191]
  v_exp_f32 v183, v183
  v_mfma_f32_16x16x32_bf16 v[192:195], v[176:179], v[108:111], v[192:195]
  buffer_load_ushort v126, v29, s[28:31], s43 offen offset:2336
  v_mfma_f32_16x16x32_bf16 a[96:99], a[160:163], v[208:211], a[96:99]
  v_exp_f32 v184, v184
  v_mfma_f32_16x16x32_bf16 a[100:103], a[164:167], v[208:211], a[100:103]
  buffer_load_ushort v127, v29, s[28:31], s43 offen offset:3488
  buffer_load_ushort v128, v29, s[28:31], s44 offen offset:32
  v_mfma_f32_16x16x32_bf16 a[104:107], a[168:171], v[208:211], a[104:107]
  v_exp_f32 v185, v185
  v_mfma_f32_16x16x32_bf16 a[108:111], a[172:175], v[208:211], a[108:111]
  buffer_load_ushort v129, v29, s[28:31], s44 offen offset:1184
  v_mfma_f32_16x16x32_bf16 a[112:115], a[176:179], v[208:211], a[112:115]
  v_exp_f32 v186, v186
  v_mfma_f32_16x16x32_bf16 a[116:119], a[180:183], v[208:211], a[116:119]
  v_exp_f32 v187, v187
  v_mfma_f32_16x16x32_bf16 a[120:123], a[184:187], v[208:211], a[120:123]
  v_cvt_pk_bf16_f32 v204, v180, v181
  v_cvt_pk_bf16_f32 v205, v182, v183
  v_mfma_f32_16x16x32_bf16 a[124:127], a[188:191], v[208:211], a[124:127]
  v_cvt_pk_bf16_f32 v206, v184, v185
  v_cvt_pk_bf16_f32 v207, v186, v187
  v_mfma_f32_16x16x32_bf16 a[236:239], a[244:247], v[208:211], a[236:239]
  buffer_load_ushort v130, v29, s[28:31], s44 offen offset:2336
  v_mfma_f32_16x16x32_bf16 v[180:183], v[148:151], v[52:55], v[232:235]
  v_exp_f32 v188, v188
  v_mfma_f32_16x16x32_bf16 v[184:187], v[164:167], v[52:55], v[232:235]
  buffer_load_ushort v131, v29, s[28:31], s44 offen offset:3488
  buffer_load_ushort v132, v29, s[28:31], s43 offen offset:64
  v_mfma_f32_16x16x32_bf16 v[180:183], v[152:155], v[72:75], v[180:183]
  v_exp_f32 v189, v189
  v_mfma_f32_16x16x32_bf16 v[184:187], v[168:171], v[72:75], v[184:187]
  buffer_load_ushort v133, v29, s[28:31], s43 offen offset:1216
  v_mfma_f32_16x16x32_bf16 v[180:183], v[156:159], v[92:95], v[180:183]
  v_exp_f32 v190, v190
  v_mfma_f32_16x16x32_bf16 v[184:187], v[172:175], v[92:95], v[184:187]
  buffer_load_ushort v134, v29, s[28:31], s43 offen offset:2368
  v_mfma_f32_16x16x32_bf16 v[180:183], v[160:163], v[112:115], v[180:183]
  v_exp_f32 v191, v191
  v_mfma_f32_16x16x32_bf16 v[184:187], v[176:179], v[112:115], v[184:187]
  buffer_load_ushort v135, v29, s[28:31], s43 offen offset:3520
  buffer_load_ushort v136, v29, s[28:31], s44 offen offset:64
  v_mfma_f32_16x16x32_bf16 a[128:131], a[160:163], v[212:215], a[128:131]
  v_exp_f32 v192, v192
  v_mfma_f32_16x16x32_bf16 a[132:135], a[164:167], v[212:215], a[132:135]
  buffer_load_ushort v137, v29, s[28:31], s44 offen offset:1216
  v_mfma_f32_16x16x32_bf16 a[136:139], a[168:171], v[212:215], a[136:139]
  v_exp_f32 v193, v193
  v_mfma_f32_16x16x32_bf16 a[140:143], a[172:175], v[212:215], a[140:143]
  buffer_load_ushort v138, v29, s[28:31], s44 offen offset:2368
  v_mfma_f32_16x16x32_bf16 a[144:147], a[176:179], v[212:215], a[144:147]
  v_exp_f32 v194, v194
  v_mfma_f32_16x16x32_bf16 a[148:151], a[180:183], v[212:215], a[148:151]
  v_exp_f32 v195, v195
  v_mfma_f32_16x16x32_bf16 a[152:155], a[184:187], v[212:215], a[152:155]
  v_cvt_pk_bf16_f32 v208, v188, v189
  v_cvt_pk_bf16_f32 v209, v190, v191
  v_mfma_f32_16x16x32_bf16 a[156:159], a[188:191], v[212:215], a[156:159]
  v_cvt_pk_bf16_f32 v210, v192, v193
  v_cvt_pk_bf16_f32 v211, v194, v195
  v_mfma_f32_16x16x32_bf16 a[240:243], a[244:247], v[212:215], a[240:243]
  buffer_load_ushort v139, v29, s[28:31], s44 offen offset:3520
  s_waitcnt lgkmcnt(0)
  s_barrier
  v_mfma_f32_16x16x32_bf16 a[0:3], a[192:195], v[196:199], a[0:3]
  v_exp_f32 v180, v180
  v_mfma_f32_16x16x32_bf16 a[4:7], a[196:199], v[196:199], a[4:7]
  v_exp_f32 v181, v181
  v_mfma_f32_16x16x32_bf16 a[8:11], a[200:203], v[196:199], a[8:11]
  v_exp_f32 v182, v182
  v_mfma_f32_16x16x32_bf16 a[12:15], a[204:207], v[196:199], a[12:15]
  v_exp_f32 v183, v183
  v_mfma_f32_16x16x32_bf16 a[16:19], a[208:211], v[196:199], a[16:19]
  v_exp_f32 v184, v184
  v_mfma_f32_16x16x32_bf16 a[20:23], a[212:215], v[196:199], a[20:23]
  v_exp_f32 v185, v185
  v_mfma_f32_16x16x32_bf16 a[24:27], a[216:219], v[196:199], a[24:27]
  v_exp_f32 v186, v186
  v_mfma_f32_16x16x32_bf16 a[28:31], a[220:223], v[196:199], a[28:31]
  v_exp_f32 v187, v187
  v_mfma_f32_16x16x32_bf16 a[224:227], a[244:247], v[196:199], a[224:227]
  v_cvt_pk_bf16_f32 v212, v180, v181
  v_cvt_pk_bf16_f32 v213, v182, v183
  v_cvt_pk_bf16_f32 v214, v184, v185
  v_cvt_pk_bf16_f32 v215, v186, v187
  s_add_u32 m0, s47, 81920
  s_add_u32 s51, s37, 128
  buffer_load_dwordx4 v11, s[8:11], s51 offen lds
  s_add_u32 m0, s47, 83968
  s_add_u32 s51, s38, 128
  buffer_load_dwordx4 v11, s[8:11], s51 offen lds
  v_mfma_f32_16x16x32_bf16 a[32:35], a[192:195], v[200:203], a[32:35]
  s_add_u32 m0, s47, 86016
  s_add_u32 s51, s39, 128
  buffer_load_dwordx4 v11, s[8:11], s51 offen lds
  v_mfma_f32_16x16x32_bf16 a[36:39], a[196:199], v[200:203], a[36:39]
  s_add_u32 m0, s47, 88064
  s_add_u32 s51, s40, 128
  buffer_load_dwordx4 v11, s[8:11], s51 offen lds
  v_mfma_f32_16x16x32_bf16 a[40:43], a[200:203], v[200:203], a[40:43]
  s_add_u32 m0, s47, 90112
  s_add_u32 s51, s41, 128
  buffer_load_dwordx4 v11, s[8:11], s51 offen lds
  v_mfma_f32_16x16x32_bf16 a[44:47], a[204:207], v[200:203], a[44:47]
  s_add_u32 m0, s79, 16384
  s_add_u32 s51, s52, 524288
  buffer_load_dwordx4 v7, s[20:23], s51 offen offset:0 lds
  v_mfma_f32_16x16x32_bf16 a[48:51], a[208:211], v[200:203], a[48:51]
  buffer_load_dwordx4 v8, s[20:23], s51 offen offset:1024 lds
  v_mfma_f32_16x16x32_bf16 a[52:55], a[212:215], v[200:203], a[52:55]
  buffer_load_dwordx4 v9, s[20:23], s51 offen offset:2048 lds
  v_mfma_f32_16x16x32_bf16 a[56:59], a[216:219], v[200:203], a[56:59]
  buffer_load_dwordx4 v10, s[20:23], s51 offen offset:3072 lds
  v_mfma_f32_16x16x32_bf16 a[60:63], a[220:223], v[200:203], a[60:63]
  v_mfma_f32_16x16x32_bf16 a[228:231], a[244:247], v[200:203], a[228:231]
  v_mfma_f32_16x16x32_bf16 a[64:67], a[192:195], v[204:207], a[64:67]
  v_mfma_f32_16x16x32_bf16 a[68:71], a[196:199], v[204:207], a[68:71]
  v_mfma_f32_16x16x32_bf16 a[72:75], a[200:203], v[204:207], a[72:75]
  v_mfma_f32_16x16x32_bf16 a[76:79], a[204:207], v[204:207], a[76:79]
  v_mfma_f32_16x16x32_bf16 a[80:83], a[208:211], v[204:207], a[80:83]
  v_mfma_f32_16x16x32_bf16 a[84:87], a[212:215], v[204:207], a[84:87]
  v_mfma_f32_16x16x32_bf16 a[88:91], a[216:219], v[204:207], a[88:91]
  v_mfma_f32_16x16x32_bf16 a[92:95], a[220:223], v[204:207], a[92:95]
  v_mfma_f32_16x16x32_bf16 a[232:235], a[244:247], v[204:207], a[232:235]
  v_mfma_f32_16x16x32_bf16 a[96:99], a[192:195], v[208:211], a[96:99]
  v_mfma_f32_16x16x32_bf16 a[100:103], a[196:199], v[208:211], a[100:103]
  v_mfma_f32_16x16x32_bf16 a[104:107], a[200:203], v[208:211], a[104:107]
  v_mfma_f32_16x16x32_bf16 a[108:111], a[204:207], v[208:211], a[108:111]
  v_mfma_f32_16x16x32_bf16 a[112:115], a[208:211], v[208:211], a[112:115]
  v_mfma_f32_16x16x32_bf16 a[116:119], a[212:215], v[208:211], a[116:119]
  v_mfma_f32_16x16x32_bf16 a[120:123], a[216:219], v[208:211], a[120:123]
  v_mfma_f32_16x16x32_bf16 a[124:127], a[220:223], v[208:211], a[124:127]
  v_mfma_f32_16x16x32_bf16 a[236:239], a[244:247], v[208:211], a[236:239]
  v_mfma_f32_16x16x32_bf16 a[128:131], a[192:195], v[212:215], a[128:131]
  v_mfma_f32_16x16x32_bf16 a[132:135], a[196:199], v[212:215], a[132:135]
  v_mfma_f32_16x16x32_bf16 a[136:139], a[200:203], v[212:215], a[136:139]
  v_mfma_f32_16x16x32_bf16 a[140:143], a[204:207], v[212:215], a[140:143]
  v_mfma_f32_16x16x32_bf16 a[144:147], a[208:211], v[212:215], a[144:147]
  v_mfma_f32_16x16x32_bf16 a[148:151], a[212:215], v[212:215], a[148:151]
  v_mfma_f32_16x16x32_bf16 a[152:155], a[216:219], v[212:215], a[152:155]
  v_mfma_f32_16x16x32_bf16 a[156:159], a[220:223], v[212:215], a[156:159]
  v_mfma_f32_16x16x32_bf16 a[240:243], a[244:247], v[212:215], a[240:243]
  s_nop 7
  s_mov_b64 s[62:63], 0
  v_accvgpr_read_b32 v216, a224
  v_accvgpr_read_b32 v217, a228
  v_accvgpr_read_b32 v218, a232
  v_accvgpr_read_b32 v219, a236
  v_accvgpr_read_b32 v220, a240
  v_cmp_nlt_f32 vcc, v216, v35
  v_rcp_f32 v216, v216
  s_or_b64 s[62:63], s[62:63], vcc
  v_cmp_nlt_f32 vcc, v217, v35
  v_rcp_f32 v217, v217
  s_or_b64 s[62:63], s[62:63], vcc
  v_cmp_nlt_f32 vcc, v218, v35
  v_rcp_f32 v218, v218
  s_or_b64 s[62:63], s[62:63], vcc
  v_cmp_nlt_f32 vcc, v219, v35
  v_rcp_f32 v219, v219
  s_or_b64 s[62:63], s[62:63], vcc
  v_cmp_nlt_f32 vcc, v220, v35
  v_rcp_f32 v220, v220
  s_or_b64 s[62:63], s[62:63], vcc
  v_accvgpr_read_b32 v180, a0
  v_accvgpr_read_b32 v181, a1
  v_accvgpr_read_b32 v182, a2
  v_accvgpr_read_b32 v183, a3
  v_accvgpr_read_b32 v184, a4
  v_accvgpr_read_b32 v185, a5
  v_accvgpr_read_b32 v186, a6
  v_accvgpr_read_b32 v187, a7
  v_mul_f32 v180, v180, v216
  v_mul_f32 v181, v181, v216
  v_mul_f32 v182, v182, v216
  v_mul_f32 v183, v183, v216
  v_mul_f32 v184, v184, v216
  v_mul_f32 v185, v185, v216
  v_mul_f32 v186, v186, v216
  v_mul_f32 v187, v187, v216
  v_cvt_pk_bf16_f32 v236, v180, v181
  v_cvt_pk_bf16_f32 v237, v182, v183
  v_cvt_pk_bf16_f32 v238, v184, v185
  v_cvt_pk_bf16_f32 v239, v186, v187
  s_add_u32 s50, s42, 0
  buffer_store_dwordx4 v[236:239], v28, s[24:27], s50 offen offset:0
  v_accvgpr_read_b32 v188, a8
  v_accvgpr_read_b32 v189, a9
  v_accvgpr_read_b32 v190, a10
  v_accvgpr_read_b32 v191, a11
  v_accvgpr_read_b32 v192, a12
  v_accvgpr_read_b32 v193, a13
  v_accvgpr_read_b32 v194, a14
  v_accvgpr_read_b32 v195, a15
  v_mul_f32 v188, v188, v216
  v_mul_f32 v189, v189, v216
  v_mul_f32 v190, v190, v216
  v_mul_f32 v191, v191, v216
  v_mul_f32 v192, v192, v216
  v_mul_f32 v193, v193, v216
  v_mul_f32 v194, v194, v216
  v_mul_f32 v195, v195, v216
  v_cvt_pk_bf16_f32 v240, v188, v189
  v_cvt_pk_bf16_f32 v241, v190, v191
  v_cvt_pk_bf16_f32 v242, v192, v193
  v_cvt_pk_bf16_f32 v243, v194, v195
  buffer_store_dwordx4 v[240:243], v28, s[24:27], s50 offen offset:1024
  v_accvgpr_read_b32 v196, a16
  v_accvgpr_read_b32 v197, a17
  v_accvgpr_read_b32 v198, a18
  v_accvgpr_read_b32 v199, a19
  v_accvgpr_read_b32 v200, a20
  v_accvgpr_read_b32 v201, a21
  v_accvgpr_read_b32 v202, a22
  v_accvgpr_read_b32 v203, a23
  v_mul_f32 v196, v196, v216
  v_mul_f32 v197, v197, v216
  v_mul_f32 v198, v198, v216
  v_mul_f32 v199, v199, v216
  v_mul_f32 v200, v200, v216
  v_mul_f32 v201, v201, v216
  v_mul_f32 v202, v202, v216
  v_mul_f32 v203, v203, v216
  v_cvt_pk_bf16_f32 v244, v196, v197
  v_cvt_pk_bf16_f32 v245, v198, v199
  v_cvt_pk_bf16_f32 v246, v200, v201
  v_cvt_pk_bf16_f32 v247, v202, v203
  buffer_store_dwordx4 v[244:247], v28, s[24:27], s50 offen offset:2048
  v_accvgpr_read_b32 v204, a24
  v_accvgpr_read_b32 v205, a25
  v_accvgpr_read_b32 v206, a26
  v_accvgpr_read_b32 v207, a27
  v_accvgpr_read_b32 v208, a28
  v_accvgpr_read_b32 v209, a29
  v_accvgpr_read_b32 v210, a30
  v_accvgpr_read_b32 v211, a31
  v_mul_f32 v204, v204, v216
  v_mul_f32 v205, v205, v216
  v_mul_f32 v206, v206, v216
  v_mul_f32 v207, v207, v216
  v_mul_f32 v208, v208, v216
  v_mul_f32 v209, v209, v216
  v_mul_f32 v210, v210, v216
  v_mul_f32 v211, v211, v216
  v_cvt_pk_bf16_f32 v248, v204, v205
  v_cvt_pk_bf16_f32 v249, v206, v207
  v_cvt_pk_bf16_f32 v250, v208, v209
  v_cvt_pk_bf16_f32 v251, v210, v211
  buffer_store_dwordx4 v[248:251], v28, s[24:27], s50 offen offset:3072
  v_accvgpr_read_b32 v180, a32
  v_accvgpr_read_b32 v181, a33
  v_accvgpr_read_b32 v182, a34
  v_accvgpr_read_b32 v183, a35
  v_accvgpr_read_b32 v184, a36
  v_accvgpr_read_b32 v185, a37
  v_accvgpr_read_b32 v186, a38
  v_accvgpr_read_b32 v187, a39
  v_mul_f32 v180, v180, v217
  v_mul_f32 v181, v181, v217
  v_mul_f32 v182, v182, v217
  v_mul_f32 v183, v183, v217
  v_mul_f32 v184, v184, v217
  v_mul_f32 v185, v185, v217
  v_mul_f32 v186, v186, v217
  v_mul_f32 v187, v187, v217
  v_cvt_pk_bf16_f32 v236, v180, v181
  v_cvt_pk_bf16_f32 v237, v182, v183
  v_cvt_pk_bf16_f32 v238, v184, v185
  v_cvt_pk_bf16_f32 v239, v186, v187
  s_add_u32 s50, s42, 131072
  buffer_store_dwordx4 v[236:239], v28, s[24:27], s50 offen offset:0
  v_accvgpr_read_b32 v188, a40
  v_accvgpr_read_b32 v189, a41
  v_accvgpr_read_b32 v190, a42
  v_accvgpr_read_b32 v191, a43
  v_accvgpr_read_b32 v192, a44
  v_accvgpr_read_b32 v193, a45
  v_accvgpr_read_b32 v194, a46
  v_accvgpr_read_b32 v195, a47
  v_mul_f32 v188, v188, v217
  v_mul_f32 v189, v189, v217
  v_mul_f32 v190, v190, v217
  v_mul_f32 v191, v191, v217
  v_mul_f32 v192, v192, v217
  v_mul_f32 v193, v193, v217
  v_mul_f32 v194, v194, v217
  v_mul_f32 v195, v195, v217
  v_cvt_pk_bf16_f32 v240, v188, v189
  v_cvt_pk_bf16_f32 v241, v190, v191
  v_cvt_pk_bf16_f32 v242, v192, v193
  v_cvt_pk_bf16_f32 v243, v194, v195
  buffer_store_dwordx4 v[240:243], v28, s[24:27], s50 offen offset:1024
  v_accvgpr_read_b32 v196, a48
  v_accvgpr_read_b32 v197, a49
  v_accvgpr_read_b32 v198, a50
  v_accvgpr_read_b32 v199, a51
  v_accvgpr_read_b32 v200, a52
  v_accvgpr_read_b32 v201, a53
  v_accvgpr_read_b32 v202, a54
  v_accvgpr_read_b32 v203, a55
  v_mul_f32 v196, v196, v217
  v_mul_f32 v197, v197, v217
  v_mul_f32 v198, v198, v217
  v_mul_f32 v199, v199, v217
  v_mul_f32 v200, v200, v217
  v_mul_f32 v201, v201, v217
  v_mul_f32 v202, v202, v217
  v_mul_f32 v203, v203, v217
  v_cvt_pk_bf16_f32 v244, v196, v197
  v_cvt_pk_bf16_f32 v245, v198, v199
  v_cvt_pk_bf16_f32 v246, v200, v201
  v_cvt_pk_bf16_f32 v247, v202, v203
  buffer_store_dwordx4 v[244:247], v28, s[24:27], s50 offen offset:2048
  v_accvgpr_read_b32 v204, a56
  v_accvgpr_read_b32 v205, a57
  v_accvgpr_read_b32 v206, a58
  v_accvgpr_read_b32 v207, a59
  v_accvgpr_read_b32 v208, a60
  v_accvgpr_read_b32 v209, a61
  v_accvgpr_read_b32 v210, a62
  v_accvgpr_read_b32 v211, a63
  v_mul_f32 v204, v204, v217
  v_mul_f32 v205, v205, v217
  v_mul_f32 v206, v206, v217
  v_mul_f32 v207, v207, v217
  v_mul_f32 v208, v208, v217
  v_mul_f32 v209, v209, v217
  v_mul_f32 v210, v210, v217
  v_mul_f32 v211, v211, v217
  v_cvt_pk_bf16_f32 v248, v204, v205
  v_cvt_pk_bf16_f32 v249, v206, v207
  v_cvt_pk_bf16_f32 v250, v208, v209
  v_cvt_pk_bf16_f32 v251, v210, v211
  buffer_store_dwordx4 v[248:251], v28, s[24:27], s50 offen offset:3072
  v_accvgpr_read_b32 v180, a64
  v_accvgpr_read_b32 v181, a65
  v_accvgpr_read_b32 v182, a66
  v_accvgpr_read_b32 v183, a67
  v_accvgpr_read_b32 v184, a68
  v_accvgpr_read_b32 v185, a69
  v_accvgpr_read_b32 v186, a70
  v_accvgpr_read_b32 v187, a71
  v_mul_f32 v180, v180, v218
  v_mul_f32 v181, v181, v218
  v_mul_f32 v182, v182, v218
  v_mul_f32 v183, v183, v218
  v_mul_f32 v184, v184, v218
  v_mul_f32 v185, v185, v218
  v_mul_f32 v186, v186, v218
  v_mul_f32 v187, v187, v218
  v_cvt_pk_bf16_f32 v236, v180, v181
  v_cvt_pk_bf16_f32 v237, v182, v183
  v_cvt_pk_bf16_f32 v238, v184, v185
  v_cvt_pk_bf16_f32 v239, v186, v187
  s_add_u32 s50, s42, 262144
  buffer_store_dwordx4 v[236:239], v28, s[24:27], s50 offen offset:0
  v_accvgpr_read_b32 v188, a72
  v_accvgpr_read_b32 v189, a73
  v_accvgpr_read_b32 v190, a74
  v_accvgpr_read_b32 v191, a75
  v_accvgpr_read_b32 v192, a76
  v_accvgpr_read_b32 v193, a77
  v_accvgpr_read_b32 v194, a78
  v_accvgpr_read_b32 v195, a79
  v_mul_f32 v188, v188, v218
  v_mul_f32 v189, v189, v218
  v_mul_f32 v190, v190, v218
  v_mul_f32 v191, v191, v218
  v_mul_f32 v192, v192, v218
  v_mul_f32 v193, v193, v218
  v_mul_f32 v194, v194, v218
  v_mul_f32 v195, v195, v218
  v_cvt_pk_bf16_f32 v240, v188, v189
  v_cvt_pk_bf16_f32 v241, v190, v191
  v_cvt_pk_bf16_f32 v242, v192, v193
  v_cvt_pk_bf16_f32 v243, v194, v195
  buffer_store_dwordx4 v[240:243], v28, s[24:27], s50 offen offset:1024
  v_accvgpr_read_b32 v196, a80
  v_accvgpr_read_b32 v197, a81
  v_accvgpr_read_b32 v198, a82
  v_accvgpr_read_b32 v199, a83
  v_accvgpr_read_b32 v200, a84
  v_accvgpr_read_b32 v201, a85
  v_accvgpr_read_b32 v202, a86
  v_accvgpr_read_b32 v203, a87
  v_mul_f32 v196, v196, v218
  v_mul_f32 v197, v197, v218
  v_mul_f32 v198, v198, v218
  v_mul_f32 v199, v199, v218
  v_mul_f32 v200, v200, v218
  v_mul_f32 v201, v201, v218
  v_mul_f32 v202, v202, v218
  v_mul_f32 v203, v203, v218
  v_cvt_pk_bf16_f32 v244, v196, v197
  v_cvt_pk_bf16_f32 v245, v198, v199
  v_cvt_pk_bf16_f32 v246, v200, v201
  v_cvt_pk_bf16_f32 v247, v202, v203
  buffer_store_dwordx4 v[244:247], v28, s[24:27], s50 offen offset:2048
  v_accvgpr_read_b32 v204, a88
  v_accvgpr_read_b32 v205, a89
  v_accvgpr_read_b32 v206, a90
  v_accvgpr_read_b32 v207, a91
  v_accvgpr_read_b32 v208, a92
  v_accvgpr_read_b32 v209, a93
  v_accvgpr_read_b32 v210, a94
  v_accvgpr_read_b32 v211, a95
  v_mul_f32 v204, v204, v218
  v_mul_f32 v205, v205, v218
  v_mul_f32 v206, v206, v218
  v_mul_f32 v207, v207, v218
  v_mul_f32 v208, v208, v218
  v_mul_f32 v209, v209, v218
  v_mul_f32 v210, v210, v218
  v_mul_f32 v211, v211, v218
  v_cvt_pk_bf16_f32 v248, v204, v205
  v_cvt_pk_bf16_f32 v249, v206, v207
  v_cvt_pk_bf16_f32 v250, v208, v209
  v_cvt_pk_bf16_f32 v251, v210, v211
  buffer_store_dwordx4 v[248:251], v28, s[24:27], s50 offen offset:3072
  v_accvgpr_read_b32 v180, a96
  v_accvgpr_read_b32 v181, a97
  v_accvgpr_read_b32 v182, a98
  v_accvgpr_read_b32 v183, a99
  v_accvgpr_read_b32 v184, a100
  v_accvgpr_read_b32 v185, a101
  v_accvgpr_read_b32 v186, a102
  v_accvgpr_read_b32 v187, a103
  v_mul_f32 v180, v180, v219
  v_mul_f32 v181, v181, v219
  v_mul_f32 v182, v182, v219
  v_mul_f32 v183, v183, v219
  v_mul_f32 v184, v184, v219
  v_mul_f32 v185, v185, v219
  v_mul_f32 v186, v186, v219
  v_mul_f32 v187, v187, v219
  v_cvt_pk_bf16_f32 v236, v180, v181
  v_cvt_pk_bf16_f32 v237, v182, v183
  v_cvt_pk_bf16_f32 v238, v184, v185
  v_cvt_pk_bf16_f32 v239, v186, v187
  s_add_u32 s50, s42, 393216
  buffer_store_dwordx4 v[236:239], v28, s[24:27], s50 offen offset:0
  v_accvgpr_read_b32 v188, a104
  v_accvgpr_read_b32 v189, a105
  v_accvgpr_read_b32 v190, a106
  v_accvgpr_read_b32 v191, a107
  v_accvgpr_read_b32 v192, a108
  v_accvgpr_read_b32 v193, a109
  v_accvgpr_read_b32 v194, a110
  v_accvgpr_read_b32 v195, a111
  v_mul_f32 v188, v188, v219
  v_mul_f32 v189, v189, v219
  v_mul_f32 v190, v190, v219
  v_mul_f32 v191, v191, v219
  v_mul_f32 v192, v192, v219
  v_mul_f32 v193, v193, v219
  v_mul_f32 v194, v194, v219
  v_mul_f32 v195, v195, v219
  v_cvt_pk_bf16_f32 v240, v188, v189
  v_cvt_pk_bf16_f32 v241, v190, v191
  v_cvt_pk_bf16_f32 v242, v192, v193
  v_cvt_pk_bf16_f32 v243, v194, v195
  buffer_store_dwordx4 v[240:243], v28, s[24:27], s50 offen offset:1024
  v_accvgpr_read_b32 v196, a112
  v_accvgpr_read_b32 v197, a113
  v_accvgpr_read_b32 v198, a114
  v_accvgpr_read_b32 v199, a115
  v_accvgpr_read_b32 v200, a116
  v_accvgpr_read_b32 v201, a117
  v_accvgpr_read_b32 v202, a118
  v_accvgpr_read_b32 v203, a119
  v_mul_f32 v196, v196, v219
  v_mul_f32 v197, v197, v219
  v_mul_f32 v198, v198, v219
  v_mul_f32 v199, v199, v219
  v_mul_f32 v200, v200, v219
  v_mul_f32 v201, v201, v219
  v_mul_f32 v202, v202, v219
  v_mul_f32 v203, v203, v219
  v_cvt_pk_bf16_f32 v244, v196, v197
  v_cvt_pk_bf16_f32 v245, v198, v199
  v_cvt_pk_bf16_f32 v246, v200, v201
  v_cvt_pk_bf16_f32 v247, v202, v203
  buffer_store_dwordx4 v[244:247], v28, s[24:27], s50 offen offset:2048
  v_accvgpr_read_b32 v204, a120
  v_accvgpr_read_b32 v205, a121
  v_accvgpr_read_b32 v206, a122
  v_accvgpr_read_b32 v207, a123
  v_accvgpr_read_b32 v208, a124
  v_accvgpr_read_b32 v209, a125
  v_accvgpr_read_b32 v210, a126
  v_accvgpr_read_b32 v211, a127
  v_mul_f32 v204, v204, v219
  v_mul_f32 v205, v205, v219
  v_mul_f32 v206, v206, v219
  v_mul_f32 v207, v207, v219
  v_mul_f32 v208, v208, v219
  v_mul_f32 v209, v209, v219
  v_mul_f32 v210, v210, v219
  v_mul_f32 v211, v211, v219
  v_cvt_pk_bf16_f32 v248, v204, v205
  v_cvt_pk_bf16_f32 v249, v206, v207
  v_cvt_pk_bf16_f32 v250, v208, v209
  v_cvt_pk_bf16_f32 v251, v210, v211
  buffer_store_dwordx4 v[248:251], v28, s[24:27], s50 offen offset:3072
  v_accvgpr_read_b32 v180, a128
  v_accvgpr_read_b32 v181, a129
  v_accvgpr_read_b32 v182, a130
  v_accvgpr_read_b32 v183, a131
  v_accvgpr_read_b32 v184, a132
  v_accvgpr_read_b32 v185, a133
  v_accvgpr_read_b32 v186, a134
  v_accvgpr_read_b32 v187, a135
  v_mul_f32 v180, v180, v220
  v_mul_f32 v181, v181, v220
  v_mul_f32 v182, v182, v220
  v_mul_f32 v183, v183, v220
  v_mul_f32 v184, v184, v220
  v_mul_f32 v185, v185, v220
  v_mul_f32 v186, v186, v220
  v_mul_f32 v187, v187, v220
  v_cvt_pk_bf16_f32 v236, v180, v181
  v_cvt_pk_bf16_f32 v237, v182, v183
  v_cvt_pk_bf16_f32 v238, v184, v185
  v_cvt_pk_bf16_f32 v239, v186, v187
  s_add_u32 s50, s42, 524288
  buffer_store_dwordx4 v[236:239], v28, s[24:27], s50 offen offset:0
  v_accvgpr_read_b32 v188, a136
  v_accvgpr_read_b32 v189, a137
  v_accvgpr_read_b32 v190, a138
  v_accvgpr_read_b32 v191, a139
  v_accvgpr_read_b32 v192, a140
  v_accvgpr_read_b32 v193, a141
  v_accvgpr_read_b32 v194, a142
  v_accvgpr_read_b32 v195, a143
  v_mul_f32 v188, v188, v220
  v_mul_f32 v189, v189, v220
  v_mul_f32 v190, v190, v220
  v_mul_f32 v191, v191, v220
  v_mul_f32 v192, v192, v220
  v_mul_f32 v193, v193, v220
  v_mul_f32 v194, v194, v220
  v_mul_f32 v195, v195, v220
  v_cvt_pk_bf16_f32 v240, v188, v189
  v_cvt_pk_bf16_f32 v241, v190, v191
  v_cvt_pk_bf16_f32 v242, v192, v193
  v_cvt_pk_bf16_f32 v243, v194, v195
  buffer_store_dwordx4 v[240:243], v28, s[24:27], s50 offen offset:1024
  v_accvgpr_read_b32 v196, a144
  v_accvgpr_read_b32 v197, a145
  v_accvgpr_read_b32 v198, a146
  v_accvgpr_read_b32 v199, a147
  v_accvgpr_read_b32 v200, a148
  v_accvgpr_read_b32 v201, a149
  v_accvgpr_read_b32 v202, a150
  v_accvgpr_read_b32 v203, a151
  v_mul_f32 v196, v196, v220
  v_mul_f32 v197, v197, v220
  v_mul_f32 v198, v198, v220
  v_mul_f32 v199, v199, v220
  v_mul_f32 v200, v200, v220
  v_mul_f32 v201, v201, v220
  v_mul_f32 v202, v202, v220
  v_mul_f32 v203, v203, v220
  v_cvt_pk_bf16_f32 v244, v196, v197
  v_cvt_pk_bf16_f32 v245, v198, v199
  v_cvt_pk_bf16_f32 v246, v200, v201
  v_cvt_pk_bf16_f32 v247, v202, v203
  buffer_store_dwordx4 v[244:247], v28, s[24:27], s50 offen offset:2048
  v_accvgpr_read_b32 v204, a152
  v_accvgpr_read_b32 v205, a153
  v_accvgpr_read_b32 v206, a154
  v_accvgpr_read_b32 v207, a155
  v_accvgpr_read_b32 v208, a156
  v_accvgpr_read_b32 v209, a157
  v_accvgpr_read_b32 v210, a158
  v_accvgpr_read_b32 v211, a159
  v_mul_f32 v204, v204, v220
  v_mul_f32 v205, v205, v220
  v_mul_f32 v206, v206, v220
  v_mul_f32 v207, v207, v220
  v_mul_f32 v208, v208, v220
  v_mul_f32 v209, v209, v220
  v_mul_f32 v210, v210, v220
  v_mul_f32 v211, v211, v220
  v_cvt_pk_bf16_f32 v248, v204, v205
  v_cvt_pk_bf16_f32 v249, v206, v207
  v_cvt_pk_bf16_f32 v250, v208, v209
  v_cvt_pk_bf16_f32 v251, v210, v211
  buffer_store_dwordx4 v[248:251], v28, s[24:27], s50 offen offset:3072
  s_waitcnt vmcnt(29)
  v_lshl_or_b32 v148, v117, 16, v116
  v_lshl_or_b32 v149, v119, 16, v118
  v_lshl_or_b32 v150, v121, 16, v120
  v_lshl_or_b32 v151, v123, 16, v122
  s_add_u32 s50, s45, 0
  buffer_store_dwordx4 v[148:151], v28, s[24:27], s50 offen
  v_lshl_or_b32 v152, v125, 16, v124
  v_lshl_or_b32 v153, v127, 16, v126
  v_lshl_or_b32 v154, v129, 16, v128
  v_lshl_or_b32 v155, v131, 16, v130
  s_add_u32 s50, s45, 131072
  buffer_store_dwordx4 v[152:155], v28, s[24:27], s50 offen
  v_lshl_or_b32 v156, v133, 16, v132
  v_lshl_or_b32 v157, v135, 16, v134
  v_lshl_or_b32 v158, v137, 16, v136
  v_lshl_or_b32 v159, v139, 16, v138
  s_add_u32 s50, s45, 262144
  buffer_store_dwordx4 v[156:159], v28, s[24:27], s50 offen
  s_cmp_lg_u64 s[62:63], 0
  s_cselect_b32 s50, 1, 0
  s_and_b32 s51, s46, 1
  s_lshl_b32 s50, s50, s51
  s_or_b32 s53, s53, s50
  s_add_u32 s46, s46, 1
  s_cmp_eq_u32 s46, 1
  s_cbranch_scc0 L_notwarm
  s_xor_b32 s33, s54, 2
  s_branch L_warm
L_notwarm:
  s_cmp_eq_u32 s46, 2
  s_cbranch_scc0 L_noexch
  s_waitcnt vmcnt(0) lgkmcnt(0)
  s_barrier
  v_mov_b32 v30, s55
  v_lshlrev_b32 v30, 2, v30
  v_mov_b32 v31, s53
  ds_write_b32 v30, v31
  s_waitcnt lgkmcnt(0)
  s_barrier
  v_mov_b32 v30, 0
  ds_read_b128 v[236:239], v30
  s_waitcnt lgkmcnt(0)
  v_or3_b32 v32, v236, v237, v238
  v_or_b32 v32, v32, v239
  s_nop 0
  v_readfirstlane_b32 s56, v32
  s_nop 3
  s_barrier
L_noexch:
  s_and_b32 s50, s56, 3
  s_cmp_eq_u32 s50, 0
  s_cbranch_scc1 L_a_done
  s_and_b32 s51, s56, 1
  s_xor_b32 s51, s51, 1
  s_lshl_b32 s58, s51, 1
  s_xor_b32 s33, s54, s58
  s_add_u32 s51, s51, 1
  s_andn2_b32 s56, s56, s51
  s_or_b32 s56, s56, 4
  s_waitcnt vmcnt(0) lgkmcnt(0)
  s_barrier
  s_branch L_cold
L_a_done:
  s_endpgm
.p2align 8
oproj_kernel:
  s_cmp_ge_u32 s2, 256
  s_cbranch_scc1 L_b_done
  s_load_dwordx2 s[4:5], s[0:1], 40
  s_load_dwordx2 s[6:7], s[0:1], 56
  v_lshrrev_b32 v1, 6, v0
  v_and_b32 v2, 63, v0
  s_nop 0
  v_readfirstlane_b32 s3, v1
  v_lshlrev_b32 v3, 4, v2
  s_and_b32 s16, s2, 7
  s_lshl_b32 s16, s16, 3
  s_lshr_b32 s17, s2, 5
  s_add_u32 s16, s16, s17
  s_lshr_b32 s17, s2, 3
  s_and_b32 s17, s17, 3
  s_lshl_b32 s18, s3, 15
  s_mul_i32 s20, s16, 655360
  s_add_u32 s20, s20, s18
  s_add_u32 s21, s20, 131072
  s_add_u32 s22, s20, 262144
  s_add_u32 s23, s20, 393216
  s_add_u32 s24, s20, 524288
  s_mul_i32 s25, s17, 1179648
  s_add_u32 s25, s25, s18
  s_add_u32 s25, s25, 41943040
  s_add_u32 s26, s25, 131072
  s_add_u32 s27, s25, 262144
  s_add_u32 s28, s25, 393216
  s_add_u32 s29, s25, 524288
  s_add_u32 s30, s25, 655360
  s_add_u32 s31, s25, 786432
  s_add_u32 s32, s25, 917504
  s_add_u32 s33, s25, 1048576
  s_waitcnt lgkmcnt(0)
  s_mov_b32 s8, s6
  s_and_b32 s9, s7, 0xffff
  s_mov_b32 s10, 46661632
  s_mov_b32 s11, 0x00020000
  s_mov_b32 s12, s4
  s_and_b32 s13, s5, 0xffff
  s_mov_b32 s14, 5898240
  s_mov_b32 s15, 0x00020000
  s_mov_b32 s19, 0
  s_add_u32 s18, s19, 0
  s_and_b32 s18, s18, 7
  s_lshl_b32 s18, s18, 12
  v_add_u32 v235, s18, v3
  s_add_u32 s18, s19, 1
  s_and_b32 s18, s18, 7
  s_lshl_b32 s18, s18, 12
  v_add_u32 v4, s18, v3
  s_add_u32 s18, s19, 2
  s_and_b32 s18, s18, 7
  s_lshl_b32 s18, s18, 12
  v_add_u32 v5, s18, v3
  s_add_u32 s18, s19, 3
  s_and_b32 s18, s18, 7
  s_lshl_b32 s18, s18, 12
  v_add_u32 v6, s18, v3
  s_add_u32 s18, s19, 4
  s_and_b32 s18, s18, 7
  s_lshl_b32 s18, s18, 12
  v_add_u32 v7, s18, v3
  s_add_u32 s18, s19, 5
  s_and_b32 s18, s18, 7
  s_lshl_b32 s18, s18, 12
  v_add_u32 v232, s18, v3
  s_add_u32 s18, s19, 6
  s_and_b32 s18, s18, 7
  s_lshl_b32 s18, s18, 12
  v_add_u32 v233, s18, v3
  s_add_u32 s18, s19, 7
  s_and_b32 s18, s18, 7
  s_lshl_b32 s18, s18, 12
  v_add_u32 v234, s18, v3
  s_lshl_b32 s78, s2, 2
  s_add_u32 s78, s78, s3
  s_lshl_b32 s78, s78, 7
  s_add_u32 s78, s78, 0x4100000
  buffer_load_dwordx4 v[8:11], v235, s[8:11], s20 offen offset:0
  buffer_load_dwordx4 v[28:31], v235, s[8:11], s25 offen offset:0
  buffer_load_dwordx4 v[12:15], v235, s[8:11], s21 offen offset:0
  buffer_load_dwordx4 v[16:19], v235, s[8:11], s22 offen offset:0
  buffer_load_dwordx4 v[20:23], v235, s[8:11], s23 offen offset:0
  buffer_load_dwordx4 v[24:27], v235, s[8:11], s24 offen offset:0
  buffer_load_dwordx4 v[32:35], v235, s[8:11], s26 offen offset:0
  buffer_load_dwordx4 v[36:39], v235, s[8:11], s27 offen offset:0
  buffer_load_dwordx4 v[40:43], v235, s[8:11], s28 offen offset:0
  buffer_load_dwordx4 v[44:47], v235, s[8:11], s29 offen offset:0
  buffer_load_dwordx4 v[48:51], v235, s[8:11], s30 offen offset:0
  buffer_load_dwordx4 v[52:55], v235, s[8:11], s31 offen offset:0
  buffer_load_dwordx4 v[56:59], v235, s[8:11], s32 offen offset:0
  buffer_load_dwordx4 v[60:63], v235, s[8:11], s33 offen offset:0
  buffer_load_dwordx4 v[64:67], v235, s[8:11], s20 offen offset:1024
  buffer_load_dwordx4 v[84:87], v235, s[8:11], s25 offen offset:1024
  buffer_load_dwordx4 v[68:71], v235, s[8:11], s21 offen offset:1024
  buffer_load_dwordx4 v[72:75], v235, s[8:11], s22 offen offset:1024
  buffer_load_dwordx4 v[76:79], v235, s[8:11], s23 offen offset:1024
  buffer_load_dwordx4 v[80:83], v235, s[8:11], s24 offen offset:1024
  buffer_load_dwordx4 v[88:91], v235, s[8:11], s26 offen offset:1024
  buffer_load_dwordx4 v[92:95], v235, s[8:11], s27 offen offset:1024
  buffer_load_dwordx4 v[96:99], v235, s[8:11], s28 offen offset:1024
  buffer_load_dwordx4 v[100:103], v235, s[8:11], s29 offen offset:1024
  buffer_load_dwordx4 v[104:107], v235, s[8:11], s30 offen offset:1024
  buffer_load_dwordx4 v[108:111], v235, s[8:11], s31 offen offset:1024
  buffer_load_dwordx4 v[112:115], v235, s[8:11], s32 offen offset:1024
  buffer_load_dwordx4 v[116:119], v235, s[8:11], s33 offen offset:1024
  buffer_load_dwordx4 v[120:123], v235, s[8:11], s20 offen offset:2048
  buffer_load_dwordx4 v[140:143], v235, s[8:11], s25 offen offset:2048
  buffer_load_dwordx4 v[124:127], v235, s[8:11], s21 offen offset:2048
  buffer_load_dwordx4 v[128:131], v235, s[8:11], s22 offen offset:2048
  buffer_load_dwordx4 v[132:135], v235, s[8:11], s23 offen offset:2048
  buffer_load_dwordx4 v[136:139], v235, s[8:11], s24 offen offset:2048
  buffer_load_dwordx4 v[144:147], v235, s[8:11], s26 offen offset:2048
  buffer_load_dwordx4 v[148:151], v235, s[8:11], s27 offen offset:2048
  buffer_load_dwordx4 v[152:155], v235, s[8:11], s28 offen offset:2048
  buffer_load_dwordx4 v[156:159], v235, s[8:11], s29 offen offset:2048
  buffer_load_dwordx4 v[160:163], v235, s[8:11], s30 offen offset:2048
  buffer_load_dwordx4 v[164:167], v235, s[8:11], s31 offen offset:2048
  buffer_load_dwordx4 v[168:171], v235, s[8:11], s32 offen offset:2048
  buffer_load_dwordx4 v[172:175], v235, s[8:11], s33 offen offset:2048
  buffer_load_dwordx4 v[176:179], v235, s[8:11], s20 offen offset:3072
  buffer_load_dwordx4 v[196:199], v235, s[8:11], s25 offen offset:3072
  buffer_load_dwordx4 v[180:183], v235, s[8:11], s21 offen offset:3072
  buffer_load_dwordx4 v[184:187], v235, s[8:11], s22 offen offset:3072
  buffer_load_dwordx4 v[188:191], v235, s[8:11], s23 offen offset:3072
  buffer_load_dwordx4 v[192:195], v235, s[8:11], s24 offen offset:3072
  buffer_load_dwordx4 v[200:203], v235, s[8:11], s26 offen offset:3072
  buffer_load_dwordx4 v[204:207], v235, s[8:11], s27 offen offset:3072
  buffer_load_dwordx4 v[208:211], v235, s[8:11], s28 offen offset:3072
  buffer_load_dwordx4 v[212:215], v235, s[8:11], s29 offen offset:3072
  buffer_load_dwordx4 v[216:219], v235, s[8:11], s30 offen offset:3072
  buffer_load_dwordx4 v[220:223], v235, s[8:11], s31 offen offset:3072
  buffer_load_dwordx4 v[224:227], v235, s[8:11], s32 offen offset:3072
  buffer_load_dwordx4 v[228:231], v235, s[8:11], s33 offen offset:3072
  s_cmp_gt_u32 s3, 0
  s_cselect_b32 s18, 1, 0
  s_sub_u32 s18, s3, s18
  s_mul_i32 s18, s18, 12288
  s_add_u32 s18, s18, 0
  s_cmp_eq_u32 s3, 0
  s_cselect_b32 s18, 147456, s18
  v_add_u32 v236, s18, v3
  s_cmp_gt_u32 s3, 1
  s_cselect_b32 s18, 1, 0
  s_sub_u32 s18, s3, s18
  s_mul_i32 s18, s18, 12288
  s_add_u32 s18, s18, 36864
  s_cmp_eq_u32 s3, 1
  s_cselect_b32 s18, 147456, s18
  v_add_u32 v237, s18, v3
  s_cmp_gt_u32 s3, 2
  s_cselect_b32 s18, 1, 0
  s_sub_u32 s18, s3, s18
  s_mul_i32 s18, s18, 12288
  s_add_u32 s18, s18, 73728
  s_cmp_eq_u32 s3, 2
  s_cselect_b32 s18, 147456, s18
  v_add_u32 v238, s18, v3
  s_cmp_gt_u32 s3, 3
  s_cselect_b32 s18, 1, 0
  s_sub_u32 s18, s3, s18
  s_mul_i32 s18, s18, 12288
  s_add_u32 s18, s18, 110592
  s_cmp_eq_u32 s3, 3
  s_cselect_b32 s18, 147456, s18
  v_add_u32 v239, s18, v3
  s_waitcnt vmcnt(42)
  v_mfma_f32_16x16x32_bf16 a[0:3], v[28:31], v[8:11], 0
  v_mfma_f32_16x16x32_bf16 a[4:7], v[28:31], v[12:15], 0
  buffer_load_dwordx4 a[180:183], v4, s[8:11], s20 offen offset:0
  v_mfma_f32_16x16x32_bf16 a[8:11], v[28:31], v[16:19], 0
  v_mfma_f32_16x16x32_bf16 a[12:15], v[28:31], v[20:23], 0
  v_mfma_f32_16x16x32_bf16 a[16:19], v[28:31], v[24:27], 0
  buffer_load_dwordx4 a[200:203], v4, s[8:11], s25 offen offset:0
  v_mfma_f32_16x16x32_bf16 a[20:23], v[32:35], v[8:11], 0
  v_mfma_f32_16x16x32_bf16 a[24:27], v[32:35], v[12:15], 0
  v_mfma_f32_16x16x32_bf16 a[28:31], v[32:35], v[16:19], 0
  buffer_load_dwordx4 a[184:187], v4, s[8:11], s21 offen offset:0
  v_mfma_f32_16x16x32_bf16 a[32:35], v[32:35], v[20:23], 0
  v_mfma_f32_16x16x32_bf16 a[36:39], v[32:35], v[24:27], 0
  v_mfma_f32_16x16x32_bf16 a[40:43], v[36:39], v[8:11], 0
  buffer_load_dwordx4 a[188:191], v4, s[8:11], s22 offen offset:0
  v_mfma_f32_16x16x32_bf16 a[44:47], v[36:39], v[12:15], 0
  v_mfma_f32_16x16x32_bf16 a[48:51], v[36:39], v[16:19], 0
  v_mfma_f32_16x16x32_bf16 a[52:55], v[36:39], v[20:23], 0
  buffer_load_dwordx4 a[192:195], v4, s[8:11], s23 offen offset:0
  v_mfma_f32_16x16x32_bf16 a[56:59], v[36:39], v[24:27], 0
  v_mfma_f32_16x16x32_bf16 a[60:63], v[40:43], v[8:11], 0
  v_mfma_f32_16x16x32_bf16 a[64:67], v[40:43], v[12:15], 0
  buffer_load_dwordx4 a[196:199], v4, s[8:11], s24 offen offset:0
  v_mfma_f32_16x16x32_bf16 a[68:71], v[40:43], v[16:19], 0
  v_mfma_f32_16x16x32_bf16 a[72:75], v[40:43], v[20:23], 0
  v_mfma_f32_16x16x32_bf16 a[76:79], v[40:43], v[24:27], 0
  buffer_load_dwordx4 a[204:207], v4, s[8:11], s26 offen offset:0
  v_mfma_f32_16x16x32_bf16 a[80:83], v[44:47], v[8:11], 0
  v_mfma_f32_16x16x32_bf16 a[84:87], v[44:47], v[12:15], 0
  v_mfma_f32_16x16x32_bf16 a[88:91], v[44:47], v[16:19], 0
  buffer_load_dwordx4 a[208:211], v4, s[8:11], s27 offen offset:0
  v_mfma_f32_16x16x32_bf16 a[92:95], v[44:47], v[20:23], 0
  v_mfma_f32_16x16x32_bf16 a[96:99], v[44:47], v[24:27], 0
  v_mfma_f32_16x16x32_bf16 a[100:103], v[48:51], v[8:11], 0
  buffer_load_dwordx4 a[212:215], v4, s[8:11], s28 offen offset:0
  v_mfma_f32_16x16x32_bf16 a[104:107], v[48:51], v[12:15], 0
  v_mfma_f32_16x16x32_bf16 a[108:111], v[48:51], v[16:19], 0
  v_mfma_f32_16x16x32_bf16 a[112:115], v[48:51], v[20:23], 0
  buffer_load_dwordx4 a[216:219], v4, s[8:11], s29 offen offset:0
  v_mfma_f32_16x16x32_bf16 a[116:119], v[48:51], v[24:27], 0
  v_mfma_f32_16x16x32_bf16 a[120:123], v[52:55], v[8:11], 0
  v_mfma_f32_16x16x32_bf16 a[124:127], v[52:55], v[12:15], 0
  buffer_load_dwordx4 a[220:223], v4, s[8:11], s30 offen offset:0
  v_mfma_f32_16x16x32_bf16 a[128:131], v[52:55], v[16:19], 0
  v_mfma_f32_16x16x32_bf16 a[132:135], v[52:55], v[20:23], 0
  v_mfma_f32_16x16x32_bf16 a[136:139], v[52:55], v[24:27], 0
  buffer_load_dwordx4 a[224:227], v4, s[8:11], s31 offen offset:0
  v_mfma_f32_16x16x32_bf16 a[140:143], v[56:59], v[8:11], 0
  v_mfma_f32_16x16x32_bf16 a[144:147], v[56:59], v[12:15], 0
  v_mfma_f32_16x16x32_bf16 a[148:151], v[56:59], v[16:19], 0
  buffer_load_dwordx4 a[228:231], v4, s[8:11], s32 offen offset:0
  v_mfma_f32_16x16x32_bf16 a[152:155], v[56:59], v[20:23], 0
  v_mfma_f32_16x16x32_bf16 a[156:159], v[56:59], v[24:27], 0
  v_mfma_f32_16x16x32_bf16 a[160:163], v[60:63], v[8:11], 0
  buffer_load_dwordx4 a[232:235], v4, s[8:11], s33 offen offset:0
  v_mfma_f32_16x16x32_bf16 a[164:167], v[60:63], v[12:15], 0
  v_mfma_f32_16x16x32_bf16 a[168:171], v[60:63], v[16:19], 0
  v_mfma_f32_16x16x32_bf16 a[172:175], v[60:63], v[20:23], 0
  v_mfma_f32_16x16x32_bf16 a[176:179], v[60:63], v[24:27], 0
  s_waitcnt vmcnt(42)
  v_mfma_f32_16x16x32_bf16 a[0:3], v[84:87], v[64:67], a[0:3]
  v_mfma_f32_16x16x32_bf16 a[4:7], v[84:87], v[68:71], a[4:7]
  buffer_load_dwordx4 v[8:11], v4, s[8:11], s20 offen offset:1024
  v_mfma_f32_16x16x32_bf16 a[8:11], v[84:87], v[72:75], a[8:11]
  v_mfma_f32_16x16x32_bf16 a[12:15], v[84:87], v[76:79], a[12:15]
  v_mfma_f32_16x16x32_bf16 a[16:19], v[84:87], v[80:83], a[16:19]
  buffer_load_dwordx4 v[28:31], v4, s[8:11], s25 offen offset:1024
  v_mfma_f32_16x16x32_bf16 a[20:23], v[88:91], v[64:67], a[20:23]
  v_mfma_f32_16x16x32_bf16 a[24:27], v[88:91], v[68:71], a[24:27]
  v_mfma_f32_16x16x32_bf16 a[28:31], v[88:91], v[72:75], a[28:31]
  buffer_load_dwordx4 v[12:15], v4, s[8:11], s21 offen offset:1024
  v_mfma_f32_16x16x32_bf16 a[32:35], v[88:91], v[76:79], a[32:35]
  v_mfma_f32_16x16x32_bf16 a[36:39], v[88:91], v[80:83], a[36:39]
  v_mfma_f32_16x16x32_bf16 a[40:43], v[92:95], v[64:67], a[40:43]
  buffer_load_dwordx4 v[16:19], v4, s[8:11], s22 offen offset:1024
  v_mfma_f32_16x16x32_bf16 a[44:47], v[92:95], v[68:71], a[44:47]
  v_mfma_f32_16x16x32_bf16 a[48:51], v[92:95], v[72:75], a[48:51]
  v_mfma_f32_16x16x32_bf16 a[52:55], v[92:95], v[76:79], a[52:55]
  buffer_load_dwordx4 v[20:23], v4, s[8:11], s23 offen offset:1024
  v_mfma_f32_16x16x32_bf16 a[56:59], v[92:95], v[80:83], a[56:59]
  v_mfma_f32_16x16x32_bf16 a[60:63], v[96:99], v[64:67], a[60:63]
  v_mfma_f32_16x16x32_bf16 a[64:67], v[96:99], v[68:71], a[64:67]
  buffer_load_dwordx4 v[24:27], v4, s[8:11], s24 offen offset:1024
  v_mfma_f32_16x16x32_bf16 a[68:71], v[96:99], v[72:75], a[68:71]
  v_mfma_f32_16x16x32_bf16 a[72:75], v[96:99], v[76:79], a[72:75]
  v_mfma_f32_16x16x32_bf16 a[76:79], v[96:99], v[80:83], a[76:79]
  buffer_load_dwordx4 v[32:35], v4, s[8:11], s26 offen offset:1024
  v_mfma_f32_16x16x32_bf16 a[80:83], v[100:103], v[64:67], a[80:83]
  v_mfma_f32_16x16x32_bf16 a[84:87], v[100:103], v[68:71], a[84:87]
  v_mfma_f32_16x16x32_bf16 a[88:91], v[100:103], v[72:75], a[88:91]
  buffer_load_dwordx4 v[36:39], v4, s[8:11], s27 offen offset:1024
  v_mfma_f32_16x16x32_bf16 a[92:95], v[100:103], v[76:79], a[92:95]
  v_mfma_f32_16x16x32_bf16 a[96:99], v[100:103], v[80:83], a[96:99]
  v_mfma_f32_16x16x32_bf16 a[100:103], v[104:107], v[64:67], a[100:103]
  buffer_load_dwordx4 v[40:43], v4, s[8:11], s28 offen offset:1024
  v_mfma_f32_16x16x32_bf16 a[104:107], v[104:107], v[68:71], a[104:107]
  v_mfma_f32_16x16x32_bf16 a[108:111], v[104:107], v[72:75], a[108:111]
  v_mfma_f32_16x16x32_bf16 a[112:115], v[104:107], v[76:79], a[112:115]
  buffer_load_dwordx4 v[44:47], v4, s[8:11], s29 offen offset:1024
  v_mfma_f32_16x16x32_bf16 a[116:119], v[104:107], v[80:83], a[116:119]
  v_mfma_f32_16x16x32_bf16 a[120:123], v[108:111], v[64:67], a[120:123]
  v_mfma_f32_16x16x32_bf16 a[124:127], v[108:111], v[68:71], a[124:127]
  buffer_load_dwordx4 v[48:51], v4, s[8:11], s30 offen offset:1024
  v_mfma_f32_16x16x32_bf16 a[128:131], v[108:111], v[72:75], a[128:131]
  v_mfma_f32_16x16x32_bf16 a[132:135], v[108:111], v[76:79], a[132:135]
  v_mfma_f32_16x16x32_bf16 a[136:139], v[108:111], v[80:83], a[136:139]
  buffer_load_dwordx4 v[52:55], v4, s[8:11], s31 offen offset:1024
  v_mfma_f32_16x16x32_bf16 a[140:143], v[112:115], v[64:67], a[140:143]
  v_mfma_f32_16x16x32_bf16 a[144:147], v[112:115], v[68:71], a[144:147]
  v_mfma_f32_16x16x32_bf16 a[148:151], v[112:115], v[72:75], a[148:151]
  buffer_load_dwordx4 v[56:59], v4, s[8:11], s32 offen offset:1024
  v_mfma_f32_16x16x32_bf16 a[152:155], v[112:115], v[76:79], a[152:155]
  v_mfma_f32_16x16x32_bf16 a[156:159], v[112:115], v[80:83], a[156:159]
  v_mfma_f32_16x16x32_bf16 a[160:163], v[116:119], v[64:67], a[160:163]
  buffer_load_dwordx4 v[60:63], v4, s[8:11], s33 offen offset:1024
  v_mfma_f32_16x16x32_bf16 a[164:167], v[116:119], v[68:71], a[164:167]
  v_mfma_f32_16x16x32_bf16 a[168:171], v[116:119], v[72:75], a[168:171]
  v_mfma_f32_16x16x32_bf16 a[172:175], v[116:119], v[76:79], a[172:175]
  v_mfma_f32_16x16x32_bf16 a[176:179], v[116:119], v[80:83], a[176:179]
  s_waitcnt vmcnt(42)
  v_mfma_f32_16x16x32_bf16 a[0:3], v[140:143], v[120:123], a[0:3]
  v_mfma_f32_16x16x32_bf16 a[4:7], v[140:143], v[124:127], a[4:7]
  buffer_load_dwordx4 v[64:67], v4, s[8:11], s20 offen offset:2048
  v_mfma_f32_16x16x32_bf16 a[8:11], v[140:143], v[128:131], a[8:11]
  v_mfma_f32_16x16x32_bf16 a[12:15], v[140:143], v[132:135], a[12:15]
  v_mfma_f32_16x16x32_bf16 a[16:19], v[140:143], v[136:139], a[16:19]
  buffer_load_dwordx4 v[84:87], v4, s[8:11], s25 offen offset:2048
  v_mfma_f32_16x16x32_bf16 a[20:23], v[144:147], v[120:123], a[20:23]
  v_mfma_f32_16x16x32_bf16 a[24:27], v[144:147], v[124:127], a[24:27]
  v_mfma_f32_16x16x32_bf16 a[28:31], v[144:147], v[128:131], a[28:31]
  buffer_load_dwordx4 v[68:71], v4, s[8:11], s21 offen offset:2048
  v_mfma_f32_16x16x32_bf16 a[32:35], v[144:147], v[132:135], a[32:35]
  v_mfma_f32_16x16x32_bf16 a[36:39], v[144:147], v[136:139], a[36:39]
  v_mfma_f32_16x16x32_bf16 a[40:43], v[148:151], v[120:123], a[40:43]
  buffer_load_dwordx4 v[72:75], v4, s[8:11], s22 offen offset:2048
  v_mfma_f32_16x16x32_bf16 a[44:47], v[148:151], v[124:127], a[44:47]
  v_mfma_f32_16x16x32_bf16 a[48:51], v[148:151], v[128:131], a[48:51]
  v_mfma_f32_16x16x32_bf16 a[52:55], v[148:151], v[132:135], a[52:55]
  buffer_load_dwordx4 v[76:79], v4, s[8:11], s23 offen offset:2048
  v_mfma_f32_16x16x32_bf16 a[56:59], v[148:151], v[136:139], a[56:59]
  v_mfma_f32_16x16x32_bf16 a[60:63], v[152:155], v[120:123], a[60:63]
  v_mfma_f32_16x16x32_bf16 a[64:67], v[152:155], v[124:127], a[64:67]
  buffer_load_dwordx4 v[80:83], v4, s[8:11], s24 offen offset:2048
  v_mfma_f32_16x16x32_bf16 a[68:71], v[152:155], v[128:131], a[68:71]
  v_mfma_f32_16x16x32_bf16 a[72:75], v[152:155], v[132:135], a[72:75]
  v_mfma_f32_16x16x32_bf16 a[76:79], v[152:155], v[136:139], a[76:79]
  buffer_load_dwordx4 v[88:91], v4, s[8:11], s26 offen offset:2048
  v_mfma_f32_16x16x32_bf16 a[80:83], v[156:159], v[120:123], a[80:83]
  v_mfma_f32_16x16x32_bf16 a[84:87], v[156:159], v[124:127], a[84:87]
  v_mfma_f32_16x16x32_bf16 a[88:91], v[156:159], v[128:131], a[88:91]
  buffer_load_dwordx4 v[92:95], v4, s[8:11], s27 offen offset:2048
  v_mfma_f32_16x16x32_bf16 a[92:95], v[156:159], v[132:135], a[92:95]
  v_mfma_f32_16x16x32_bf16 a[96:99], v[156:159], v[136:139], a[96:99]
  v_mfma_f32_16x16x32_bf16 a[100:103], v[160:163], v[120:123], a[100:103]
  buffer_load_dwordx4 v[96:99], v4, s[8:11], s28 offen offset:2048
  v_mfma_f32_16x16x32_bf16 a[104:107], v[160:163], v[124:127], a[104:107]
  v_mfma_f32_16x16x32_bf16 a[108:111], v[160:163], v[128:131], a[108:111]
  v_mfma_f32_16x16x32_bf16 a[112:115], v[160:163], v[132:135], a[112:115]
  buffer_load_dwordx4 v[100:103], v4, s[8:11], s29 offen offset:2048
  v_mfma_f32_16x16x32_bf16 a[116:119], v[160:163], v[136:139], a[116:119]
  v_mfma_f32_16x16x32_bf16 a[120:123], v[164:167], v[120:123], a[120:123]
  v_mfma_f32_16x16x32_bf16 a[124:127], v[164:167], v[124:127], a[124:127]
  buffer_load_dwordx4 v[104:107], v4, s[8:11], s30 offen offset:2048
  v_mfma_f32_16x16x32_bf16 a[128:131], v[164:167], v[128:131], a[128:131]
  v_mfma_f32_16x16x32_bf16 a[132:135], v[164:167], v[132:135], a[132:135]
  v_mfma_f32_16x16x32_bf16 a[136:139], v[164:167], v[136:139], a[136:139]
  buffer_load_dwordx4 v[108:111], v4, s[8:11], s31 offen offset:2048
  v_mfma_f32_16x16x32_bf16 a[140:143], v[168:171], v[120:123], a[140:143]
  v_mfma_f32_16x16x32_bf16 a[144:147], v[168:171], v[124:127], a[144:147]
  v_mfma_f32_16x16x32_bf16 a[148:151], v[168:171], v[128:131], a[148:151]
  buffer_load_dwordx4 v[112:115], v4, s[8:11], s32 offen offset:2048
  v_mfma_f32_16x16x32_bf16 a[152:155], v[168:171], v[132:135], a[152:155]
  v_mfma_f32_16x16x32_bf16 a[156:159], v[168:171], v[136:139], a[156:159]
  v_mfma_f32_16x16x32_bf16 a[160:163], v[172:175], v[120:123], a[160:163]
  buffer_load_dwordx4 v[116:119], v4, s[8:11], s33 offen offset:2048
  v_mfma_f32_16x16x32_bf16 a[164:167], v[172:175], v[124:127], a[164:167]
  v_mfma_f32_16x16x32_bf16 a[168:171], v[172:175], v[128:131], a[168:171]
  v_mfma_f32_16x16x32_bf16 a[172:175], v[172:175], v[132:135], a[172:175]
  v_mfma_f32_16x16x32_bf16 a[176:179], v[172:175], v[136:139], a[176:179]
  s_waitcnt vmcnt(42)
  v_mfma_f32_16x16x32_bf16 a[0:3], v[196:199], v[176:179], a[0:3]
  v_mfma_f32_16x16x32_bf16 a[4:7], v[196:199], v[180:183], a[4:7]
  buffer_load_dwordx4 v[120:123], v4, s[8:11], s20 offen offset:3072
  v_mfma_f32_16x16x32_bf16 a[8:11], v[196:199], v[184:187], a[8:11]
  v_mfma_f32_16x16x32_bf16 a[12:15], v[196:199], v[188:191], a[12:15]
  v_mfma_f32_16x16x32_bf16 a[16:19], v[196:199], v[192:195], a[16:19]
  buffer_load_dwordx4 v[140:143], v4, s[8:11], s25 offen offset:3072
  v_mfma_f32_16x16x32_bf16 a[20:23], v[200:203], v[176:179], a[20:23]
  v_mfma_f32_16x16x32_bf16 a[24:27], v[200:203], v[180:183], a[24:27]
  v_mfma_f32_16x16x32_bf16 a[28:31], v[200:203], v[184:187], a[28:31]
  buffer_load_dwordx4 v[124:127], v4, s[8:11], s21 offen offset:3072
  v_mfma_f32_16x16x32_bf16 a[32:35], v[200:203], v[188:191], a[32:35]
  v_mfma_f32_16x16x32_bf16 a[36:39], v[200:203], v[192:195], a[36:39]
  v_mfma_f32_16x16x32_bf16 a[40:43], v[204:207], v[176:179], a[40:43]
  buffer_load_dwordx4 v[128:131], v4, s[8:11], s22 offen offset:3072
  v_mfma_f32_16x16x32_bf16 a[44:47], v[204:207], v[180:183], a[44:47]
  v_mfma_f32_16x16x32_bf16 a[48:51], v[204:207], v[184:187], a[48:51]
  v_mfma_f32_16x16x32_bf16 a[52:55], v[204:207], v[188:191], a[52:55]
  buffer_load_dwordx4 v[132:135], v4, s[8:11], s23 offen offset:3072
  v_mfma_f32_16x16x32_bf16 a[56:59], v[204:207], v[192:195], a[56:59]
  v_mfma_f32_16x16x32_bf16 a[60:63], v[208:211], v[176:179], a[60:63]
  v_mfma_f32_16x16x32_bf16 a[64:67], v[208:211], v[180:183], a[64:67]
  buffer_load_dwordx4 v[136:139], v4, s[8:11], s24 offen offset:3072
  v_mfma_f32_16x16x32_bf16 a[68:71], v[208:211], v[184:187], a[68:71]
  v_mfma_f32_16x16x32_bf16 a[72:75], v[208:211], v[188:191], a[72:75]
  v_mfma_f32_16x16x32_bf16 a[76:79], v[208:211], v[192:195], a[76:79]
  buffer_load_dwordx4 v[144:147], v4, s[8:11], s26 offen offset:3072
  v_mfma_f32_16x16x32_bf16 a[80:83], v[212:215], v[176:179], a[80:83]
  v_mfma_f32_16x16x32_bf16 a[84:87], v[212:215], v[180:183], a[84:87]
  v_mfma_f32_16x16x32_bf16 a[88:91], v[212:215], v[184:187], a[88:91]
  buffer_load_dwordx4 v[148:151], v4, s[8:11], s27 offen offset:3072
  v_mfma_f32_16x16x32_bf16 a[92:95], v[212:215], v[188:191], a[92:95]
  v_mfma_f32_16x16x32_bf16 a[96:99], v[212:215], v[192:195], a[96:99]
  v_mfma_f32_16x16x32_bf16 a[100:103], v[216:219], v[176:179], a[100:103]
  buffer_load_dwordx4 v[152:155], v4, s[8:11], s28 offen offset:3072
  v_mfma_f32_16x16x32_bf16 a[104:107], v[216:219], v[180:183], a[104:107]
  v_mfma_f32_16x16x32_bf16 a[108:111], v[216:219], v[184:187], a[108:111]
  v_mfma_f32_16x16x32_bf16 a[112:115], v[216:219], v[188:191], a[112:115]
  buffer_load_dwordx4 v[156:159], v4, s[8:11], s29 offen offset:3072
  v_mfma_f32_16x16x32_bf16 a[116:119], v[216:219], v[192:195], a[116:119]
  v_mfma_f32_16x16x32_bf16 a[120:123], v[220:223], v[176:179], a[120:123]
  v_mfma_f32_16x16x32_bf16 a[124:127], v[220:223], v[180:183], a[124:127]
  buffer_load_dwordx4 v[160:163], v4, s[8:11], s30 offen offset:3072
  v_mfma_f32_16x16x32_bf16 a[128:131], v[220:223], v[184:187], a[128:131]
  v_mfma_f32_16x16x32_bf16 a[132:135], v[220:223], v[188:191], a[132:135]
  v_mfma_f32_16x16x32_bf16 a[136:139], v[220:223], v[192:195], a[136:139]
  buffer_load_dwordx4 v[164:167], v4, s[8:11], s31 offen offset:3072
  v_mfma_f32_16x16x32_bf16 a[140:143], v[224:227], v[176:179], a[140:143]
  v_mfma_f32_16x16x32_bf16 a[144:147], v[224:227], v[180:183], a[144:147]
  v_mfma_f32_16x16x32_bf16 a[148:151], v[224:227], v[184:187], a[148:151]
  buffer_load_dwordx4 v[168:171], v4, s[8:11], s32 offen offset:3072
  v_mfma_f32_16x16x32_bf16 a[152:155], v[224:227], v[188:191], a[152:155]
  v_mfma_f32_16x16x32_bf16 a[156:159], v[224:227], v[192:195], a[156:159]
  v_mfma_f32_16x16x32_bf16 a[160:163], v[228:231], v[176:179], a[160:163]
  buffer_load_dwordx4 v[172:175], v4, s[8:11], s33 offen offset:3072
  v_mfma_f32_16x16x32_bf16 a[164:167], v[228:231], v[180:183], a[164:167]
  v_mfma_f32_16x16x32_bf16 a[168:171], v[228:231], v[184:187], a[168:171]
  v_mfma_f32_16x16x32_bf16 a[172:175], v[228:231], v[188:191], a[172:175]
  v_mfma_f32_16x16x32_bf16 a[176:179], v[228:231], v[192:195], a[176:179]
  s_waitcnt vmcnt(42)
  v_mfma_f32_16x16x32_bf16 a[0:3], a[200:203], a[180:183], a[0:3]
  v_mfma_f32_16x16x32_bf16 a[4:7], a[200:203], a[184:187], a[4:7]
  buffer_load_dwordx4 v[176:179], v5, s[8:11], s20 offen offset:0
  v_mfma_f32_16x16x32_bf16 a[8:11], a[200:203], a[188:191], a[8:11]
  v_mfma_f32_16x16x32_bf16 a[12:15], a[200:203], a[192:195], a[12:15]
  v_mfma_f32_16x16x32_bf16 a[16:19], a[200:203], a[196:199], a[16:19]
  buffer_load_dwordx4 v[196:199], v5, s[8:11], s25 offen offset:0
  v_mfma_f32_16x16x32_bf16 a[20:23], a[204:207], a[180:183], a[20:23]
  v_mfma_f32_16x16x32_bf16 a[24:27], a[204:207], a[184:187], a[24:27]
  v_mfma_f32_16x16x32_bf16 a[28:31], a[204:207], a[188:191], a[28:31]
  buffer_load_dwordx4 v[180:183], v5, s[8:11], s21 offen offset:0
  v_mfma_f32_16x16x32_bf16 a[32:35], a[204:207], a[192:195], a[32:35]
  v_mfma_f32_16x16x32_bf16 a[36:39], a[204:207], a[196:199], a[36:39]
  v_mfma_f32_16x16x32_bf16 a[40:43], a[208:211], a[180:183], a[40:43]
  buffer_load_dwordx4 v[184:187], v5, s[8:11], s22 offen offset:0
  v_mfma_f32_16x16x32_bf16 a[44:47], a[208:211], a[184:187], a[44:47]
  v_mfma_f32_16x16x32_bf16 a[48:51], a[208:211], a[188:191], a[48:51]
  v_mfma_f32_16x16x32_bf16 a[52:55], a[208:211], a[192:195], a[52:55]
  buffer_load_dwordx4 v[188:191], v5, s[8:11], s23 offen offset:0
  v_mfma_f32_16x16x32_bf16 a[56:59], a[208:211], a[196:199], a[56:59]
  v_mfma_f32_16x16x32_bf16 a[60:63], a[212:215], a[180:183], a[60:63]
  v_mfma_f32_16x16x32_bf16 a[64:67], a[212:215], a[184:187], a[64:67]
  buffer_load_dwordx4 v[192:195], v5, s[8:11], s24 offen offset:0
  v_mfma_f32_16x16x32_bf16 a[68:71], a[212:215], a[188:191], a[68:71]
  v_mfma_f32_16x16x32_bf16 a[72:75], a[212:215], a[192:195], a[72:75]
  v_mfma_f32_16x16x32_bf16 a[76:79], a[212:215], a[196:199], a[76:79]
  buffer_load_dwordx4 v[200:203], v5, s[8:11], s26 offen offset:0
  v_mfma_f32_16x16x32_bf16 a[80:83], a[216:219], a[180:183], a[80:83]
  v_mfma_f32_16x16x32_bf16 a[84:87], a[216:219], a[184:187], a[84:87]
  v_mfma_f32_16x16x32_bf16 a[88:91], a[216:219], a[188:191], a[88:91]
  buffer_load_dwordx4 v[204:207], v5, s[8:11], s27 offen offset:0
  v_mfma_f32_16x16x32_bf16 a[92:95], a[216:219], a[192:195], a[92:95]
  v_mfma_f32_16x16x32_bf16 a[96:99], a[216:219], a[196:199], a[96:99]
  v_mfma_f32_16x16x32_bf16 a[100:103], a[220:223], a[180:183], a[100:103]
  buffer_load_dwordx4 v[208:211], v5, s[8:11], s28 offen offset:0
  v_mfma_f32_16x16x32_bf16 a[104:107], a[220:223], a[184:187], a[104:107]
  v_mfma_f32_16x16x32_bf16 a[108:111], a[220:223], a[188:191], a[108:111]
  v_mfma_f32_16x16x32_bf16 a[112:115], a[220:223], a[192:195], a[112:115]
  buffer_load_dwordx4 v[212:215], v5, s[8:11], s29 offen offset:0
  v_mfma_f32_16x16x32_bf16 a[116:119], a[220:223], a[196:199], a[116:119]
  v_mfma_f32_16x16x32_bf16 a[120:123], a[224:227], a[180:183], a[120:123]
  v_mfma_f32_16x16x32_bf16 a[124:127], a[224:227], a[184:187], a[124:127]
  buffer_load_dwordx4 v[216:219], v5, s[8:11], s30 offen offset:0
  v_mfma_f32_16x16x32_bf16 a[128:131], a[224:227], a[188:191], a[128:131]
  v_mfma_f32_16x16x32_bf16 a[132:135], a[224:227], a[192:195], a[132:135]
  v_mfma_f32_16x16x32_bf16 a[136:139], a[224:227], a[196:199], a[136:139]
  buffer_load_dwordx4 v[220:223], v5, s[8:11], s31 offen offset:0
  v_mfma_f32_16x16x32_bf16 a[140:143], a[228:231], a[180:183], a[140:143]
  v_mfma_f32_16x16x32_bf16 a[144:147], a[228:231], a[184:187], a[144:147]
  v_mfma_f32_16x16x32_bf16 a[148:151], a[228:231], a[188:191], a[148:151]
  buffer_load_dwordx4 v[224:227], v5, s[8:11], s32 offen offset:0
  v_mfma_f32_16x16x32_bf16 a[152:155], a[228:231], a[192:195], a[152:155]
  v_mfma_f32_16x16x32_bf16 a[156:159], a[228:231], a[196:199], a[156:159]
  v_mfma_f32_16x16x32_bf16 a[160:163], a[232:235], a[180:183], a[160:163]
  buffer_load_dwordx4 v[228:231], v5, s[8:11], s33 offen offset:0
  v_mfma_f32_16x16x32_bf16 a[164:167], a[232:235], a[184:187], a[164:167]
  v_mfma_f32_16x16x32_bf16 a[168:171], a[232:235], a[188:191], a[168:171]
  v_mfma_f32_16x16x32_bf16 a[172:175], a[232:235], a[192:195], a[172:175]
  v_mfma_f32_16x16x32_bf16 a[176:179], a[232:235], a[196:199], a[176:179]
  s_waitcnt vmcnt(42)
  v_mfma_f32_16x16x32_bf16 a[0:3], v[28:31], v[8:11], a[0:3]
  v_mfma_f32_16x16x32_bf16 a[4:7], v[28:31], v[12:15], a[4:7]
  buffer_load_dwordx4 a[180:183], v5, s[8:11], s20 offen offset:1024
  v_mfma_f32_16x16x32_bf16 a[8:11], v[28:31], v[16:19], a[8:11]
  v_mfma_f32_16x16x32_bf16 a[12:15], v[28:31], v[20:23], a[12:15]
  v_mfma_f32_16x16x32_bf16 a[16:19], v[28:31], v[24:27], a[16:19]
  buffer_load_dwordx4 a[200:203], v5, s[8:11], s25 offen offset:1024
  v_mfma_f32_16x16x32_bf16 a[20:23], v[32:35], v[8:11], a[20:23]
  v_mfma_f32_16x16x32_bf16 a[24:27], v[32:35], v[12:15], a[24:27]
  v_mfma_f32_16x16x32_bf16 a[28:31], v[32:35], v[16:19], a[28:31]
  buffer_load_dwordx4 a[184:187], v5, s[8:11], s21 offen offset:1024
  v_mfma_f32_16x16x32_bf16 a[32:35], v[32:35], v[20:23], a[32:35]
  v_mfma_f32_16x16x32_bf16 a[36:39], v[32:35], v[24:27], a[36:39]
  v_mfma_f32_16x16x32_bf16 a[40:43], v[36:39], v[8:11], a[40:43]
  buffer_load_dwordx4 a[188:191], v5, s[8:11], s22 offen offset:1024
  v_mfma_f32_16x16x32_bf16 a[44:47], v[36:39], v[12:15], a[44:47]
  v_mfma_f32_16x16x32_bf16 a[48:51], v[36:39], v[16:19], a[48:51]
  v_mfma_f32_16x16x32_bf16 a[52:55], v[36:39], v[20:23], a[52:55]
  buffer_load_dwordx4 a[192:195], v5, s[8:11], s23 offen offset:1024
  v_mfma_f32_16x16x32_bf16 a[56:59], v[36:39], v[24:27], a[56:59]
  v_mfma_f32_16x16x32_bf16 a[60:63], v[40:43], v[8:11], a[60:63]
  v_mfma_f32_16x16x32_bf16 a[64:67], v[40:43], v[12:15], a[64:67]
  buffer_load_dwordx4 a[196:199], v5, s[8:11], s24 offen offset:1024
  v_mfma_f32_16x16x32_bf16 a[68:71], v[40:43], v[16:19], a[68:71]
  v_mfma_f32_16x16x32_bf16 a[72:75], v[40:43], v[20:23], a[72:75]
  v_mfma_f32_16x16x32_bf16 a[76:79], v[40:43], v[24:27], a[76:79]
  buffer_load_dwordx4 a[204:207], v5, s[8:11], s26 offen offset:1024
  v_mfma_f32_16x16x32_bf16 a[80:83], v[44:47], v[8:11], a[80:83]
  v_mfma_f32_16x16x32_bf16 a[84:87], v[44:47], v[12:15], a[84:87]
  v_mfma_f32_16x16x32_bf16 a[88:91], v[44:47], v[16:19], a[88:91]
  buffer_load_dwordx4 a[208:211], v5, s[8:11], s27 offen offset:1024
  v_mfma_f32_16x16x32_bf16 a[92:95], v[44:47], v[20:23], a[92:95]
  v_mfma_f32_16x16x32_bf16 a[96:99], v[44:47], v[24:27], a[96:99]
  v_mfma_f32_16x16x32_bf16 a[100:103], v[48:51], v[8:11], a[100:103]
  buffer_load_dwordx4 a[212:215], v5, s[8:11], s28 offen offset:1024
  v_mfma_f32_16x16x32_bf16 a[104:107], v[48:51], v[12:15], a[104:107]
  v_mfma_f32_16x16x32_bf16 a[108:111], v[48:51], v[16:19], a[108:111]
  v_mfma_f32_16x16x32_bf16 a[112:115], v[48:51], v[20:23], a[112:115]
  buffer_load_dwordx4 a[216:219], v5, s[8:11], s29 offen offset:1024
  v_mfma_f32_16x16x32_bf16 a[116:119], v[48:51], v[24:27], a[116:119]
  v_mfma_f32_16x16x32_bf16 a[120:123], v[52:55], v[8:11], a[120:123]
  v_mfma_f32_16x16x32_bf16 a[124:127], v[52:55], v[12:15], a[124:127]
  buffer_load_dwordx4 a[220:223], v5, s[8:11], s30 offen offset:1024
  v_mfma_f32_16x16x32_bf16 a[128:131], v[52:55], v[16:19], a[128:131]
  v_mfma_f32_16x16x32_bf16 a[132:135], v[52:55], v[20:23], a[132:135]
  v_mfma_f32_16x16x32_bf16 a[136:139], v[52:55], v[24:27], a[136:139]
  buffer_load_dwordx4 a[224:227], v5, s[8:11], s31 offen offset:1024
  v_mfma_f32_16x16x32_bf16 a[140:143], v[56:59], v[8:11], a[140:143]
  v_mfma_f32_16x16x32_bf16 a[144:147], v[56:59], v[12:15], a[144:147]
  v_mfma_f32_16x16x32_bf16 a[148:151], v[56:59], v[16:19], a[148:151]
  buffer_load_dwordx4 a[228:231], v5, s[8:11], s32 offen offset:1024
  v_mfma_f32_16x16x32_bf16 a[152:155], v[56:59], v[20:23], a[152:155]
  v_mfma_f32_16x16x32_bf16 a[156:159], v[56:59], v[24:27], a[156:159]
  v_mfma_f32_16x16x32_bf16 a[160:163], v[60:63], v[8:11], a[160:163]
  buffer_load_dwordx4 a[232:235], v5, s[8:11], s33 offen offset:1024
  v_mfma_f32_16x16x32_bf16 a[164:167], v[60:63], v[12:15], a[164:167]
  v_mfma_f32_16x16x32_bf16 a[168:171], v[60:63], v[16:19], a[168:171]
  v_mfma_f32_16x16x32_bf16 a[172:175], v[60:63], v[20:23], a[172:175]
  v_mfma_f32_16x16x32_bf16 a[176:179], v[60:63], v[24:27], a[176:179]
  s_waitcnt vmcnt(42)
  v_mfma_f32_16x16x32_bf16 a[0:3], v[84:87], v[64:67], a[0:3]
  v_mfma_f32_16x16x32_bf16 a[4:7], v[84:87], v[68:71], a[4:7]
  buffer_load_dwordx4 v[8:11], v5, s[8:11], s20 offen offset:2048
  v_mfma_f32_16x16x32_bf16 a[8:11], v[84:87], v[72:75], a[8:11]
  v_mfma_f32_16x16x32_bf16 a[12:15], v[84:87], v[76:79], a[12:15]
  v_mfma_f32_16x16x32_bf16 a[16:19], v[84:87], v[80:83], a[16:19]
  buffer_load_dwordx4 v[28:31], v5, s[8:11], s25 offen offset:2048
  v_mfma_f32_16x16x32_bf16 a[20:23], v[88:91], v[64:67], a[20:23]
  v_mfma_f32_16x16x32_bf16 a[24:27], v[88:91], v[68:71], a[24:27]
  v_mfma_f32_16x16x32_bf16 a[28:31], v[88:91], v[72:75], a[28:31]
  buffer_load_dwordx4 v[12:15], v5, s[8:11], s21 offen offset:2048
  v_mfma_f32_16x16x32_bf16 a[32:35], v[88:91], v[76:79], a[32:35]
  v_mfma_f32_16x16x32_bf16 a[36:39], v[88:91], v[80:83], a[36:39]
  v_mfma_f32_16x16x32_bf16 a[40:43], v[92:95], v[64:67], a[40:43]
  buffer_load_dwordx4 v[16:19], v5, s[8:11], s22 offen offset:2048
  v_mfma_f32_16x16x32_bf16 a[44:47], v[92:95], v[68:71], a[44:47]
  v_mfma_f32_16x16x32_bf16 a[48:51], v[92:95], v[72:75], a[48:51]
  v_mfma_f32_16x16x32_bf16 a[52:55], v[92:95], v[76:79], a[52:55]
  buffer_load_dwordx4 v[20:23], v5, s[8:11], s23 offen offset:2048
  v_mfma_f32_16x16x32_bf16 a[56:59], v[92:95], v[80:83], a[56:59]
  v_mfma_f32_16x16x32_bf16 a[60:63], v[96:99], v[64:67], a[60:63]
  v_mfma_f32_16x16x32_bf16 a[64:67], v[96:99], v[68:71], a[64:67]
  buffer_load_dwordx4 v[24:27], v5, s[8:11], s24 offen offset:2048
  v_mfma_f32_16x16x32_bf16 a[68:71], v[96:99], v[72:75], a[68:71]
  v_mfma_f32_16x16x32_bf16 a[72:75], v[96:99], v[76:79], a[72:75]
  v_mfma_f32_16x16x32_bf16 a[76:79], v[96:99], v[80:83], a[76:79]
  buffer_load_dwordx4 v[32:35], v5, s[8:11], s26 offen offset:2048
  v_mfma_f32_16x16x32_bf16 a[80:83], v[100:103], v[64:67], a[80:83]
  v_mfma_f32_16x16x32_bf16 a[84:87], v[100:103], v[68:71], a[84:87]
  v_mfma_f32_16x16x32_bf16 a[88:91], v[100:103], v[72:75], a[88:91]
  buffer_load_dwordx4 v[36:39], v5, s[8:11], s27 offen offset:2048
  v_mfma_f32_16x16x32_bf16 a[92:95], v[100:103], v[76:79], a[92:95]
  v_mfma_f32_16x16x32_bf16 a[96:99], v[100:103], v[80:83], a[96:99]
  v_mfma_f32_16x16x32_bf16 a[100:103], v[104:107], v[64:67], a[100:103]
  buffer_load_dwordx4 v[40:43], v5, s[8:11], s28 offen offset:2048
  v_mfma_f32_16x16x32_bf16 a[104:107], v[104:107], v[68:71], a[104:107]
  v_mfma_f32_16x16x32_bf16 a[108:111], v[104:107], v[72:75], a[108:111]
  v_mfma_f32_16x16x32_bf16 a[112:115], v[104:107], v[76:79], a[112:115]
  buffer_load_dwordx4 v[44:47], v5, s[8:11], s29 offen offset:2048
  v_mfma_f32_16x16x32_bf16 a[116:119], v[104:107], v[80:83], a[116:119]
  v_mfma_f32_16x16x32_bf16 a[120:123], v[108:111], v[64:67], a[120:123]
  v_mfma_f32_16x16x32_bf16 a[124:127], v[108:111], v[68:71], a[124:127]
  buffer_load_dwordx4 v[48:51], v5, s[8:11], s30 offen offset:2048
  v_mfma_f32_16x16x32_bf16 a[128:131], v[108:111], v[72:75], a[128:131]
  v_mfma_f32_16x16x32_bf16 a[132:135], v[108:111], v[76:79], a[132:135]
  v_mfma_f32_16x16x32_bf16 a[136:139], v[108:111], v[80:83], a[136:139]
  buffer_load_dwordx4 v[52:55], v5, s[8:11], s31 offen offset:2048
  v_mfma_f32_16x16x32_bf16 a[140:143], v[112:115], v[64:67], a[140:143]
  v_mfma_f32_16x16x32_bf16 a[144:147], v[112:115], v[68:71], a[144:147]
  v_mfma_f32_16x16x32_bf16 a[148:151], v[112:115], v[72:75], a[148:151]
  buffer_load_dwordx4 v[56:59], v5, s[8:11], s32 offen offset:2048
  v_mfma_f32_16x16x32_bf16 a[152:155], v[112:115], v[76:79], a[152:155]
  v_mfma_f32_16x16x32_bf16 a[156:159], v[112:115], v[80:83], a[156:159]
  v_mfma_f32_16x16x32_bf16 a[160:163], v[116:119], v[64:67], a[160:163]
  buffer_load_dwordx4 v[60:63], v5, s[8:11], s33 offen offset:2048
  v_mfma_f32_16x16x32_bf16 a[164:167], v[116:119], v[68:71], a[164:167]
  v_mfma_f32_16x16x32_bf16 a[168:171], v[116:119], v[72:75], a[168:171]
  v_mfma_f32_16x16x32_bf16 a[172:175], v[116:119], v[76:79], a[172:175]
  v_mfma_f32_16x16x32_bf16 a[176:179], v[116:119], v[80:83], a[176:179]
  s_waitcnt vmcnt(42)
  v_mfma_f32_16x16x32_bf16 a[0:3], v[140:143], v[120:123], a[0:3]
  v_mfma_f32_16x16x32_bf16 a[4:7], v[140:143], v[124:127], a[4:7]
  buffer_load_dwordx4 v[64:67], v5, s[8:11], s20 offen offset:3072
  v_mfma_f32_16x16x32_bf16 a[8:11], v[140:143], v[128:131], a[8:11]
  v_mfma_f32_16x16x32_bf16 a[12:15], v[140:143], v[132:135], a[12:15]
  v_mfma_f32_16x16x32_bf16 a[16:19], v[140:143], v[136:139], a[16:19]
  buffer_load_dwordx4 v[84:87], v5, s[8:11], s25 offen offset:3072
  v_mfma_f32_16x16x32_bf16 a[20:23], v[144:147], v[120:123], a[20:23]
  v_mfma_f32_16x16x32_bf16 a[24:27], v[144:147], v[124:127], a[24:27]
  v_mfma_f32_16x16x32_bf16 a[28:31], v[144:147], v[128:131], a[28:31]
  buffer_load_dwordx4 v[68:71], v5, s[8:11], s21 offen offset:3072
  v_mfma_f32_16x16x32_bf16 a[32:35], v[144:147], v[132:135], a[32:35]
  v_mfma_f32_16x16x32_bf16 a[36:39], v[144:147], v[136:139], a[36:39]
  v_mfma_f32_16x16x32_bf16 a[40:43], v[148:151], v[120:123], a[40:43]
  buffer_load_dwordx4 v[72:75], v5, s[8:11], s22 offen offset:3072
  v_mfma_f32_16x16x32_bf16 a[44:47], v[148:151], v[124:127], a[44:47]
  v_mfma_f32_16x16x32_bf16 a[48:51], v[148:151], v[128:131], a[48:51]
  v_mfma_f32_16x16x32_bf16 a[52:55], v[148:151], v[132:135], a[52:55]
  buffer_load_dwordx4 v[76:79], v5, s[8:11], s23 offen offset:3072
  v_mfma_f32_16x16x32_bf16 a[56:59], v[148:151], v[136:139], a[56:59]
  v_mfma_f32_16x16x32_bf16 a[60:63], v[152:155], v[120:123], a[60:63]
  v_mfma_f32_16x16x32_bf16 a[64:67], v[152:155], v[124:127], a[64:67]
  buffer_load_dwordx4 v[80:83], v5, s[8:11], s24 offen offset:3072
  v_mfma_f32_16x16x32_bf16 a[68:71], v[152:155], v[128:131], a[68:71]
  v_mfma_f32_16x16x32_bf16 a[72:75], v[152:155], v[132:135], a[72:75]
  v_mfma_f32_16x16x32_bf16 a[76:79], v[152:155], v[136:139], a[76:79]
  buffer_load_dwordx4 v[88:91], v5, s[8:11], s26 offen offset:3072
  v_mfma_f32_16x16x32_bf16 a[80:83], v[156:159], v[120:123], a[80:83]
  v_mfma_f32_16x16x32_bf16 a[84:87], v[156:159], v[124:127], a[84:87]
  v_mfma_f32_16x16x32_bf16 a[88:91], v[156:159], v[128:131], a[88:91]
  buffer_load_dwordx4 v[92:95], v5, s[8:11], s27 offen offset:3072
  v_mfma_f32_16x16x32_bf16 a[92:95], v[156:159], v[132:135], a[92:95]
  v_mfma_f32_16x16x32_bf16 a[96:99], v[156:159], v[136:139], a[96:99]
  v_mfma_f32_16x16x32_bf16 a[100:103], v[160:163], v[120:123], a[100:103]
  buffer_load_dwordx4 v[96:99], v5, s[8:11], s28 offen offset:3072
  v_mfma_f32_16x16x32_bf16 a[104:107], v[160:163], v[124:127], a[104:107]
  v_mfma_f32_16x16x32_bf16 a[108:111], v[160:163], v[128:131], a[108:111]
  v_mfma_f32_16x16x32_bf16 a[112:115], v[160:163], v[132:135], a[112:115]
  buffer_load_dwordx4 v[100:103], v5, s[8:11], s29 offen offset:3072
  v_mfma_f32_16x16x32_bf16 a[116:119], v[160:163], v[136:139], a[116:119]
  v_mfma_f32_16x16x32_bf16 a[120:123], v[164:167], v[120:123], a[120:123]
  v_mfma_f32_16x16x32_bf16 a[124:127], v[164:167], v[124:127], a[124:127]
  buffer_load_dwordx4 v[104:107], v5, s[8:11], s30 offen offset:3072
  v_mfma_f32_16x16x32_bf16 a[128:131], v[164:167], v[128:131], a[128:131]
  v_mfma_f32_16x16x32_bf16 a[132:135], v[164:167], v[132:135], a[132:135]
  v_mfma_f32_16x16x32_bf16 a[136:139], v[164:167], v[136:139], a[136:139]
  buffer_load_dwordx4 v[108:111], v5, s[8:11], s31 offen offset:3072
  v_mfma_f32_16x16x32_bf16 a[140:143], v[168:171], v[120:123], a[140:143]
  v_mfma_f32_16x16x32_bf16 a[144:147], v[168:171], v[124:127], a[144:147]
  v_mfma_f32_16x16x32_bf16 a[148:151], v[168:171], v[128:131], a[148:151]
  buffer_load_dwordx4 v[112:115], v5, s[8:11], s32 offen offset:3072
  v_mfma_f32_16x16x32_bf16 a[152:155], v[168:171], v[132:135], a[152:155]
  v_mfma_f32_16x16x32_bf16 a[156:159], v[168:171], v[136:139], a[156:159]
  v_mfma_f32_16x16x32_bf16 a[160:163], v[172:175], v[120:123], a[160:163]
  buffer_load_dwordx4 v[116:119], v5, s[8:11], s33 offen offset:3072
  v_mfma_f32_16x16x32_bf16 a[164:167], v[172:175], v[124:127], a[164:167]
  v_mfma_f32_16x16x32_bf16 a[168:171], v[172:175], v[128:131], a[168:171]
  v_mfma_f32_16x16x32_bf16 a[172:175], v[172:175], v[132:135], a[172:175]
  v_mfma_f32_16x16x32_bf16 a[176:179], v[172:175], v[136:139], a[176:179]
  s_waitcnt vmcnt(42)
  v_mfma_f32_16x16x32_bf16 a[0:3], v[196:199], v[176:179], a[0:3]
  v_mfma_f32_16x16x32_bf16 a[4:7], v[196:199], v[180:183], a[4:7]
  buffer_load_dwordx4 v[120:123], v6, s[8:11], s20 offen offset:0
  v_mfma_f32_16x16x32_bf16 a[8:11], v[196:199], v[184:187], a[8:11]
  v_mfma_f32_16x16x32_bf16 a[12:15], v[196:199], v[188:191], a[12:15]
  v_mfma_f32_16x16x32_bf16 a[16:19], v[196:199], v[192:195], a[16:19]
  buffer_load_dwordx4 v[140:143], v6, s[8:11], s25 offen offset:0
  v_mfma_f32_16x16x32_bf16 a[20:23], v[200:203], v[176:179], a[20:23]
  v_mfma_f32_16x16x32_bf16 a[24:27], v[200:203], v[180:183], a[24:27]
  v_mfma_f32_16x16x32_bf16 a[28:31], v[200:203], v[184:187], a[28:31]
  buffer_load_dwordx4 v[124:127], v6, s[8:11], s21 offen offset:0
  v_mfma_f32_16x16x32_bf16 a[32:35], v[200:203], v[188:191], a[32:35]
  v_mfma_f32_16x16x32_bf16 a[36:39], v[200:203], v[192:195], a[36:39]
  v_mfma_f32_16x16x32_bf16 a[40:43], v[204:207], v[176:179], a[40:43]
  buffer_load_dwordx4 v[128:131], v6, s[8:11], s22 offen offset:0
  v_mfma_f32_16x16x32_bf16 a[44:47], v[204:207], v[180:183], a[44:47]
  v_mfma_f32_16x16x32_bf16 a[48:51], v[204:207], v[184:187], a[48:51]
  v_mfma_f32_16x16x32_bf16 a[52:55], v[204:207], v[188:191], a[52:55]
  buffer_load_dwordx4 v[132:135], v6, s[8:11], s23 offen offset:0
  v_mfma_f32_16x16x32_bf16 a[56:59], v[204:207], v[192:195], a[56:59]
  v_mfma_f32_16x16x32_bf16 a[60:63], v[208:211], v[176:179], a[60:63]
  v_mfma_f32_16x16x32_bf16 a[64:67], v[208:211], v[180:183], a[64:67]
  buffer_load_dwordx4 v[136:139], v6, s[8:11], s24 offen offset:0
  v_mfma_f32_16x16x32_bf16 a[68:71], v[208:211], v[184:187], a[68:71]
  v_mfma_f32_16x16x32_bf16 a[72:75], v[208:211], v[188:191], a[72:75]
  v_mfma_f32_16x16x32_bf16 a[76:79], v[208:211], v[192:195], a[76:79]
  buffer_load_dwordx4 v[144:147], v6, s[8:11], s26 offen offset:0
  v_mfma_f32_16x16x32_bf16 a[80:83], v[212:215], v[176:179], a[80:83]
  v_mfma_f32_16x16x32_bf16 a[84:87], v[212:215], v[180:183], a[84:87]
  v_mfma_f32_16x16x32_bf16 a[88:91], v[212:215], v[184:187], a[88:91]
  buffer_load_dwordx4 v[148:151], v6, s[8:11], s27 offen offset:0
  v_mfma_f32_16x16x32_bf16 a[92:95], v[212:215], v[188:191], a[92:95]
  v_mfma_f32_16x16x32_bf16 a[96:99], v[212:215], v[192:195], a[96:99]
  v_mfma_f32_16x16x32_bf16 a[100:103], v[216:219], v[176:179], a[100:103]
  buffer_load_dwordx4 v[152:155], v6, s[8:11], s28 offen offset:0
  v_mfma_f32_16x16x32_bf16 a[104:107], v[216:219], v[180:183], a[104:107]
  v_mfma_f32_16x16x32_bf16 a[108:111], v[216:219], v[184:187], a[108:111]
  v_mfma_f32_16x16x32_bf16 a[112:115], v[216:219], v[188:191], a[112:115]
  buffer_load_dwordx4 v[156:159], v6, s[8:11], s29 offen offset:0
  v_mfma_f32_16x16x32_bf16 a[116:119], v[216:219], v[192:195], a[116:119]
  v_mfma_f32_16x16x32_bf16 a[120:123], v[220:223], v[176:179], a[120:123]
  v_mfma_f32_16x16x32_bf16 a[124:127], v[220:223], v[180:183], a[124:127]
  buffer_load_dwordx4 v[160:163], v6, s[8:11], s30 offen offset:0
  v_mfma_f32_16x16x32_bf16 a[128:131], v[220:223], v[184:187], a[128:131]
  v_mfma_f32_16x16x32_bf16 a[132:135], v[220:223], v[188:191], a[132:135]
  v_mfma_f32_16x16x32_bf16 a[136:139], v[220:223], v[192:195], a[136:139]
  buffer_load_dwordx4 v[164:167], v6, s[8:11], s31 offen offset:0
  v_mfma_f32_16x16x32_bf16 a[140:143], v[224:227], v[176:179], a[140:143]
  v_mfma_f32_16x16x32_bf16 a[144:147], v[224:227], v[180:183], a[144:147]
  v_mfma_f32_16x16x32_bf16 a[148:151], v[224:227], v[184:187], a[148:151]
  buffer_load_dwordx4 v[168:171], v6, s[8:11], s32 offen offset:0
  v_mfma_f32_16x16x32_bf16 a[152:155], v[224:227], v[188:191], a[152:155]
  v_mfma_f32_16x16x32_bf16 a[156:159], v[224:227], v[192:195], a[156:159]
  v_mfma_f32_16x16x32_bf16 a[160:163], v[228:231], v[176:179], a[160:163]
  buffer_load_dwordx4 v[172:175], v6, s[8:11], s33 offen offset:0
  v_mfma_f32_16x16x32_bf16 a[164:167], v[228:231], v[180:183], a[164:167]
  v_mfma_f32_16x16x32_bf16 a[168:171], v[228:231], v[184:187], a[168:171]
  v_mfma_f32_16x16x32_bf16 a[172:175], v[228:231], v[188:191], a[172:175]
  v_mfma_f32_16x16x32_bf16 a[176:179], v[228:231], v[192:195], a[176:179]
  s_waitcnt vmcnt(42)
  v_mfma_f32_16x16x32_bf16 a[0:3], a[200:203], a[180:183], a[0:3]
  v_mfma_f32_16x16x32_bf16 a[4:7], a[200:203], a[184:187], a[4:7]
  buffer_load_dwordx4 v[176:179], v6, s[8:11], s20 offen offset:1024
  v_mfma_f32_16x16x32_bf16 a[8:11], a[200:203], a[188:191], a[8:11]
  v_mfma_f32_16x16x32_bf16 a[12:15], a[200:203], a[192:195], a[12:15]
  v_mfma_f32_16x16x32_bf16 a[16:19], a[200:203], a[196:199], a[16:19]
  buffer_load_dwordx4 v[196:199], v6, s[8:11], s25 offen offset:1024
  v_mfma_f32_16x16x32_bf16 a[20:23], a[204:207], a[180:183], a[20:23]
  v_mfma_f32_16x16x32_bf16 a[24:27], a[204:207], a[184:187], a[24:27]
  v_mfma_f32_16x16x32_bf16 a[28:31], a[204:207], a[188:191], a[28:31]
  buffer_load_dwordx4 v[180:183], v6, s[8:11], s21 offen offset:1024
  v_mfma_f32_16x16x32_bf16 a[32:35], a[204:207], a[192:195], a[32:35]
  v_mfma_f32_16x16x32_bf16 a[36:39], a[204:207], a[196:199], a[36:39]
  v_mfma_f32_16x16x32_bf16 a[40:43], a[208:211], a[180:183], a[40:43]
  buffer_load_dwordx4 v[184:187], v6, s[8:11], s22 offen offset:1024
  v_mfma_f32_16x16x32_bf16 a[44:47], a[208:211], a[184:187], a[44:47]
  v_mfma_f32_16x16x32_bf16 a[48:51], a[208:211], a[188:191], a[48:51]
  v_mfma_f32_16x16x32_bf16 a[52:55], a[208:211], a[192:195], a[52:55]
  buffer_load_dwordx4 v[188:191], v6, s[8:11], s23 offen offset:1024
  v_mfma_f32_16x16x32_bf16 a[56:59], a[208:211], a[196:199], a[56:59]
  v_mfma_f32_16x16x32_bf16 a[60:63], a[212:215], a[180:183], a[60:63]
  v_mfma_f32_16x16x32_bf16 a[64:67], a[212:215], a[184:187], a[64:67]
  buffer_load_dwordx4 v[192:195], v6, s[8:11], s24 offen offset:1024
  v_mfma_f32_16x16x32_bf16 a[68:71], a[212:215], a[188:191], a[68:71]
  v_mfma_f32_16x16x32_bf16 a[72:75], a[212:215], a[192:195], a[72:75]
  v_mfma_f32_16x16x32_bf16 a[76:79], a[212:215], a[196:199], a[76:79]
  buffer_load_dwordx4 v[200:203], v6, s[8:11], s26 offen offset:1024
  v_mfma_f32_16x16x32_bf16 a[80:83], a[216:219], a[180:183], a[80:83]
  v_mfma_f32_16x16x32_bf16 a[84:87], a[216:219], a[184:187], a[84:87]
  v_mfma_f32_16x16x32_bf16 a[88:91], a[216:219], a[188:191], a[88:91]
  buffer_load_dwordx4 v[204:207], v6, s[8:11], s27 offen offset:1024
  v_mfma_f32_16x16x32_bf16 a[92:95], a[216:219], a[192:195], a[92:95]
  v_mfma_f32_16x16x32_bf16 a[96:99], a[216:219], a[196:199], a[96:99]
  v_mfma_f32_16x16x32_bf16 a[100:103], a[220:223], a[180:183], a[100:103]
  buffer_load_dwordx4 v[208:211], v6, s[8:11], s28 offen offset:1024
  v_mfma_f32_16x16x32_bf16 a[104:107], a[220:223], a[184:187], a[104:107]
  v_mfma_f32_16x16x32_bf16 a[108:111], a[220:223], a[188:191], a[108:111]
  v_mfma_f32_16x16x32_bf16 a[112:115], a[220:223], a[192:195], a[112:115]
  buffer_load_dwordx4 v[212:215], v6, s[8:11], s29 offen offset:1024
  v_mfma_f32_16x16x32_bf16 a[116:119], a[220:223], a[196:199], a[116:119]
  v_mfma_f32_16x16x32_bf16 a[120:123], a[224:227], a[180:183], a[120:123]
  v_mfma_f32_16x16x32_bf16 a[124:127], a[224:227], a[184:187], a[124:127]
  buffer_load_dwordx4 v[216:219], v6, s[8:11], s30 offen offset:1024
  v_mfma_f32_16x16x32_bf16 a[128:131], a[224:227], a[188:191], a[128:131]
  v_mfma_f32_16x16x32_bf16 a[132:135], a[224:227], a[192:195], a[132:135]
  v_mfma_f32_16x16x32_bf16 a[136:139], a[224:227], a[196:199], a[136:139]
  buffer_load_dwordx4 v[220:223], v6, s[8:11], s31 offen offset:1024
  v_mfma_f32_16x16x32_bf16 a[140:143], a[228:231], a[180:183], a[140:143]
  v_mfma_f32_16x16x32_bf16 a[144:147], a[228:231], a[184:187], a[144:147]
  v_mfma_f32_16x16x32_bf16 a[148:151], a[228:231], a[188:191], a[148:151]
  buffer_load_dwordx4 v[224:227], v6, s[8:11], s32 offen offset:1024
  v_mfma_f32_16x16x32_bf16 a[152:155], a[228:231], a[192:195], a[152:155]
  v_mfma_f32_16x16x32_bf16 a[156:159], a[228:231], a[196:199], a[156:159]
  v_mfma_f32_16x16x32_bf16 a[160:163], a[232:235], a[180:183], a[160:163]
  buffer_load_dwordx4 v[228:231], v6, s[8:11], s33 offen offset:1024
  v_mfma_f32_16x16x32_bf16 a[164:167], a[232:235], a[184:187], a[164:167]
  v_mfma_f32_16x16x32_bf16 a[168:171], a[232:235], a[188:191], a[168:171]
  v_mfma_f32_16x16x32_bf16 a[172:175], a[232:235], a[192:195], a[172:175]
  v_mfma_f32_16x16x32_bf16 a[176:179], a[232:235], a[196:199], a[176:179]
  s_waitcnt vmcnt(42)
  v_mfma_f32_16x16x32_bf16 a[0:3], v[28:31], v[8:11], a[0:3]
  v_mfma_f32_16x16x32_bf16 a[4:7], v[28:31], v[12:15], a[4:7]
  buffer_load_dwordx4 a[180:183], v6, s[8:11], s20 offen offset:2048
  v_mfma_f32_16x16x32_bf16 a[8:11], v[28:31], v[16:19], a[8:11]
  v_mfma_f32_16x16x32_bf16 a[12:15], v[28:31], v[20:23], a[12:15]
  v_mfma_f32_16x16x32_bf16 a[16:19], v[28:31], v[24:27], a[16:19]
  buffer_load_dwordx4 a[200:203], v6, s[8:11], s25 offen offset:2048
  v_mfma_f32_16x16x32_bf16 a[20:23], v[32:35], v[8:11], a[20:23]
  v_mfma_f32_16x16x32_bf16 a[24:27], v[32:35], v[12:15], a[24:27]
  v_mfma_f32_16x16x32_bf16 a[28:31], v[32:35], v[16:19], a[28:31]
  buffer_load_dwordx4 a[184:187], v6, s[8:11], s21 offen offset:2048
  v_mfma_f32_16x16x32_bf16 a[32:35], v[32:35], v[20:23], a[32:35]
  v_mfma_f32_16x16x32_bf16 a[36:39], v[32:35], v[24:27], a[36:39]
  v_mfma_f32_16x16x32_bf16 a[40:43], v[36:39], v[8:11], a[40:43]
  buffer_load_dwordx4 a[188:191], v6, s[8:11], s22 offen offset:2048
  v_mfma_f32_16x16x32_bf16 a[44:47], v[36:39], v[12:15], a[44:47]
  v_mfma_f32_16x16x32_bf16 a[48:51], v[36:39], v[16:19], a[48:51]
  v_mfma_f32_16x16x32_bf16 a[52:55], v[36:39], v[20:23], a[52:55]
  buffer_load_dwordx4 a[192:195], v6, s[8:11], s23 offen offset:2048
  v_mfma_f32_16x16x32_bf16 a[56:59], v[36:39], v[24:27], a[56:59]
  v_mfma_f32_16x16x32_bf16 a[60:63], v[40:43], v[8:11], a[60:63]
  v_mfma_f32_16x16x32_bf16 a[64:67], v[40:43], v[12:15], a[64:67]
  buffer_load_dwordx4 a[196:199], v6, s[8:11], s24 offen offset:2048
  v_mfma_f32_16x16x32_bf16 a[68:71], v[40:43], v[16:19], a[68:71]
  v_mfma_f32_16x16x32_bf16 a[72:75], v[40:43], v[20:23], a[72:75]
  v_mfma_f32_16x16x32_bf16 a[76:79], v[40:43], v[24:27], a[76:79]
  buffer_load_dwordx4 a[204:207], v6, s[8:11], s26 offen offset:2048
  v_mfma_f32_16x16x32_bf16 a[80:83], v[44:47], v[8:11], a[80:83]
  v_mfma_f32_16x16x32_bf16 a[84:87], v[44:47], v[12:15], a[84:87]
  v_mfma_f32_16x16x32_bf16 a[88:91], v[44:47], v[16:19], a[88:91]
  buffer_load_dwordx4 a[208:211], v6, s[8:11], s27 offen offset:2048
  v_mfma_f32_16x16x32_bf16 a[92:95], v[44:47], v[20:23], a[92:95]
  v_mfma_f32_16x16x32_bf16 a[96:99], v[44:47], v[24:27], a[96:99]
  v_mfma_f32_16x16x32_bf16 a[100:103], v[48:51], v[8:11], a[100:103]
  buffer_load_dwordx4 a[212:215], v6, s[8:11], s28 offen offset:2048
  v_mfma_f32_16x16x32_bf16 a[104:107], v[48:51], v[12:15], a[104:107]
  v_mfma_f32_16x16x32_bf16 a[108:111], v[48:51], v[16:19], a[108:111]
  v_mfma_f32_16x16x32_bf16 a[112:115], v[48:51], v[20:23], a[112:115]
  buffer_load_dwordx4 a[216:219], v6, s[8:11], s29 offen offset:2048
  v_mfma_f32_16x16x32_bf16 a[116:119], v[48:51], v[24:27], a[116:119]
  v_mfma_f32_16x16x32_bf16 a[120:123], v[52:55], v[8:11], a[120:123]
  v_mfma_f32_16x16x32_bf16 a[124:127], v[52:55], v[12:15], a[124:127]
  buffer_load_dwordx4 a[220:223], v6, s[8:11], s30 offen offset:2048
  v_mfma_f32_16x16x32_bf16 a[128:131], v[52:55], v[16:19], a[128:131]
  v_mfma_f32_16x16x32_bf16 a[132:135], v[52:55], v[20:23], a[132:135]
  v_mfma_f32_16x16x32_bf16 a[136:139], v[52:55], v[24:27], a[136:139]
  buffer_load_dwordx4 a[224:227], v6, s[8:11], s31 offen offset:2048
  v_mfma_f32_16x16x32_bf16 a[140:143], v[56:59], v[8:11], a[140:143]
  v_mfma_f32_16x16x32_bf16 a[144:147], v[56:59], v[12:15], a[144:147]
  v_mfma_f32_16x16x32_bf16 a[148:151], v[56:59], v[16:19], a[148:151]
  buffer_load_dwordx4 a[228:231], v6, s[8:11], s32 offen offset:2048
  v_mfma_f32_16x16x32_bf16 a[152:155], v[56:59], v[20:23], a[152:155]
  v_mfma_f32_16x16x32_bf16 a[156:159], v[56:59], v[24:27], a[156:159]
  v_mfma_f32_16x16x32_bf16 a[160:163], v[60:63], v[8:11], a[160:163]
  buffer_load_dwordx4 a[232:235], v6, s[8:11], s33 offen offset:2048
  v_mfma_f32_16x16x32_bf16 a[164:167], v[60:63], v[12:15], a[164:167]
  v_mfma_f32_16x16x32_bf16 a[168:171], v[60:63], v[16:19], a[168:171]
  v_mfma_f32_16x16x32_bf16 a[172:175], v[60:63], v[20:23], a[172:175]
  v_mfma_f32_16x16x32_bf16 a[176:179], v[60:63], v[24:27], a[176:179]
  s_waitcnt vmcnt(42)
  v_mfma_f32_16x16x32_bf16 a[0:3], v[84:87], v[64:67], a[0:3]
  v_mfma_f32_16x16x32_bf16 a[4:7], v[84:87], v[68:71], a[4:7]
  buffer_load_dwordx4 v[8:11], v6, s[8:11], s20 offen offset:3072
  v_mfma_f32_16x16x32_bf16 a[8:11], v[84:87], v[72:75], a[8:11]
  v_mfma_f32_16x16x32_bf16 a[12:15], v[84:87], v[76:79], a[12:15]
  v_mfma_f32_16x16x32_bf16 a[16:19], v[84:87], v[80:83], a[16:19]
  buffer_load_dwordx4 v[28:31], v6, s[8:11], s25 offen offset:3072
  v_mfma_f32_16x16x32_bf16 a[20:23], v[88:91], v[64:67], a[20:23]
  v_mfma_f32_16x16x32_bf16 a[24:27], v[88:91], v[68:71], a[24:27]
  v_mfma_f32_16x16x32_bf16 a[28:31], v[88:91], v[72:75], a[28:31]
  buffer_load_dwordx4 v[12:15], v6, s[8:11], s21 offen offset:3072
  v_mfma_f32_16x16x32_bf16 a[32:35], v[88:91], v[76:79], a[32:35]
  v_mfma_f32_16x16x32_bf16 a[36:39], v[88:91], v[80:83], a[36:39]
  v_mfma_f32_16x16x32_bf16 a[40:43], v[92:95], v[64:67], a[40:43]
  buffer_load_dwordx4 v[16:19], v6, s[8:11], s22 offen offset:3072
  v_mfma_f32_16x16x32_bf16 a[44:47], v[92:95], v[68:71], a[44:47]
  v_mfma_f32_16x16x32_bf16 a[48:51], v[92:95], v[72:75], a[48:51]
  v_mfma_f32_16x16x32_bf16 a[52:55], v[92:95], v[76:79], a[52:55]
  buffer_load_dwordx4 v[20:23], v6, s[8:11], s23 offen offset:3072
  v_mfma_f32_16x16x32_bf16 a[56:59], v[92:95], v[80:83], a[56:59]
  v_mfma_f32_16x16x32_bf16 a[60:63], v[96:99], v[64:67], a[60:63]
  v_mfma_f32_16x16x32_bf16 a[64:67], v[96:99], v[68:71], a[64:67]
  buffer_load_dwordx4 v[24:27], v6, s[8:11], s24 offen offset:3072
  v_mfma_f32_16x16x32_bf16 a[68:71], v[96:99], v[72:75], a[68:71]
  v_mfma_f32_16x16x32_bf16 a[72:75], v[96:99], v[76:79], a[72:75]
  v_mfma_f32_16x16x32_bf16 a[76:79], v[96:99], v[80:83], a[76:79]
  buffer_load_dwordx4 v[32:35], v6, s[8:11], s26 offen offset:3072
  v_mfma_f32_16x16x32_bf16 a[80:83], v[100:103], v[64:67], a[80:83]
  v_mfma_f32_16x16x32_bf16 a[84:87], v[100:103], v[68:71], a[84:87]
  v_mfma_f32_16x16x32_bf16 a[88:91], v[100:103], v[72:75], a[88:91]
  buffer_load_dwordx4 v[36:39], v6, s[8:11], s27 offen offset:3072
  v_mfma_f32_16x16x32_bf16 a[92:95], v[100:103], v[76:79], a[92:95]
  v_mfma_f32_16x16x32_bf16 a[96:99], v[100:103], v[80:83], a[96:99]
  v_mfma_f32_16x16x32_bf16 a[100:103], v[104:107], v[64:67], a[100:103]
  buffer_load_dwordx4 v[40:43], v6, s[8:11], s28 offen offset:3072
  v_mfma_f32_16x16x32_bf16 a[104:107], v[104:107], v[68:71], a[104:107]
  v_mfma_f32_16x16x32_bf16 a[108:111], v[104:107], v[72:75], a[108:111]
  v_mfma_f32_16x16x32_bf16 a[112:115], v[104:107], v[76:79], a[112:115]
  buffer_load_dwordx4 v[44:47], v6, s[8:11], s29 offen offset:3072
  v_mfma_f32_16x16x32_bf16 a[116:119], v[104:107], v[80:83], a[116:119]
  v_mfma_f32_16x16x32_bf16 a[120:123], v[108:111], v[64:67], a[120:123]
  v_mfma_f32_16x16x32_bf16 a[124:127], v[108:111], v[68:71], a[124:127]
  buffer_load_dwordx4 v[48:51], v6, s[8:11], s30 offen offset:3072
  v_mfma_f32_16x16x32_bf16 a[128:131], v[108:111], v[72:75], a[128:131]
  v_mfma_f32_16x16x32_bf16 a[132:135], v[108:111], v[76:79], a[132:135]
  v_mfma_f32_16x16x32_bf16 a[136:139], v[108:111], v[80:83], a[136:139]
  buffer_load_dwordx4 v[52:55], v6, s[8:11], s31 offen offset:3072
  v_mfma_f32_16x16x32_bf16 a[140:143], v[112:115], v[64:67], a[140:143]
  v_mfma_f32_16x16x32_bf16 a[144:147], v[112:115], v[68:71], a[144:147]
  v_mfma_f32_16x16x32_bf16 a[148:151], v[112:115], v[72:75], a[148:151]
  buffer_load_dwordx4 v[56:59], v6, s[8:11], s32 offen offset:3072
  v_mfma_f32_16x16x32_bf16 a[152:155], v[112:115], v[76:79], a[152:155]
  v_mfma_f32_16x16x32_bf16 a[156:159], v[112:115], v[80:83], a[156:159]
  v_mfma_f32_16x16x32_bf16 a[160:163], v[116:119], v[64:67], a[160:163]
  buffer_load_dwordx4 v[60:63], v6, s[8:11], s33 offen offset:3072
  v_mfma_f32_16x16x32_bf16 a[164:167], v[116:119], v[68:71], a[164:167]
  v_mfma_f32_16x16x32_bf16 a[168:171], v[116:119], v[72:75], a[168:171]
  v_mfma_f32_16x16x32_bf16 a[172:175], v[116:119], v[76:79], a[172:175]
  v_mfma_f32_16x16x32_bf16 a[176:179], v[116:119], v[80:83], a[176:179]
  s_waitcnt vmcnt(42)
  v_mfma_f32_16x16x32_bf16 a[0:3], v[140:143], v[120:123], a[0:3]
  v_mfma_f32_16x16x32_bf16 a[4:7], v[140:143], v[124:127], a[4:7]
  buffer_load_dwordx4 v[64:67], v7, s[8:11], s20 offen offset:0
  v_mfma_f32_16x16x32_bf16 a[8:11], v[140:143], v[128:131], a[8:11]
  v_mfma_f32_16x16x32_bf16 a[12:15], v[140:143], v[132:135], a[12:15]
  v_mfma_f32_16x16x32_bf16 a[16:19], v[140:143], v[136:139], a[16:19]
  buffer_load_dwordx4 v[84:87], v7, s[8:11], s25 offen offset:0
  v_mfma_f32_16x16x32_bf16 a[20:23], v[144:147], v[120:123], a[20:23]
  v_mfma_f32_16x16x32_bf16 a[24:27], v[144:147], v[124:127], a[24:27]
  v_mfma_f32_16x16x32_bf16 a[28:31], v[144:147], v[128:131], a[28:31]
  buffer_load_dwordx4 v[68:71], v7, s[8:11], s21 offen offset:0
  v_mfma_f32_16x16x32_bf16 a[32:35], v[144:147], v[132:135], a[32:35]
  v_mfma_f32_16x16x32_bf16 a[36:39], v[144:147], v[136:139], a[36:39]
  v_mfma_f32_16x16x32_bf16 a[40:43], v[148:151], v[120:123], a[40:43]
  buffer_load_dwordx4 v[72:75], v7, s[8:11], s22 offen offset:0
  v_mfma_f32_16x16x32_bf16 a[44:47], v[148:151], v[124:127], a[44:47]
  v_mfma_f32_16x16x32_bf16 a[48:51], v[148:151], v[128:131], a[48:51]
  v_mfma_f32_16x16x32_bf16 a[52:55], v[148:151], v[132:135], a[52:55]
  buffer_load_dwordx4 v[76:79], v7, s[8:11], s23 offen offset:0
  v_mfma_f32_16x16x32_bf16 a[56:59], v[148:151], v[136:139], a[56:59]
  v_mfma_f32_16x16x32_bf16 a[60:63], v[152:155], v[120:123], a[60:63]
  v_mfma_f32_16x16x32_bf16 a[64:67], v[152:155], v[124:127], a[64:67]
  buffer_load_dwordx4 v[80:83], v7, s[8:11], s24 offen offset:0
  v_mfma_f32_16x16x32_bf16 a[68:71], v[152:155], v[128:131], a[68:71]
  v_mfma_f32_16x16x32_bf16 a[72:75], v[152:155], v[132:135], a[72:75]
  v_mfma_f32_16x16x32_bf16 a[76:79], v[152:155], v[136:139], a[76:79]
  buffer_load_dwordx4 v[88:91], v7, s[8:11], s26 offen offset:0
  v_mfma_f32_16x16x32_bf16 a[80:83], v[156:159], v[120:123], a[80:83]
  v_mfma_f32_16x16x32_bf16 a[84:87], v[156:159], v[124:127], a[84:87]
  v_mfma_f32_16x16x32_bf16 a[88:91], v[156:159], v[128:131], a[88:91]
  buffer_load_dwordx4 v[92:95], v7, s[8:11], s27 offen offset:0
  v_mfma_f32_16x16x32_bf16 a[92:95], v[156:159], v[132:135], a[92:95]
  v_mfma_f32_16x16x32_bf16 a[96:99], v[156:159], v[136:139], a[96:99]
  v_mfma_f32_16x16x32_bf16 a[100:103], v[160:163], v[120:123], a[100:103]
  buffer_load_dwordx4 v[96:99], v7, s[8:11], s28 offen offset:0
  v_mfma_f32_16x16x32_bf16 a[104:107], v[160:163], v[124:127], a[104:107]
  v_mfma_f32_16x16x32_bf16 a[108:111], v[160:163], v[128:131], a[108:111]
  v_mfma_f32_16x16x32_bf16 a[112:115], v[160:163], v[132:135], a[112:115]
  buffer_load_dwordx4 v[100:103], v7, s[8:11], s29 offen offset:0
  v_mfma_f32_16x16x32_bf16 a[116:119], v[160:163], v[136:139], a[116:119]
  v_mfma_f32_16x16x32_bf16 a[120:123], v[164:167], v[120:123], a[120:123]
  v_mfma_f32_16x16x32_bf16 a[124:127], v[164:167], v[124:127], a[124:127]
  buffer_load_dwordx4 v[104:107], v7, s[8:11], s30 offen offset:0
  v_mfma_f32_16x16x32_bf16 a[128:131], v[164:167], v[128:131], a[128:131]
  v_mfma_f32_16x16x32_bf16 a[132:135], v[164:167], v[132:135], a[132:135]
  v_mfma_f32_16x16x32_bf16 a[136:139], v[164:167], v[136:139], a[136:139]
  buffer_load_dwordx4 v[108:111], v7, s[8:11], s31 offen offset:0
  v_mfma_f32_16x16x32_bf16 a[140:143], v[168:171], v[120:123], a[140:143]
  v_mfma_f32_16x16x32_bf16 a[144:147], v[168:171], v[124:127], a[144:147]
  v_mfma_f32_16x16x32_bf16 a[148:151], v[168:171], v[128:131], a[148:151]
  buffer_load_dwordx4 v[112:115], v7, s[8:11], s32 offen offset:0
  v_mfma_f32_16x16x32_bf16 a[152:155], v[168:171], v[132:135], a[152:155]
  v_mfma_f32_16x16x32_bf16 a[156:159], v[168:171], v[136:139], a[156:159]
  v_mfma_f32_16x16x32_bf16 a[160:163], v[172:175], v[120:123], a[160:163]
  buffer_load_dwordx4 v[116:119], v7, s[8:11], s33 offen offset:0
  v_mfma_f32_16x16x32_bf16 a[164:167], v[172:175], v[124:127], a[164:167]
  v_mfma_f32_16x16x32_bf16 a[168:171], v[172:175], v[128:131], a[168:171]
  v_mfma_f32_16x16x32_bf16 a[172:175], v[172:175], v[132:135], a[172:175]
  v_mfma_f32_16x16x32_bf16 a[176:179], v[172:175], v[136:139], a[176:179]
  s_waitcnt vmcnt(42)
  v_mfma_f32_16x16x32_bf16 a[0:3], v[196:199], v[176:179], a[0:3]
  v_mfma_f32_16x16x32_bf16 a[4:7], v[196:199], v[180:183], a[4:7]
  buffer_load_dwordx4 v[120:123], v7, s[8:11], s20 offen offset:1024
  v_mfma_f32_16x16x32_bf16 a[8:11], v[196:199], v[184:187], a[8:11]
  v_mfma_f32_16x16x32_bf16 a[12:15], v[196:199], v[188:191], a[12:15]
  v_mfma_f32_16x16x32_bf16 a[16:19], v[196:199], v[192:195], a[16:19]
  buffer_load_dwordx4 v[140:143], v7, s[8:11], s25 offen offset:1024
  v_mfma_f32_16x16x32_bf16 a[20:23], v[200:203], v[176:179], a[20:23]
  v_mfma_f32_16x16x32_bf16 a[24:27], v[200:203], v[180:183], a[24:27]
  v_mfma_f32_16x16x32_bf16 a[28:31], v[200:203], v[184:187], a[28:31]
  buffer_load_dwordx4 v[124:127], v7, s[8:11], s21 offen offset:1024
  v_mfma_f32_16x16x32_bf16 a[32:35], v[200:203], v[188:191], a[32:35]
  v_mfma_f32_16x16x32_bf16 a[36:39], v[200:203], v[192:195], a[36:39]
  v_mfma_f32_16x16x32_bf16 a[40:43], v[204:207], v[176:179], a[40:43]
  buffer_load_dwordx4 v[128:131], v7, s[8:11], s22 offen offset:1024
  v_mfma_f32_16x16x32_bf16 a[44:47], v[204:207], v[180:183], a[44:47]
  v_mfma_f32_16x16x32_bf16 a[48:51], v[204:207], v[184:187], a[48:51]
  v_mfma_f32_16x16x32_bf16 a[52:55], v[204:207], v[188:191], a[52:55]
  buffer_load_dwordx4 v[132:135], v7, s[8:11], s23 offen offset:1024
  v_mfma_f32_16x16x32_bf16 a[56:59], v[204:207], v[192:195], a[56:59]
  v_mfma_f32_16x16x32_bf16 a[60:63], v[208:211], v[176:179], a[60:63]
  v_mfma_f32_16x16x32_bf16 a[64:67], v[208:211], v[180:183], a[64:67]
  buffer_load_dwordx4 v[136:139], v7, s[8:11], s24 offen offset:1024
  v_mfma_f32_16x16x32_bf16 a[68:71], v[208:211], v[184:187], a[68:71]
  v_mfma_f32_16x16x32_bf16 a[72:75], v[208:211], v[188:191], a[72:75]
  v_mfma_f32_16x16x32_bf16 a[76:79], v[208:211], v[192:195], a[76:79]
  buffer_load_dwordx4 v[144:147], v7, s[8:11], s26 offen offset:1024
  v_mfma_f32_16x16x32_bf16 a[80:83], v[212:215], v[176:179], a[80:83]
  v_mfma_f32_16x16x32_bf16 a[84:87], v[212:215], v[180:183], a[84:87]
  v_mfma_f32_16x16x32_bf16 a[88:91], v[212:215], v[184:187], a[88:91]
  buffer_load_dwordx4 v[148:151], v7, s[8:11], s27 offen offset:1024
  v_mfma_f32_16x16x32_bf16 a[92:95], v[212:215], v[188:191], a[92:95]
  v_mfma_f32_16x16x32_bf16 a[96:99], v[212:215], v[192:195], a[96:99]
  v_mfma_f32_16x16x32_bf16 a[100:103], v[216:219], v[176:179], a[100:103]
  buffer_load_dwordx4 v[152:155], v7, s[8:11], s28 offen offset:1024
  v_mfma_f32_16x16x32_bf16 a[104:107], v[216:219], v[180:183], a[104:107]
  v_mfma_f32_16x16x32_bf16 a[108:111], v[216:219], v[184:187], a[108:111]
  v_mfma_f32_16x16x32_bf16 a[112:115], v[216:219], v[188:191], a[112:115]
  buffer_load_dwordx4 v[156:159], v7, s[8:11], s29 offen offset:1024
  v_mfma_f32_16x16x32_bf16 a[116:119], v[216:219], v[192:195], a[116:119]
  v_mfma_f32_16x16x32_bf16 a[120:123], v[220:223], v[176:179], a[120:123]
  v_mfma_f32_16x16x32_bf16 a[124:127], v[220:223], v[180:183], a[124:127]
  buffer_load_dwordx4 v[160:163], v7, s[8:11], s30 offen offset:1024
  v_mfma_f32_16x16x32_bf16 a[128:131], v[220:223], v[184:187], a[128:131]
  v_mfma_f32_16x16x32_bf16 a[132:135], v[220:223], v[188:191], a[132:135]
  v_mfma_f32_16x16x32_bf16 a[136:139], v[220:223], v[192:195], a[136:139]
  buffer_load_dwordx4 v[164:167], v7, s[8:11], s31 offen offset:1024
  v_mfma_f32_16x16x32_bf16 a[140:143], v[224:227], v[176:179], a[140:143]
  v_mfma_f32_16x16x32_bf16 a[144:147], v[224:227], v[180:183], a[144:147]
  v_mfma_f32_16x16x32_bf16 a[148:151], v[224:227], v[184:187], a[148:151]
  buffer_load_dwordx4 v[168:171], v7, s[8:11], s32 offen offset:1024
  v_mfma_f32_16x16x32_bf16 a[152:155], v[224:227], v[188:191], a[152:155]
  v_mfma_f32_16x16x32_bf16 a[156:159], v[224:227], v[192:195], a[156:159]
  v_mfma_f32_16x16x32_bf16 a[160:163], v[228:231], v[176:179], a[160:163]
  buffer_load_dwordx4 v[172:175], v7, s[8:11], s33 offen offset:1024
  v_mfma_f32_16x16x32_bf16 a[164:167], v[228:231], v[180:183], a[164:167]
  v_mfma_f32_16x16x32_bf16 a[168:171], v[228:231], v[184:187], a[168:171]
  v_mfma_f32_16x16x32_bf16 a[172:175], v[228:231], v[188:191], a[172:175]
  v_mfma_f32_16x16x32_bf16 a[176:179], v[228:231], v[192:195], a[176:179]
  s_waitcnt vmcnt(42)
  v_mfma_f32_16x16x32_bf16 a[0:3], a[200:203], a[180:183], a[0:3]
  v_mfma_f32_16x16x32_bf16 a[4:7], a[200:203], a[184:187], a[4:7]
  buffer_load_dwordx4 v[176:179], v7, s[8:11], s20 offen offset:2048
  v_mfma_f32_16x16x32_bf16 a[8:11], a[200:203], a[188:191], a[8:11]
  v_mfma_f32_16x16x32_bf16 a[12:15], a[200:203], a[192:195], a[12:15]
  v_mfma_f32_16x16x32_bf16 a[16:19], a[200:203], a[196:199], a[16:19]
  buffer_load_dwordx4 v[196:199], v7, s[8:11], s25 offen offset:2048
  v_mfma_f32_16x16x32_bf16 a[20:23], a[204:207], a[180:183], a[20:23]
  v_mfma_f32_16x16x32_bf16 a[24:27], a[204:207], a[184:187], a[24:27]
  v_mfma_f32_16x16x32_bf16 a[28:31], a[204:207], a[188:191], a[28:31]
  buffer_load_dwordx4 v[180:183], v7, s[8:11], s21 offen offset:2048
  v_mfma_f32_16x16x32_bf16 a[32:35], a[204:207], a[192:195], a[32:35]
  v_mfma_f32_16x16x32_bf16 a[36:39], a[204:207], a[196:199], a[36:39]
  v_mfma_f32_16x16x32_bf16 a[40:43], a[208:211], a[180:183], a[40:43]
  buffer_load_dwordx4 v[184:187], v7, s[8:11], s22 offen offset:2048
  v_mfma_f32_16x16x32_bf16 a[44:47], a[208:211], a[184:187], a[44:47]
  v_mfma_f32_16x16x32_bf16 a[48:51], a[208:211], a[188:191], a[48:51]
  v_mfma_f32_16x16x32_bf16 a[52:55], a[208:211], a[192:195], a[52:55]
  buffer_load_dwordx4 v[188:191], v7, s[8:11], s23 offen offset:2048
  v_mfma_f32_16x16x32_bf16 a[56:59], a[208:211], a[196:199], a[56:59]
  v_mfma_f32_16x16x32_bf16 a[60:63], a[212:215], a[180:183], a[60:63]
  v_mfma_f32_16x16x32_bf16 a[64:67], a[212:215], a[184:187], a[64:67]
  buffer_load_dwordx4 v[192:195], v7, s[8:11], s24 offen offset:2048
  v_mfma_f32_16x16x32_bf16 a[68:71], a[212:215], a[188:191], a[68:71]
  v_mfma_f32_16x16x32_bf16 a[72:75], a[212:215], a[192:195], a[72:75]
  v_mfma_f32_16x16x32_bf16 a[76:79], a[212:215], a[196:199], a[76:79]
  buffer_load_dwordx4 v[200:203], v7, s[8:11], s26 offen offset:2048
  v_mfma_f32_16x16x32_bf16 a[80:83], a[216:219], a[180:183], a[80:83]
  v_mfma_f32_16x16x32_bf16 a[84:87], a[216:219], a[184:187], a[84:87]
  v_mfma_f32_16x16x32_bf16 a[88:91], a[216:219], a[188:191], a[88:91]
  buffer_load_dwordx4 v[204:207], v7, s[8:11], s27 offen offset:2048
  v_mfma_f32_16x16x32_bf16 a[92:95], a[216:219], a[192:195], a[92:95]
  v_mfma_f32_16x16x32_bf16 a[96:99], a[216:219], a[196:199], a[96:99]
  v_mfma_f32_16x16x32_bf16 a[100:103], a[220:223], a[180:183], a[100:103]
  buffer_load_dwordx4 v[208:211], v7, s[8:11], s28 offen offset:2048
  v_mfma_f32_16x16x32_bf16 a[104:107], a[220:223], a[184:187], a[104:107]
  v_mfma_f32_16x16x32_bf16 a[108:111], a[220:223], a[188:191], a[108:111]
  v_mfma_f32_16x16x32_bf16 a[112:115], a[220:223], a[192:195], a[112:115]
  buffer_load_dwordx4 v[212:215], v7, s[8:11], s29 offen offset:2048
  v_mfma_f32_16x16x32_bf16 a[116:119], a[220:223], a[196:199], a[116:119]
  v_mfma_f32_16x16x32_bf16 a[120:123], a[224:227], a[180:183], a[120:123]
  v_mfma_f32_16x16x32_bf16 a[124:127], a[224:227], a[184:187], a[124:127]
  buffer_load_dwordx4 v[216:219], v7, s[8:11], s30 offen offset:2048
  v_mfma_f32_16x16x32_bf16 a[128:131], a[224:227], a[188:191], a[128:131]
  v_mfma_f32_16x16x32_bf16 a[132:135], a[224:227], a[192:195], a[132:135]
  v_mfma_f32_16x16x32_bf16 a[136:139], a[224:227], a[196:199], a[136:139]
  buffer_load_dwordx4 v[220:223], v7, s[8:11], s31 offen offset:2048
  v_mfma_f32_16x16x32_bf16 a[140:143], a[228:231], a[180:183], a[140:143]
  v_mfma_f32_16x16x32_bf16 a[144:147], a[228:231], a[184:187], a[144:147]
  v_mfma_f32_16x16x32_bf16 a[148:151], a[228:231], a[188:191], a[148:151]
  buffer_load_dwordx4 v[224:227], v7, s[8:11], s32 offen offset:2048
  v_mfma_f32_16x16x32_bf16 a[152:155], a[228:231], a[192:195], a[152:155]
  v_mfma_f32_16x16x32_bf16 a[156:159], a[228:231], a[196:199], a[156:159]
  v_mfma_f32_16x16x32_bf16 a[160:163], a[232:235], a[180:183], a[160:163]
  buffer_load_dwordx4 v[228:231], v7, s[8:11], s33 offen offset:2048
  v_mfma_f32_16x16x32_bf16 a[164:167], a[232:235], a[184:187], a[164:167]
  v_mfma_f32_16x16x32_bf16 a[168:171], a[232:235], a[188:191], a[168:171]
  v_mfma_f32_16x16x32_bf16 a[172:175], a[232:235], a[192:195], a[172:175]
  v_mfma_f32_16x16x32_bf16 a[176:179], a[232:235], a[196:199], a[176:179]
  s_waitcnt vmcnt(42)
  v_mfma_f32_16x16x32_bf16 a[0:3], v[28:31], v[8:11], a[0:3]
  v_mfma_f32_16x16x32_bf16 a[4:7], v[28:31], v[12:15], a[4:7]
  buffer_load_dwordx4 a[180:183], v7, s[8:11], s20 offen offset:3072
  v_mfma_f32_16x16x32_bf16 a[8:11], v[28:31], v[16:19], a[8:11]
  v_mfma_f32_16x16x32_bf16 a[12:15], v[28:31], v[20:23], a[12:15]
  v_mfma_f32_16x16x32_bf16 a[16:19], v[28:31], v[24:27], a[16:19]
  buffer_load_dwordx4 a[200:203], v7, s[8:11], s25 offen offset:3072
  v_mfma_f32_16x16x32_bf16 a[20:23], v[32:35], v[8:11], a[20:23]
  v_mfma_f32_16x16x32_bf16 a[24:27], v[32:35], v[12:15], a[24:27]
  v_mfma_f32_16x16x32_bf16 a[28:31], v[32:35], v[16:19], a[28:31]
  buffer_load_dwordx4 a[184:187], v7, s[8:11], s21 offen offset:3072
  v_mfma_f32_16x16x32_bf16 a[32:35], v[32:35], v[20:23], a[32:35]
  v_mfma_f32_16x16x32_bf16 a[36:39], v[32:35], v[24:27], a[36:39]
  v_mfma_f32_16x16x32_bf16 a[40:43], v[36:39], v[8:11], a[40:43]
  buffer_load_dwordx4 a[188:191], v7, s[8:11], s22 offen offset:3072
  v_mfma_f32_16x16x32_bf16 a[44:47], v[36:39], v[12:15], a[44:47]
  v_mfma_f32_16x16x32_bf16 a[48:51], v[36:39], v[16:19], a[48:51]
  v_mfma_f32_16x16x32_bf16 a[52:55], v[36:39], v[20:23], a[52:55]
  buffer_load_dwordx4 a[192:195], v7, s[8:11], s23 offen offset:3072
  v_mfma_f32_16x16x32_bf16 a[56:59], v[36:39], v[24:27], a[56:59]
  v_mfma_f32_16x16x32_bf16 a[60:63], v[40:43], v[8:11], a[60:63]
  v_mfma_f32_16x16x32_bf16 a[64:67], v[40:43], v[12:15], a[64:67]
  buffer_load_dwordx4 a[196:199], v7, s[8:11], s24 offen offset:3072
  v_mfma_f32_16x16x32_bf16 a[68:71], v[40:43], v[16:19], a[68:71]
  v_mfma_f32_16x16x32_bf16 a[72:75], v[40:43], v[20:23], a[72:75]
  v_mfma_f32_16x16x32_bf16 a[76:79], v[40:43], v[24:27], a[76:79]
  buffer_load_dwordx4 a[204:207], v7, s[8:11], s26 offen offset:3072
  v_mfma_f32_16x16x32_bf16 a[80:83], v[44:47], v[8:11], a[80:83]
  v_mfma_f32_16x16x32_bf16 a[84:87], v[44:47], v[12:15], a[84:87]
  v_mfma_f32_16x16x32_bf16 a[88:91], v[44:47], v[16:19], a[88:91]
  buffer_load_dwordx4 a[208:211], v7, s[8:11], s27 offen offset:3072
  v_mfma_f32_16x16x32_bf16 a[92:95], v[44:47], v[20:23], a[92:95]
  v_mfma_f32_16x16x32_bf16 a[96:99], v[44:47], v[24:27], a[96:99]
  v_mfma_f32_16x16x32_bf16 a[100:103], v[48:51], v[8:11], a[100:103]
  buffer_load_dwordx4 a[212:215], v7, s[8:11], s28 offen offset:3072
  v_mfma_f32_16x16x32_bf16 a[104:107], v[48:51], v[12:15], a[104:107]
  v_mfma_f32_16x16x32_bf16 a[108:111], v[48:51], v[16:19], a[108:111]
  v_mfma_f32_16x16x32_bf16 a[112:115], v[48:51], v[20:23], a[112:115]
  buffer_load_dwordx4 a[216:219], v7, s[8:11], s29 offen offset:3072
  v_mfma_f32_16x16x32_bf16 a[116:119], v[48:51], v[24:27], a[116:119]
  v_mfma_f32_16x16x32_bf16 a[120:123], v[52:55], v[8:11], a[120:123]
  v_mfma_f32_16x16x32_bf16 a[124:127], v[52:55], v[12:15], a[124:127]
  buffer_load_dwordx4 a[220:223], v7, s[8:11], s30 offen offset:3072
  v_mfma_f32_16x16x32_bf16 a[128:131], v[52:55], v[16:19], a[128:131]
  v_mfma_f32_16x16x32_bf16 a[132:135], v[52:55], v[20:23], a[132:135]
  v_mfma_f32_16x16x32_bf16 a[136:139], v[52:55], v[24:27], a[136:139]
  buffer_load_dwordx4 a[224:227], v7, s[8:11], s31 offen offset:3072
  v_mfma_f32_16x16x32_bf16 a[140:143], v[56:59], v[8:11], a[140:143]
  v_mfma_f32_16x16x32_bf16 a[144:147], v[56:59], v[12:15], a[144:147]
  v_mfma_f32_16x16x32_bf16 a[148:151], v[56:59], v[16:19], a[148:151]
  buffer_load_dwordx4 a[228:231], v7, s[8:11], s32 offen offset:3072
  v_mfma_f32_16x16x32_bf16 a[152:155], v[56:59], v[20:23], a[152:155]
  v_mfma_f32_16x16x32_bf16 a[156:159], v[56:59], v[24:27], a[156:159]
  v_mfma_f32_16x16x32_bf16 a[160:163], v[60:63], v[8:11], a[160:163]
  buffer_load_dwordx4 a[232:235], v7, s[8:11], s33 offen offset:3072
  v_mfma_f32_16x16x32_bf16 a[164:167], v[60:63], v[12:15], a[164:167]
  v_mfma_f32_16x16x32_bf16 a[168:171], v[60:63], v[16:19], a[168:171]
  v_mfma_f32_16x16x32_bf16 a[172:175], v[60:63], v[20:23], a[172:175]
  v_mfma_f32_16x16x32_bf16 a[176:179], v[60:63], v[24:27], a[176:179]
  s_waitcnt vmcnt(42)
  v_mfma_f32_16x16x32_bf16 a[0:3], v[84:87], v[64:67], a[0:3]
  v_mfma_f32_16x16x32_bf16 a[4:7], v[84:87], v[68:71], a[4:7]
  buffer_load_dwordx4 v[8:11], v232, s[8:11], s20 offen offset:0
  v_mfma_f32_16x16x32_bf16 a[8:11], v[84:87], v[72:75], a[8:11]
  v_mfma_f32_16x16x32_bf16 a[12:15], v[84:87], v[76:79], a[12:15]
  v_mfma_f32_16x16x32_bf16 a[16:19], v[84:87], v[80:83], a[16:19]
  buffer_load_dwordx4 v[28:31], v232, s[8:11], s25 offen offset:0
  v_mfma_f32_16x16x32_bf16 a[20:23], v[88:91], v[64:67], a[20:23]
  v_mfma_f32_16x16x32_bf16 a[24:27], v[88:91], v[68:71], a[24:27]
  v_mfma_f32_16x16x32_bf16 a[28:31], v[88:91], v[72:75], a[28:31]
  buffer_load_dwordx4 v[12:15], v232, s[8:11], s21 offen offset:0
  v_mfma_f32_16x16x32_bf16 a[32:35], v[88:91], v[76:79], a[32:35]
  v_mfma_f32_16x16x32_bf16 a[36:39], v[88:91], v[80:83], a[36:39]
  v_mfma_f32_16x16x32_bf16 a[40:43], v[92:95], v[64:67], a[40:43]
  buffer_load_dwordx4 v[16:19], v232, s[8:11], s22 offen offset:0
  v_mfma_f32_16x16x32_bf16 a[44:47], v[92:95], v[68:71], a[44:47]
  v_mfma_f32_16x16x32_bf16 a[48:51], v[92:95], v[72:75], a[48:51]
  v_mfma_f32_16x16x32_bf16 a[52:55], v[92:95], v[76:79], a[52:55]
  buffer_load_dwordx4 v[20:23], v232, s[8:11], s23 offen offset:0
  v_mfma_f32_16x16x32_bf16 a[56:59], v[92:95], v[80:83], a[56:59]
  v_mfma_f32_16x16x32_bf16 a[60:63], v[96:99], v[64:67], a[60:63]
  v_mfma_f32_16x16x32_bf16 a[64:67], v[96:99], v[68:71], a[64:67]
  buffer_load_dwordx4 v[24:27], v232, s[8:11], s24 offen offset:0
  v_mfma_f32_16x16x32_bf16 a[68:71], v[96:99], v[72:75], a[68:71]
  v_mfma_f32_16x16x32_bf16 a[72:75], v[96:99], v[76:79], a[72:75]
  v_mfma_f32_16x16x32_bf16 a[76:79], v[96:99], v[80:83], a[76:79]
  buffer_load_dwordx4 v[32:35], v232, s[8:11], s26 offen offset:0
  v_mfma_f32_16x16x32_bf16 a[80:83], v[100:103], v[64:67], a[80:83]
  v_mfma_f32_16x16x32_bf16 a[84:87], v[100:103], v[68:71], a[84:87]
  v_mfma_f32_16x16x32_bf16 a[88:91], v[100:103], v[72:75], a[88:91]
  buffer_load_dwordx4 v[36:39], v232, s[8:11], s27 offen offset:0
  v_mfma_f32_16x16x32_bf16 a[92:95], v[100:103], v[76:79], a[92:95]
  v_mfma_f32_16x16x32_bf16 a[96:99], v[100:103], v[80:83], a[96:99]
  v_mfma_f32_16x16x32_bf16 a[100:103], v[104:107], v[64:67], a[100:103]
  buffer_load_dwordx4 v[40:43], v232, s[8:11], s28 offen offset:0
  v_mfma_f32_16x16x32_bf16 a[104:107], v[104:107], v[68:71], a[104:107]
  v_mfma_f32_16x16x32_bf16 a[108:111], v[104:107], v[72:75], a[108:111]
  v_mfma_f32_16x16x32_bf16 a[112:115], v[104:107], v[76:79], a[112:115]
  buffer_load_dwordx4 v[44:47], v232, s[8:11], s29 offen offset:0
  v_mfma_f32_16x16x32_bf16 a[116:119], v[104:107], v[80:83], a[116:119]
  v_mfma_f32_16x16x32_bf16 a[120:123], v[108:111], v[64:67], a[120:123]
  v_mfma_f32_16x16x32_bf16 a[124:127], v[108:111], v[68:71], a[124:127]
  buffer_load_dwordx4 v[48:51], v232, s[8:11], s30 offen offset:0
  v_mfma_f32_16x16x32_bf16 a[128:131], v[108:111], v[72:75], a[128:131]
  v_mfma_f32_16x16x32_bf16 a[132:135], v[108:111], v[76:79], a[132:135]
  v_mfma_f32_16x16x32_bf16 a[136:139], v[108:111], v[80:83], a[136:139]
  buffer_load_dwordx4 v[52:55], v232, s[8:11], s31 offen offset:0
  v_mfma_f32_16x16x32_bf16 a[140:143], v[112:115], v[64:67], a[140:143]
  v_mfma_f32_16x16x32_bf16 a[144:147], v[112:115], v[68:71], a[144:147]
  v_mfma_f32_16x16x32_bf16 a[148:151], v[112:115], v[72:75], a[148:151]
  buffer_load_dwordx4 v[56:59], v232, s[8:11], s32 offen offset:0
  v_mfma_f32_16x16x32_bf16 a[152:155], v[112:115], v[76:79], a[152:155]
  v_mfma_f32_16x16x32_bf16 a[156:159], v[112:115], v[80:83], a[156:159]
  v_mfma_f32_16x16x32_bf16 a[160:163], v[116:119], v[64:67], a[160:163]
  buffer_load_dwordx4 v[60:63], v232, s[8:11], s33 offen offset:0
  v_mfma_f32_16x16x32_bf16 a[164:167], v[116:119], v[68:71], a[164:167]
  v_mfma_f32_16x16x32_bf16 a[168:171], v[116:119], v[72:75], a[168:171]
  v_mfma_f32_16x16x32_bf16 a[172:175], v[116:119], v[76:79], a[172:175]
  v_mfma_f32_16x16x32_bf16 a[176:179], v[116:119], v[80:83], a[176:179]
  s_waitcnt vmcnt(42)
  v_mfma_f32_16x16x32_bf16 a[0:3], v[140:143], v[120:123], a[0:3]
  v_mfma_f32_16x16x32_bf16 a[4:7], v[140:143], v[124:127], a[4:7]
  buffer_load_dwordx4 v[64:67], v232, s[8:11], s20 offen offset:1024
  v_mfma_f32_16x16x32_bf16 a[8:11], v[140:143], v[128:131], a[8:11]
  v_mfma_f32_16x16x32_bf16 a[12:15], v[140:143], v[132:135], a[12:15]
  v_mfma_f32_16x16x32_bf16 a[16:19], v[140:143], v[136:139], a[16:19]
  buffer_load_dwordx4 v[84:87], v232, s[8:11], s25 offen offset:1024
  v_mfma_f32_16x16x32_bf16 a[20:23], v[144:147], v[120:123], a[20:23]
  v_mfma_f32_16x16x32_bf16 a[24:27], v[144:147], v[124:127], a[24:27]
  v_mfma_f32_16x16x32_bf16 a[28:31], v[144:147], v[128:131], a[28:31]
  buffer_load_dwordx4 v[68:71], v232, s[8:11], s21 offen offset:1024
  v_mfma_f32_16x16x32_bf16 a[32:35], v[144:147], v[132:135], a[32:35]
  v_mfma_f32_16x16x32_bf16 a[36:39], v[144:147], v[136:139], a[36:39]
  v_mfma_f32_16x16x32_bf16 a[40:43], v[148:151], v[120:123], a[40:43]
  buffer_load_dwordx4 v[72:75], v232, s[8:11], s22 offen offset:1024
  v_mfma_f32_16x16x32_bf16 a[44:47], v[148:151], v[124:127], a[44:47]
  v_mfma_f32_16x16x32_bf16 a[48:51], v[148:151], v[128:131], a[48:51]
  v_mfma_f32_16x16x32_bf16 a[52:55], v[148:151], v[132:135], a[52:55]
  buffer_load_dwordx4 v[76:79], v232, s[8:11], s23 offen offset:1024
  v_mfma_f32_16x16x32_bf16 a[56:59], v[148:151], v[136:139], a[56:59]
  v_mfma_f32_16x16x32_bf16 a[60:63], v[152:155], v[120:123], a[60:63]
  v_mfma_f32_16x16x32_bf16 a[64:67], v[152:155], v[124:127], a[64:67]
  buffer_load_dwordx4 v[80:83], v232, s[8:11], s24 offen offset:1024
  v_mfma_f32_16x16x32_bf16 a[68:71], v[152:155], v[128:131], a[68:71]
  v_mfma_f32_16x16x32_bf16 a[72:75], v[152:155], v[132:135], a[72:75]
  v_mfma_f32_16x16x32_bf16 a[76:79], v[152:155], v[136:139], a[76:79]
  buffer_load_dwordx4 v[88:91], v232, s[8:11], s26 offen offset:1024
  v_mfma_f32_16x16x32_bf16 a[80:83], v[156:159], v[120:123], a[80:83]
  v_mfma_f32_16x16x32_bf16 a[84:87], v[156:159], v[124:127], a[84:87]
  v_mfma_f32_16x16x32_bf16 a[88:91], v[156:159], v[128:131], a[88:91]
  buffer_load_dwordx4 v[92:95], v232, s[8:11], s27 offen offset:1024
  v_mfma_f32_16x16x32_bf16 a[92:95], v[156:159], v[132:135], a[92:95]
  v_mfma_f32_16x16x32_bf16 a[96:99], v[156:159], v[136:139], a[96:99]
  v_mfma_f32_16x16x32_bf16 a[100:103], v[160:163], v[120:123], a[100:103]
  buffer_load_dwordx4 v[96:99], v232, s[8:11], s28 offen offset:1024
  v_mfma_f32_16x16x32_bf16 a[104:107], v[160:163], v[124:127], a[104:107]
  v_mfma_f32_16x16x32_bf16 a[108:111], v[160:163], v[128:131], a[108:111]
  v_mfma_f32_16x16x32_bf16 a[112:115], v[160:163], v[132:135], a[112:115]
  buffer_load_dwordx4 v[100:103], v232, s[8:11], s29 offen offset:1024
  v_mfma_f32_16x16x32_bf16 a[116:119], v[160:163], v[136:139], a[116:119]
  v_mfma_f32_16x16x32_bf16 a[120:123], v[164:167], v[120:123], a[120:123]
  v_mfma_f32_16x16x32_bf16 a[124:127], v[164:167], v[124:127], a[124:127]
  buffer_load_dwordx4 v[104:107], v232, s[8:11], s30 offen offset:1024
  v_mfma_f32_16x16x32_bf16 a[128:131], v[164:167], v[128:131], a[128:131]
  v_mfma_f32_16x16x32_bf16 a[132:135], v[164:167], v[132:135], a[132:135]
  v_mfma_f32_16x16x32_bf16 a[136:139], v[164:167], v[136:139], a[136:139]
  buffer_load_dwordx4 v[108:111], v232, s[8:11], s31 offen offset:1024
  v_mfma_f32_16x16x32_bf16 a[140:143], v[168:171], v[120:123], a[140:143]
  v_mfma_f32_16x16x32_bf16 a[144:147], v[168:171], v[124:127], a[144:147]
  v_mfma_f32_16x16x32_bf16 a[148:151], v[168:171], v[128:131], a[148:151]
  buffer_load_dwordx4 v[112:115], v232, s[8:11], s32 offen offset:1024
  v_mfma_f32_16x16x32_bf16 a[152:155], v[168:171], v[132:135], a[152:155]
  v_mfma_f32_16x16x32_bf16 a[156:159], v[168:171], v[136:139], a[156:159]
  v_mfma_f32_16x16x32_bf16 a[160:163], v[172:175], v[120:123], a[160:163]
  buffer_load_dwordx4 v[116:119], v232, s[8:11], s33 offen offset:1024
  v_mfma_f32_16x16x32_bf16 a[164:167], v[172:175], v[124:127], a[164:167]
  v_mfma_f32_16x16x32_bf16 a[168:171], v[172:175], v[128:131], a[168:171]
  v_mfma_f32_16x16x32_bf16 a[172:175], v[172:175], v[132:135], a[172:175]
  v_mfma_f32_16x16x32_bf16 a[176:179], v[172:175], v[136:139], a[176:179]
  s_waitcnt vmcnt(42)
  v_mfma_f32_16x16x32_bf16 a[0:3], v[196:199], v[176:179], a[0:3]
  v_mfma_f32_16x16x32_bf16 a[4:7], v[196:199], v[180:183], a[4:7]
  buffer_load_dwordx4 v[120:123], v232, s[8:11], s20 offen offset:2048
  v_mfma_f32_16x16x32_bf16 a[8:11], v[196:199], v[184:187], a[8:11]
  v_mfma_f32_16x16x32_bf16 a[12:15], v[196:199], v[188:191], a[12:15]
  v_mfma_f32_16x16x32_bf16 a[16:19], v[196:199], v[192:195], a[16:19]
  buffer_load_dwordx4 v[140:143], v232, s[8:11], s25 offen offset:2048
  v_mfma_f32_16x16x32_bf16 a[20:23], v[200:203], v[176:179], a[20:23]
  v_mfma_f32_16x16x32_bf16 a[24:27], v[200:203], v[180:183], a[24:27]
  v_mfma_f32_16x16x32_bf16 a[28:31], v[200:203], v[184:187], a[28:31]
  buffer_load_dwordx4 v[124:127], v232, s[8:11], s21 offen offset:2048
  v_mfma_f32_16x16x32_bf16 a[32:35], v[200:203], v[188:191], a[32:35]
  v_mfma_f32_16x16x32_bf16 a[36:39], v[200:203], v[192:195], a[36:39]
  v_mfma_f32_16x16x32_bf16 a[40:43], v[204:207], v[176:179], a[40:43]
  buffer_load_dwordx4 v[128:131], v232, s[8:11], s22 offen offset:2048
  v_mfma_f32_16x16x32_bf16 a[44:47], v[204:207], v[180:183], a[44:47]
  v_mfma_f32_16x16x32_bf16 a[48:51], v[204:207], v[184:187], a[48:51]
  v_mfma_f32_16x16x32_bf16 a[52:55], v[204:207], v[188:191], a[52:55]
  buffer_load_dwordx4 v[132:135], v232, s[8:11], s23 offen offset:2048
  v_mfma_f32_16x16x32_bf16 a[56:59], v[204:207], v[192:195], a[56:59]
  v_mfma_f32_16x16x32_bf16 a[60:63], v[208:211], v[176:179], a[60:63]
  v_mfma_f32_16x16x32_bf16 a[64:67], v[208:211], v[180:183], a[64:67]
  buffer_load_dwordx4 v[136:139], v232, s[8:11], s24 offen offset:2048
  v_mfma_f32_16x16x32_bf16 a[68:71], v[208:211], v[184:187], a[68:71]
  v_mfma_f32_16x16x32_bf16 a[72:75], v[208:211], v[188:191], a[72:75]
  v_mfma_f32_16x16x32_bf16 a[76:79], v[208:211], v[192:195], a[76:79]
  buffer_load_dwordx4 v[144:147], v232, s[8:11], s26 offen offset:2048
  v_mfma_f32_16x16x32_bf16 a[80:83], v[212:215], v[176:179], a[80:83]
  v_mfma_f32_16x16x32_bf16 a[84:87], v[212:215], v[180:183], a[84:87]
  v_mfma_f32_16x16x32_bf16 a[88:91], v[212:215], v[184:187], a[88:91]
  buffer_load_dwordx4 v[148:151], v232, s[8:11], s27 offen offset:2048
  v_mfma_f32_16x16x32_bf16 a[92:95], v[212:215], v[188:191], a[92:95]
  v_mfma_f32_16x16x32_bf16 a[96:99], v[212:215], v[192:195], a[96:99]
  v_mfma_f32_16x16x32_bf16 a[100:103], v[216:219], v[176:179], a[100:103]
  buffer_load_dwordx4 v[152:155], v232, s[8:11], s28 offen offset:2048
  v_mfma_f32_16x16x32_bf16 a[104:107], v[216:219], v[180:183], a[104:107]
  v_mfma_f32_16x16x32_bf16 a[108:111], v[216:219], v[184:187], a[108:111]
  v_mfma_f32_16x16x32_bf16 a[112:115], v[216:219], v[188:191], a[112:115]
  buffer_load_dwordx4 v[156:159], v232, s[8:11], s29 offen offset:2048
  v_mfma_f32_16x16x32_bf16 a[116:119], v[216:219], v[192:195], a[116:119]
  v_mfma_f32_16x16x32_bf16 a[120:123], v[220:223], v[176:179], a[120:123]
  v_mfma_f32_16x16x32_bf16 a[124:127], v[220:223], v[180:183], a[124:127]
  buffer_load_dwordx4 v[160:163], v232, s[8:11], s30 offen offset:2048
  v_mfma_f32_16x16x32_bf16 a[128:131], v[220:223], v[184:187], a[128:131]
  v_mfma_f32_16x16x32_bf16 a[132:135], v[220:223], v[188:191], a[132:135]
  v_mfma_f32_16x16x32_bf16 a[136:139], v[220:223], v[192:195], a[136:139]
  buffer_load_dwordx4 v[164:167], v232, s[8:11], s31 offen offset:2048
  v_mfma_f32_16x16x32_bf16 a[140:143], v[224:227], v[176:179], a[140:143]
  v_mfma_f32_16x16x32_bf16 a[144:147], v[224:227], v[180:183], a[144:147]
  v_mfma_f32_16x16x32_bf16 a[148:151], v[224:227], v[184:187], a[148:151]
  buffer_load_dwordx4 v[168:171], v232, s[8:11], s32 offen offset:2048
  v_mfma_f32_16x16x32_bf16 a[152:155], v[224:227], v[188:191], a[152:155]
  v_mfma_f32_16x16x32_bf16 a[156:159], v[224:227], v[192:195], a[156:159]
  v_mfma_f32_16x16x32_bf16 a[160:163], v[228:231], v[176:179], a[160:163]
  buffer_load_dwordx4 v[172:175], v232, s[8:11], s33 offen offset:2048
  v_mfma_f32_16x16x32_bf16 a[164:167], v[228:231], v[180:183], a[164:167]
  v_mfma_f32_16x16x32_bf16 a[168:171], v[228:231], v[184:187], a[168:171]
  v_mfma_f32_16x16x32_bf16 a[172:175], v[228:231], v[188:191], a[172:175]
  v_mfma_f32_16x16x32_bf16 a[176:179], v[228:231], v[192:195], a[176:179]
  s_waitcnt vmcnt(42)
  v_mfma_f32_16x16x32_bf16 a[0:3], a[200:203], a[180:183], a[0:3]
  v_mfma_f32_16x16x32_bf16 a[4:7], a[200:203], a[184:187], a[4:7]
  buffer_load_dwordx4 v[176:179], v232, s[8:11], s20 offen offset:3072
  v_mfma_f32_16x16x32_bf16 a[8:11], a[200:203], a[188:191], a[8:11]
  v_mfma_f32_16x16x32_bf16 a[12:15], a[200:203], a[192:195], a[12:15]
  v_mfma_f32_16x16x32_bf16 a[16:19], a[200:203], a[196:199], a[16:19]
  buffer_load_dwordx4 v[196:199], v232, s[8:11], s25 offen offset:3072
  v_mfma_f32_16x16x32_bf16 a[20:23], a[204:207], a[180:183], a[20:23]
  v_mfma_f32_16x16x32_bf16 a[24:27], a[204:207], a[184:187], a[24:27]
  v_mfma_f32_16x16x32_bf16 a[28:31], a[204:207], a[188:191], a[28:31]
  buffer_load_dwordx4 v[180:183], v232, s[8:11], s21 offen offset:3072
  v_mfma_f32_16x16x32_bf16 a[32:35], a[204:207], a[192:195], a[32:35]
  v_mfma_f32_16x16x32_bf16 a[36:39], a[204:207], a[196:199], a[36:39]
  v_mfma_f32_16x16x32_bf16 a[40:43], a[208:211], a[180:183], a[40:43]
  buffer_load_dwordx4 v[184:187], v232, s[8:11], s22 offen offset:3072
  v_mfma_f32_16x16x32_bf16 a[44:47], a[208:211], a[184:187], a[44:47]
  v_mfma_f32_16x16x32_bf16 a[48:51], a[208:211], a[188:191], a[48:51]
  v_mfma_f32_16x16x32_bf16 a[52:55], a[208:211], a[192:195], a[52:55]
  buffer_load_dwordx4 v[188:191], v232, s[8:11], s23 offen offset:3072
  v_mfma_f32_16x16x32_bf16 a[56:59], a[208:211], a[196:199], a[56:59]
  v_mfma_f32_16x16x32_bf16 a[60:63], a[212:215], a[180:183], a[60:63]
  v_mfma_f32_16x16x32_bf16 a[64:67], a[212:215], a[184:187], a[64:67]
  buffer_load_dwordx4 v[192:195], v232, s[8:11], s24 offen offset:3072
  v_mfma_f32_16x16x32_bf16 a[68:71], a[212:215], a[188:191], a[68:71]
  v_mfma_f32_16x16x32_bf16 a[72:75], a[212:215], a[192:195], a[72:75]
  v_mfma_f32_16x16x32_bf16 a[76:79], a[212:215], a[196:199], a[76:79]
  buffer_load_dwordx4 v[200:203], v232, s[8:11], s26 offen offset:3072
  v_mfma_f32_16x16x32_bf16 a[80:83], a[216:219], a[180:183], a[80:83]
  v_mfma_f32_16x16x32_bf16 a[84:87], a[216:219], a[184:187], a[84:87]
  v_mfma_f32_16x16x32_bf16 a[88:91], a[216:219], a[188:191], a[88:91]
  buffer_load_dwordx4 v[204:207], v232, s[8:11], s27 offen offset:3072
  v_mfma_f32_16x16x32_bf16 a[92:95], a[216:219], a[192:195], a[92:95]
  v_mfma_f32_16x16x32_bf16 a[96:99], a[216:219], a[196:199], a[96:99]
  v_mfma_f32_16x16x32_bf16 a[100:103], a[220:223], a[180:183], a[100:103]
  buffer_load_dwordx4 v[208:211], v232, s[8:11], s28 offen offset:3072
  v_mfma_f32_16x16x32_bf16 a[104:107], a[220:223], a[184:187], a[104:107]
  v_mfma_f32_16x16x32_bf16 a[108:111], a[220:223], a[188:191], a[108:111]
  v_mfma_f32_16x16x32_bf16 a[112:115], a[220:223], a[192:195], a[112:115]
  buffer_load_dwordx4 v[212:215], v232, s[8:11], s29 offen offset:3072
  v_mfma_f32_16x16x32_bf16 a[116:119], a[220:223], a[196:199], a[116:119]
  v_mfma_f32_16x16x32_bf16 a[120:123], a[224:227], a[180:183], a[120:123]
  v_mfma_f32_16x16x32_bf16 a[124:127], a[224:227], a[184:187], a[124:127]
  buffer_load_dwordx4 v[216:219], v232, s[8:11], s30 offen offset:3072
  v_mfma_f32_16x16x32_bf16 a[128:131], a[224:227], a[188:191], a[128:131]
  v_mfma_f32_16x16x32_bf16 a[132:135], a[224:227], a[192:195], a[132:135]
  v_mfma_f32_16x16x32_bf16 a[136:139], a[224:227], a[196:199], a[136:139]
  buffer_load_dwordx4 v[220:223], v232, s[8:11], s31 offen offset:3072
  v_mfma_f32_16x16x32_bf16 a[140:143], a[228:231], a[180:183], a[140:143]
  v_mfma_f32_16x16x32_bf16 a[144:147], a[228:231], a[184:187], a[144:147]
  v_mfma_f32_16x16x32_bf16 a[148:151], a[228:231], a[188:191], a[148:151]
  buffer_load_dwordx4 v[224:227], v232, s[8:11], s32 offen offset:3072
  v_mfma_f32_16x16x32_bf16 a[152:155], a[228:231], a[192:195], a[152:155]
  v_mfma_f32_16x16x32_bf16 a[156:159], a[228:231], a[196:199], a[156:159]
  v_mfma_f32_16x16x32_bf16 a[160:163], a[232:235], a[180:183], a[160:163]
  buffer_load_dwordx4 v[228:231], v232, s[8:11], s33 offen offset:3072
  v_mfma_f32_16x16x32_bf16 a[164:167], a[232:235], a[184:187], a[164:167]
  v_mfma_f32_16x16x32_bf16 a[168:171], a[232:235], a[188:191], a[168:171]
  v_mfma_f32_16x16x32_bf16 a[172:175], a[232:235], a[192:195], a[172:175]
  v_mfma_f32_16x16x32_bf16 a[176:179], a[232:235], a[196:199], a[176:179]
  s_waitcnt vmcnt(42)
  v_mfma_f32_16x16x32_bf16 a[0:3], v[28:31], v[8:11], a[0:3]
  v_mfma_f32_16x16x32_bf16 a[4:7], v[28:31], v[12:15], a[4:7]
  buffer_load_dwordx4 a[180:183], v233, s[8:11], s20 offen offset:0
  v_mfma_f32_16x16x32_bf16 a[8:11], v[28:31], v[16:19], a[8:11]
  v_mfma_f32_16x16x32_bf16 a[12:15], v[28:31], v[20:23], a[12:15]
  v_mfma_f32_16x16x32_bf16 a[16:19], v[28:31], v[24:27], a[16:19]
  buffer_load_dwordx4 a[200:203], v233, s[8:11], s25 offen offset:0
  v_mfma_f32_16x16x32_bf16 a[20:23], v[32:35], v[8:11], a[20:23]
  v_mfma_f32_16x16x32_bf16 a[24:27], v[32:35], v[12:15], a[24:27]
  v_mfma_f32_16x16x32_bf16 a[28:31], v[32:35], v[16:19], a[28:31]
  buffer_load_dwordx4 a[184:187], v233, s[8:11], s21 offen offset:0
  v_mfma_f32_16x16x32_bf16 a[32:35], v[32:35], v[20:23], a[32:35]
  v_mfma_f32_16x16x32_bf16 a[36:39], v[32:35], v[24:27], a[36:39]
  v_mfma_f32_16x16x32_bf16 a[40:43], v[36:39], v[8:11], a[40:43]
  buffer_load_dwordx4 a[188:191], v233, s[8:11], s22 offen offset:0
  v_mfma_f32_16x16x32_bf16 a[44:47], v[36:39], v[12:15], a[44:47]
  v_mfma_f32_16x16x32_bf16 a[48:51], v[36:39], v[16:19], a[48:51]
  v_mfma_f32_16x16x32_bf16 a[52:55], v[36:39], v[20:23], a[52:55]
  buffer_load_dwordx4 a[192:195], v233, s[8:11], s23 offen offset:0
  v_mfma_f32_16x16x32_bf16 a[56:59], v[36:39], v[24:27], a[56:59]
  v_mfma_f32_16x16x32_bf16 a[60:63], v[40:43], v[8:11], a[60:63]
  v_mfma_f32_16x16x32_bf16 a[64:67], v[40:43], v[12:15], a[64:67]
  buffer_load_dwordx4 a[196:199], v233, s[8:11], s24 offen offset:0
  v_mfma_f32_16x16x32_bf16 a[68:71], v[40:43], v[16:19], a[68:71]
  v_mfma_f32_16x16x32_bf16 a[72:75], v[40:43], v[20:23], a[72:75]
  v_mfma_f32_16x16x32_bf16 a[76:79], v[40:43], v[24:27], a[76:79]
  buffer_load_dwordx4 a[204:207], v233, s[8:11], s26 offen offset:0
  v_mfma_f32_16x16x32_bf16 a[80:83], v[44:47], v[8:11], a[80:83]
  v_mfma_f32_16x16x32_bf16 a[84:87], v[44:47], v[12:15], a[84:87]
  v_mfma_f32_16x16x32_bf16 a[88:91], v[44:47], v[16:19], a[88:91]
  buffer_load_dwordx4 a[208:211], v233, s[8:11], s27 offen offset:0
  v_mfma_f32_16x16x32_bf16 a[92:95], v[44:47], v[20:23], a[92:95]
  v_mfma_f32_16x16x32_bf16 a[96:99], v[44:47], v[24:27], a[96:99]
  v_mfma_f32_16x16x32_bf16 a[100:103], v[48:51], v[8:11], a[100:103]
  buffer_load_dwordx4 a[212:215], v233, s[8:11], s28 offen offset:0
  v_mfma_f32_16x16x32_bf16 a[104:107], v[48:51], v[12:15], a[104:107]
  v_mfma_f32_16x16x32_bf16 a[108:111], v[48:51], v[16:19], a[108:111]
  v_mfma_f32_16x16x32_bf16 a[112:115], v[48:51], v[20:23], a[112:115]
  buffer_load_dwordx4 a[216:219], v233, s[8:11], s29 offen offset:0
  v_mfma_f32_16x16x32_bf16 a[116:119], v[48:51], v[24:27], a[116:119]
  v_mfma_f32_16x16x32_bf16 a[120:123], v[52:55], v[8:11], a[120:123]
  v_mfma_f32_16x16x32_bf16 a[124:127], v[52:55], v[12:15], a[124:127]
  buffer_load_dwordx4 a[220:223], v233, s[8:11], s30 offen offset:0
  v_mfma_f32_16x16x32_bf16 a[128:131], v[52:55], v[16:19], a[128:131]
  v_mfma_f32_16x16x32_bf16 a[132:135], v[52:55], v[20:23], a[132:135]
  v_mfma_f32_16x16x32_bf16 a[136:139], v[52:55], v[24:27], a[136:139]
  buffer_load_dwordx4 a[224:227], v233, s[8:11], s31 offen offset:0
  v_mfma_f32_16x16x32_bf16 a[140:143], v[56:59], v[8:11], a[140:143]
  v_mfma_f32_16x16x32_bf16 a[144:147], v[56:59], v[12:15], a[144:147]
  v_mfma_f32_16x16x32_bf16 a[148:151], v[56:59], v[16:19], a[148:151]
  buffer_load_dwordx4 a[228:231], v233, s[8:11], s32 offen offset:0
  v_mfma_f32_16x16x32_bf16 a[152:155], v[56:59], v[20:23], a[152:155]
  v_mfma_f32_16x16x32_bf16 a[156:159], v[56:59], v[24:27], a[156:159]
  v_mfma_f32_16x16x32_bf16 a[160:163], v[60:63], v[8:11], a[160:163]
  buffer_load_dwordx4 a[232:235], v233, s[8:11], s33 offen offset:0
  v_mfma_f32_16x16x32_bf16 a[164:167], v[60:63], v[12:15], a[164:167]
  v_mfma_f32_16x16x32_bf16 a[168:171], v[60:63], v[16:19], a[168:171]
  v_mfma_f32_16x16x32_bf16 a[172:175], v[60:63], v[20:23], a[172:175]
  v_mfma_f32_16x16x32_bf16 a[176:179], v[60:63], v[24:27], a[176:179]
  s_waitcnt vmcnt(42)
  v_mfma_f32_16x16x32_bf16 a[0:3], v[84:87], v[64:67], a[0:3]
  v_mfma_f32_16x16x32_bf16 a[4:7], v[84:87], v[68:71], a[4:7]
  buffer_load_dwordx4 v[8:11], v233, s[8:11], s20 offen offset:1024
  v_mfma_f32_16x16x32_bf16 a[8:11], v[84:87], v[72:75], a[8:11]
  v_mfma_f32_16x16x32_bf16 a[12:15], v[84:87], v[76:79], a[12:15]
  v_mfma_f32_16x16x32_bf16 a[16:19], v[84:87], v[80:83], a[16:19]
  buffer_load_dwordx4 v[28:31], v233, s[8:11], s25 offen offset:1024
  v_mfma_f32_16x16x32_bf16 a[20:23], v[88:91], v[64:67], a[20:23]
  v_mfma_f32_16x16x32_bf16 a[24:27], v[88:91], v[68:71], a[24:27]
  v_mfma_f32_16x16x32_bf16 a[28:31], v[88:91], v[72:75], a[28:31]
  buffer_load_dwordx4 v[12:15], v233, s[8:11], s21 offen offset:1024
  v_mfma_f32_16x16x32_bf16 a[32:35], v[88:91], v[76:79], a[32:35]
  v_mfma_f32_16x16x32_bf16 a[36:39], v[88:91], v[80:83], a[36:39]
  v_mfma_f32_16x16x32_bf16 a[40:43], v[92:95], v[64:67], a[40:43]
  buffer_load_dwordx4 v[16:19], v233, s[8:11], s22 offen offset:1024
  v_mfma_f32_16x16x32_bf16 a[44:47], v[92:95], v[68:71], a[44:47]
  v_mfma_f32_16x16x32_bf16 a[48:51], v[92:95], v[72:75], a[48:51]
  v_mfma_f32_16x16x32_bf16 a[52:55], v[92:95], v[76:79], a[52:55]
  buffer_load_dwordx4 v[20:23], v233, s[8:11], s23 offen offset:1024
  v_mfma_f32_16x16x32_bf16 a[56:59], v[92:95], v[80:83], a[56:59]
  v_mfma_f32_16x16x32_bf16 a[60:63], v[96:99], v[64:67], a[60:63]
  v_mfma_f32_16x16x32_bf16 a[64:67], v[96:99], v[68:71], a[64:67]
  buffer_load_dwordx4 v[24:27], v233, s[8:11], s24 offen offset:1024
  v_mfma_f32_16x16x32_bf16 a[68:71], v[96:99], v[72:75], a[68:71]
  v_mfma_f32_16x16x32_bf16 a[72:75], v[96:99], v[76:79], a[72:75]
  v_mfma_f32_16x16x32_bf16 a[76:79], v[96:99], v[80:83], a[76:79]
  buffer_load_dwordx4 v[32:35], v233, s[8:11], s26 offen offset:1024
  v_mfma_f32_16x16x32_bf16 a[80:83], v[100:103], v[64:67], a[80:83]
  v_mfma_f32_16x16x32_bf16 a[84:87], v[100:103], v[68:71], a[84:87]
  v_mfma_f32_16x16x32_bf16 a[88:91], v[100:103], v[72:75], a[88:91]
  buffer_load_dwordx4 v[36:39], v233, s[8:11], s27 offen offset:1024
  v_mfma_f32_16x16x32_bf16 a[92:95], v[100:103], v[76:79], a[92:95]
  v_mfma_f32_16x16x32_bf16 a[96:99], v[100:103], v[80:83], a[96:99]
  v_mfma_f32_16x16x32_bf16 a[100:103], v[104:107], v[64:67], a[100:103]
  buffer_load_dwordx4 v[40:43], v233, s[8:11], s28 offen offset:1024
  v_mfma_f32_16x16x32_bf16 a[104:107], v[104:107], v[68:71], a[104:107]
  v_mfma_f32_16x16x32_bf16 a[108:111], v[104:107], v[72:75], a[108:111]
  v_mfma_f32_16x16x32_bf16 a[112:115], v[104:107], v[76:79], a[112:115]
  buffer_load_dwordx4 v[44:47], v233, s[8:11], s29 offen offset:1024
  v_mfma_f32_16x16x32_bf16 a[116:119], v[104:107], v[80:83], a[116:119]
  v_mfma_f32_16x16x32_bf16 a[120:123], v[108:111], v[64:67], a[120:123]
  v_mfma_f32_16x16x32_bf16 a[124:127], v[108:111], v[68:71], a[124:127]
  buffer_load_dwordx4 v[48:51], v233, s[8:11], s30 offen offset:1024
  v_mfma_f32_16x16x32_bf16 a[128:131], v[108:111], v[72:75], a[128:131]
  v_mfma_f32_16x16x32_bf16 a[132:135], v[108:111], v[76:79], a[132:135]
  v_mfma_f32_16x16x32_bf16 a[136:139], v[108:111], v[80:83], a[136:139]
  buffer_load_dwordx4 v[52:55], v233, s[8:11], s31 offen offset:1024
  v_mfma_f32_16x16x32_bf16 a[140:143], v[112:115], v[64:67], a[140:143]
  v_mfma_f32_16x16x32_bf16 a[144:147], v[112:115], v[68:71], a[144:147]
  v_mfma_f32_16x16x32_bf16 a[148:151], v[112:115], v[72:75], a[148:151]
  buffer_load_dwordx4 v[56:59], v233, s[8:11], s32 offen offset:1024
  v_mfma_f32_16x16x32_bf16 a[152:155], v[112:115], v[76:79], a[152:155]
  v_mfma_f32_16x16x32_bf16 a[156:159], v[112:115], v[80:83], a[156:159]
  v_mfma_f32_16x16x32_bf16 a[160:163], v[116:119], v[64:67], a[160:163]
  buffer_load_dwordx4 v[60:63], v233, s[8:11], s33 offen offset:1024
  v_mfma_f32_16x16x32_bf16 a[164:167], v[116:119], v[68:71], a[164:167]
  v_mfma_f32_16x16x32_bf16 a[168:171], v[116:119], v[72:75], a[168:171]
  v_mfma_f32_16x16x32_bf16 a[172:175], v[116:119], v[76:79], a[172:175]
  v_mfma_f32_16x16x32_bf16 a[176:179], v[116:119], v[80:83], a[176:179]
  s_waitcnt vmcnt(42)
  v_mfma_f32_16x16x32_bf16 a[0:3], v[140:143], v[120:123], a[0:3]
  v_mfma_f32_16x16x32_bf16 a[4:7], v[140:143], v[124:127], a[4:7]
  buffer_load_dwordx4 v[64:67], v233, s[8:11], s20 offen offset:2048
  v_mfma_f32_16x16x32_bf16 a[8:11], v[140:143], v[128:131], a[8:11]
  v_mfma_f32_16x16x32_bf16 a[12:15], v[140:143], v[132:135], a[12:15]
  v_mfma_f32_16x16x32_bf16 a[16:19], v[140:143], v[136:139], a[16:19]
  buffer_load_dwordx4 v[84:87], v233, s[8:11], s25 offen offset:2048
  v_mfma_f32_16x16x32_bf16 a[20:23], v[144:147], v[120:123], a[20:23]
  v_mfma_f32_16x16x32_bf16 a[24:27], v[144:147], v[124:127], a[24:27]
  v_mfma_f32_16x16x32_bf16 a[28:31], v[144:147], v[128:131], a[28:31]
  buffer_load_dwordx4 v[68:71], v233, s[8:11], s21 offen offset:2048
  v_mfma_f32_16x16x32_bf16 a[32:35], v[144:147], v[132:135], a[32:35]
  v_mfma_f32_16x16x32_bf16 a[36:39], v[144:147], v[136:139], a[36:39]
  v_mfma_f32_16x16x32_bf16 a[40:43], v[148:151], v[120:123], a[40:43]
  buffer_load_dwordx4 v[72:75], v233, s[8:11], s22 offen offset:2048
  v_mfma_f32_16x16x32_bf16 a[44:47], v[148:151], v[124:127], a[44:47]
  v_mfma_f32_16x16x32_bf16 a[48:51], v[148:151], v[128:131], a[48:51]
  v_mfma_f32_16x16x32_bf16 a[52:55], v[148:151], v[132:135], a[52:55]
  buffer_load_dwordx4 v[76:79], v233, s[8:11], s23 offen offset:2048
  v_mfma_f32_16x16x32_bf16 a[56:59], v[148:151], v[136:139], a[56:59]
  v_mfma_f32_16x16x32_bf16 a[60:63], v[152:155], v[120:123], a[60:63]
  v_mfma_f32_16x16x32_bf16 a[64:67], v[152:155], v[124:127], a[64:67]
  buffer_load_dwordx4 v[80:83], v233, s[8:11], s24 offen offset:2048
  v_mfma_f32_16x16x32_bf16 a[68:71], v[152:155], v[128:131], a[68:71]
  v_mfma_f32_16x16x32_bf16 a[72:75], v[152:155], v[132:135], a[72:75]
  v_mfma_f32_16x16x32_bf16 a[76:79], v[152:155], v[136:139], a[76:79]
  buffer_load_dwordx4 v[88:91], v233, s[8:11], s26 offen offset:2048
  v_mfma_f32_16x16x32_bf16 a[80:83], v[156:159], v[120:123], a[80:83]
  v_mfma_f32_16x16x32_bf16 a[84:87], v[156:159], v[124:127], a[84:87]
  v_mfma_f32_16x16x32_bf16 a[88:91], v[156:159], v[128:131], a[88:91]
  buffer_load_dwordx4 v[92:95], v233, s[8:11], s27 offen offset:2048
  v_mfma_f32_16x16x32_bf16 a[92:95], v[156:159], v[132:135], a[92:95]
  v_mfma_f32_16x16x32_bf16 a[96:99], v[156:159], v[136:139], a[96:99]
  v_mfma_f32_16x16x32_bf16 a[100:103], v[160:163], v[120:123], a[100:103]
  buffer_load_dwordx4 v[96:99], v233, s[8:11], s28 offen offset:2048
  v_mfma_f32_16x16x32_bf16 a[104:107], v[160:163], v[124:127], a[104:107]
  v_mfma_f32_16x16x32_bf16 a[108:111], v[160:163], v[128:131], a[108:111]
  v_mfma_f32_16x16x32_bf16 a[112:115], v[160:163], v[132:135], a[112:115]
  buffer_load_dwordx4 v[100:103], v233, s[8:11], s29 offen offset:2048
  v_mfma_f32_16x16x32_bf16 a[116:119], v[160:163], v[136:139], a[116:119]
  v_mfma_f32_16x16x32_bf16 a[120:123], v[164:167], v[120:123], a[120:123]
  v_mfma_f32_16x16x32_bf16 a[124:127], v[164:167], v[124:127], a[124:127]
  buffer_load_dwordx4 v[104:107], v233, s[8:11], s30 offen offset:2048
  v_mfma_f32_16x16x32_bf16 a[128:131], v[164:167], v[128:131], a[128:131]
  v_mfma_f32_16x16x32_bf16 a[132:135], v[164:167], v[132:135], a[132:135]
  v_mfma_f32_16x16x32_bf16 a[136:139], v[164:167], v[136:139], a[136:139]
  buffer_load_dwordx4 v[108:111], v233, s[8:11], s31 offen offset:2048
  v_mfma_f32_16x16x32_bf16 a[140:143], v[168:171], v[120:123], a[140:143]
  v_mfma_f32_16x16x32_bf16 a[144:147], v[168:171], v[124:127], a[144:147]
  v_mfma_f32_16x16x32_bf16 a[148:151], v[168:171], v[128:131], a[148:151]
  buffer_load_dwordx4 v[112:115], v233, s[8:11], s32 offen offset:2048
  v_mfma_f32_16x16x32_bf16 a[152:155], v[168:171], v[132:135], a[152:155]
  v_mfma_f32_16x16x32_bf16 a[156:159], v[168:171], v[136:139], a[156:159]
  v_mfma_f32_16x16x32_bf16 a[160:163], v[172:175], v[120:123], a[160:163]
  buffer_load_dwordx4 v[116:119], v233, s[8:11], s33 offen offset:2048
  v_mfma_f32_16x16x32_bf16 a[164:167], v[172:175], v[124:127], a[164:167]
  v_mfma_f32_16x16x32_bf16 a[168:171], v[172:175], v[128:131], a[168:171]
  v_mfma_f32_16x16x32_bf16 a[172:175], v[172:175], v[132:135], a[172:175]
  v_mfma_f32_16x16x32_bf16 a[176:179], v[172:175], v[136:139], a[176:179]
  s_waitcnt vmcnt(42)
  v_mfma_f32_16x16x32_bf16 a[0:3], v[196:199], v[176:179], a[0:3]
  v_mfma_f32_16x16x32_bf16 a[4:7], v[196:199], v[180:183], a[4:7]
  buffer_load_dwordx4 v[120:123], v233, s[8:11], s20 offen offset:3072
  v_mfma_f32_16x16x32_bf16 a[8:11], v[196:199], v[184:187], a[8:11]
  v_mfma_f32_16x16x32_bf16 a[12:15], v[196:199], v[188:191], a[12:15]
  v_mfma_f32_16x16x32_bf16 a[16:19], v[196:199], v[192:195], a[16:19]
  buffer_load_dwordx4 v[140:143], v233, s[8:11], s25 offen offset:3072
  v_mfma_f32_16x16x32_bf16 a[20:23], v[200:203], v[176:179], a[20:23]
  v_mfma_f32_16x16x32_bf16 a[24:27], v[200:203], v[180:183], a[24:27]
  v_mfma_f32_16x16x32_bf16 a[28:31], v[200:203], v[184:187], a[28:31]
  buffer_load_dwordx4 v[124:127], v233, s[8:11], s21 offen offset:3072
  v_mfma_f32_16x16x32_bf16 a[32:35], v[200:203], v[188:191], a[32:35]
  v_mfma_f32_16x16x32_bf16 a[36:39], v[200:203], v[192:195], a[36:39]
  v_mfma_f32_16x16x32_bf16 a[40:43], v[204:207], v[176:179], a[40:43]
  buffer_load_dwordx4 v[128:131], v233, s[8:11], s22 offen offset:3072
  v_mfma_f32_16x16x32_bf16 a[44:47], v[204:207], v[180:183], a[44:47]
  v_mfma_f32_16x16x32_bf16 a[48:51], v[204:207], v[184:187], a[48:51]
  v_mfma_f32_16x16x32_bf16 a[52:55], v[204:207], v[188:191], a[52:55]
  buffer_load_dwordx4 v[132:135], v233, s[8:11], s23 offen offset:3072
  v_mfma_f32_16x16x32_bf16 a[56:59], v[204:207], v[192:195], a[56:59]
  v_mfma_f32_16x16x32_bf16 a[60:63], v[208:211], v[176:179], a[60:63]
  v_mfma_f32_16x16x32_bf16 a[64:67], v[208:211], v[180:183], a[64:67]
  buffer_load_dwordx4 v[136:139], v233, s[8:11], s24 offen offset:3072
  v_mfma_f32_16x16x32_bf16 a[68:71], v[208:211], v[184:187], a[68:71]
  v_mfma_f32_16x16x32_bf16 a[72:75], v[208:211], v[188:191], a[72:75]
  v_mfma_f32_16x16x32_bf16 a[76:79], v[208:211], v[192:195], a[76:79]
  buffer_load_dwordx4 v[144:147], v233, s[8:11], s26 offen offset:3072
  v_mfma_f32_16x16x32_bf16 a[80:83], v[212:215], v[176:179], a[80:83]
  v_mfma_f32_16x16x32_bf16 a[84:87], v[212:215], v[180:183], a[84:87]
  v_mfma_f32_16x16x32_bf16 a[88:91], v[212:215], v[184:187], a[88:91]
  buffer_load_dwordx4 v[148:151], v233, s[8:11], s27 offen offset:3072
  v_mfma_f32_16x16x32_bf16 a[92:95], v[212:215], v[188:191], a[92:95]
  v_mfma_f32_16x16x32_bf16 a[96:99], v[212:215], v[192:195], a[96:99]
  v_mfma_f32_16x16x32_bf16 a[100:103], v[216:219], v[176:179], a[100:103]
  buffer_load_dwordx4 v[152:155], v233, s[8:11], s28 offen offset:3072
  v_mfma_f32_16x16x32_bf16 a[104:107], v[216:219], v[180:183], a[104:107]
  v_mfma_f32_16x16x32_bf16 a[108:111], v[216:219], v[184:187], a[108:111]
  v_mfma_f32_16x16x32_bf16 a[112:115], v[216:219], v[188:191], a[112:115]
  buffer_load_dwordx4 v[156:159], v233, s[8:11], s29 offen offset:3072
  v_mfma_f32_16x16x32_bf16 a[116:119], v[216:219], v[192:195], a[116:119]
  v_mfma_f32_16x16x32_bf16 a[120:123], v[220:223], v[176:179], a[120:123]
  v_mfma_f32_16x16x32_bf16 a[124:127], v[220:223], v[180:183], a[124:127]
  buffer_load_dwordx4 v[160:163], v233, s[8:11], s30 offen offset:3072
  v_mfma_f32_16x16x32_bf16 a[128:131], v[220:223], v[184:187], a[128:131]
  v_mfma_f32_16x16x32_bf16 a[132:135], v[220:223], v[188:191], a[132:135]
  v_mfma_f32_16x16x32_bf16 a[136:139], v[220:223], v[192:195], a[136:139]
  buffer_load_dwordx4 v[164:167], v233, s[8:11], s31 offen offset:3072
  v_mfma_f32_16x16x32_bf16 a[140:143], v[224:227], v[176:179], a[140:143]
  v_mfma_f32_16x16x32_bf16 a[144:147], v[224:227], v[180:183], a[144:147]
  v_mfma_f32_16x16x32_bf16 a[148:151], v[224:227], v[184:187], a[148:151]
  buffer_load_dwordx4 v[168:171], v233, s[8:11], s32 offen offset:3072
  v_mfma_f32_16x16x32_bf16 a[152:155], v[224:227], v[188:191], a[152:155]
  v_mfma_f32_16x16x32_bf16 a[156:159], v[224:227], v[192:195], a[156:159]
  v_mfma_f32_16x16x32_bf16 a[160:163], v[228:231], v[176:179], a[160:163]
  buffer_load_dwordx4 v[172:175], v233, s[8:11], s33 offen offset:3072
  v_mfma_f32_16x16x32_bf16 a[164:167], v[228:231], v[180:183], a[164:167]
  v_mfma_f32_16x16x32_bf16 a[168:171], v[228:231], v[184:187], a[168:171]
  v_mfma_f32_16x16x32_bf16 a[172:175], v[228:231], v[188:191], a[172:175]
  v_mfma_f32_16x16x32_bf16 a[176:179], v[228:231], v[192:195], a[176:179]
  s_waitcnt vmcnt(42)
  v_mfma_f32_16x16x32_bf16 a[0:3], a[200:203], a[180:183], a[0:3]
  v_mfma_f32_16x16x32_bf16 a[4:7], a[200:203], a[184:187], a[4:7]
  buffer_load_dwordx4 v[176:179], v234, s[8:11], s20 offen offset:0
  v_mfma_f32_16x16x32_bf16 a[8:11], a[200:203], a[188:191], a[8:11]
  v_mfma_f32_16x16x32_bf16 a[12:15], a[200:203], a[192:195], a[12:15]
  v_mfma_f32_16x16x32_bf16 a[16:19], a[200:203], a[196:199], a[16:19]
  buffer_load_dwordx4 v[196:199], v234, s[8:11], s25 offen offset:0
  v_mfma_f32_16x16x32_bf16 a[20:23], a[204:207], a[180:183], a[20:23]
  v_mfma_f32_16x16x32_bf16 a[24:27], a[204:207], a[184:187], a[24:27]
  v_mfma_f32_16x16x32_bf16 a[28:31], a[204:207], a[188:191], a[28:31]
  buffer_load_dwordx4 v[180:183], v234, s[8:11], s21 offen offset:0
  v_mfma_f32_16x16x32_bf16 a[32:35], a[204:207], a[192:195], a[32:35]
  v_mfma_f32_16x16x32_bf16 a[36:39], a[204:207], a[196:199], a[36:39]
  v_mfma_f32_16x16x32_bf16 a[40:43], a[208:211], a[180:183], a[40:43]
  buffer_load_dwordx4 v[184:187], v234, s[8:11], s22 offen offset:0
  v_mfma_f32_16x16x32_bf16 a[44:47], a[208:211], a[184:187], a[44:47]
  v_mfma_f32_16x16x32_bf16 a[48:51], a[208:211], a[188:191], a[48:51]
  v_mfma_f32_16x16x32_bf16 a[52:55], a[208:211], a[192:195], a[52:55]
  buffer_load_dwordx4 v[188:191], v234, s[8:11], s23 offen offset:0
  v_mfma_f32_16x16x32_bf16 a[56:59], a[208:211], a[196:199], a[56:59]
  v_mfma_f32_16x16x32_bf16 a[60:63], a[212:215], a[180:183], a[60:63]
  v_mfma_f32_16x16x32_bf16 a[64:67], a[212:215], a[184:187], a[64:67]
  buffer_load_dwordx4 v[192:195], v234, s[8:11], s24 offen offset:0
  v_mfma_f32_16x16x32_bf16 a[68:71], a[212:215], a[188:191], a[68:71]
  v_mfma_f32_16x16x32_bf16 a[72:75], a[212:215], a[192:195], a[72:75]
  v_mfma_f32_16x16x32_bf16 a[76:79], a[212:215], a[196:199], a[76:79]
  buffer_load_dwordx4 v[200:203], v234, s[8:11], s26 offen offset:0
  v_mfma_f32_16x16x32_bf16 a[80:83], a[216:219], a[180:183], a[80:83]
  v_mfma_f32_16x16x32_bf16 a[84:87], a[216:219], a[184:187], a[84:87]
  v_mfma_f32_16x16x32_bf16 a[88:91], a[216:219], a[188:191], a[88:91]
  buffer_load_dwordx4 v[204:207], v234, s[8:11], s27 offen offset:0
  v_mfma_f32_16x16x32_bf16 a[92:95], a[216:219], a[192:195], a[92:95]
  v_mfma_f32_16x16x32_bf16 a[96:99], a[216:219], a[196:199], a[96:99]
  v_mfma_f32_16x16x32_bf16 a[100:103], a[220:223], a[180:183], a[100:103]
  buffer_load_dwordx4 v[208:211], v234, s[8:11], s28 offen offset:0
  v_mfma_f32_16x16x32_bf16 a[104:107], a[220:223], a[184:187], a[104:107]
  v_mfma_f32_16x16x32_bf16 a[108:111], a[220:223], a[188:191], a[108:111]
  v_mfma_f32_16x16x32_bf16 a[112:115], a[220:223], a[192:195], a[112:115]
  buffer_load_dwordx4 v[212:215], v234, s[8:11], s29 offen offset:0
  v_mfma_f32_16x16x32_bf16 a[116:119], a[220:223], a[196:199], a[116:119]
  v_mfma_f32_16x16x32_bf16 a[120:123], a[224:227], a[180:183], a[120:123]
  v_mfma_f32_16x16x32_bf16 a[124:127], a[224:227], a[184:187], a[124:127]
  buffer_load_dwordx4 v[216:219], v234, s[8:11], s30 offen offset:0
  v_mfma_f32_16x16x32_bf16 a[128:131], a[224:227], a[188:191], a[128:131]
  v_mfma_f32_16x16x32_bf16 a[132:135], a[224:227], a[192:195], a[132:135]
  v_mfma_f32_16x16x32_bf16 a[136:139], a[224:227], a[196:199], a[136:139]
  buffer_load_dwordx4 v[220:223], v234, s[8:11], s31 offen offset:0
  v_mfma_f32_16x16x32_bf16 a[140:143], a[228:231], a[180:183], a[140:143]
  v_mfma_f32_16x16x32_bf16 a[144:147], a[228:231], a[184:187], a[144:147]
  v_mfma_f32_16x16x32_bf16 a[148:151], a[228:231], a[188:191], a[148:151]
  buffer_load_dwordx4 v[224:227], v234, s[8:11], s32 offen offset:0
  v_mfma_f32_16x16x32_bf16 a[152:155], a[228:231], a[192:195], a[152:155]
  v_mfma_f32_16x16x32_bf16 a[156:159], a[228:231], a[196:199], a[156:159]
  v_mfma_f32_16x16x32_bf16 a[160:163], a[232:235], a[180:183], a[160:163]
  buffer_load_dwordx4 v[228:231], v234, s[8:11], s33 offen offset:0
  v_mfma_f32_16x16x32_bf16 a[164:167], a[232:235], a[184:187], a[164:167]
  v_mfma_f32_16x16x32_bf16 a[168:171], a[232:235], a[188:191], a[168:171]
  v_mfma_f32_16x16x32_bf16 a[172:175], a[232:235], a[192:195], a[172:175]
  v_mfma_f32_16x16x32_bf16 a[176:179], a[232:235], a[196:199], a[176:179]
  s_waitcnt vmcnt(42)
  v_mfma_f32_16x16x32_bf16 a[0:3], v[28:31], v[8:11], a[0:3]
  v_mfma_f32_16x16x32_bf16 a[4:7], v[28:31], v[12:15], a[4:7]
  buffer_load_dwordx4 a[180:183], v234, s[8:11], s20 offen offset:1024
  v_mfma_f32_16x16x32_bf16 a[8:11], v[28:31], v[16:19], a[8:11]
  v_mfma_f32_16x16x32_bf16 a[12:15], v[28:31], v[20:23], a[12:15]
  v_mfma_f32_16x16x32_bf16 a[16:19], v[28:31], v[24:27], a[16:19]
  buffer_load_dwordx4 a[200:203], v234, s[8:11], s25 offen offset:1024
  v_mfma_f32_16x16x32_bf16 a[20:23], v[32:35], v[8:11], a[20:23]
  v_mfma_f32_16x16x32_bf16 a[24:27], v[32:35], v[12:15], a[24:27]
  v_mfma_f32_16x16x32_bf16 a[28:31], v[32:35], v[16:19], a[28:31]
  buffer_load_dwordx4 a[184:187], v234, s[8:11], s21 offen offset:1024
  v_mfma_f32_16x16x32_bf16 a[32:35], v[32:35], v[20:23], a[32:35]
  v_mfma_f32_16x16x32_bf16 a[36:39], v[32:35], v[24:27], a[36:39]
  v_mfma_f32_16x16x32_bf16 a[40:43], v[36:39], v[8:11], a[40:43]
  buffer_load_dwordx4 a[188:191], v234, s[8:11], s22 offen offset:1024
  v_mfma_f32_16x16x32_bf16 a[44:47], v[36:39], v[12:15], a[44:47]
  v_mfma_f32_16x16x32_bf16 a[48:51], v[36:39], v[16:19], a[48:51]
  v_mfma_f32_16x16x32_bf16 a[52:55], v[36:39], v[20:23], a[52:55]
  buffer_load_dwordx4 a[192:195], v234, s[8:11], s23 offen offset:1024
  v_mfma_f32_16x16x32_bf16 a[56:59], v[36:39], v[24:27], a[56:59]
  v_mfma_f32_16x16x32_bf16 a[60:63], v[40:43], v[8:11], a[60:63]
  v_mfma_f32_16x16x32_bf16 a[64:67], v[40:43], v[12:15], a[64:67]
  buffer_load_dwordx4 a[196:199], v234, s[8:11], s24 offen offset:1024
  v_mfma_f32_16x16x32_bf16 a[68:71], v[40:43], v[16:19], a[68:71]
  v_mfma_f32_16x16x32_bf16 a[72:75], v[40:43], v[20:23], a[72:75]
  v_mfma_f32_16x16x32_bf16 a[76:79], v[40:43], v[24:27], a[76:79]
  buffer_load_dwordx4 a[204:207], v234, s[8:11], s26 offen offset:1024
  v_mfma_f32_16x16x32_bf16 a[80:83], v[44:47], v[8:11], a[80:83]
  v_mfma_f32_16x16x32_bf16 a[84:87], v[44:47], v[12:15], a[84:87]
  v_mfma_f32_16x16x32_bf16 a[88:91], v[44:47], v[16:19], a[88:91]
  buffer_load_dwordx4 a[208:211], v234, s[8:11], s27 offen offset:1024
  v_mfma_f32_16x16x32_bf16 a[92:95], v[44:47], v[20:23], a[92:95]
  v_mfma_f32_16x16x32_bf16 a[96:99], v[44:47], v[24:27], a[96:99]
  v_mfma_f32_16x16x32_bf16 a[100:103], v[48:51], v[8:11], a[100:103]
  buffer_load_dwordx4 a[212:215], v234, s[8:11], s28 offen offset:1024
  v_mfma_f32_16x16x32_bf16 a[104:107], v[48:51], v[12:15], a[104:107]
  v_mfma_f32_16x16x32_bf16 a[108:111], v[48:51], v[16:19], a[108:111]
  v_mfma_f32_16x16x32_bf16 a[112:115], v[48:51], v[20:23], a[112:115]
  buffer_load_dwordx4 a[216:219], v234, s[8:11], s29 offen offset:1024
  v_mfma_f32_16x16x32_bf16 a[116:119], v[48:51], v[24:27], a[116:119]
  v_mfma_f32_16x16x32_bf16 a[120:123], v[52:55], v[8:11], a[120:123]
  v_mfma_f32_16x16x32_bf16 a[124:127], v[52:55], v[12:15], a[124:127]
  buffer_load_dwordx4 a[220:223], v234, s[8:11], s30 offen offset:1024
  v_mfma_f32_16x16x32_bf16 a[128:131], v[52:55], v[16:19], a[128:131]
  v_mfma_f32_16x16x32_bf16 a[132:135], v[52:55], v[20:23], a[132:135]
  v_mfma_f32_16x16x32_bf16 a[136:139], v[52:55], v[24:27], a[136:139]
  buffer_load_dwordx4 a[224:227], v234, s[8:11], s31 offen offset:1024
  v_mfma_f32_16x16x32_bf16 a[140:143], v[56:59], v[8:11], a[140:143]
  v_mfma_f32_16x16x32_bf16 a[144:147], v[56:59], v[12:15], a[144:147]
  v_mfma_f32_16x16x32_bf16 a[148:151], v[56:59], v[16:19], a[148:151]
  buffer_load_dwordx4 a[228:231], v234, s[8:11], s32 offen offset:1024
  v_mfma_f32_16x16x32_bf16 a[152:155], v[56:59], v[20:23], a[152:155]
  v_mfma_f32_16x16x32_bf16 a[156:159], v[56:59], v[24:27], a[156:159]
  v_mfma_f32_16x16x32_bf16 a[160:163], v[60:63], v[8:11], a[160:163]
  buffer_load_dwordx4 a[232:235], v234, s[8:11], s33 offen offset:1024
  v_mfma_f32_16x16x32_bf16 a[164:167], v[60:63], v[12:15], a[164:167]
  v_mfma_f32_16x16x32_bf16 a[168:171], v[60:63], v[16:19], a[168:171]
  v_mfma_f32_16x16x32_bf16 a[172:175], v[60:63], v[20:23], a[172:175]
  v_mfma_f32_16x16x32_bf16 a[176:179], v[60:63], v[24:27], a[176:179]
  s_waitcnt vmcnt(42)
  v_mfma_f32_16x16x32_bf16 a[0:3], v[84:87], v[64:67], a[0:3]
  v_mfma_f32_16x16x32_bf16 a[4:7], v[84:87], v[68:71], a[4:7]
  buffer_load_dwordx4 v[8:11], v234, s[8:11], s20 offen offset:2048
  v_mfma_f32_16x16x32_bf16 a[8:11], v[84:87], v[72:75], a[8:11]
  v_mfma_f32_16x16x32_bf16 a[12:15], v[84:87], v[76:79], a[12:15]
  v_mfma_f32_16x16x32_bf16 a[16:19], v[84:87], v[80:83], a[16:19]
  buffer_load_dwordx4 v[28:31], v234, s[8:11], s25 offen offset:2048
  v_mfma_f32_16x16x32_bf16 a[20:23], v[88:91], v[64:67], a[20:23]
  v_mfma_f32_16x16x32_bf16 a[24:27], v[88:91], v[68:71], a[24:27]
  v_mfma_f32_16x16x32_bf16 a[28:31], v[88:91], v[72:75], a[28:31]
  buffer_load_dwordx4 v[12:15], v234, s[8:11], s21 offen offset:2048
  v_mfma_f32_16x16x32_bf16 a[32:35], v[88:91], v[76:79], a[32:35]
  v_mfma_f32_16x16x32_bf16 a[36:39], v[88:91], v[80:83], a[36:39]
  v_mfma_f32_16x16x32_bf16 a[40:43], v[92:95], v[64:67], a[40:43]
  buffer_load_dwordx4 v[16:19], v234, s[8:11], s22 offen offset:2048
  v_mfma_f32_16x16x32_bf16 a[44:47], v[92:95], v[68:71], a[44:47]
  v_mfma_f32_16x16x32_bf16 a[48:51], v[92:95], v[72:75], a[48:51]
  v_mfma_f32_16x16x32_bf16 a[52:55], v[92:95], v[76:79], a[52:55]
  buffer_load_dwordx4 v[20:23], v234, s[8:11], s23 offen offset:2048
  v_mfma_f32_16x16x32_bf16 a[56:59], v[92:95], v[80:83], a[56:59]
  v_mfma_f32_16x16x32_bf16 a[60:63], v[96:99], v[64:67], a[60:63]
  v_mfma_f32_16x16x32_bf16 a[64:67], v[96:99], v[68:71], a[64:67]
  buffer_load_dwordx4 v[24:27], v234, s[8:11], s24 offen offset:2048
  v_mfma_f32_16x16x32_bf16 a[68:71], v[96:99], v[72:75], a[68:71]
  v_mfma_f32_16x16x32_bf16 a[72:75], v[96:99], v[76:79], a[72:75]
  v_mfma_f32_16x16x32_bf16 a[76:79], v[96:99], v[80:83], a[76:79]
  buffer_load_dwordx4 v[32:35], v234, s[8:11], s26 offen offset:2048
  v_mfma_f32_16x16x32_bf16 a[80:83], v[100:103], v[64:67], a[80:83]
  v_mfma_f32_16x16x32_bf16 a[84:87], v[100:103], v[68:71], a[84:87]
  v_mfma_f32_16x16x32_bf16 a[88:91], v[100:103], v[72:75], a[88:91]
  buffer_load_dwordx4 v[36:39], v234, s[8:11], s27 offen offset:2048
  v_mfma_f32_16x16x32_bf16 a[92:95], v[100:103], v[76:79], a[92:95]
  v_mfma_f32_16x16x32_bf16 a[96:99], v[100:103], v[80:83], a[96:99]
  v_mfma_f32_16x16x32_bf16 a[100:103], v[104:107], v[64:67], a[100:103]
  buffer_load_dwordx4 v[40:43], v234, s[8:11], s28 offen offset:2048
  v_mfma_f32_16x16x32_bf16 a[104:107], v[104:107], v[68:71], a[104:107]
  v_mfma_f32_16x16x32_bf16 a[108:111], v[104:107], v[72:75], a[108:111]
  v_mfma_f32_16x16x32_bf16 a[112:115], v[104:107], v[76:79], a[112:115]
  buffer_load_dwordx4 v[44:47], v234, s[8:11], s29 offen offset:2048
  v_mfma_f32_16x16x32_bf16 a[116:119], v[104:107], v[80:83], a[116:119]
  v_mfma_f32_16x16x32_bf16 a[120:123], v[108:111], v[64:67], a[120:123]
  v_mfma_f32_16x16x32_bf16 a[124:127], v[108:111], v[68:71], a[124:127]
  buffer_load_dwordx4 v[48:51], v234, s[8:11], s30 offen offset:2048
  v_mfma_f32_16x16x32_bf16 a[128:131], v[108:111], v[72:75], a[128:131]
  v_mfma_f32_16x16x32_bf16 a[132:135], v[108:111], v[76:79], a[132:135]
  v_mfma_f32_16x16x32_bf16 a[136:139], v[108:111], v[80:83], a[136:139]
  buffer_load_dwordx4 v[52:55], v234, s[8:11], s31 offen offset:2048
  v_mfma_f32_16x16x32_bf16 a[140:143], v[112:115], v[64:67], a[140:143]
  v_mfma_f32_16x16x32_bf16 a[144:147], v[112:115], v[68:71], a[144:147]
  v_mfma_f32_16x16x32_bf16 a[148:151], v[112:115], v[72:75], a[148:151]
  buffer_load_dwordx4 v[56:59], v234, s[8:11], s32 offen offset:2048
  v_mfma_f32_16x16x32_bf16 a[152:155], v[112:115], v[76:79], a[152:155]
  v_mfma_f32_16x16x32_bf16 a[156:159], v[112:115], v[80:83], a[156:159]
  v_mfma_f32_16x16x32_bf16 a[160:163], v[116:119], v[64:67], a[160:163]
  buffer_load_dwordx4 v[60:63], v234, s[8:11], s33 offen offset:2048
  v_mfma_f32_16x16x32_bf16 a[164:167], v[116:119], v[68:71], a[164:167]
  v_mfma_f32_16x16x32_bf16 a[168:171], v[116:119], v[72:75], a[168:171]
  v_mfma_f32_16x16x32_bf16 a[172:175], v[116:119], v[76:79], a[172:175]
  v_mfma_f32_16x16x32_bf16 a[176:179], v[116:119], v[80:83], a[176:179]
  s_waitcnt vmcnt(42)
  v_mfma_f32_16x16x32_bf16 a[0:3], v[140:143], v[120:123], a[0:3]
  v_mfma_f32_16x16x32_bf16 a[4:7], v[140:143], v[124:127], a[4:7]
  buffer_load_dwordx4 v[64:67], v234, s[8:11], s20 offen offset:3072
  v_mfma_f32_16x16x32_bf16 a[8:11], v[140:143], v[128:131], a[8:11]
  v_mfma_f32_16x16x32_bf16 a[12:15], v[140:143], v[132:135], a[12:15]
  v_mfma_f32_16x16x32_bf16 a[16:19], v[140:143], v[136:139], a[16:19]
  buffer_load_dwordx4 v[84:87], v234, s[8:11], s25 offen offset:3072
  v_mfma_f32_16x16x32_bf16 a[20:23], v[144:147], v[120:123], a[20:23]
  v_mfma_f32_16x16x32_bf16 a[24:27], v[144:147], v[124:127], a[24:27]
  v_mfma_f32_16x16x32_bf16 a[28:31], v[144:147], v[128:131], a[28:31]
  buffer_load_dwordx4 v[68:71], v234, s[8:11], s21 offen offset:3072
  v_mfma_f32_16x16x32_bf16 a[32:35], v[144:147], v[132:135], a[32:35]
  v_mfma_f32_16x16x32_bf16 a[36:39], v[144:147], v[136:139], a[36:39]
  v_mfma_f32_16x16x32_bf16 a[40:43], v[148:151], v[120:123], a[40:43]
  buffer_load_dwordx4 v[72:75], v234, s[8:11], s22 offen offset:3072
  v_mfma_f32_16x16x32_bf16 a[44:47], v[148:151], v[124:127], a[44:47]
  v_mfma_f32_16x16x32_bf16 a[48:51], v[148:151], v[128:131], a[48:51]
  v_mfma_f32_16x16x32_bf16 a[52:55], v[148:151], v[132:135], a[52:55]
  buffer_load_dwordx4 v[76:79], v234, s[8:11], s23 offen offset:3072
  v_mfma_f32_16x16x32_bf16 a[56:59], v[148:151], v[136:139], a[56:59]
  v_mfma_f32_16x16x32_bf16 a[60:63], v[152:155], v[120:123], a[60:63]
  v_mfma_f32_16x16x32_bf16 a[64:67], v[152:155], v[124:127], a[64:67]
  buffer_load_dwordx4 v[80:83], v234, s[8:11], s24 offen offset:3072
  v_mfma_f32_16x16x32_bf16 a[68:71], v[152:155], v[128:131], a[68:71]
  v_mfma_f32_16x16x32_bf16 a[72:75], v[152:155], v[132:135], a[72:75]
  v_mfma_f32_16x16x32_bf16 a[76:79], v[152:155], v[136:139], a[76:79]
  buffer_load_dwordx4 v[88:91], v234, s[8:11], s26 offen offset:3072
  v_mfma_f32_16x16x32_bf16 a[80:83], v[156:159], v[120:123], a[80:83]
  v_mfma_f32_16x16x32_bf16 a[84:87], v[156:159], v[124:127], a[84:87]
  v_mfma_f32_16x16x32_bf16 a[88:91], v[156:159], v[128:131], a[88:91]
  buffer_load_dwordx4 v[92:95], v234, s[8:11], s27 offen offset:3072
  v_mfma_f32_16x16x32_bf16 a[92:95], v[156:159], v[132:135], a[92:95]
  v_mfma_f32_16x16x32_bf16 a[96:99], v[156:159], v[136:139], a[96:99]
  v_mfma_f32_16x16x32_bf16 a[100:103], v[160:163], v[120:123], a[100:103]
  buffer_load_dwordx4 v[96:99], v234, s[8:11], s28 offen offset:3072
  v_mfma_f32_16x16x32_bf16 a[104:107], v[160:163], v[124:127], a[104:107]
  v_mfma_f32_16x16x32_bf16 a[108:111], v[160:163], v[128:131], a[108:111]
  v_mfma_f32_16x16x32_bf16 a[112:115], v[160:163], v[132:135], a[112:115]
  buffer_load_dwordx4 v[100:103], v234, s[8:11], s29 offen offset:3072
  v_mfma_f32_16x16x32_bf16 a[116:119], v[160:163], v[136:139], a[116:119]
  v_mfma_f32_16x16x32_bf16 a[120:123], v[164:167], v[120:123], a[120:123]
  v_mfma_f32_16x16x32_bf16 a[124:127], v[164:167], v[124:127], a[124:127]
  buffer_load_dwordx4 v[104:107], v234, s[8:11], s30 offen offset:3072
  v_mfma_f32_16x16x32_bf16 a[128:131], v[164:167], v[128:131], a[128:131]
  v_mfma_f32_16x16x32_bf16 a[132:135], v[164:167], v[132:135], a[132:135]
  v_mfma_f32_16x16x32_bf16 a[136:139], v[164:167], v[136:139], a[136:139]
  buffer_load_dwordx4 v[108:111], v234, s[8:11], s31 offen offset:3072
  v_mfma_f32_16x16x32_bf16 a[140:143], v[168:171], v[120:123], a[140:143]
  v_mfma_f32_16x16x32_bf16 a[144:147], v[168:171], v[124:127], a[144:147]
  v_mfma_f32_16x16x32_bf16 a[148:151], v[168:171], v[128:131], a[148:151]
  buffer_load_dwordx4 v[112:115], v234, s[8:11], s32 offen offset:3072
  v_mfma_f32_16x16x32_bf16 a[152:155], v[168:171], v[132:135], a[152:155]
  v_mfma_f32_16x16x32_bf16 a[156:159], v[168:171], v[136:139], a[156:159]
  v_mfma_f32_16x16x32_bf16 a[160:163], v[172:175], v[120:123], a[160:163]
  buffer_load_dwordx4 v[116:119], v234, s[8:11], s33 offen offset:3072
  v_mfma_f32_16x16x32_bf16 a[164:167], v[172:175], v[124:127], a[164:167]
  v_mfma_f32_16x16x32_bf16 a[168:171], v[172:175], v[128:131], a[168:171]
  v_mfma_f32_16x16x32_bf16 a[172:175], v[172:175], v[132:135], a[172:175]
  v_mfma_f32_16x16x32_bf16 a[176:179], v[172:175], v[136:139], a[176:179]
  s_waitcnt vmcnt(42)
  v_mfma_f32_16x16x32_bf16 a[0:3], v[196:199], v[176:179], a[0:3]
  v_mfma_f32_16x16x32_bf16 a[4:7], v[196:199], v[180:183], a[4:7]
  v_mfma_f32_16x16x32_bf16 a[8:11], v[196:199], v[184:187], a[8:11]
  v_mfma_f32_16x16x32_bf16 a[12:15], v[196:199], v[188:191], a[12:15]
  v_mfma_f32_16x16x32_bf16 a[16:19], v[196:199], v[192:195], a[16:19]
  v_mfma_f32_16x16x32_bf16 a[20:23], v[200:203], v[176:179], a[20:23]
  v_mfma_f32_16x16x32_bf16 a[24:27], v[200:203], v[180:183], a[24:27]
  v_mfma_f32_16x16x32_bf16 a[28:31], v[200:203], v[184:187], a[28:31]
  v_mfma_f32_16x16x32_bf16 a[32:35], v[200:203], v[188:191], a[32:35]
  v_mfma_f32_16x16x32_bf16 a[36:39], v[200:203], v[192:195], a[36:39]
  v_mfma_f32_16x16x32_bf16 a[40:43], v[204:207], v[176:179], a[40:43]
  v_mfma_f32_16x16x32_bf16 a[44:47], v[204:207], v[180:183], a[44:47]
  v_mfma_f32_16x16x32_bf16 a[48:51], v[204:207], v[184:187], a[48:51]
  v_mfma_f32_16x16x32_bf16 a[52:55], v[204:207], v[188:191], a[52:55]
  v_mfma_f32_16x16x32_bf16 a[56:59], v[204:207], v[192:195], a[56:59]
  v_mfma_f32_16x16x32_bf16 a[60:63], v[208:211], v[176:179], a[60:63]
  v_mfma_f32_16x16x32_bf16 a[64:67], v[208:211], v[180:183], a[64:67]
  v_mfma_f32_16x16x32_bf16 a[68:71], v[208:211], v[184:187], a[68:71]
  v_mfma_f32_16x16x32_bf16 a[72:75], v[208:211], v[188:191], a[72:75]
  v_mfma_f32_16x16x32_bf16 a[76:79], v[208:211], v[192:195], a[76:79]
  v_mfma_f32_16x16x32_bf16 a[80:83], v[212:215], v[176:179], a[80:83]
  v_mfma_f32_16x16x32_bf16 a[84:87], v[212:215], v[180:183], a[84:87]
  v_mfma_f32_16x16x32_bf16 a[88:91], v[212:215], v[184:187], a[88:91]
  v_mfma_f32_16x16x32_bf16 a[92:95], v[212:215], v[188:191], a[92:95]
  v_mfma_f32_16x16x32_bf16 a[96:99], v[212:215], v[192:195], a[96:99]
  v_mfma_f32_16x16x32_bf16 a[100:103], v[216:219], v[176:179], a[100:103]
  v_mfma_f32_16x16x32_bf16 a[104:107], v[216:219], v[180:183], a[104:107]
  v_mfma_f32_16x16x32_bf16 a[108:111], v[216:219], v[184:187], a[108:111]
  v_mfma_f32_16x16x32_bf16 a[112:115], v[216:219], v[188:191], a[112:115]
  v_mfma_f32_16x16x32_bf16 a[116:119], v[216:219], v[192:195], a[116:119]
  v_mfma_f32_16x16x32_bf16 a[120:123], v[220:223], v[176:179], a[120:123]
  v_mfma_f32_16x16x32_bf16 a[124:127], v[220:223], v[180:183], a[124:127]
  v_mfma_f32_16x16x32_bf16 a[128:131], v[220:223], v[184:187], a[128:131]
  v_mfma_f32_16x16x32_bf16 a[132:135], v[220:223], v[188:191], a[132:135]
  v_mfma_f32_16x16x32_bf16 a[136:139], v[220:223], v[192:195], a[136:139]
  v_mfma_f32_16x16x32_bf16 a[140:143], v[224:227], v[176:179], a[140:143]
  v_mfma_f32_16x16x32_bf16 a[144:147], v[224:227], v[180:183], a[144:147]
  v_mfma_f32_16x16x32_bf16 a[148:151], v[224:227], v[184:187], a[148:151]
  v_mfma_f32_16x16x32_bf16 a[152:155], v[224:227], v[188:191], a[152:155]
  v_mfma_f32_16x16x32_bf16 a[156:159], v[224:227], v[192:195], a[156:159]
  v_mfma_f32_16x16x32_bf16 a[160:163], v[228:231], v[176:179], a[160:163]
  v_mfma_f32_16x16x32_bf16 a[164:167], v[228:231], v[180:183], a[164:167]
  v_mfma_f32_16x16x32_bf16 a[168:171], v[228:231], v[184:187], a[168:171]
  v_mfma_f32_16x16x32_bf16 a[172:175], v[228:231], v[188:191], a[172:175]
  v_mfma_f32_16x16x32_bf16 a[176:179], v[228:231], v[192:195], a[176:179]
  s_waitcnt vmcnt(28)
  v_mfma_f32_16x16x32_bf16 a[0:3], a[200:203], a[180:183], a[0:3]
  v_mfma_f32_16x16x32_bf16 a[4:7], a[200:203], a[184:187], a[4:7]
  v_mfma_f32_16x16x32_bf16 a[8:11], a[200:203], a[188:191], a[8:11]
  v_mfma_f32_16x16x32_bf16 a[12:15], a[200:203], a[192:195], a[12:15]
  v_mfma_f32_16x16x32_bf16 a[16:19], a[200:203], a[196:199], a[16:19]
  v_mfma_f32_16x16x32_bf16 a[20:23], a[204:207], a[180:183], a[20:23]
  v_mfma_f32_16x16x32_bf16 a[24:27], a[204:207], a[184:187], a[24:27]
  v_mfma_f32_16x16x32_bf16 a[28:31], a[204:207], a[188:191], a[28:31]
  v_mfma_f32_16x16x32_bf16 a[32:35], a[204:207], a[192:195], a[32:35]
  v_mfma_f32_16x16x32_bf16 a[36:39], a[204:207], a[196:199], a[36:39]
  v_mfma_f32_16x16x32_bf16 a[40:43], a[208:211], a[180:183], a[40:43]
  v_mfma_f32_16x16x32_bf16 a[44:47], a[208:211], a[184:187], a[44:47]
  v_mfma_f32_16x16x32_bf16 a[48:51], a[208:211], a[188:191], a[48:51]
  v_mfma_f32_16x16x32_bf16 a[52:55], a[208:211], a[192:195], a[52:55]
  v_mfma_f32_16x16x32_bf16 a[56:59], a[208:211], a[196:199], a[56:59]
  v_mfma_f32_16x16x32_bf16 a[60:63], a[212:215], a[180:183], a[60:63]
  v_mfma_f32_16x16x32_bf16 a[64:67], a[212:215], a[184:187], a[64:67]
  v_mfma_f32_16x16x32_bf16 a[68:71], a[212:215], a[188:191], a[68:71]
  v_mfma_f32_16x16x32_bf16 a[72:75], a[212:215], a[192:195], a[72:75]
  v_mfma_f32_16x16x32_bf16 a[76:79], a[212:215], a[196:199], a[76:79]
  v_mfma_f32_16x16x32_bf16 a[80:83], a[216:219], a[180:183], a[80:83]
  v_mfma_f32_16x16x32_bf16 a[84:87], a[216:219], a[184:187], a[84:87]
  v_mfma_f32_16x16x32_bf16 a[88:91], a[216:219], a[188:191], a[88:91]
  v_mfma_f32_16x16x32_bf16 a[92:95], a[216:219], a[192:195], a[92:95]
  v_mfma_f32_16x16x32_bf16 a[96:99], a[216:219], a[196:199], a[96:99]
  v_mfma_f32_16x16x32_bf16 a[100:103], a[220:223], a[180:183], a[100:103]
  v_mfma_f32_16x16x32_bf16 a[104:107], a[220:223], a[184:187], a[104:107]
  v_mfma_f32_16x16x32_bf16 a[108:111], a[220:223], a[188:191], a[108:111]
  v_mfma_f32_16x16x32_bf16 a[112:115], a[220:223], a[192:195], a[112:115]
  v_mfma_f32_16x16x32_bf16 a[116:119], a[220:223], a[196:199], a[116:119]
  v_mfma_f32_16x16x32_bf16 a[120:123], a[224:227], a[180:183], a[120:123]
  v_mfma_f32_16x16x32_bf16 a[124:127], a[224:227], a[184:187], a[124:127]
  v_mfma_f32_16x16x32_bf16 a[128:131], a[224:227], a[188:191], a[128:131]
  v_mfma_f32_16x16x32_bf16 a[132:135], a[224:227], a[192:195], a[132:135]
  v_mfma_f32_16x16x32_bf16 a[136:139], a[224:227], a[196:199], a[136:139]
  v_mfma_f32_16x16x32_bf16 a[140:143], a[228:231], a[180:183], a[140:143]
  v_mfma_f32_16x16x32_bf16 a[144:147], a[228:231], a[184:187], a[144:147]
  v_mfma_f32_16x16x32_bf16 a[148:151], a[228:231], a[188:191], a[148:151]
  v_mfma_f32_16x16x32_bf16 a[152:155], a[228:231], a[192:195], a[152:155]
  v_mfma_f32_16x16x32_bf16 a[156:159], a[228:231], a[196:199], a[156:159]
  v_mfma_f32_16x16x32_bf16 a[160:163], a[232:235], a[180:183], a[160:163]
  v_mfma_f32_16x16x32_bf16 a[164:167], a[232:235], a[184:187], a[164:167]
  v_mfma_f32_16x16x32_bf16 a[168:171], a[232:235], a[188:191], a[168:171]
  v_mfma_f32_16x16x32_bf16 a[172:175], a[232:235], a[192:195], a[172:175]
  v_mfma_f32_16x16x32_bf16 a[176:179], a[232:235], a[196:199], a[176:179]
  s_waitcnt vmcnt(14)
  v_mfma_f32_16x16x32_bf16 a[0:3], v[28:31], v[8:11], a[0:3]
  v_mfma_f32_16x16x32_bf16 a[4:7], v[28:31], v[12:15], a[4:7]
  v_mfma_f32_16x16x32_bf16 a[8:11], v[28:31], v[16:19], a[8:11]
  v_mfma_f32_16x16x32_bf16 a[12:15], v[28:31], v[20:23], a[12:15]
  v_mfma_f32_16x16x32_bf16 a[16:19], v[28:31], v[24:27], a[16:19]
  v_mfma_f32_16x16x32_bf16 a[20:23], v[32:35], v[8:11], a[20:23]
  v_mfma_f32_16x16x32_bf16 a[24:27], v[32:35], v[12:15], a[24:27]
  v_mfma_f32_16x16x32_bf16 a[28:31], v[32:35], v[16:19], a[28:31]
  v_mfma_f32_16x16x32_bf16 a[32:35], v[32:35], v[20:23], a[32:35]
  v_mfma_f32_16x16x32_bf16 a[36:39], v[32:35], v[24:27], a[36:39]
  v_mfma_f32_16x16x32_bf16 a[40:43], v[36:39], v[8:11], a[40:43]
  v_mfma_f32_16x16x32_bf16 a[44:47], v[36:39], v[12:15], a[44:47]
  v_mfma_f32_16x16x32_bf16 a[48:51], v[36:39], v[16:19], a[48:51]
  v_mfma_f32_16x16x32_bf16 a[52:55], v[36:39], v[20:23], a[52:55]
  v_mfma_f32_16x16x32_bf16 a[56:59], v[36:39], v[24:27], a[56:59]
  v_mfma_f32_16x16x32_bf16 a[60:63], v[40:43], v[8:11], a[60:63]
  v_mfma_f32_16x16x32_bf16 a[64:67], v[40:43], v[12:15], a[64:67]
  v_mfma_f32_16x16x32_bf16 a[68:71], v[40:43], v[16:19], a[68:71]
  v_mfma_f32_16x16x32_bf16 a[72:75], v[40:43], v[20:23], a[72:75]
  v_mfma_f32_16x16x32_bf16 a[76:79], v[40:43], v[24:27], a[76:79]
  v_mfma_f32_16x16x32_bf16 a[80:83], v[44:47], v[8:11], a[80:83]
  v_mfma_f32_16x16x32_bf16 a[84:87], v[44:47], v[12:15], a[84:87]
  v_mfma_f32_16x16x32_bf16 a[88:91], v[44:47], v[16:19], a[88:91]
  v_mfma_f32_16x16x32_bf16 a[92:95], v[44:47], v[20:23], a[92:95]
  v_mfma_f32_16x16x32_bf16 a[96:99], v[44:47], v[24:27], a[96:99]
  v_mfma_f32_16x16x32_bf16 a[100:103], v[48:51], v[8:11], a[100:103]
  v_mfma_f32_16x16x32_bf16 a[104:107], v[48:51], v[12:15], a[104:107]
  v_mfma_f32_16x16x32_bf16 a[108:111], v[48:51], v[16:19], a[108:111]
  v_mfma_f32_16x16x32_bf16 a[112:115], v[48:51], v[20:23], a[112:115]
  v_mfma_f32_16x16x32_bf16 a[116:119], v[48:51], v[24:27], a[116:119]
  v_mfma_f32_16x16x32_bf16 a[120:123], v[52:55], v[8:11], a[120:123]
  v_mfma_f32_16x16x32_bf16 a[124:127], v[52:55], v[12:15], a[124:127]
  v_mfma_f32_16x16x32_bf16 a[128:131], v[52:55], v[16:19], a[128:131]
  v_mfma_f32_16x16x32_bf16 a[132:135], v[52:55], v[20:23], a[132:135]
  v_mfma_f32_16x16x32_bf16 a[136:139], v[52:55], v[24:27], a[136:139]
  v_mfma_f32_16x16x32_bf16 a[140:143], v[56:59], v[8:11], a[140:143]
  v_mfma_f32_16x16x32_bf16 a[144:147], v[56:59], v[12:15], a[144:147]
  v_mfma_f32_16x16x32_bf16 a[148:151], v[56:59], v[16:19], a[148:151]
  v_mfma_f32_16x16x32_bf16 a[152:155], v[56:59], v[20:23], a[152:155]
  v_mfma_f32_16x16x32_bf16 a[156:159], v[56:59], v[24:27], a[156:159]
  v_mfma_f32_16x16x32_bf16 a[160:163], v[60:63], v[8:11], a[160:163]
  v_mfma_f32_16x16x32_bf16 a[164:167], v[60:63], v[12:15], a[164:167]
  v_mfma_f32_16x16x32_bf16 a[168:171], v[60:63], v[16:19], a[168:171]
  v_mfma_f32_16x16x32_bf16 a[172:175], v[60:63], v[20:23], a[172:175]
  v_mfma_f32_16x16x32_bf16 a[176:179], v[60:63], v[24:27], a[176:179]
  s_nop 7
  v_and_b32 v5, 15, v2
  v_mul_u32_u24 v5, 1152, v5
  v_lshrrev_b32 v6, 4, v2
  v_lshl_add_u32 v5, v6, 3, v5
  s_mul_i32 s18, s16, 92160
  s_mul_i32 s19, s17, 288
  s_add_u32 s18, s18, s19
  s_add_u32 s20, s18, 0
  s_add_u32 s21, s18, 18432
  s_add_u32 s22, s18, 36864
  s_add_u32 s23, s18, 55296
  s_add_u32 s24, s18, 73728
  s_mul_i32 s18, s3, 36864
  v_add_u32 v232, s18, v3
  s_cmp_lg_u32 s3, 0
  s_cbranch_scc1 L_b_skipr0
  s_waitcnt vmcnt(0)
  v_mfma_f32_16x16x32_bf16 a[4:7], v[84:87], v[68:71], a[4:7]
  v_mfma_f32_16x16x32_bf16 a[8:11], v[84:87], v[72:75], a[8:11]
  v_mfma_f32_16x16x32_bf16 a[12:15], v[84:87], v[76:79], a[12:15]
  v_mfma_f32_16x16x32_bf16 a[20:23], v[88:91], v[64:67], a[20:23]
  ds_write_b128 v237, a[4:7] offset:0
  v_mfma_f32_16x16x32_bf16 a[24:27], v[88:91], v[68:71], a[24:27]
  ds_write_b128 v238, a[8:11] offset:0
  v_mfma_f32_16x16x32_bf16 a[28:31], v[88:91], v[72:75], a[28:31]
  ds_write_b128 v239, a[12:15] offset:0
  v_mfma_f32_16x16x32_bf16 a[36:39], v[88:91], v[80:83], a[36:39]
  ds_write_b128 v237, a[20:23] offset:1024
  v_mfma_f32_16x16x32_bf16 a[40:43], v[92:95], v[64:67], a[40:43]
  ds_write_b128 v238, a[24:27] offset:1024
  v_mfma_f32_16x16x32_bf16 a[44:47], v[92:95], v[68:71], a[44:47]
  ds_write_b128 v239, a[28:31] offset:1024
  v_mfma_f32_16x16x32_bf16 a[52:55], v[92:95], v[76:79], a[52:55]
  ds_write_b128 v237, a[36:39] offset:2048
  v_mfma_f32_16x16x32_bf16 a[56:59], v[92:95], v[80:83], a[56:59]
  ds_write_b128 v238, a[40:43] offset:2048
  v_mfma_f32_16x16x32_bf16 a[60:63], v[96:99], v[64:67], a[60:63]
  ds_write_b128 v239, a[44:47] offset:2048
  v_mfma_f32_16x16x32_bf16 a[68:71], v[96:99], v[72:75], a[68:71]
  ds_write_b128 v237, a[52:55] offset:3072
  v_mfma_f32_16x16x32_bf16 a[72:75], v[96:99], v[76:79], a[72:75]
  ds_write_b128 v238, a[56:59] offset:3072
  v_mfma_f32_16x16x32_bf16 a[76:79], v[96:99], v[80:83], a[76:79]
  ds_write_b128 v239, a[60:63] offset:3072
  v_mfma_f32_16x16x32_bf16 a[84:87], v[100:103], v[68:71], a[84:87]
  ds_write_b128 v237, a[68:71] offset:4096
  v_mfma_f32_16x16x32_bf16 a[88:91], v[100:103], v[72:75], a[88:91]
  ds_write_b128 v238, a[72:75] offset:4096
  v_mfma_f32_16x16x32_bf16 a[92:95], v[100:103], v[76:79], a[92:95]
  ds_write_b128 v239, a[76:79] offset:4096
  v_mfma_f32_16x16x32_bf16 a[100:103], v[104:107], v[64:67], a[100:103]
  ds_write_b128 v237, a[84:87] offset:5120
  v_mfma_f32_16x16x32_bf16 a[104:107], v[104:107], v[68:71], a[104:107]
  ds_write_b128 v238, a[88:91] offset:5120
  v_mfma_f32_16x16x32_bf16 a[108:111], v[104:107], v[72:75], a[108:111]
  ds_write_b128 v239, a[92:95] offset:5120
  v_mfma_f32_16x16x32_bf16 a[116:119], v[104:107], v[80:83], a[116:119]
  ds_write_b128 v237, a[100:103] offset:6144
  v_mfma_f32_16x16x32_bf16 a[120:123], v[108:111], v[64:67], a[120:123]
  ds_write_b128 v238, a[104:107] offset:6144
  v_mfma_f32_16x16x32_bf16 a[124:127], v[108:111], v[68:71], a[124:127]
  ds_write_b128 v239, a[108:111] offset:6144
  v_mfma_f32_16x16x32_bf16 a[132:135], v[108:111], v[76:79], a[132:135]
  ds_write_b128 v237, a[116:119] offset:7168
  v_mfma_f32_16x16x32_bf16 a[136:139], v[108:111], v[80:83], a[136:139]
  ds_write_b128 v238, a[120:123] offset:7168
  v_mfma_f32_16x16x32_bf16 a[140:143], v[112:115], v[64:67], a[140:143]
  ds_write_b128 v239, a[124:127] offset:7168
  v_mfma_f32_16x16x32_bf16 a[148:151], v[112:115], v[72:75], a[148:151]
  ds_write_b128 v237, a[132:135] offset:8192
  v_mfma_f32_16x16x32_bf16 a[152:155], v[112:115], v[76:79], a[152:155]
  ds_write_b128 v238, a[136:139] offset:8192
  v_mfma_f32_16x16x32_bf16 a[156:159], v[112:115], v[80:83], a[156:159]
  ds_write_b128 v239, a[140:143] offset:8192
  v_mfma_f32_16x16x32_bf16 a[164:167], v[116:119], v[68:71], a[164:167]
  ds_write_b128 v237, a[148:151] offset:9216
  v_mfma_f32_16x16x32_bf16 a[168:171], v[116:119], v[72:75], a[168:171]
  ds_write_b128 v238, a[152:155] offset:9216
  v_mfma_f32_16x16x32_bf16 a[172:175], v[116:119], v[76:79], a[172:175]
  ds_write_b128 v239, a[156:159] offset:9216
  v_mfma_f32_16x16x32_bf16 a[0:3], v[84:87], v[64:67], a[0:3]
  ds_write_b128 v237, a[164:167] offset:10240
  v_mfma_f32_16x16x32_bf16 a[16:19], v[84:87], v[80:83], a[16:19]
  ds_write_b128 v238, a[168:171] offset:10240
  v_mfma_f32_16x16x32_bf16 a[32:35], v[88:91], v[76:79], a[32:35]
  ds_write_b128 v239, a[172:175] offset:10240
  v_mfma_f32_16x16x32_bf16 a[48:51], v[92:95], v[72:75], a[48:51]
  v_mfma_f32_16x16x32_bf16 a[64:67], v[96:99], v[68:71], a[64:67]
  v_mfma_f32_16x16x32_bf16 a[80:83], v[100:103], v[64:67], a[80:83]
  v_mfma_f32_16x16x32_bf16 a[96:99], v[100:103], v[80:83], a[96:99]
  v_mfma_f32_16x16x32_bf16 a[112:115], v[104:107], v[76:79], a[112:115]
  v_mfma_f32_16x16x32_bf16 a[128:131], v[108:111], v[72:75], a[128:131]
  v_mfma_f32_16x16x32_bf16 a[144:147], v[112:115], v[68:71], a[144:147]
  v_mfma_f32_16x16x32_bf16 a[160:163], v[116:119], v[64:67], a[160:163]
  v_mfma_f32_16x16x32_bf16 a[176:179], v[116:119], v[80:83], a[176:179]
  s_nop 7
  s_nop 7
  v_accvgpr_read_b32 v160, a0
  v_accvgpr_read_b32 v161, a1
  v_accvgpr_read_b32 v162, a2
  v_accvgpr_read_b32 v163, a3
  v_accvgpr_read_b32 v164, a16
  v_accvgpr_read_b32 v165, a17
  v_accvgpr_read_b32 v166, a18
  v_accvgpr_read_b32 v167, a19
  v_accvgpr_read_b32 v168, a32
  v_accvgpr_read_b32 v169, a33
  v_accvgpr_read_b32 v170, a34
  v_accvgpr_read_b32 v171, a35
  v_accvgpr_read_b32 v172, a48
  v_accvgpr_read_b32 v173, a49
  v_accvgpr_read_b32 v174, a50
  v_accvgpr_read_b32 v175, a51
  v_accvgpr_read_b32 v176, a64
  v_accvgpr_read_b32 v177, a65
  v_accvgpr_read_b32 v178, a66
  v_accvgpr_read_b32 v179, a67
  v_accvgpr_read_b32 v180, a80
  v_accvgpr_read_b32 v181, a81
  v_accvgpr_read_b32 v182, a82
  v_accvgpr_read_b32 v183, a83
  v_accvgpr_read_b32 v184, a96
  v_accvgpr_read_b32 v185, a97
  v_accvgpr_read_b32 v186, a98
  v_accvgpr_read_b32 v187, a99
  v_accvgpr_read_b32 v188, a112
  v_accvgpr_read_b32 v189, a113
  v_accvgpr_read_b32 v190, a114
  v_accvgpr_read_b32 v191, a115
  v_accvgpr_read_b32 v192, a128
  v_accvgpr_read_b32 v193, a129
  v_accvgpr_read_b32 v194, a130
  v_accvgpr_read_b32 v195, a131
  v_accvgpr_read_b32 v196, a144
  v_accvgpr_read_b32 v197, a145
  v_accvgpr_read_b32 v198, a146
  v_accvgpr_read_b32 v199, a147
  v_accvgpr_read_b32 v200, a160
  v_accvgpr_read_b32 v201, a161
  v_accvgpr_read_b32 v202, a162
  v_accvgpr_read_b32 v203, a163
  v_accvgpr_read_b32 v204, a176
  v_accvgpr_read_b32 v205, a177
  v_accvgpr_read_b32 v206, a178
  v_accvgpr_read_b32 v207, a179
  s_waitcnt lgkmcnt(0)
  s_barrier
  ds_read_b128 v[8:11], v232 offset:0
  ds_read_b128 v[12:15], v232 offset:12288
  ds_read_b128 v[16:19], v232 offset:24576
  ds_read_b128 v[20:23], v232 offset:1024
  ds_read_b128 v[24:27], v232 offset:13312
  ds_read_b128 v[28:31], v232 offset:25600
  ds_read_b128 v[32:35], v232 offset:2048
  ds_read_b128 v[36:39], v232 offset:14336
  ds_read_b128 v[40:43], v232 offset:26624
  ds_read_b128 v[44:47], v232 offset:3072
  ds_read_b128 v[48:51], v232 offset:15360
  ds_read_b128 v[52:55], v232 offset:27648
  ds_read_b128 v[56:59], v232 offset:4096
  ds_read_b128 v[60:63], v232 offset:16384
  ds_read_b128 v[64:67], v232 offset:28672
  s_waitcnt lgkmcnt(12)
  ds_read_b128 v[68:71], v232 offset:5120
  ds_read_b128 v[72:75], v232 offset:17408
  ds_read_b128 v[76:79], v232 offset:29696
  v_add_f32 v160, v160, v8
  v_add_f32 v12, v12, v16
  v_add_f32 v161, v161, v9
  v_add_f32 v13, v13, v17
  v_add_f32 v162, v162, v10
  v_add_f32 v14, v14, v18
  v_add_f32 v163, v163, v11
  v_add_f32 v15, v15, v19
  v_add_f32 v160, v160, v12
  v_add_f32 v161, v161, v13
  v_add_f32 v162, v162, v14
  v_add_f32 v163, v163, v15
  v_cvt_pk_bf16_f32 v8, v160, v161
  v_cvt_pk_bf16_f32 v9, v162, v163
  buffer_store_dwordx2 v[8:9], v5, s[12:15], s20 offen offset:0
  s_waitcnt lgkmcnt(12)
  ds_read_b128 v[80:83], v232 offset:6144
  ds_read_b128 v[84:87], v232 offset:18432
  ds_read_b128 v[88:91], v232 offset:30720
  v_add_f32 v164, v164, v20
  v_add_f32 v24, v24, v28
  v_add_f32 v165, v165, v21
  v_add_f32 v25, v25, v29
  v_add_f32 v166, v166, v22
  v_add_f32 v26, v26, v30
  v_add_f32 v167, v167, v23
  v_add_f32 v27, v27, v31
  v_add_f32 v164, v164, v24
  v_add_f32 v165, v165, v25
  v_add_f32 v166, v166, v26
  v_add_f32 v167, v167, v27
  v_cvt_pk_bf16_f32 v20, v164, v165
  v_cvt_pk_bf16_f32 v21, v166, v167
  buffer_store_dwordx2 v[20:21], v5, s[12:15], s24 offen offset:0
  s_waitcnt lgkmcnt(12)
  ds_read_b128 v[92:95], v232 offset:7168
  ds_read_b128 v[96:99], v232 offset:19456
  ds_read_b128 v[100:103], v232 offset:31744
  v_add_f32 v168, v168, v32
  v_add_f32 v36, v36, v40
  v_add_f32 v169, v169, v33
  v_add_f32 v37, v37, v41
  v_add_f32 v170, v170, v34
  v_add_f32 v38, v38, v42
  v_add_f32 v171, v171, v35
  v_add_f32 v39, v39, v43
  v_add_f32 v168, v168, v36
  v_add_f32 v169, v169, v37
  v_add_f32 v170, v170, v38
  v_add_f32 v171, v171, v39
  v_cvt_pk_bf16_f32 v32, v168, v169
  v_cvt_pk_bf16_f32 v33, v170, v171
  buffer_store_dwordx2 v[32:33], v5, s[12:15], s23 offen offset:32
  s_waitcnt lgkmcnt(12)
  ds_read_b128 v[104:107], v232 offset:8192
  ds_read_b128 v[108:111], v232 offset:20480
  ds_read_b128 v[112:115], v232 offset:32768
  v_add_f32 v172, v172, v44
  v_add_f32 v48, v48, v52
  v_add_f32 v173, v173, v45
  v_add_f32 v49, v49, v53
  v_add_f32 v174, v174, v46
  v_add_f32 v50, v50, v54
  v_add_f32 v175, v175, v47
  v_add_f32 v51, v51, v55
  v_add_f32 v172, v172, v48
  v_add_f32 v173, v173, v49
  v_add_f32 v174, v174, v50
  v_add_f32 v175, v175, v51
  v_cvt_pk_bf16_f32 v44, v172, v173
  v_cvt_pk_bf16_f32 v45, v174, v175
  buffer_store_dwordx2 v[44:45], v5, s[12:15], s22 offen offset:64
  s_waitcnt lgkmcnt(12)
  ds_read_b128 v[116:119], v232 offset:9216
  ds_read_b128 v[120:123], v232 offset:21504
  ds_read_b128 v[124:127], v232 offset:33792
  v_add_f32 v176, v176, v56
  v_add_f32 v60, v60, v64
  v_add_f32 v177, v177, v57
  v_add_f32 v61, v61, v65
  v_add_f32 v178, v178, v58
  v_add_f32 v62, v62, v66
  v_add_f32 v179, v179, v59
  v_add_f32 v63, v63, v67
  v_add_f32 v176, v176, v60
  v_add_f32 v177, v177, v61
  v_add_f32 v178, v178, v62
  v_add_f32 v179, v179, v63
  v_cvt_pk_bf16_f32 v56, v176, v177
  v_cvt_pk_bf16_f32 v57, v178, v179
  buffer_store_dwordx2 v[56:57], v5, s[12:15], s21 offen offset:96
  s_waitcnt lgkmcnt(12)
  ds_read_b128 v[128:131], v232 offset:10240
  ds_read_b128 v[132:135], v232 offset:22528
  ds_read_b128 v[136:139], v232 offset:34816
  v_add_f32 v180, v180, v68
  v_add_f32 v72, v72, v76
  v_add_f32 v181, v181, v69
  v_add_f32 v73, v73, v77
  v_add_f32 v182, v182, v70
  v_add_f32 v74, v74, v78
  v_add_f32 v183, v183, v71
  v_add_f32 v75, v75, v79
  v_add_f32 v180, v180, v72
  v_add_f32 v181, v181, v73
  v_add_f32 v182, v182, v74
  v_add_f32 v183, v183, v75
  v_cvt_pk_bf16_f32 v68, v180, v181
  v_cvt_pk_bf16_f32 v69, v182, v183
  buffer_store_dwordx2 v[68:69], v5, s[12:15], s20 offen offset:128
  s_waitcnt lgkmcnt(12)
  ds_read_b128 v[140:143], v232 offset:11264
  ds_read_b128 v[144:147], v232 offset:23552
  ds_read_b128 v[148:151], v232 offset:35840
  v_add_f32 v184, v184, v80
  v_add_f32 v84, v84, v88
  v_add_f32 v185, v185, v81
  v_add_f32 v85, v85, v89
  v_add_f32 v186, v186, v82
  v_add_f32 v86, v86, v90
  v_add_f32 v187, v187, v83
  v_add_f32 v87, v87, v91
  v_add_f32 v184, v184, v84
  v_add_f32 v185, v185, v85
  v_add_f32 v186, v186, v86
  v_add_f32 v187, v187, v87
  v_cvt_pk_bf16_f32 v80, v184, v185
  v_cvt_pk_bf16_f32 v81, v186, v187
  buffer_store_dwordx2 v[80:81], v5, s[12:15], s24 offen offset:128
  s_waitcnt lgkmcnt(12)
  v_add_f32 v188, v188, v92
  v_add_f32 v96, v96, v100
  v_add_f32 v189, v189, v93
  v_add_f32 v97, v97, v101
  v_add_f32 v190, v190, v94
  v_add_f32 v98, v98, v102
  v_add_f32 v191, v191, v95
  v_add_f32 v99, v99, v103
  v_add_f32 v188, v188, v96
  v_add_f32 v189, v189, v97
  v_add_f32 v190, v190, v98
  v_add_f32 v191, v191, v99
  v_cvt_pk_bf16_f32 v92, v188, v189
  v_cvt_pk_bf16_f32 v93, v190, v191
  buffer_store_dwordx2 v[92:93], v5, s[12:15], s23 offen offset:160
  s_waitcnt lgkmcnt(9)
  v_add_f32 v192, v192, v104
  v_add_f32 v108, v108, v112
  v_add_f32 v193, v193, v105
  v_add_f32 v109, v109, v113
  v_add_f32 v194, v194, v106
  v_add_f32 v110, v110, v114
  v_add_f32 v195, v195, v107
  v_add_f32 v111, v111, v115
  v_add_f32 v192, v192, v108
  v_add_f32 v193, v193, v109
  v_add_f32 v194, v194, v110
  v_add_f32 v195, v195, v111
  v_cvt_pk_bf16_f32 v104, v192, v193
  v_cvt_pk_bf16_f32 v105, v194, v195
  buffer_store_dwordx2 v[104:105], v5, s[12:15], s22 offen offset:192
  s_waitcnt lgkmcnt(6)
  v_add_f32 v196, v196, v116
  v_add_f32 v120, v120, v124
  v_add_f32 v197, v197, v117
  v_add_f32 v121, v121, v125
  v_add_f32 v198, v198, v118
  v_add_f32 v122, v122, v126
  v_add_f32 v199, v199, v119
  v_add_f32 v123, v123, v127
  v_add_f32 v196, v196, v120
  v_add_f32 v197, v197, v121
  v_add_f32 v198, v198, v122
  v_add_f32 v199, v199, v123
  v_cvt_pk_bf16_f32 v116, v196, v197
  v_cvt_pk_bf16_f32 v117, v198, v199
  buffer_store_dwordx2 v[116:117], v5, s[12:15], s21 offen offset:224
  s_waitcnt lgkmcnt(3)
  v_add_f32 v200, v200, v128
  v_add_f32 v132, v132, v136
  v_add_f32 v201, v201, v129
  v_add_f32 v133, v133, v137
  v_add_f32 v202, v202, v130
  v_add_f32 v134, v134, v138
  v_add_f32 v203, v203, v131
  v_add_f32 v135, v135, v139
  v_add_f32 v200, v200, v132
  v_add_f32 v201, v201, v133
  v_add_f32 v202, v202, v134
  v_add_f32 v203, v203, v135
  v_cvt_pk_bf16_f32 v128, v200, v201
  v_cvt_pk_bf16_f32 v129, v202, v203
  buffer_store_dwordx2 v[128:129], v5, s[12:15], s20 offen offset:256
  s_waitcnt lgkmcnt(0)
  v_add_f32 v204, v204, v140
  v_add_f32 v144, v144, v148
  v_add_f32 v205, v205, v141
  v_add_f32 v145, v145, v149
  v_add_f32 v206, v206, v142
  v_add_f32 v146, v146, v150
  v_add_f32 v207, v207, v143
  v_add_f32 v147, v147, v151
  v_add_f32 v204, v204, v144
  v_add_f32 v205, v205, v145
  v_add_f32 v206, v206, v146
  v_add_f32 v207, v207, v147
  v_cvt_pk_bf16_f32 v140, v204, v205
  v_cvt_pk_bf16_f32 v141, v206, v207
  buffer_store_dwordx2 v[140:141], v5, s[12:15], s24 offen offset:256
L_b_skipr0:
  s_cmp_lg_u32 s3, 1
  s_cbranch_scc1 L_b_skipr1
  s_waitcnt vmcnt(0)
  v_mfma_f32_16x16x32_bf16 a[0:3], v[84:87], v[64:67], a[0:3]
  v_mfma_f32_16x16x32_bf16 a[8:11], v[84:87], v[72:75], a[8:11]
  v_mfma_f32_16x16x32_bf16 a[12:15], v[84:87], v[76:79], a[12:15]
  v_mfma_f32_16x16x32_bf16 a[16:19], v[84:87], v[80:83], a[16:19]
  ds_write_b128 v236, a[0:3] offset:0
  v_mfma_f32_16x16x32_bf16 a[24:27], v[88:91], v[68:71], a[24:27]
  ds_write_b128 v238, a[8:11] offset:0
  v_mfma_f32_16x16x32_bf16 a[28:31], v[88:91], v[72:75], a[28:31]
  ds_write_b128 v239, a[12:15] offset:0
  v_mfma_f32_16x16x32_bf16 a[32:35], v[88:91], v[76:79], a[32:35]
  ds_write_b128 v236, a[16:19] offset:1024
  v_mfma_f32_16x16x32_bf16 a[40:43], v[92:95], v[64:67], a[40:43]
  ds_write_b128 v238, a[24:27] offset:1024
  v_mfma_f32_16x16x32_bf16 a[44:47], v[92:95], v[68:71], a[44:47]
  ds_write_b128 v239, a[28:31] offset:1024
  v_mfma_f32_16x16x32_bf16 a[48:51], v[92:95], v[72:75], a[48:51]
  ds_write_b128 v236, a[32:35] offset:2048
  v_mfma_f32_16x16x32_bf16 a[56:59], v[92:95], v[80:83], a[56:59]
  ds_write_b128 v238, a[40:43] offset:2048
  v_mfma_f32_16x16x32_bf16 a[60:63], v[96:99], v[64:67], a[60:63]
  ds_write_b128 v239, a[44:47] offset:2048
  v_mfma_f32_16x16x32_bf16 a[64:67], v[96:99], v[68:71], a[64:67]
  ds_write_b128 v236, a[48:51] offset:3072
  v_mfma_f32_16x16x32_bf16 a[72:75], v[96:99], v[76:79], a[72:75]
  ds_write_b128 v238, a[56:59] offset:3072
  v_mfma_f32_16x16x32_bf16 a[76:79], v[96:99], v[80:83], a[76:79]
  ds_write_b128 v239, a[60:63] offset:3072
  v_mfma_f32_16x16x32_bf16 a[80:83], v[100:103], v[64:67], a[80:83]
  ds_write_b128 v236, a[64:67] offset:4096
  v_mfma_f32_16x16x32_bf16 a[88:91], v[100:103], v[72:75], a[88:91]
  ds_write_b128 v238, a[72:75] offset:4096
  v_mfma_f32_16x16x32_bf16 a[92:95], v[100:103], v[76:79], a[92:95]
  ds_write_b128 v239, a[76:79] offset:4096
  v_mfma_f32_16x16x32_bf16 a[96:99], v[100:103], v[80:83], a[96:99]
  ds_write_b128 v236, a[80:83] offset:5120
  v_mfma_f32_16x16x32_bf16 a[104:107], v[104:107], v[68:71], a[104:107]
  ds_write_b128 v238, a[88:91] offset:5120
  v_mfma_f32_16x16x32_bf16 a[108:111], v[104:107], v[72:75], a[108:111]
  ds_write_b128 v239, a[92:95] offset:5120
  v_mfma_f32_16x16x32_bf16 a[112:115], v[104:107], v[76:79], a[112:115]
  ds_write_b128 v236, a[96:99] offset:6144
  v_mfma_f32_16x16x32_bf16 a[120:123], v[108:111], v[64:67], a[120:123]
  ds_write_b128 v238, a[104:107] offset:6144
  v_mfma_f32_16x16x32_bf16 a[124:127], v[108:111], v[68:71], a[124:127]
  ds_write_b128 v239, a[108:111] offset:6144
  v_mfma_f32_16x16x32_bf16 a[128:131], v[108:111], v[72:75], a[128:131]
  ds_write_b128 v236, a[112:115] offset:7168
  v_mfma_f32_16x16x32_bf16 a[136:139], v[108:111], v[80:83], a[136:139]
  ds_write_b128 v238, a[120:123] offset:7168
  v_mfma_f32_16x16x32_bf16 a[140:143], v[112:115], v[64:67], a[140:143]
  ds_write_b128 v239, a[124:127] offset:7168
  v_mfma_f32_16x16x32_bf16 a[144:147], v[112:115], v[68:71], a[144:147]
  ds_write_b128 v236, a[128:131] offset:8192
  v_mfma_f32_16x16x32_bf16 a[152:155], v[112:115], v[76:79], a[152:155]
  ds_write_b128 v238, a[136:139] offset:8192
  v_mfma_f32_16x16x32_bf16 a[156:159], v[112:115], v[80:83], a[156:159]
  ds_write_b128 v239, a[140:143] offset:8192
  v_mfma_f32_16x16x32_bf16 a[160:163], v[116:119], v[64:67], a[160:163]
  ds_write_b128 v236, a[144:147] offset:9216
  v_mfma_f32_16x16x32_bf16 a[168:171], v[116:119], v[72:75], a[168:171]
  ds_write_b128 v238, a[152:155] offset:9216
  v_mfma_f32_16x16x32_bf16 a[172:175], v[116:119], v[76:79], a[172:175]
  ds_write_b128 v239, a[156:159] offset:9216
  v_mfma_f32_16x16x32_bf16 a[176:179], v[116:119], v[80:83], a[176:179]
  ds_write_b128 v236, a[160:163] offset:10240
  v_mfma_f32_16x16x32_bf16 a[4:7], v[84:87], v[68:71], a[4:7]
  ds_write_b128 v238, a[168:171] offset:10240
  v_mfma_f32_16x16x32_bf16 a[20:23], v[88:91], v[64:67], a[20:23]
  ds_write_b128 v239, a[172:175] offset:10240
  v_mfma_f32_16x16x32_bf16 a[36:39], v[88:91], v[80:83], a[36:39]
  ds_write_b128 v236, a[176:179] offset:11264
  v_mfma_f32_16x16x32_bf16 a[52:55], v[92:95], v[76:79], a[52:55]
  v_mfma_f32_16x16x32_bf16 a[68:71], v[96:99], v[72:75], a[68:71]
  v_mfma_f32_16x16x32_bf16 a[84:87], v[100:103], v[68:71], a[84:87]
  v_mfma_f32_16x16x32_bf16 a[100:103], v[104:107], v[64:67], a[100:103]
  v_mfma_f32_16x16x32_bf16 a[116:119], v[104:107], v[80:83], a[116:119]
  v_mfma_f32_16x16x32_bf16 a[132:135], v[108:111], v[76:79], a[132:135]
  v_mfma_f32_16x16x32_bf16 a[148:151], v[112:115], v[72:75], a[148:151]
  v_mfma_f32_16x16x32_bf16 a[164:167], v[116:119], v[68:71], a[164:167]
  s_nop 7
  s_nop 7
  v_accvgpr_read_b32 v160, a4
  v_accvgpr_read_b32 v161, a5
  v_accvgpr_read_b32 v162, a6
  v_accvgpr_read_b32 v163, a7
  v_accvgpr_read_b32 v164, a20
  v_accvgpr_read_b32 v165, a21
  v_accvgpr_read_b32 v166, a22
  v_accvgpr_read_b32 v167, a23
  v_accvgpr_read_b32 v168, a36
  v_accvgpr_read_b32 v169, a37
  v_accvgpr_read_b32 v170, a38
  v_accvgpr_read_b32 v171, a39
  v_accvgpr_read_b32 v172, a52
  v_accvgpr_read_b32 v173, a53
  v_accvgpr_read_b32 v174, a54
  v_accvgpr_read_b32 v175, a55
  v_accvgpr_read_b32 v176, a68
  v_accvgpr_read_b32 v177, a69
  v_accvgpr_read_b32 v178, a70
  v_accvgpr_read_b32 v179, a71
  v_accvgpr_read_b32 v180, a84
  v_accvgpr_read_b32 v181, a85
  v_accvgpr_read_b32 v182, a86
  v_accvgpr_read_b32 v183, a87
  v_accvgpr_read_b32 v184, a100
  v_accvgpr_read_b32 v185, a101
  v_accvgpr_read_b32 v186, a102
  v_accvgpr_read_b32 v187, a103
  v_accvgpr_read_b32 v188, a116
  v_accvgpr_read_b32 v189, a117
  v_accvgpr_read_b32 v190, a118
  v_accvgpr_read_b32 v191, a119
  v_accvgpr_read_b32 v192, a132
  v_accvgpr_read_b32 v193, a133
  v_accvgpr_read_b32 v194, a134
  v_accvgpr_read_b32 v195, a135
  v_accvgpr_read_b32 v196, a148
  v_accvgpr_read_b32 v197, a149
  v_accvgpr_read_b32 v198, a150
  v_accvgpr_read_b32 v199, a151
  v_accvgpr_read_b32 v200, a164
  v_accvgpr_read_b32 v201, a165
  v_accvgpr_read_b32 v202, a166
  v_accvgpr_read_b32 v203, a167
  s_waitcnt lgkmcnt(0)
  s_barrier
  ds_read_b128 v[8:11], v232 offset:0
  ds_read_b128 v[12:15], v232 offset:12288
  ds_read_b128 v[16:19], v232 offset:24576
  ds_read_b128 v[20:23], v232 offset:1024
  ds_read_b128 v[24:27], v232 offset:13312
  ds_read_b128 v[28:31], v232 offset:25600
  ds_read_b128 v[32:35], v232 offset:2048
  ds_read_b128 v[36:39], v232 offset:14336
  ds_read_b128 v[40:43], v232 offset:26624
  ds_read_b128 v[44:47], v232 offset:3072
  ds_read_b128 v[48:51], v232 offset:15360
  ds_read_b128 v[52:55], v232 offset:27648
  ds_read_b128 v[56:59], v232 offset:4096
  ds_read_b128 v[60:63], v232 offset:16384
  ds_read_b128 v[64:67], v232 offset:28672
  s_waitcnt lgkmcnt(12)
  ds_read_b128 v[68:71], v232 offset:5120
  ds_read_b128 v[72:75], v232 offset:17408
  ds_read_b128 v[76:79], v232 offset:29696
  v_add_f32 v160, v160, v8
  v_add_f32 v12, v12, v16
  v_add_f32 v161, v161, v9
  v_add_f32 v13, v13, v17
  v_add_f32 v162, v162, v10
  v_add_f32 v14, v14, v18
  v_add_f32 v163, v163, v11
  v_add_f32 v15, v15, v19
  v_add_f32 v160, v160, v12
  v_add_f32 v161, v161, v13
  v_add_f32 v162, v162, v14
  v_add_f32 v163, v163, v15
  v_cvt_pk_bf16_f32 v8, v160, v161
  v_cvt_pk_bf16_f32 v9, v162, v163
  buffer_store_dwordx2 v[8:9], v5, s[12:15], s21 offen offset:0
  s_waitcnt lgkmcnt(12)
  ds_read_b128 v[80:83], v232 offset:6144
  ds_read_b128 v[84:87], v232 offset:18432
  ds_read_b128 v[88:91], v232 offset:30720
  v_add_f32 v164, v164, v20
  v_add_f32 v24, v24, v28
  v_add_f32 v165, v165, v21
  v_add_f32 v25, v25, v29
  v_add_f32 v166, v166, v22
  v_add_f32 v26, v26, v30
  v_add_f32 v167, v167, v23
  v_add_f32 v27, v27, v31
  v_add_f32 v164, v164, v24
  v_add_f32 v165, v165, v25
  v_add_f32 v166, v166, v26
  v_add_f32 v167, v167, v27
  v_cvt_pk_bf16_f32 v20, v164, v165
  v_cvt_pk_bf16_f32 v21, v166, v167
  buffer_store_dwordx2 v[20:21], v5, s[12:15], s20 offen offset:32
  s_waitcnt lgkmcnt(12)
  ds_read_b128 v[92:95], v232 offset:7168
  ds_read_b128 v[96:99], v232 offset:19456
  ds_read_b128 v[100:103], v232 offset:31744
  v_add_f32 v168, v168, v32
  v_add_f32 v36, v36, v40
  v_add_f32 v169, v169, v33
  v_add_f32 v37, v37, v41
  v_add_f32 v170, v170, v34
  v_add_f32 v38, v38, v42
  v_add_f32 v171, v171, v35
  v_add_f32 v39, v39, v43
  v_add_f32 v168, v168, v36
  v_add_f32 v169, v169, v37
  v_add_f32 v170, v170, v38
  v_add_f32 v171, v171, v39
  v_cvt_pk_bf16_f32 v32, v168, v169
  v_cvt_pk_bf16_f32 v33, v170, v171
  buffer_store_dwordx2 v[32:33], v5, s[12:15], s24 offen offset:32
  s_waitcnt lgkmcnt(12)
  ds_read_b128 v[104:107], v232 offset:8192
  ds_read_b128 v[108:111], v232 offset:20480
  ds_read_b128 v[112:115], v232 offset:32768
  v_add_f32 v172, v172, v44
  v_add_f32 v48, v48, v52
  v_add_f32 v173, v173, v45
  v_add_f32 v49, v49, v53
  v_add_f32 v174, v174, v46
  v_add_f32 v50, v50, v54
  v_add_f32 v175, v175, v47
  v_add_f32 v51, v51, v55
  v_add_f32 v172, v172, v48
  v_add_f32 v173, v173, v49
  v_add_f32 v174, v174, v50
  v_add_f32 v175, v175, v51
  v_cvt_pk_bf16_f32 v44, v172, v173
  v_cvt_pk_bf16_f32 v45, v174, v175
  buffer_store_dwordx2 v[44:45], v5, s[12:15], s23 offen offset:64
  s_waitcnt lgkmcnt(12)
  ds_read_b128 v[116:119], v232 offset:9216
  ds_read_b128 v[120:123], v232 offset:21504
  ds_read_b128 v[124:127], v232 offset:33792
  v_add_f32 v176, v176, v56
  v_add_f32 v60, v60, v64
  v_add_f32 v177, v177, v57
  v_add_f32 v61, v61, v65
  v_add_f32 v178, v178, v58
  v_add_f32 v62, v62, v66
  v_add_f32 v179, v179, v59
  v_add_f32 v63, v63, v67
  v_add_f32 v176, v176, v60
  v_add_f32 v177, v177, v61
  v_add_f32 v178, v178, v62
  v_add_f32 v179, v179, v63
  v_cvt_pk_bf16_f32 v56, v176, v177
  v_cvt_pk_bf16_f32 v57, v178, v179
  buffer_store_dwordx2 v[56:57], v5, s[12:15], s22 offen offset:96
  s_waitcnt lgkmcnt(12)
  ds_read_b128 v[128:131], v232 offset:10240
  ds_read_b128 v[132:135], v232 offset:22528
  ds_read_b128 v[136:139], v232 offset:34816
  v_add_f32 v180, v180, v68
  v_add_f32 v72, v72, v76
  v_add_f32 v181, v181, v69
  v_add_f32 v73, v73, v77
  v_add_f32 v182, v182, v70
  v_add_f32 v74, v74, v78
  v_add_f32 v183, v183, v71
  v_add_f32 v75, v75, v79
  v_add_f32 v180, v180, v72
  v_add_f32 v181, v181, v73
  v_add_f32 v182, v182, v74
  v_add_f32 v183, v183, v75
  v_cvt_pk_bf16_f32 v68, v180, v181
  v_cvt_pk_bf16_f32 v69, v182, v183
  buffer_store_dwordx2 v[68:69], v5, s[12:15], s21 offen offset:128
  s_waitcnt lgkmcnt(12)
  v_add_f32 v184, v184, v80
  v_add_f32 v84, v84, v88
  v_add_f32 v185, v185, v81
  v_add_f32 v85, v85, v89
  v_add_f32 v186, v186, v82
  v_add_f32 v86, v86, v90
  v_add_f32 v187, v187, v83
  v_add_f32 v87, v87, v91
  v_add_f32 v184, v184, v84
  v_add_f32 v185, v185, v85
  v_add_f32 v186, v186, v86
  v_add_f32 v187, v187, v87
  v_cvt_pk_bf16_f32 v80, v184, v185
  v_cvt_pk_bf16_f32 v81, v186, v187
  buffer_store_dwordx2 v[80:81], v5, s[12:15], s20 offen offset:160
  s_waitcnt lgkmcnt(9)
  v_add_f32 v188, v188, v92
  v_add_f32 v96, v96, v100
  v_add_f32 v189, v189, v93
  v_add_f32 v97, v97, v101
  v_add_f32 v190, v190, v94
  v_add_f32 v98, v98, v102
  v_add_f32 v191, v191, v95
  v_add_f32 v99, v99, v103
  v_add_f32 v188, v188, v96
  v_add_f32 v189, v189, v97
  v_add_f32 v190, v190, v98
  v_add_f32 v191, v191, v99
  v_cvt_pk_bf16_f32 v92, v188, v189
  v_cvt_pk_bf16_f32 v93, v190, v191
  buffer_store_dwordx2 v[92:93], v5, s[12:15], s24 offen offset:160
  s_waitcnt lgkmcnt(6)
  v_add_f32 v192, v192, v104
  v_add_f32 v108, v108, v112
  v_add_f32 v193, v193, v105
  v_add_f32 v109, v109, v113
  v_add_f32 v194, v194, v106
  v_add_f32 v110, v110, v114
  v_add_f32 v195, v195, v107
  v_add_f32 v111, v111, v115
  v_add_f32 v192, v192, v108
  v_add_f32 v193, v193, v109
  v_add_f32 v194, v194, v110
  v_add_f32 v195, v195, v111
  v_cvt_pk_bf16_f32 v104, v192, v193
  v_cvt_pk_bf16_f32 v105, v194, v195
  buffer_store_dwordx2 v[104:105], v5, s[12:15], s23 offen offset:192
  s_waitcnt lgkmcnt(3)
  v_add_f32 v196, v196, v116
  v_add_f32 v120, v120, v124
  v_add_f32 v197, v197, v117
  v_add_f32 v121, v121, v125
  v_add_f32 v198, v198, v118
  v_add_f32 v122, v122, v126
  v_add_f32 v199, v199, v119
  v_add_f32 v123, v123, v127
  v_add_f32 v196, v196, v120
  v_add_f32 v197, v197, v121
  v_add_f32 v198, v198, v122
  v_add_f32 v199, v199, v123
  v_cvt_pk_bf16_f32 v116, v196, v197
  v_cvt_pk_bf16_f32 v117, v198, v199
  buffer_store_dwordx2 v[116:117], v5, s[12:15], s22 offen offset:224
  s_waitcnt lgkmcnt(0)
  v_add_f32 v200, v200, v128
  v_add_f32 v132, v132, v136
  v_add_f32 v201, v201, v129
  v_add_f32 v133, v133, v137
  v_add_f32 v202, v202, v130
  v_add_f32 v134, v134, v138
  v_add_f32 v203, v203, v131
  v_add_f32 v135, v135, v139
  v_add_f32 v200, v200, v132
  v_add_f32 v201, v201, v133
  v_add_f32 v202, v202, v134
  v_add_f32 v203, v203, v135
  v_cvt_pk_bf16_f32 v128, v200, v201
  v_cvt_pk_bf16_f32 v129, v202, v203
  buffer_store_dwordx2 v[128:129], v5, s[12:15], s21 offen offset:256
L_b_skipr1:
  s_cmp_lg_u32 s3, 2
  s_cbranch_scc1 L_b_skipr2
  s_waitcnt vmcnt(0)
  v_mfma_f32_16x16x32_bf16 a[0:3], v[84:87], v[64:67], a[0:3]
  v_mfma_f32_16x16x32_bf16 a[4:7], v[84:87], v[68:71], a[4:7]
  v_mfma_f32_16x16x32_bf16 a[12:15], v[84:87], v[76:79], a[12:15]
  v_mfma_f32_16x16x32_bf16 a[16:19], v[84:87], v[80:83], a[16:19]
  ds_write_b128 v236, a[0:3] offset:0
  v_mfma_f32_16x16x32_bf16 a[20:23], v[88:91], v[64:67], a[20:23]
  ds_write_b128 v237, a[4:7] offset:0
  v_mfma_f32_16x16x32_bf16 a[28:31], v[88:91], v[72:75], a[28:31]
  ds_write_b128 v239, a[12:15] offset:0
  v_mfma_f32_16x16x32_bf16 a[32:35], v[88:91], v[76:79], a[32:35]
  ds_write_b128 v236, a[16:19] offset:1024
  v_mfma_f32_16x16x32_bf16 a[36:39], v[88:91], v[80:83], a[36:39]
  ds_write_b128 v237, a[20:23] offset:1024
  v_mfma_f32_16x16x32_bf16 a[44:47], v[92:95], v[68:71], a[44:47]
  ds_write_b128 v239, a[28:31] offset:1024
  v_mfma_f32_16x16x32_bf16 a[48:51], v[92:95], v[72:75], a[48:51]
  ds_write_b128 v236, a[32:35] offset:2048
  v_mfma_f32_16x16x32_bf16 a[52:55], v[92:95], v[76:79], a[52:55]
  ds_write_b128 v237, a[36:39] offset:2048
  v_mfma_f32_16x16x32_bf16 a[60:63], v[96:99], v[64:67], a[60:63]
  ds_write_b128 v239, a[44:47] offset:2048
  v_mfma_f32_16x16x32_bf16 a[64:67], v[96:99], v[68:71], a[64:67]
  ds_write_b128 v236, a[48:51] offset:3072
  v_mfma_f32_16x16x32_bf16 a[68:71], v[96:99], v[72:75], a[68:71]
  ds_write_b128 v237, a[52:55] offset:3072
  v_mfma_f32_16x16x32_bf16 a[76:79], v[96:99], v[80:83], a[76:79]
  ds_write_b128 v239, a[60:63] offset:3072
  v_mfma_f32_16x16x32_bf16 a[80:83], v[100:103], v[64:67], a[80:83]
  ds_write_b128 v236, a[64:67] offset:4096
  v_mfma_f32_16x16x32_bf16 a[84:87], v[100:103], v[68:71], a[84:87]
  ds_write_b128 v237, a[68:71] offset:4096
  v_mfma_f32_16x16x32_bf16 a[92:95], v[100:103], v[76:79], a[92:95]
  ds_write_b128 v239, a[76:79] offset:4096
  v_mfma_f32_16x16x32_bf16 a[96:99], v[100:103], v[80:83], a[96:99]
  ds_write_b128 v236, a[80:83] offset:5120
  v_mfma_f32_16x16x32_bf16 a[100:103], v[104:107], v[64:67], a[100:103]
  ds_write_b128 v237, a[84:87] offset:5120
  v_mfma_f32_16x16x32_bf16 a[108:111], v[104:107], v[72:75], a[108:111]
  ds_write_b128 v239, a[92:95] offset:5120
  v_mfma_f32_16x16x32_bf16 a[112:115], v[104:107], v[76:79], a[112:115]
  ds_write_b128 v236, a[96:99] offset:6144
  v_mfma_f32_16x16x32_bf16 a[116:119], v[104:107], v[80:83], a[116:119]
  ds_write_b128 v237, a[100:103] offset:6144
  v_mfma_f32_16x16x32_bf16 a[124:127], v[108:111], v[68:71], a[124:127]
  ds_write_b128 v239, a[108:111] offset:6144
  v_mfma_f32_16x16x32_bf16 a[128:131], v[108:111], v[72:75], a[128:131]
  ds_write_b128 v236, a[112:115] offset:7168
  v_mfma_f32_16x16x32_bf16 a[132:135], v[108:111], v[76:79], a[132:135]
  ds_write_b128 v237, a[116:119] offset:7168
  v_mfma_f32_16x16x32_bf16 a[140:143], v[112:115], v[64:67], a[140:143]
  ds_write_b128 v239, a[124:127] offset:7168
  v_mfma_f32_16x16x32_bf16 a[144:147], v[112:115], v[68:71], a[144:147]
  ds_write_b128 v236, a[128:131] offset:8192
  v_mfma_f32_16x16x32_bf16 a[148:151], v[112:115], v[72:75], a[148:151]
  ds_write_b128 v237, a[132:135] offset:8192
  v_mfma_f32_16x16x32_bf16 a[156:159], v[112:115], v[80:83], a[156:159]
  ds_write_b128 v239, a[140:143] offset:8192
  v_mfma_f32_16x16x32_bf16 a[160:163], v[116:119], v[64:67], a[160:163]
  ds_write_b128 v236, a[144:147] offset:9216
  v_mfma_f32_16x16x32_bf16 a[164:167], v[116:119], v[68:71], a[164:167]
  ds_write_b128 v237, a[148:151] offset:9216
  v_mfma_f32_16x16x32_bf16 a[172:175], v[116:119], v[76:79], a[172:175]
  ds_write_b128 v239, a[156:159] offset:9216
  v_mfma_f32_16x16x32_bf16 a[176:179], v[116:119], v[80:83], a[176:179]
  ds_write_b128 v236, a[160:163] offset:10240
  v_mfma_f32_16x16x32_bf16 a[8:11], v[84:87], v[72:75], a[8:11]
  ds_write_b128 v237, a[164:167] offset:10240
  v_mfma_f32_16x16x32_bf16 a[24:27], v[88:91], v[68:71], a[24:27]
  ds_write_b128 v239, a[172:175] offset:10240
  v_mfma_f32_16x16x32_bf16 a[40:43], v[92:95], v[64:67], a[40:43]
  ds_write_b128 v236, a[176:179] offset:11264
  v_mfma_f32_16x16x32_bf16 a[56:59], v[92:95], v[80:83], a[56:59]
  v_mfma_f32_16x16x32_bf16 a[72:75], v[96:99], v[76:79], a[72:75]
  v_mfma_f32_16x16x32_bf16 a[88:91], v[100:103], v[72:75], a[88:91]
  v_mfma_f32_16x16x32_bf16 a[104:107], v[104:107], v[68:71], a[104:107]
  v_mfma_f32_16x16x32_bf16 a[120:123], v[108:111], v[64:67], a[120:123]
  v_mfma_f32_16x16x32_bf16 a[136:139], v[108:111], v[80:83], a[136:139]
  v_mfma_f32_16x16x32_bf16 a[152:155], v[112:115], v[76:79], a[152:155]
  v_mfma_f32_16x16x32_bf16 a[168:171], v[116:119], v[72:75], a[168:171]
  s_nop 7
  s_nop 7
  v_accvgpr_read_b32 v160, a8
  v_accvgpr_read_b32 v161, a9
  v_accvgpr_read_b32 v162, a10
  v_accvgpr_read_b32 v163, a11
  v_accvgpr_read_b32 v164, a24
  v_accvgpr_read_b32 v165, a25
  v_accvgpr_read_b32 v166, a26
  v_accvgpr_read_b32 v167, a27
  v_accvgpr_read_b32 v168, a40
  v_accvgpr_read_b32 v169, a41
  v_accvgpr_read_b32 v170, a42
  v_accvgpr_read_b32 v171, a43
  v_accvgpr_read_b32 v172, a56
  v_accvgpr_read_b32 v173, a57
  v_accvgpr_read_b32 v174, a58
  v_accvgpr_read_b32 v175, a59
  v_accvgpr_read_b32 v176, a72
  v_accvgpr_read_b32 v177, a73
  v_accvgpr_read_b32 v178, a74
  v_accvgpr_read_b32 v179, a75
  v_accvgpr_read_b32 v180, a88
  v_accvgpr_read_b32 v181, a89
  v_accvgpr_read_b32 v182, a90
  v_accvgpr_read_b32 v183, a91
  v_accvgpr_read_b32 v184, a104
  v_accvgpr_read_b32 v185, a105
  v_accvgpr_read_b32 v186, a106
  v_accvgpr_read_b32 v187, a107
  v_accvgpr_read_b32 v188, a120
  v_accvgpr_read_b32 v189, a121
  v_accvgpr_read_b32 v190, a122
  v_accvgpr_read_b32 v191, a123
  v_accvgpr_read_b32 v192, a136
  v_accvgpr_read_b32 v193, a137
  v_accvgpr_read_b32 v194, a138
  v_accvgpr_read_b32 v195, a139
  v_accvgpr_read_b32 v196, a152
  v_accvgpr_read_b32 v197, a153
  v_accvgpr_read_b32 v198, a154
  v_accvgpr_read_b32 v199, a155
  v_accvgpr_read_b32 v200, a168
  v_accvgpr_read_b32 v201, a169
  v_accvgpr_read_b32 v202, a170
  v_accvgpr_read_b32 v203, a171
  s_waitcnt lgkmcnt(0)
  s_barrier
  ds_read_b128 v[8:11], v232 offset:0
  ds_read_b128 v[12:15], v232 offset:12288
  ds_read_b128 v[16:19], v232 offset:24576
  ds_read_b128 v[20:23], v232 offset:1024
  ds_read_b128 v[24:27], v232 offset:13312
  ds_read_b128 v[28:31], v232 offset:25600
  ds_read_b128 v[32:35], v232 offset:2048
  ds_read_b128 v[36:39], v232 offset:14336
  ds_read_b128 v[40:43], v232 offset:26624
  ds_read_b128 v[44:47], v232 offset:3072
  ds_read_b128 v[48:51], v232 offset:15360
  ds_read_b128 v[52:55], v232 offset:27648
  ds_read_b128 v[56:59], v232 offset:4096
  ds_read_b128 v[60:63], v232 offset:16384
  ds_read_b128 v[64:67], v232 offset:28672
  s_waitcnt lgkmcnt(12)
  ds_read_b128 v[68:71], v232 offset:5120
  ds_read_b128 v[72:75], v232 offset:17408
  ds_read_b128 v[76:79], v232 offset:29696
  v_add_f32 v160, v160, v8
  v_add_f32 v12, v12, v16
  v_add_f32 v161, v161, v9
  v_add_f32 v13, v13, v17
  v_add_f32 v162, v162, v10
  v_add_f32 v14, v14, v18
  v_add_f32 v163, v163, v11
  v_add_f32 v15, v15, v19
  v_add_f32 v160, v160, v12
  v_add_f32 v161, v161, v13
  v_add_f32 v162, v162, v14
  v_add_f32 v163, v163, v15
  v_cvt_pk_bf16_f32 v8, v160, v161
  v_cvt_pk_bf16_f32 v9, v162, v163
  buffer_store_dwordx2 v[8:9], v5, s[12:15], s22 offen offset:0
  s_waitcnt lgkmcnt(12)
  ds_read_b128 v[80:83], v232 offset:6144
  ds_read_b128 v[84:87], v232 offset:18432
  ds_read_b128 v[88:91], v232 offset:30720
  v_add_f32 v164, v164, v20
  v_add_f32 v24, v24, v28
  v_add_f32 v165, v165, v21
  v_add_f32 v25, v25, v29
  v_add_f32 v166, v166, v22
  v_add_f32 v26, v26, v30
  v_add_f32 v167, v167, v23
  v_add_f32 v27, v27, v31
  v_add_f32 v164, v164, v24
  v_add_f32 v165, v165, v25
  v_add_f32 v166, v166, v26
  v_add_f32 v167, v167, v27
  v_cvt_pk_bf16_f32 v20, v164, v165
  v_cvt_pk_bf16_f32 v21, v166, v167
  buffer_store_dwordx2 v[20:21], v5, s[12:15], s21 offen offset:32
  s_waitcnt lgkmcnt(12)
  ds_read_b128 v[92:95], v232 offset:7168
  ds_read_b128 v[96:99], v232 offset:19456
  ds_read_b128 v[100:103], v232 offset:31744
  v_add_f32 v168, v168, v32
  v_add_f32 v36, v36, v40
  v_add_f32 v169, v169, v33
  v_add_f32 v37, v37, v41
  v_add_f32 v170, v170, v34
  v_add_f32 v38, v38, v42
  v_add_f32 v171, v171, v35
  v_add_f32 v39, v39, v43
  v_add_f32 v168, v168, v36
  v_add_f32 v169, v169, v37
  v_add_f32 v170, v170, v38
  v_add_f32 v171, v171, v39
  v_cvt_pk_bf16_f32 v32, v168, v169
  v_cvt_pk_bf16_f32 v33, v170, v171
  buffer_store_dwordx2 v[32:33], v5, s[12:15], s20 offen offset:64
  s_waitcnt lgkmcnt(12)
  ds_read_b128 v[104:107], v232 offset:8192
  ds_read_b128 v[108:111], v232 offset:20480
  ds_read_b128 v[112:115], v232 offset:32768
  v_add_f32 v172, v172, v44
  v_add_f32 v48, v48, v52
  v_add_f32 v173, v173, v45
  v_add_f32 v49, v49, v53
  v_add_f32 v174, v174, v46
  v_add_f32 v50, v50, v54
  v_add_f32 v175, v175, v47
  v_add_f32 v51, v51, v55
  v_add_f32 v172, v172, v48
  v_add_f32 v173, v173, v49
  v_add_f32 v174, v174, v50
  v_add_f32 v175, v175, v51
  v_cvt_pk_bf16_f32 v44, v172, v173
  v_cvt_pk_bf16_f32 v45, v174, v175
  buffer_store_dwordx2 v[44:45], v5, s[12:15], s24 offen offset:64
  s_waitcnt lgkmcnt(12)
  ds_read_b128 v[116:119], v232 offset:9216
  ds_read_b128 v[120:123], v232 offset:21504
  ds_read_b128 v[124:127], v232 offset:33792
  v_add_f32 v176, v176, v56
  v_add_f32 v60, v60, v64
  v_add_f32 v177, v177, v57
  v_add_f32 v61, v61, v65
  v_add_f32 v178, v178, v58
  v_add_f32 v62, v62, v66
  v_add_f32 v179, v179, v59
  v_add_f32 v63, v63, v67
  v_add_f32 v176, v176, v60
  v_add_f32 v177, v177, v61
  v_add_f32 v178, v178, v62
  v_add_f32 v179, v179, v63
  v_cvt_pk_bf16_f32 v56, v176, v177
  v_cvt_pk_bf16_f32 v57, v178, v179
  buffer_store_dwordx2 v[56:57], v5, s[12:15], s23 offen offset:96
  s_waitcnt lgkmcnt(12)
  ds_read_b128 v[128:131], v232 offset:10240
  ds_read_b128 v[132:135], v232 offset:22528
  ds_read_b128 v[136:139], v232 offset:34816
  v_add_f32 v180, v180, v68
  v_add_f32 v72, v72, v76
  v_add_f32 v181, v181, v69
  v_add_f32 v73, v73, v77
  v_add_f32 v182, v182, v70
  v_add_f32 v74, v74, v78
  v_add_f32 v183, v183, v71
  v_add_f32 v75, v75, v79
  v_add_f32 v180, v180, v72
  v_add_f32 v181, v181, v73
  v_add_f32 v182, v182, v74
  v_add_f32 v183, v183, v75
  v_cvt_pk_bf16_f32 v68, v180, v181
  v_cvt_pk_bf16_f32 v69, v182, v183
  buffer_store_dwordx2 v[68:69], v5, s[12:15], s22 offen offset:128
  s_waitcnt lgkmcnt(12)
  v_add_f32 v184, v184, v80
  v_add_f32 v84, v84, v88
  v_add_f32 v185, v185, v81
  v_add_f32 v85, v85, v89
  v_add_f32 v186, v186, v82
  v_add_f32 v86, v86, v90
  v_add_f32 v187, v187, v83
  v_add_f32 v87, v87, v91
  v_add_f32 v184, v184, v84
  v_add_f32 v185, v185, v85
  v_add_f32 v186, v186, v86
  v_add_f32 v187, v187, v87
  v_cvt_pk_bf16_f32 v80, v184, v185
  v_cvt_pk_bf16_f32 v81, v186, v187
  buffer_store_dwordx2 v[80:81], v5, s[12:15], s21 offen offset:160
  s_waitcnt lgkmcnt(9)
  v_add_f32 v188, v188, v92
  v_add_f32 v96, v96, v100
  v_add_f32 v189, v189, v93
  v_add_f32 v97, v97, v101
  v_add_f32 v190, v190, v94
  v_add_f32 v98, v98, v102
  v_add_f32 v191, v191, v95
  v_add_f32 v99, v99, v103
  v_add_f32 v188, v188, v96
  v_add_f32 v189, v189, v97
  v_add_f32 v190, v190, v98
  v_add_f32 v191, v191, v99
  v_cvt_pk_bf16_f32 v92, v188, v189
  v_cvt_pk_bf16_f32 v93, v190, v191
  buffer_store_dwordx2 v[92:93], v5, s[12:15], s20 offen offset:192
  s_waitcnt lgkmcnt(6)
  v_add_f32 v192, v192, v104
  v_add_f32 v108, v108, v112
  v_add_f32 v193, v193, v105
  v_add_f32 v109, v109, v113
  v_add_f32 v194, v194, v106
  v_add_f32 v110, v110, v114
  v_add_f32 v195, v195, v107
  v_add_f32 v111, v111, v115
  v_add_f32 v192, v192, v108
  v_add_f32 v193, v193, v109
  v_add_f32 v194, v194, v110
  v_add_f32 v195, v195, v111
  v_cvt_pk_bf16_f32 v104, v192, v193
  v_cvt_pk_bf16_f32 v105, v194, v195
  buffer_store_dwordx2 v[104:105], v5, s[12:15], s24 offen offset:192
  s_waitcnt lgkmcnt(3)
  v_add_f32 v196, v196, v116
  v_add_f32 v120, v120, v124
  v_add_f32 v197, v197, v117
  v_add_f32 v121, v121, v125
  v_add_f32 v198, v198, v118
  v_add_f32 v122, v122, v126
  v_add_f32 v199, v199, v119
  v_add_f32 v123, v123, v127
  v_add_f32 v196, v196, v120
  v_add_f32 v197, v197, v121
  v_add_f32 v198, v198, v122
  v_add_f32 v199, v199, v123
  v_cvt_pk_bf16_f32 v116, v196, v197
  v_cvt_pk_bf16_f32 v117, v198, v199
  buffer_store_dwordx2 v[116:117], v5, s[12:15], s23 offen offset:224
  s_waitcnt lgkmcnt(0)
  v_add_f32 v200, v200, v128
  v_add_f32 v132, v132, v136
  v_add_f32 v201, v201, v129
  v_add_f32 v133, v133, v137
  v_add_f32 v202, v202, v130
  v_add_f32 v134, v134, v138
  v_add_f32 v203, v203, v131
  v_add_f32 v135, v135, v139
  v_add_f32 v200, v200, v132
  v_add_f32 v201, v201, v133
  v_add_f32 v202, v202, v134
  v_add_f32 v203, v203, v135
  v_cvt_pk_bf16_f32 v128, v200, v201
  v_cvt_pk_bf16_f32 v129, v202, v203
  buffer_store_dwordx2 v[128:129], v5, s[12:15], s22 offen offset:256
L_b_skipr2:
  s_cmp_lg_u32 s3, 3
  s_cbranch_scc1 L_b_skipr3
  s_waitcnt vmcnt(0)
  v_mfma_f32_16x16x32_bf16 a[0:3], v[84:87], v[64:67], a[0:3]
  v_mfma_f32_16x16x32_bf16 a[4:7], v[84:87], v[68:71], a[4:7]
  v_mfma_f32_16x16x32_bf16 a[8:11], v[84:87], v[72:75], a[8:11]
  v_mfma_f32_16x16x32_bf16 a[16:19], v[84:87], v[80:83], a[16:19]
  ds_write_b128 v236, a[0:3] offset:0
  v_mfma_f32_16x16x32_bf16 a[20:23], v[88:91], v[64:67], a[20:23]
  ds_write_b128 v237, a[4:7] offset:0
  v_mfma_f32_16x16x32_bf16 a[24:27], v[88:91], v[68:71], a[24:27]
  ds_write_b128 v238, a[8:11] offset:0
  v_mfma_f32_16x16x32_bf16 a[32:35], v[88:91], v[76:79], a[32:35]
  ds_write_b128 v236, a[16:19] offset:1024
  v_mfma_f32_16x16x32_bf16 a[36:39], v[88:91], v[80:83], a[36:39]
  ds_write_b128 v237, a[20:23] offset:1024
  v_mfma_f32_16x16x32_bf16 a[40:43], v[92:95], v[64:67], a[40:43]
  ds_write_b128 v238, a[24:27] offset:1024
  v_mfma_f32_16x16x32_bf16 a[48:51], v[92:95], v[72:75], a[48:51]
  ds_write_b128 v236, a[32:35] offset:2048
  v_mfma_f32_16x16x32_bf16 a[52:55], v[92:95], v[76:79], a[52:55]
  ds_write_b128 v237, a[36:39] offset:2048
  v_mfma_f32_16x16x32_bf16 a[56:59], v[92:95], v[80:83], a[56:59]
  ds_write_b128 v238, a[40:43] offset:2048
  v_mfma_f32_16x16x32_bf16 a[64:67], v[96:99], v[68:71], a[64:67]
  ds_write_b128 v236, a[48:51] offset:3072
  v_mfma_f32_16x16x32_bf16 a[68:71], v[96:99], v[72:75], a[68:71]
  ds_write_b128 v237, a[52:55] offset:3072
  v_mfma_f32_16x16x32_bf16 a[72:75], v[96:99], v[76:79], a[72:75]
  ds_write_b128 v238, a[56:59] offset:3072
  v_mfma_f32_16x16x32_bf16 a[80:83], v[100:103], v[64:67], a[80:83]
  ds_write_b128 v236, a[64:67] offset:4096
  v_mfma_f32_16x16x32_bf16 a[84:87], v[100:103], v[68:71], a[84:87]
  ds_write_b128 v237, a[68:71] offset:4096
  v_mfma_f32_16x16x32_bf16 a[88:91], v[100:103], v[72:75], a[88:91]
  ds_write_b128 v238, a[72:75] offset:4096
  v_mfma_f32_16x16x32_bf16 a[96:99], v[100:103], v[80:83], a[96:99]
  ds_write_b128 v236, a[80:83] offset:5120
  v_mfma_f32_16x16x32_bf16 a[100:103], v[104:107], v[64:67], a[100:103]
  ds_write_b128 v237, a[84:87] offset:5120
  v_mfma_f32_16x16x32_bf16 a[104:107], v[104:107], v[68:71], a[104:107]
  ds_write_b128 v238, a[88:91] offset:5120
  v_mfma_f32_16x16x32_bf16 a[112:115], v[104:107], v[76:79], a[112:115]
  ds_write_b128 v236, a[96:99] offset:6144
  v_mfma_f32_16x16x32_bf16 a[116:119], v[104:107], v[80:83], a[116:119]
  ds_write_b128 v237, a[100:103] offset:6144
  v_mfma_f32_16x16x32_bf16 a[120:123], v[108:111], v[64:67], a[120:123]
  ds_write_b128 v238, a[104:107] offset:6144
  v_mfma_f32_16x16x32_bf16 a[128:131], v[108:111], v[72:75], a[128:131]
  ds_write_b128 v236, a[112:115] offset:7168
  v_mfma_f32_16x16x32_bf16 a[132:135], v[108:111], v[76:79], a[132:135]
  ds_write_b128 v237, a[116:119] offset:7168
  v_mfma_f32_16x16x32_bf16 a[136:139], v[108:111], v[80:83], a[136:139]
  ds_write_b128 v238, a[120:123] offset:7168
  v_mfma_f32_16x16x32_bf16 a[144:147], v[112:115], v[68:71], a[144:147]
  ds_write_b128 v236, a[128:131] offset:8192
  v_mfma_f32_16x16x32_bf16 a[148:151], v[112:115], v[72:75], a[148:151]
  ds_write_b128 v237, a[132:135] offset:8192
  v_mfma_f32_16x16x32_bf16 a[152:155], v[112:115], v[76:79], a[152:155]
  ds_write_b128 v238, a[136:139] offset:8192
  v_mfma_f32_16x16x32_bf16 a[160:163], v[116:119], v[64:67], a[160:163]
  ds_write_b128 v236, a[144:147] offset:9216
  v_mfma_f32_16x16x32_bf16 a[164:167], v[116:119], v[68:71], a[164:167]
  ds_write_b128 v237, a[148:151] offset:9216
  v_mfma_f32_16x16x32_bf16 a[168:171], v[116:119], v[72:75], a[168:171]
  ds_write_b128 v238, a[152:155] offset:9216
  v_mfma_f32_16x16x32_bf16 a[176:179], v[116:119], v[80:83], a[176:179]
  ds_write_b128 v236, a[160:163] offset:10240
  v_mfma_f32_16x16x32_bf16 a[12:15], v[84:87], v[76:79], a[12:15]
  ds_write_b128 v237, a[164:167] offset:10240
  v_mfma_f32_16x16x32_bf16 a[28:31], v[88:91], v[72:75], a[28:31]
  ds_write_b128 v238, a[168:171] offset:10240
  v_mfma_f32_16x16x32_bf16 a[44:47], v[92:95], v[68:71], a[44:47]
  ds_write_b128 v236, a[176:179] offset:11264
  v_mfma_f32_16x16x32_bf16 a[60:63], v[96:99], v[64:67], a[60:63]
  v_mfma_f32_16x16x32_bf16 a[76:79], v[96:99], v[80:83], a[76:79]
  v_mfma_f32_16x16x32_bf16 a[92:95], v[100:103], v[76:79], a[92:95]
  v_mfma_f32_16x16x32_bf16 a[108:111], v[104:107], v[72:75], a[108:111]
  v_mfma_f32_16x16x32_bf16 a[124:127], v[108:111], v[68:71], a[124:127]
  v_mfma_f32_16x16x32_bf16 a[140:143], v[112:115], v[64:67], a[140:143]
  v_mfma_f32_16x16x32_bf16 a[156:159], v[112:115], v[80:83], a[156:159]
  v_mfma_f32_16x16x32_bf16 a[172:175], v[116:119], v[76:79], a[172:175]
  s_nop 7
  s_nop 7
  v_accvgpr_read_b32 v160, a12
  v_accvgpr_read_b32 v161, a13
  v_accvgpr_read_b32 v162, a14
  v_accvgpr_read_b32 v163, a15
  v_accvgpr_read_b32 v164, a28
  v_accvgpr_read_b32 v165, a29
  v_accvgpr_read_b32 v166, a30
  v_accvgpr_read_b32 v167, a31
  v_accvgpr_read_b32 v168, a44
  v_accvgpr_read_b32 v169, a45
  v_accvgpr_read_b32 v170, a46
  v_accvgpr_read_b32 v171, a47
  v_accvgpr_read_b32 v172, a60
  v_accvgpr_read_b32 v173, a61
  v_accvgpr_read_b32 v174, a62
  v_accvgpr_read_b32 v175, a63
  v_accvgpr_read_b32 v176, a76
  v_accvgpr_read_b32 v177, a77
  v_accvgpr_read_b32 v178, a78
  v_accvgpr_read_b32 v179, a79
  v_accvgpr_read_b32 v180, a92
  v_accvgpr_read_b32 v181, a93
  v_accvgpr_read_b32 v182, a94
  v_accvgpr_read_b32 v183, a95
  v_accvgpr_read_b32 v184, a108
  v_accvgpr_read_b32 v185, a109
  v_accvgpr_read_b32 v186, a110
  v_accvgpr_read_b32 v187, a111
  v_accvgpr_read_b32 v188, a124
  v_accvgpr_read_b32 v189, a125
  v_accvgpr_read_b32 v190, a126
  v_accvgpr_read_b32 v191, a127
  v_accvgpr_read_b32 v192, a140
  v_accvgpr_read_b32 v193, a141
  v_accvgpr_read_b32 v194, a142
  v_accvgpr_read_b32 v195, a143
  v_accvgpr_read_b32 v196, a156
  v_accvgpr_read_b32 v197, a157
  v_accvgpr_read_b32 v198, a158
  v_accvgpr_read_b32 v199, a159
  v_accvgpr_read_b32 v200, a172
  v_accvgpr_read_b32 v201, a173
  v_accvgpr_read_b32 v202, a174
  v_accvgpr_read_b32 v203, a175
  s_waitcnt lgkmcnt(0)
  s_barrier
  ds_read_b128 v[8:11], v232 offset:0
  ds_read_b128 v[12:15], v232 offset:12288
  ds_read_b128 v[16:19], v232 offset:24576
  ds_read_b128 v[20:23], v232 offset:1024
  ds_read_b128 v[24:27], v232 offset:13312
  ds_read_b128 v[28:31], v232 offset:25600
  ds_read_b128 v[32:35], v232 offset:2048
  ds_read_b128 v[36:39], v232 offset:14336
  ds_read_b128 v[40:43], v232 offset:26624
  ds_read_b128 v[44:47], v232 offset:3072
  ds_read_b128 v[48:51], v232 offset:15360
  ds_read_b128 v[52:55], v232 offset:27648
  ds_read_b128 v[56:59], v232 offset:4096
  ds_read_b128 v[60:63], v232 offset:16384
  ds_read_b128 v[64:67], v232 offset:28672
  s_waitcnt lgkmcnt(12)
  ds_read_b128 v[68:71], v232 offset:5120
  ds_read_b128 v[72:75], v232 offset:17408
  ds_read_b128 v[76:79], v232 offset:29696
  v_add_f32 v160, v160, v8
  v_add_f32 v12, v12, v16
  v_add_f32 v161, v161, v9
  v_add_f32 v13, v13, v17
  v_add_f32 v162, v162, v10
  v_add_f32 v14, v14, v18
  v_add_f32 v163, v163, v11
  v_add_f32 v15, v15, v19
  v_add_f32 v160, v160, v12
  v_add_f32 v161, v161, v13
  v_add_f32 v162, v162, v14
  v_add_f32 v163, v163, v15
  v_cvt_pk_bf16_f32 v8, v160, v161
  v_cvt_pk_bf16_f32 v9, v162, v163
  buffer_store_dwordx2 v[8:9], v5, s[12:15], s23 offen offset:0
  s_waitcnt lgkmcnt(12)
  ds_read_b128 v[80:83], v232 offset:6144
  ds_read_b128 v[84:87], v232 offset:18432
  ds_read_b128 v[88:91], v232 offset:30720
  v_add_f32 v164, v164, v20
  v_add_f32 v24, v24, v28
  v_add_f32 v165, v165, v21
  v_add_f32 v25, v25, v29
  v_add_f32 v166, v166, v22
  v_add_f32 v26, v26, v30
  v_add_f32 v167, v167, v23
  v_add_f32 v27, v27, v31
  v_add_f32 v164, v164, v24
  v_add_f32 v165, v165, v25
  v_add_f32 v166, v166, v26
  v_add_f32 v167, v167, v27
  v_cvt_pk_bf16_f32 v20, v164, v165
  v_cvt_pk_bf16_f32 v21, v166, v167
  buffer_store_dwordx2 v[20:21], v5, s[12:15], s22 offen offset:32
  s_waitcnt lgkmcnt(12)
  ds_read_b128 v[92:95], v232 offset:7168
  ds_read_b128 v[96:99], v232 offset:19456
  ds_read_b128 v[100:103], v232 offset:31744
  v_add_f32 v168, v168, v32
  v_add_f32 v36, v36, v40
  v_add_f32 v169, v169, v33
  v_add_f32 v37, v37, v41
  v_add_f32 v170, v170, v34
  v_add_f32 v38, v38, v42
  v_add_f32 v171, v171, v35
  v_add_f32 v39, v39, v43
  v_add_f32 v168, v168, v36
  v_add_f32 v169, v169, v37
  v_add_f32 v170, v170, v38
  v_add_f32 v171, v171, v39
  v_cvt_pk_bf16_f32 v32, v168, v169
  v_cvt_pk_bf16_f32 v33, v170, v171
  buffer_store_dwordx2 v[32:33], v5, s[12:15], s21 offen offset:64
  s_waitcnt lgkmcnt(12)
  ds_read_b128 v[104:107], v232 offset:8192
  ds_read_b128 v[108:111], v232 offset:20480
  ds_read_b128 v[112:115], v232 offset:32768
  v_add_f32 v172, v172, v44
  v_add_f32 v48, v48, v52
  v_add_f32 v173, v173, v45
  v_add_f32 v49, v49, v53
  v_add_f32 v174, v174, v46
  v_add_f32 v50, v50, v54
  v_add_f32 v175, v175, v47
  v_add_f32 v51, v51, v55
  v_add_f32 v172, v172, v48
  v_add_f32 v173, v173, v49
  v_add_f32 v174, v174, v50
  v_add_f32 v175, v175, v51
  v_cvt_pk_bf16_f32 v44, v172, v173
  v_cvt_pk_bf16_f32 v45, v174, v175
  buffer_store_dwordx2 v[44:45], v5, s[12:15], s20 offen offset:96
  s_waitcnt lgkmcnt(12)
  ds_read_b128 v[116:119], v232 offset:9216
  ds_read_b128 v[120:123], v232 offset:21504
  ds_read_b128 v[124:127], v232 offset:33792
  v_add_f32 v176, v176, v56
  v_add_f32 v60, v60, v64
  v_add_f32 v177, v177, v57
  v_add_f32 v61, v61, v65
  v_add_f32 v178, v178, v58
  v_add_f32 v62, v62, v66
  v_add_f32 v179, v179, v59
  v_add_f32 v63, v63, v67
  v_add_f32 v176, v176, v60
  v_add_f32 v177, v177, v61
  v_add_f32 v178, v178, v62
  v_add_f32 v179, v179, v63
  v_cvt_pk_bf16_f32 v56, v176, v177
  v_cvt_pk_bf16_f32 v57, v178, v179
  buffer_store_dwordx2 v[56:57], v5, s[12:15], s24 offen offset:96
  s_waitcnt lgkmcnt(12)
  ds_read_b128 v[128:131], v232 offset:10240
  ds_read_b128 v[132:135], v232 offset:22528
  ds_read_b128 v[136:139], v232 offset:34816
  v_add_f32 v180, v180, v68
  v_add_f32 v72, v72, v76
  v_add_f32 v181, v181, v69
  v_add_f32 v73, v73, v77
  v_add_f32 v182, v182, v70
  v_add_f32 v74, v74, v78
  v_add_f32 v183, v183, v71
  v_add_f32 v75, v75, v79
  v_add_f32 v180, v180, v72
  v_add_f32 v181, v181, v73
  v_add_f32 v182, v182, v74
  v_add_f32 v183, v183, v75
  v_cvt_pk_bf16_f32 v68, v180, v181
  v_cvt_pk_bf16_f32 v69, v182, v183
  buffer_store_dwordx2 v[68:69], v5, s[12:15], s23 offen offset:128
  s_waitcnt lgkmcnt(12)
  v_add_f32 v184, v184, v80
  v_add_f32 v84, v84, v88
  v_add_f32 v185, v185, v81
  v_add_f32 v85, v85, v89
  v_add_f32 v186, v186, v82
  v_add_f32 v86, v86, v90
  v_add_f32 v187, v187, v83
  v_add_f32 v87, v87, v91
  v_add_f32 v184, v184, v84
  v_add_f32 v185, v185, v85
  v_add_f32 v186, v186, v86
  v_add_f32 v187, v187, v87
  v_cvt_pk_bf16_f32 v80, v184, v185
  v_cvt_pk_bf16_f32 v81, v186, v187
  buffer_store_dwordx2 v[80:81], v5, s[12:15], s22 offen offset:160
  s_waitcnt lgkmcnt(9)
  v_add_f32 v188, v188, v92
  v_add_f32 v96, v96, v100
  v_add_f32 v189, v189, v93
  v_add_f32 v97, v97, v101
  v_add_f32 v190, v190, v94
  v_add_f32 v98, v98, v102
  v_add_f32 v191, v191, v95
  v_add_f32 v99, v99, v103
  v_add_f32 v188, v188, v96
  v_add_f32 v189, v189, v97
  v_add_f32 v190, v190, v98
  v_add_f32 v191, v191, v99
  v_cvt_pk_bf16_f32 v92, v188, v189
  v_cvt_pk_bf16_f32 v93, v190, v191
  buffer_store_dwordx2 v[92:93], v5, s[12:15], s21 offen offset:192
  s_waitcnt lgkmcnt(6)
  v_add_f32 v192, v192, v104
  v_add_f32 v108, v108, v112
  v_add_f32 v193, v193, v105
  v_add_f32 v109, v109, v113
  v_add_f32 v194, v194, v106
  v_add_f32 v110, v110, v114
  v_add_f32 v195, v195, v107
  v_add_f32 v111, v111, v115
  v_add_f32 v192, v192, v108
  v_add_f32 v193, v193, v109
  v_add_f32 v194, v194, v110
  v_add_f32 v195, v195, v111
  v_cvt_pk_bf16_f32 v104, v192, v193
  v_cvt_pk_bf16_f32 v105, v194, v195
  buffer_store_dwordx2 v[104:105], v5, s[12:15], s20 offen offset:224
  s_waitcnt lgkmcnt(3)
  v_add_f32 v196, v196, v116
  v_add_f32 v120, v120, v124
  v_add_f32 v197, v197, v117
  v_add_f32 v121, v121, v125
  v_add_f32 v198, v198, v118
  v_add_f32 v122, v122, v126
  v_add_f32 v199, v199, v119
  v_add_f32 v123, v123, v127
  v_add_f32 v196, v196, v120
  v_add_f32 v197, v197, v121
  v_add_f32 v198, v198, v122
  v_add_f32 v199, v199, v123
  v_cvt_pk_bf16_f32 v116, v196, v197
  v_cvt_pk_bf16_f32 v117, v198, v199
  buffer_store_dwordx2 v[116:117], v5, s[12:15], s24 offen offset:224
  s_waitcnt lgkmcnt(0)
  v_add_f32 v200, v200, v128
  v_add_f32 v132, v132, v136
  v_add_f32 v201, v201, v129
  v_add_f32 v133, v133, v137
  v_add_f32 v202, v202, v130
  v_add_f32 v134, v134, v138
  v_add_f32 v203, v203, v131
  v_add_f32 v135, v135, v139
  v_add_f32 v200, v200, v132
  v_add_f32 v201, v201, v133
  v_add_f32 v202, v202, v134
  v_add_f32 v203, v203, v135
  v_cvt_pk_bf16_f32 v128, v200, v201
  v_cvt_pk_bf16_f32 v129, v202, v203
  buffer_store_dwordx2 v[128:129], v5, s[12:15], s23 offen offset:256
L_b_skipr3:
L_b_done:
  s_endpgm
.section .rodata,"a"
.p2align 6
.amdhsa_kernel attn_kernel
  .amdhsa_next_free_vgpr 512
  .amdhsa_next_free_sgpr 96
  .amdhsa_accum_offset 256
  .amdhsa_group_segment_fixed_size 0
  .amdhsa_kernarg_size 64
  .amdhsa_user_sgpr_count 2
  .amdhsa_user_sgpr_kernarg_segment_ptr 1
  .amdhsa_system_sgpr_workgroup_id_x 1
.end_amdhsa_kernel
.p2align 6
.amdhsa_kernel oproj_kernel
  .amdhsa_next_free_vgpr 512
  .amdhsa_next_free_sgpr 96
  .amdhsa_accum_offset 256
  .amdhsa_group_segment_fixed_size 0
  .amdhsa_kernarg_size 64
  .amdhsa_user_sgpr_count 2
  .amdhsa_user_sgpr_kernarg_segment_ptr 1
  .amdhsa_system_sgpr_workgroup_id_x 1
.end_amdhsa_kernel
```
